```python
import torch

def _softmax(x, axis=-1):
    return torch.softmax(x, dim=axis)

def _gelu(x):
    return torch.nn.functional.gelu(x, approximate='tanh')

def _silu(x):
    return torch.nn.functional.silu(x)

def _sigmoid(x):
    return torch.sigmoid(x)

def _layernorm(x, axis=-1, eps=1e-05):
    m = x.mean(dim=axis, keepdim=True)
    v = x.var(dim=axis, keepdim=True, unbiased=False)
    return (x - m) / torch.sqrt(v + eps)

def _scatter_add(tgt, idx, src, axis=0):
    return tgt.clone().index_add_(axis, idx, src)

def _segment_sum(src, seg, n):
    out = torch.zeros((n,) + src.shape[1:], dtype=src.dtype)
    return out.index_add_(0, seg, src)

def _pad(x, pw):
    flat = tuple((v for pair in reversed(pw) for v in pair))
    return torch.nn.functional.pad(x, flat)
kernel_name = 'parallel_sum__memory_aug_recurrent_mem_tr__glu_gated_geglu__prompt'

def setup_inputs():

    _w = lambda a: (lambda t: t.to(torch.bfloat16) if t.is_floating_point() else t)(torch.as_tensor(a))

    def _A_setup():
        B, S, Dm = (1, 2048, 1024)
        H, Dh = (32, 128)
        M, seg = (8, 32)
        seg = min(seg, S)
        S = S // seg * seg
        return {'x': _w((lambda *s: torch.randn(*s, dtype=torch.bfloat16) * 0.05)(B, S, Dm)), 'mem0': _w((lambda *s: torch.randn(*s, dtype=torch.bfloat16) * 0.2)(B, M, Dm)), 'Wq': _w((lambda *s: torch.randn(*s, dtype=torch.bfloat16) * 1.6)(Dm, H, Dh) * Dm ** (-0.5)), 'Wk': _w((lambda *s: torch.randn(*s, dtype=torch.bfloat16) * 1.6)(Dm, H, Dh) * Dm ** (-0.5)), 'Wv': _w((lambda *s: torch.randn(*s, dtype=torch.bfloat16) * 0.2)(Dm, H, Dh) * Dm ** (-0.5)), 'Wo': _w((lambda *s: torch.randn(*s, dtype=torch.bfloat16) * 0.2)(H, Dh, Dm) * (H * Dh) ** (-0.5)), 'seg_len': seg}
    _A_in = _A_setup()

    def _B_setup():
        B, S, Dm, Df = (1, 2048, 1024, 3584)
        return {'x': _w((lambda *s: torch.randn(*s, dtype=torch.bfloat16) * 0.05)(B, S, Dm)), 'w_gate': _w((lambda *s: torch.randn(*s, dtype=torch.bfloat16) * 0.4)(Dm, Df) * Dm ** (-0.5)), 'w_up': _w((lambda *s: torch.randn(*s, dtype=torch.bfloat16) * 0.4)(Dm, Df) * Dm ** (-0.5)), 'w_down': _w((lambda *s: torch.randn(*s, dtype=torch.bfloat16) * 0.4)(Df, Dm) * Df ** (-0.5))}
    _B_in = _B_setup()
    return {'A_x': _A_in['x'], 'A_mem0': _A_in['mem0'], 'A_Wq': _A_in['Wq'], 'A_Wk': _A_in['Wk'], 'A_Wv': _A_in['Wv'], 'A_Wo': _A_in['Wo'], 'A_seg_len': _A_in['seg_len'], 'B_x': _B_in['x'], 'B_w_gate': _B_in['w_gate'], 'B_w_up': _B_in['w_up'], 'B_w_down': _B_in['w_down']}

def reference(A_x, A_mem0, A_Wq, A_Wk, A_Wv, A_Wo, A_seg_len, B_x, B_w_gate, B_w_up, B_w_down):

    def _A_ref(x, mem0, Wq, Wk, Wv, Wo, seg_len):
        B, S, Dm = x.shape
        H, Dh = (Wq.shape[1], Wq.shape[2])
        M = mem0.shape[1]
        scale = Dh ** (-0.5)
        n_seg = S // seg_len
        L = M + seg_len
        idx = torch.arange(L)
        mask = (idx[:, None] < M) | (idx[:, None] >= idx[None, :])
        mem = mem0
        outs = []
        for s in range(n_seg):
            xs = x[:, s * seg_len:(s + 1) * seg_len, :].clone()
            h = torch.concatenate([mem, xs], axis=1)
            q = torch.einsum('btd,dhe->bhte', h, Wq)
            k = torch.einsum('btd,dhe->bhte', h, Wk)
            v = torch.einsum('btd,dhe->bhte', h, Wv)
            scores = torch.einsum('bhqe,bhke->bhqk', q, k) * scale
            scores = torch.where(mask[None, None], scores, -1000000000.0)
            p = _softmax(scores, axis=-1)
            o = torch.einsum('bhqk,bhke->bhqe', p, v)
            o = torch.einsum('bhte,hed->btd', o, Wo)
            mem = o[:, :M, :].clone()
            outs.append(o[:, M:, :])
        return torch.concatenate(outs, axis=1)

    def _B_ref(x, w_gate, w_up, w_down):
        g = torch.einsum('bsd,df->bsf', x, w_gate)
        u = torch.einsum('bsd,df->bsf', x, w_up)
        h = _gelu(g) * u
        return torch.einsum('bsf,fd->bsd', h, w_down)
    x = A_x
    xn = _layernorm(x, axis=-1)
    return x + _A_ref(xn, A_mem0, A_Wq, A_Wk, A_Wv, A_Wo, A_seg_len) + _B_ref(xn, B_w_gate, B_w_up, B_w_down)
```

```asm
; @launch grid=(256,1,1) block=(256,1,1) lds=163840
.amdgcn_target "amdgcn-amd-amdhsa--gfx950"
.text
.globl parallel_sum__memory_aug_recurrent_mem_tr__glu_gated_geglu__prompt_kernel
.p2align 8
.type parallel_sum__memory_aug_recurrent_mem_tr__glu_gated_geglu__prompt_kernel,@function
parallel_sum__memory_aug_recurrent_mem_tr__glu_gated_geglu__prompt_kernel:
s_cmp_ge_u32 s2, 256
s_cbranch_scc1 L_end
s_load_dwordx16 s[20:35], s[0:1], 0
s_load_dwordx8 s[36:43], s[0:1], 64
s_load_dwordx4 s[44:47], s[0:1], 96
v_lshrrev_b32 v2, 6, v0
v_and_b32 v1, 63, v0
v_readfirstlane_b32 s3, v2
v_lshlrev_b32 v1, 4, v1
s_waitcnt lgkmcnt(0)
s_mov_b32 s4, s46
s_and_b32 s5, s47, 0xffff
s_mov_b32 s6, 0x10000000
s_mov_b32 s7, 0x20000
s_mov_b32 s12, s20
s_and_b32 s13, s21, 0xffff
s_mov_b32 s14, 0x400000
s_mov_b32 s15, 0x20000
s_mov_b32 s16, s42
s_and_b32 s17, s43, 0xffff
s_mov_b32 s18, 0x400000
s_mov_b32 s19, 0x20000
s_mov_b32 s78, 1000000
s_cmp_lg_u32 s2, 0
s_cbranch_scc1 L_nz_1
v_mov_b32 v16, 0
v_mov_b32 v17, 0
v_mov_b32 v18, 0
v_mov_b32 v19, 0
s_mul_i32 s48, s3, 12288
s_add_u32 s48, s48, 98566144
buffer_store_dwordx4 v[16:19], v1, s[4:7], s48 offen offset:0 sc1
buffer_store_dwordx4 v[16:19], v1, s[4:7], s48 offen offset:1024 sc1
buffer_store_dwordx4 v[16:19], v1, s[4:7], s48 offen offset:2048 sc1
buffer_store_dwordx4 v[16:19], v1, s[4:7], s48 offen offset:3072 sc1
s_add_u32 s48, s48, 4096
buffer_store_dwordx4 v[16:19], v1, s[4:7], s48 offen offset:0 sc1
buffer_store_dwordx4 v[16:19], v1, s[4:7], s48 offen offset:1024 sc1
buffer_store_dwordx4 v[16:19], v1, s[4:7], s48 offen offset:2048 sc1
buffer_store_dwordx4 v[16:19], v1, s[4:7], s48 offen offset:3072 sc1
s_add_u32 s48, s48, 4096
buffer_store_dwordx4 v[16:19], v1, s[4:7], s48 offen offset:0 sc1
buffer_store_dwordx4 v[16:19], v1, s[4:7], s48 offen offset:1024 sc1
buffer_store_dwordx4 v[16:19], v1, s[4:7], s48 offen offset:2048 sc1
buffer_store_dwordx4 v[16:19], v1, s[4:7], s48 offen offset:3072 sc1
s_add_u32 s48, s48, 4096
s_getreg_b32 s48, hwreg(HW_REG_XCC_ID)
s_and_b32 s48, s48, 7
s_add_u32 s48, s48, 8
v_mov_b32 v20, s48
global_store_dword v16, v20, s[44:45] offset:48 sc1
s_waitcnt vmcnt(0)
s_barrier
global_store_dword v16, v20, s[44:45] offset:40 sc1
L_nz_1:
s_mov_b32 s99, s2
s_getreg_b32 s48, hwreg(HW_REG_XCC_ID)
s_and_b32 s48, s48, 7
s_andn2_b32 s2, s2, 7
s_or_b32 s2, s2, s48
L_role:
s_mov_b32 s98, 0
s_and_b32 s60, s2, 7
s_lshr_b32 s61, s2, 3
s_cmp_ge_u32 s60, 4
s_cbranch_scc1 L_ln
s_and_b32 s62, s61, 3
s_lshr_b32 s63, s61, 2
s_lshl_b32 s74, s60, 3
s_add_u32 s63, s63, s74
v_bfe_u32 v188, v0, 1, 3
v_lshlrev_b32 v188, 11, v188
v_bfe_u32 v189, v0, 4, 2
v_lshl_add_u32 v188, v189, 4, v188
v_and_b32 v189, 1, v0
v_lshl_add_u32 v188, v189, 3, v188
s_lshl_b32 s52, s61, 6
v_add_u32 v188, s52, v188
global_load_dwordx2 v[196:197], v188, s[22:23]
v_bfe_u32 v184, v0, 2, 4
v_bfe_u32 v185, v0, 4, 2
v_and_b32 v186, 3, v0
v_xor_b32 v186, v186, v185
v_lshlrev_b32 v186, 4, v186
s_lshl_b32 s74, s3, 8
v_add_u32 v184, s74, v184
v_lshl_add_u32 v240, v184, 13, v186
v_lshl_add_u32 v244, v184, 11, v186
v_add_u32 v241, 130048, v240
v_add_u32 v245, 31744, v244
v_add_u32 v242, 130048, v241
v_add_u32 v246, 31744, v245
v_add_u32 v243, 130048, v242
v_add_u32 v247, 31744, v246
s_lshl_b32 s50, s3, 15
s_add_u32 s50, s50, 32768
v_bfe_u32 v232, v0, 1, 3
v_lshlrev_b32 v232, 13, v232
v_and_b32 v185, 1, v0
v_lshl_add_u32 v232, v185, 10, v232
v_and_b32 v233, 15, v0
v_lshlrev_b32 v233, 10, v233
v_and_b32 v185, 7, v0
v_lshlrev_b32 v186, 13, v185
v_lshlrev_b32 v185, 11, v185
s_mov_b64 exec, 0xff0000
v_add_u32 v232, 1536, v186
v_add_u32 v233, 1536, v185
s_mov_b64 exec, -1
s_mov_b32 s8, s26
s_and_b32 s9, s27, 0xffff
s_mov_b32 s10, 8388608
s_mov_b32 s11, 0x20000
s_lshl_b32 s49, s63, 8
s_lshl_b32 s74, s62, 6
s_add_u32 s49, s49, s74
s_add_u32 m0, s50, 0
s_nop 0
buffer_load_dwordx4 v240, s[8:11], s49 offen offset:0 lds
buffer_load_dwordx4 v241, s[8:11], s49 offen offset:1024 lds
buffer_load_dwordx4 v242, s[8:11], s49 offen offset:2048 lds
buffer_load_dwordx4 v243, s[8:11], s49 offen offset:3072 lds
s_add_u32 s49, s49, 524288
s_add_u32 m0, s50, 4096
s_nop 0
buffer_load_dwordx4 v240, s[8:11], s49 offen offset:0 lds
buffer_load_dwordx4 v241, s[8:11], s49 offen offset:1024 lds
buffer_load_dwordx4 v242, s[8:11], s49 offen offset:2048 lds
buffer_load_dwordx4 v243, s[8:11], s49 offen offset:3072 lds
s_add_u32 s49, s49, 524288
s_add_u32 m0, s50, 8192
s_nop 0
buffer_load_dwordx4 v240, s[8:11], s49 offen offset:0 lds
buffer_load_dwordx4 v241, s[8:11], s49 offen offset:1024 lds
buffer_load_dwordx4 v242, s[8:11], s49 offen offset:2048 lds
buffer_load_dwordx4 v243, s[8:11], s49 offen offset:3072 lds
s_add_u32 s49, s49, 524288
s_add_u32 m0, s50, 12288
s_nop 0
buffer_load_dwordx4 v240, s[8:11], s49 offen offset:0 lds
buffer_load_dwordx4 v241, s[8:11], s49 offen offset:1024 lds
buffer_load_dwordx4 v242, s[8:11], s49 offen offset:2048 lds
buffer_load_dwordx4 v243, s[8:11], s49 offen offset:3072 lds
s_add_u32 s49, s49, 524288
s_mov_b32 s8, s28
s_and_b32 s9, s29, 0xffff
s_mov_b32 s10, 0x800000
s_mov_b32 s11, 0x20000
s_lshl_b32 s74, s61, 2
s_add_u32 s74, s74, s3
s_lshl_b32 s74, s74, 16
s_lshl_b32 s75, s60, 11
s_add_u32 s74, s74, s75
s_add_u32 s74, s74, 384
s_mov_b64 exec, 0xffffff
buffer_load_dword v192, v232, s[8:11], s74 offen
s_mov_b64 exec, -1
s_mov_b32 s8, s28
s_and_b32 s9, s29, 0xffff
s_mov_b32 s10, 8388608
s_mov_b32 s11, 0x20000
s_lshl_b32 s49, s63, 8
s_lshl_b32 s74, s62, 6
s_add_u32 s49, s49, s74
s_add_u32 m0, s50, 16384
s_nop 0
buffer_load_dwordx4 v240, s[8:11], s49 offen offset:0 lds
buffer_load_dwordx4 v241, s[8:11], s49 offen offset:1024 lds
buffer_load_dwordx4 v242, s[8:11], s49 offen offset:2048 lds
buffer_load_dwordx4 v243, s[8:11], s49 offen offset:3072 lds
s_add_u32 s49, s49, 524288
s_add_u32 m0, s50, 20480
s_nop 0
buffer_load_dwordx4 v240, s[8:11], s49 offen offset:0 lds
buffer_load_dwordx4 v241, s[8:11], s49 offen offset:1024 lds
buffer_load_dwordx4 v242, s[8:11], s49 offen offset:2048 lds
buffer_load_dwordx4 v243, s[8:11], s49 offen offset:3072 lds
s_add_u32 s49, s49, 524288
s_add_u32 m0, s50, 24576
s_nop 0
buffer_load_dwordx4 v240, s[8:11], s49 offen offset:0 lds
buffer_load_dwordx4 v241, s[8:11], s49 offen offset:1024 lds
buffer_load_dwordx4 v242, s[8:11], s49 offen offset:2048 lds
buffer_load_dwordx4 v243, s[8:11], s49 offen offset:3072 lds
s_add_u32 s49, s49, 524288
s_add_u32 m0, s50, 28672
s_nop 0
buffer_load_dwordx4 v240, s[8:11], s49 offen offset:0 lds
buffer_load_dwordx4 v241, s[8:11], s49 offen offset:1024 lds
buffer_load_dwordx4 v242, s[8:11], s49 offen offset:2048 lds
buffer_load_dwordx4 v243, s[8:11], s49 offen offset:3072 lds
s_add_u32 s49, s49, 524288
s_mov_b32 s8, s24
s_and_b32 s9, s25, 0xffff
s_mov_b32 s10, 0x800000
s_mov_b32 s11, 0x20000
s_lshl_b32 s74, s61, 2
s_add_u32 s74, s74, s3
s_lshl_b32 s74, s74, 16
s_lshl_b32 s75, s60, 11
s_add_u32 s74, s74, s75
s_add_u32 s74, s74, 384
s_mov_b64 exec, 0xffffff
buffer_load_dword v192, v232, s[8:11], s74 offen
s_mov_b64 exec, -1
s_mov_b32 s8, s30
s_and_b32 s9, s31, 0xffff
s_mov_b32 s10, 0x800000
s_mov_b32 s11, 0x20000
s_lshl_b32 s74, s61, 2
s_add_u32 s74, s74, s3
s_lshl_b32 s74, s74, 14
s_lshl_b32 s75, s60, 21
s_add_u32 s74, s74, s75
s_add_u32 s74, s74, 384
s_mov_b64 exec, 0xffffff
buffer_load_dword v192, v233, s[8:11], s74 offen
s_mov_b64 exec, -1
s_getpc_b64 s[56:57]
L_pc_4:
s_sub_u32 s56, s56, L_pc_4-parallel_sum__memory_aug_recurrent_mem_tr__glu_gated_geglu__prompt_kernel
s_subb_u32 s57, s57, 0
s_lshr_b32 s58, s2, 3
s_lshl_b32 s58, s58, 2
s_add_u32 s58, s58, s3
s_lshl_b32 s58, s58, 10
v_and_b32 v230, 7, v0
v_lshl_add_u32 v230, v230, 7, s58
s_mov_b32 s58, L_tend-parallel_sum__memory_aug_recurrent_mem_tr__glu_gated_geglu__prompt_kernel-4
v_min_u32 v230, s58, v230
global_load_dword v231, v230, s[56:57]
s_mov_b32 s73, 2000000
s_mov_b32 s33, 0
s_mov_b32 s79, 0x3e0293ee
s_mov_b32 s34, s79
s_mov_b32 s35, s79
s_mov_b32 s100, 0x00ff00ff
s_mov_b32 s101, 0x00ff00ff
s_lshl_b32 s65, s60, 16
s_lshl_b32 s74, s61, 9
s_add_u32 s65, s65, s74
s_add_u32 s67, s65, 95158272
s_add_u32 s65, s65, 94371840
s_lshl_b32 s66, s60, 17
s_lshl_b32 s74, s61, 10
s_add_u32 s66, s66, s74
s_add_u32 s66, s66, 94633984
s_lshl_b32 s68, s60, 18
s_lshr_b32 s74, s61, 3
s_lshl_b32 s74, s74, 14
s_add_u32 s68, s68, s74
s_and_b32 s74, s61, 7
s_lshl_b32 s74, s74, 10
s_add_u32 s68, s68, s74
s_add_u32 s68, s68, 96468992
s_lshl_b32 s69, s63, 13
s_lshl_b32 s74, s62, 11
s_add_u32 s70, s69, s74
s_add_u32 s69, s69, 20971520
s_add_u32 s70, s70, 37748736
s_lshl_b32 s71, s63, 11
s_lshl_b32 s74, s62, 9
s_add_u32 s71, s71, s74
s_add_u32 s72, s71, 90177536
s_add_u32 s71, s71, 85983232
v_bfe_u32 v184, v0, 4, 2
v_bfe_u32 v185, v0, 4, 1
v_bfe_u32 v186, v0, 5, 1
v_and_b32 v187, 15, v0
v_lshrrev_b32 v3, 1, v1
v_mov_b32 v2, 0x4444
v_mov_b32 v188, 0xeeee
v_and_b32 v189, 8, v0
v_cmp_ne_u32 vcc, 0, v189
v_and_b32 v189, 7, v0
v_lshlrev_b32 v189, 4, v189
v_cndmask_b32 v2, v2, v188, vcc
v_lshl_add_u32 v189, v184, 7, v189
v_mov_b32 v7, 0x7f000000
v_cndmask_b32 v7, v7, v189, vcc
s_lshl_b32 s74, s3, 11
v_add_u32 v4, s74, v1
s_lshl_b32 s74, s3, 10
v_add_u32 v11, s74, v1
s_and_b32 s75, s3, 1
v_and_b32 v12, 31, v0
v_lshlrev_b32 v13, 3, v12
v_lshlrev_b32 v12, 4, v12
s_lshl_b32 s74, s75, 9
v_add_u32 v12, s74, v12
s_lshl_b32 s74, s75, 10
v_add_u32 v18, s74, v1
s_lshl_b32 s74, s75, 3
v_add_u32 v19, s74, v1
v_lshlrev_b32 v13, 3, v187
v_lshl_add_u32 v13, v185, 8, v13
s_lshl_b32 s74, s75, 7
v_add_u32 v13, s74, v13
v_and_b32 v5, 3, v0
v_bfe_u32 v188, v0, 2, 1
v_lshl_add_u32 v5, v188, 2, v5
v_bfe_u32 v188, v0, 3, 1
v_lshl_add_u32 v5, v188, 4, v5
v_lshlrev_b32 v5, 4, v5
v_lshl_add_u32 v5, v184, 9, v5
v_lshlrev_b32 v6, 4, v187
v_lshl_add_u32 v6, v184, 9, v6
s_lshl_b32 s74, s75, 8
v_add_u32 v6, s74, v6
v_and_b32 v8, 7, v0
v_lshlrev_b32 v8, 4, v8
v_lshl_add_u32 v8, v186, 7, v8
v_lshl_add_u32 v8, v185, 3, v8
v_add_u32 v8, s74, v8
v_mul_u32_u24 v9, 640, v185
v_lshl_add_u32 v9, v187, 2, v9
v_lshl_add_u32 v9, v186, 6, v9
s_mul_i32 s74, s3, 1280
v_add_u32 v9, s74, v9
v_bfe_u32 v188, v0, 1, 3
v_mul_u32_u24 v10, 160, v188
v_lshl_add_u32 v10, v184, 5, v10
v_and_b32 v188, 1, v0
v_lshl_add_u32 v10, v188, 4, v10
v_lshlrev_b32 v188, 2, v184
v_sub_u32 v188, v187, v188
v_mov_b32 v189, 0x3f80
v_mov_b32 v190, 0x3f800000
v_cmp_eq_u32 vcc, 0, v188
s_nop 1
v_cndmask_b32 v16, 0, v189, vcc
v_cmp_eq_u32 vcc, 1, v188
s_nop 1
v_cndmask_b32 v16, v16, v190, vcc
v_cmp_eq_u32 vcc, 2, v188
s_nop 1
v_cndmask_b32 v17, 0, v189, vcc
v_cmp_eq_u32 vcc, 3, v188
s_nop 1
v_cndmask_b32 v17, v17, v190, vcc
v_cmp_eq_u32 vcc, 0, v186
v_mov_b32 v189, 0xf149f2ca
s_nop 0
v_cndmask_b32 v20, 0, v189, vcc
v_mov_b32 v24, 0x3f803f80
v_mov_b32 v28, -1
v_cndmask_b32 v21, 0, v189, vcc
v_mov_b32 v25, 0x3f803f80
v_mov_b32 v29, -1
v_cndmask_b32 v22, 0, v189, vcc
v_mov_b32 v26, 0x3f803f80
v_mov_b32 v30, -1
v_cndmask_b32 v23, 0, v189, vcc
v_mov_b32 v27, 0x3f803f80
v_mov_b32 v31, -1
v_bfe_u32 v184, v0, 2, 2
v_bfe_u32 v185, v0, 4, 1
v_bfe_u32 v186, v0, 5, 1
v_lshl_add_u32 v187, v185, 2, v184
v_lshl_add_u32 v187, v186, 4, v187
v_lshlrev_b32 v187, 6, v187
v_and_b32 v189, 1, v0
v_lshl_add_u32 v187, v189, 3, v187
v_add_u32 v187, s50, v187
v_bfe_u32 v189, v0, 1, 1
v_lshl_add_u32 v190, v189, 1, 0
v_xor_b32 v190, v190, v185
v_lshl_add_u32 v248, v190, 4, v187
v_add_u32 v190, 0, v189
v_xor_b32 v190, v190, v185
v_lshl_add_u32 v250, v190, 4, v187
v_lshl_add_u32 v190, v189, 1, 1
v_xor_b32 v190, v190, v185
v_lshl_add_u32 v249, v190, 4, v187
v_add_u32 v190, 2, v189
v_xor_b32 v190, v190, v185
v_lshl_add_u32 v251, v190, 4, v187
v_xor_b32 v236, 32, v248
v_xor_b32 v237, 32, v249
v_xor_b32 v238, 32, v250
v_xor_b32 v239, 32, v251
s_waitcnt vmcnt(19)
ds_read_b64_tr_b16 v[32:33], v248 offset:0
ds_read_b64_tr_b16 v[34:35], v236 offset:512
ds_read_b64_tr_b16 v[36:37], v248 offset:2048
ds_read_b64_tr_b16 v[38:39], v236 offset:2560
ds_read_b64_tr_b16 v[40:41], v249 offset:0
ds_read_b64_tr_b16 v[42:43], v237 offset:512
ds_read_b64_tr_b16 v[44:45], v249 offset:2048
ds_read_b64_tr_b16 v[46:47], v237 offset:2560
ds_read_b64_tr_b16 v[48:49], v248 offset:4096
ds_read_b64_tr_b16 v[50:51], v236 offset:4608
ds_read_b64_tr_b16 v[52:53], v248 offset:6144
ds_read_b64_tr_b16 v[54:55], v236 offset:6656
ds_read_b64_tr_b16 v[56:57], v249 offset:4096
ds_read_b64_tr_b16 v[58:59], v237 offset:4608
ds_read_b64_tr_b16 v[60:61], v249 offset:6144
ds_read_b64_tr_b16 v[62:63], v237 offset:6656
s_waitcnt lgkmcnt(0)
v_accvgpr_write_b32 a64, v32
v_accvgpr_write_b32 a65, v34
v_accvgpr_write_b32 a66, v33
v_accvgpr_write_b32 a67, v35
v_accvgpr_write_b32 a68, v36
v_accvgpr_write_b32 a69, v38
v_accvgpr_write_b32 a70, v37
v_accvgpr_write_b32 a71, v39
v_accvgpr_write_b32 a72, v40
v_accvgpr_write_b32 a73, v42
v_accvgpr_write_b32 a74, v41
v_accvgpr_write_b32 a75, v43
v_accvgpr_write_b32 a76, v44
v_accvgpr_write_b32 a77, v46
v_accvgpr_write_b32 a78, v45
v_accvgpr_write_b32 a79, v47
v_accvgpr_write_b32 a80, v48
v_accvgpr_write_b32 a81, v50
v_accvgpr_write_b32 a82, v49
v_accvgpr_write_b32 a83, v51
v_accvgpr_write_b32 a84, v52
v_accvgpr_write_b32 a85, v54
v_accvgpr_write_b32 a86, v53
v_accvgpr_write_b32 a87, v55
v_accvgpr_write_b32 a88, v56
v_accvgpr_write_b32 a89, v58
v_accvgpr_write_b32 a90, v57
v_accvgpr_write_b32 a91, v59
v_accvgpr_write_b32 a92, v60
v_accvgpr_write_b32 a93, v62
v_accvgpr_write_b32 a94, v61
v_accvgpr_write_b32 a95, v63
ds_read_b64_tr_b16 v[32:33], v248 offset:8192
ds_read_b64_tr_b16 v[34:35], v236 offset:8704
ds_read_b64_tr_b16 v[36:37], v248 offset:10240
ds_read_b64_tr_b16 v[38:39], v236 offset:10752
ds_read_b64_tr_b16 v[40:41], v249 offset:8192
ds_read_b64_tr_b16 v[42:43], v237 offset:8704
ds_read_b64_tr_b16 v[44:45], v249 offset:10240
ds_read_b64_tr_b16 v[46:47], v237 offset:10752
ds_read_b64_tr_b16 v[48:49], v248 offset:12288
ds_read_b64_tr_b16 v[50:51], v236 offset:12800
ds_read_b64_tr_b16 v[52:53], v248 offset:14336
ds_read_b64_tr_b16 v[54:55], v236 offset:14848
ds_read_b64_tr_b16 v[56:57], v249 offset:12288
ds_read_b64_tr_b16 v[58:59], v237 offset:12800
ds_read_b64_tr_b16 v[60:61], v249 offset:14336
ds_read_b64_tr_b16 v[62:63], v237 offset:14848
s_waitcnt lgkmcnt(0)
v_accvgpr_write_b32 a96, v32
v_accvgpr_write_b32 a97, v34
v_accvgpr_write_b32 a98, v33
v_accvgpr_write_b32 a99, v35
v_accvgpr_write_b32 a100, v36
v_accvgpr_write_b32 a101, v38
v_accvgpr_write_b32 a102, v37
v_accvgpr_write_b32 a103, v39
v_accvgpr_write_b32 a104, v40
v_accvgpr_write_b32 a105, v42
v_accvgpr_write_b32 a106, v41
v_accvgpr_write_b32 a107, v43
v_accvgpr_write_b32 a108, v44
v_accvgpr_write_b32 a109, v46
v_accvgpr_write_b32 a110, v45
v_accvgpr_write_b32 a111, v47
v_accvgpr_write_b32 a112, v48
v_accvgpr_write_b32 a113, v50
v_accvgpr_write_b32 a114, v49
v_accvgpr_write_b32 a115, v51
v_accvgpr_write_b32 a116, v52
v_accvgpr_write_b32 a117, v54
v_accvgpr_write_b32 a118, v53
v_accvgpr_write_b32 a119, v55
v_accvgpr_write_b32 a120, v56
v_accvgpr_write_b32 a121, v58
v_accvgpr_write_b32 a122, v57
v_accvgpr_write_b32 a123, v59
v_accvgpr_write_b32 a124, v60
v_accvgpr_write_b32 a125, v62
v_accvgpr_write_b32 a126, v61
v_accvgpr_write_b32 a127, v63
s_waitcnt vmcnt(3)
ds_read_b64_tr_b16 v[32:33], v250 offset:16384
ds_read_b64_tr_b16 v[34:35], v238 offset:16896
ds_read_b64_tr_b16 v[36:37], v250 offset:18432
ds_read_b64_tr_b16 v[38:39], v238 offset:18944
ds_read_b64_tr_b16 v[40:41], v251 offset:16384
ds_read_b64_tr_b16 v[42:43], v239 offset:16896
ds_read_b64_tr_b16 v[44:45], v251 offset:18432
ds_read_b64_tr_b16 v[46:47], v239 offset:18944
ds_read_b64_tr_b16 v[48:49], v250 offset:20480
ds_read_b64_tr_b16 v[50:51], v238 offset:20992
ds_read_b64_tr_b16 v[52:53], v250 offset:22528
ds_read_b64_tr_b16 v[54:55], v238 offset:23040
ds_read_b64_tr_b16 v[56:57], v251 offset:20480
ds_read_b64_tr_b16 v[58:59], v239 offset:20992
ds_read_b64_tr_b16 v[60:61], v251 offset:22528
ds_read_b64_tr_b16 v[62:63], v239 offset:23040
s_waitcnt lgkmcnt(0)
v_accvgpr_write_b32 a128, v32
v_accvgpr_write_b32 a129, v34
v_accvgpr_write_b32 a130, v33
v_accvgpr_write_b32 a131, v35
v_accvgpr_write_b32 a132, v36
v_accvgpr_write_b32 a133, v38
v_accvgpr_write_b32 a134, v37
v_accvgpr_write_b32 a135, v39
v_accvgpr_write_b32 a136, v40
v_accvgpr_write_b32 a137, v42
v_accvgpr_write_b32 a138, v41
v_accvgpr_write_b32 a139, v43
v_accvgpr_write_b32 a140, v44
v_accvgpr_write_b32 a141, v46
v_accvgpr_write_b32 a142, v45
v_accvgpr_write_b32 a143, v47
v_accvgpr_write_b32 a144, v48
v_accvgpr_write_b32 a145, v50
v_accvgpr_write_b32 a146, v49
v_accvgpr_write_b32 a147, v51
v_accvgpr_write_b32 a148, v52
v_accvgpr_write_b32 a149, v54
v_accvgpr_write_b32 a150, v53
v_accvgpr_write_b32 a151, v55
v_accvgpr_write_b32 a152, v56
v_accvgpr_write_b32 a153, v58
v_accvgpr_write_b32 a154, v57
v_accvgpr_write_b32 a155, v59
v_accvgpr_write_b32 a156, v60
v_accvgpr_write_b32 a157, v62
v_accvgpr_write_b32 a158, v61
v_accvgpr_write_b32 a159, v63
ds_read_b64_tr_b16 v[32:33], v250 offset:24576
ds_read_b64_tr_b16 v[34:35], v238 offset:25088
ds_read_b64_tr_b16 v[36:37], v250 offset:26624
ds_read_b64_tr_b16 v[38:39], v238 offset:27136
ds_read_b64_tr_b16 v[40:41], v251 offset:24576
ds_read_b64_tr_b16 v[42:43], v239 offset:25088
ds_read_b64_tr_b16 v[44:45], v251 offset:26624
ds_read_b64_tr_b16 v[46:47], v239 offset:27136
ds_read_b64_tr_b16 v[48:49], v250 offset:28672
ds_read_b64_tr_b16 v[50:51], v238 offset:29184
ds_read_b64_tr_b16 v[52:53], v250 offset:30720
ds_read_b64_tr_b16 v[54:55], v238 offset:31232
ds_read_b64_tr_b16 v[56:57], v251 offset:28672
ds_read_b64_tr_b16 v[58:59], v239 offset:29184
ds_read_b64_tr_b16 v[60:61], v251 offset:30720
ds_read_b64_tr_b16 v[62:63], v239 offset:31232
s_waitcnt lgkmcnt(0)
v_accvgpr_write_b32 a160, v32
v_accvgpr_write_b32 a161, v34
v_accvgpr_write_b32 a162, v33
v_accvgpr_write_b32 a163, v35
v_accvgpr_write_b32 a164, v36
v_accvgpr_write_b32 a165, v38
v_accvgpr_write_b32 a166, v37
v_accvgpr_write_b32 a167, v39
v_accvgpr_write_b32 a168, v40
v_accvgpr_write_b32 a169, v42
v_accvgpr_write_b32 a170, v41
v_accvgpr_write_b32 a171, v43
v_accvgpr_write_b32 a172, v44
v_accvgpr_write_b32 a173, v46
v_accvgpr_write_b32 a174, v45
v_accvgpr_write_b32 a175, v47
v_accvgpr_write_b32 a176, v48
v_accvgpr_write_b32 a177, v50
v_accvgpr_write_b32 a178, v49
v_accvgpr_write_b32 a179, v51
v_accvgpr_write_b32 a180, v52
v_accvgpr_write_b32 a181, v54
v_accvgpr_write_b32 a182, v53
v_accvgpr_write_b32 a183, v55
v_accvgpr_write_b32 a184, v56
v_accvgpr_write_b32 a185, v58
v_accvgpr_write_b32 a186, v57
v_accvgpr_write_b32 a187, v59
v_accvgpr_write_b32 a188, v60
v_accvgpr_write_b32 a189, v62
v_accvgpr_write_b32 a190, v61
v_accvgpr_write_b32 a191, v63
v_mov_b32 v234, 0
global_load_dword v228, v234, s[44:45] offset:40 sc1
s_mov_b32 s8, s24
s_and_b32 s9, s25, 0xffff
s_mov_b32 s10, 8388608
s_mov_b32 s11, 0x20000
s_lshl_b32 s49, s63, 8
s_lshl_b32 s74, s62, 6
s_add_u32 s49, s49, s74
s_add_u32 m0, s50, 0
s_nop 0
buffer_load_dwordx4 v240, s[8:11], s49 offen offset:0 lds
buffer_load_dwordx4 v241, s[8:11], s49 offen offset:1024 lds
buffer_load_dwordx4 v242, s[8:11], s49 offen offset:2048 lds
buffer_load_dwordx4 v243, s[8:11], s49 offen offset:3072 lds
s_add_u32 s49, s49, 524288
s_add_u32 m0, s50, 4096
s_nop 0
buffer_load_dwordx4 v240, s[8:11], s49 offen offset:0 lds
buffer_load_dwordx4 v241, s[8:11], s49 offen offset:1024 lds
buffer_load_dwordx4 v242, s[8:11], s49 offen offset:2048 lds
buffer_load_dwordx4 v243, s[8:11], s49 offen offset:3072 lds
s_add_u32 s49, s49, 524288
s_waitcnt vmcnt(8)
v_mov_b32 v234, 0
L_vw_6:
global_load_dword v235, v234, s[44:45] offset:48 sc1
s_mov_b32 s56, 98566144
buffer_load_dword v229, v234, s[4:7], s56 offen sc1
s_waitcnt vmcnt(0)
v_readfirstlane_b32 s97, v235
s_cmp_lg_u32 s97, 0
s_cbranch_scc1 L_vk_7
s_sleep 2
s_add_u32 s98, s98, 1
s_cmp_lt_u32 s98, 1000000
s_cbranch_scc1 L_vw_6
s_branch L_fail
L_vk_7:
s_add_u32 s97, s97, s99
s_and_b32 s97, s97, 7
s_andn2_b32 s98, s99, 7
s_or_b32 s97, s97, s98
s_cmp_eq_u32 s97, s2
s_cbranch_scc1 L_vok_5
s_mov_b32 s2, s97
s_waitcnt vmcnt(0) lgkmcnt(0)
s_barrier
s_branch L_role
L_vok_5:
s_lshl_b32 s52, s60, 5
s_add_u32 s52, s52, s61
s_lshl_b32 s53, s3, 7
s_add_u32 s52, s52, s53
s_sub_u32 s52, s52, 6
s_cmp_ge_u32 s52, 2
s_cbranch_scc1 L_nomeas_8
s_lshl_b32 s53, s52, 13
s_add_u32 s53, s53, s68
s_mov_b32 s54, -1
s_waitcnt vmcnt(0)
s_memtime s[56:57]
s_waitcnt lgkmcnt(0)
buffer_store_dwordx4 v[28:31], v1, s[4:7], s53 offen sc1
s_waitcnt vmcnt(0)
s_memtime s[58:59]
s_waitcnt lgkmcnt(0)
s_sub_u32 s55, s58, s56
s_min_u32 s54, s54, s55
s_memtime s[56:57]
s_waitcnt lgkmcnt(0)
buffer_store_dwordx4 v[28:31], v1, s[4:7], s53 offen sc1
s_waitcnt vmcnt(0)
s_memtime s[58:59]
s_waitcnt lgkmcnt(0)
s_sub_u32 s55, s58, s56
s_min_u32 s54, s54, s55
s_memtime s[56:57]
s_waitcnt lgkmcnt(0)
buffer_store_dwordx4 v[28:31], v1, s[4:7], s53 offen sc1
s_waitcnt vmcnt(0)
s_memtime s[58:59]
s_waitcnt lgkmcnt(0)
s_sub_u32 s55, s58, s56
s_min_u32 s54, s54, s55
s_lshl_b32 s52, s52, 2
v_mov_b32 v188, s52
v_mov_b32 v190, s54
global_store_dword v188, v190, s[44:45] offset:24 sc1
L_nomeas_8:
s_cmp_eq_u32 s3, 1
s_cbranch_scc1 L_pw_10
s_cmp_eq_u32 s3, 2
s_cbranch_scc1 L_pw_11
s_cmp_eq_u32 s3, 3
s_cbranch_scc1 L_pw_12
L_pw_9:
s_mov_b32 s77, 1
s_lshl_b32 s75, s77, 15
s_add_u32 s75, s75, s66
buffer_store_dwordx4 v[28:31], v1, s[4:7], s75 offen sc1
s_lshl_b32 s76, s77, 14
s_add_u32 s75, s76, s67
buffer_store_dwordx2 v[28:29], v3, s[4:7], s75 offen sc1
s_add_u32 s75, s76, s65
buffer_store_dwordx2 v[28:29], v3, s[4:7], s75 offen sc1
s_branch L_pwd_13
L_pw_10:
s_add_u32 s52, s68, 0
buffer_store_dwordx4 v[28:31], v1, s[4:7], s52 offen sc1
s_add_u32 s52, s68, 8192
buffer_store_dwordx4 v[28:31], v1, s[4:7], s52 offen sc1
s_add_u32 s52, s68, 65536
buffer_store_dwordx4 v[28:31], v1, s[4:7], s52 offen sc1
s_add_u32 s52, s68, 73728
buffer_store_dwordx4 v[28:31], v1, s[4:7], s52 offen sc1
s_add_u32 s52, s68, 131072
buffer_store_dwordx4 v[28:31], v1, s[4:7], s52 offen sc1
s_add_u32 s52, s68, 139264
buffer_store_dwordx4 v[28:31], v1, s[4:7], s52 offen sc1
s_add_u32 s52, s68, 196608
buffer_store_dwordx4 v[28:31], v1, s[4:7], s52 offen sc1
s_add_u32 s52, s68, 204800
buffer_store_dwordx4 v[28:31], v1, s[4:7], s52 offen sc1
s_branch L_pwd_13
L_pw_11:
buffer_store_dwordx4 v[28:31], v1, s[4:7], s66 offen sc1
buffer_store_dwordx2 v[28:29], v3, s[4:7], s67 offen sc1
s_branch L_pwd_13
L_pw_12:
buffer_store_dwordx2 v[196:197], v3, s[4:7], s65 offen sc1
L_pwd_13:
s_cmp_lg_u32 s3, 0
s_cbranch_scc1 L_sk0_14
v_readfirstlane_b32 s52, v228
v_readfirstlane_b32 s53, v229
s_cmp_eq_u32 s52, 0
s_cselect_b32 s53, 0, s53
s_cmp_ge_u32 s53, 16
s_cbranch_scc1 L_sk0_14
v_mov_b32 v194, v30
v_mov_b32 v195, v31
v_mov_b32 v30, 0
L_zw_15:
global_load_dword v31, v30, s[44:45] offset:40 sc1
s_waitcnt vmcnt(0)
v_readfirstlane_b32 s54, v31
s_cmp_lg_u32 s54, 0
s_cbranch_scc1 L_zok_16
s_sleep 2
s_sub_u32 s73, s73, 1
s_cmp_lg_u32 s73, 0
s_cbranch_scc1 L_zw_15
s_branch L_chexit_2
L_zok_16:
v_mov_b32 v30, v194
v_mov_b32 v31, v195
s_mov_b32 s52, 0
s_mov_b32 s53, 16
s_lshl_b32 s74, s52, 8
s_add_u32 s74, s74, 98566144
v_mov_b32 v184, 0
L_pc_17:
buffer_load_dword v185, v184, s[4:7], s74 offen sc1
s_waitcnt vmcnt(0)
v_readfirstlane_b32 s75, v185
s_cmp_ge_u32 s75, s53
s_cbranch_scc1 L_pcok_18
s_sleep 4
s_sub_u32 s73, s73, 1
s_cmp_lg_u32 s73, 0
s_cbranch_scc1 L_pc_17
s_branch L_chexit_2
L_pcok_18:
L_sk0_14:
s_barrier
s_lshl_b32 s52, s3, 14
s_add_u32 s52, s52, 0
s_lshl_b32 s54, s62, 11
s_add_u32 s54, s54, s69
s_cmp_ge_u32 s3, 2
s_cselect_b32 s53, s70, s54
s_and_b32 s54, s3, 1
s_lshl_b32 s54, s54, 8
s_add_u32 s53, s53, s54
s_add_u32 s52, s52, 155189248
v_and_b32 v14, 15, v0
v_lshlrev_b32 v14, 4, v14
v_bfe_u32 v15, v0, 4, 2
v_lshl_add_u32 v14, v15, 9, v14
s_lshl_b32 s74, s3, 13
v_add_u32 v224, s74, v1
s_lshl_b32 s74, s3, 11
v_add_u32 v15, s74, v1
s_add_u32 s75, s52, 0
buffer_load_dwordx4 v[32:35], v14, s[4:7], s75 offen offset:0 sc1
buffer_load_dwordx4 v[36:39], v14, s[4:7], s75 offen offset:256 sc1
buffer_load_dwordx4 v[40:43], v14, s[4:7], s75 offen offset:2048 sc1
buffer_load_dwordx4 v[44:47], v14, s[4:7], s75 offen offset:2304 sc1
s_add_u32 s75, s52, 4096
buffer_load_dwordx4 v[48:51], v14, s[4:7], s75 offen offset:0 sc1
buffer_load_dwordx4 v[52:55], v14, s[4:7], s75 offen offset:256 sc1
buffer_load_dwordx4 v[56:59], v14, s[4:7], s75 offen offset:2048 sc1
buffer_load_dwordx4 v[60:63], v14, s[4:7], s75 offen offset:2304 sc1
s_add_u32 s75, s52, 8192
buffer_load_dwordx4 v[64:67], v14, s[4:7], s75 offen offset:0 sc1
buffer_load_dwordx4 v[68:71], v14, s[4:7], s75 offen offset:256 sc1
buffer_load_dwordx4 v[72:75], v14, s[4:7], s75 offen offset:2048 sc1
buffer_load_dwordx4 v[76:79], v14, s[4:7], s75 offen offset:2304 sc1
s_add_u32 s75, s52, 12288
buffer_load_dwordx4 v[80:83], v14, s[4:7], s75 offen offset:0 sc1
buffer_load_dwordx4 v[84:87], v14, s[4:7], s75 offen offset:256 sc1
buffer_load_dwordx4 v[88:91], v14, s[4:7], s75 offen offset:2048 sc1
buffer_load_dwordx4 v[92:95], v14, s[4:7], s75 offen offset:2304 sc1
s_add_u32 s75, s52, 65536
buffer_load_dwordx4 v[96:99], v14, s[4:7], s75 offen offset:0 sc1
buffer_load_dwordx4 v[100:103], v14, s[4:7], s75 offen offset:256 sc1
buffer_load_dwordx4 v[104:107], v14, s[4:7], s75 offen offset:2048 sc1
buffer_load_dwordx4 v[108:111], v14, s[4:7], s75 offen offset:2304 sc1
s_add_u32 s75, s52, 69632
buffer_load_dwordx4 v[112:115], v14, s[4:7], s75 offen offset:0 sc1
buffer_load_dwordx4 v[116:119], v14, s[4:7], s75 offen offset:256 sc1
buffer_load_dwordx4 v[120:123], v14, s[4:7], s75 offen offset:2048 sc1
buffer_load_dwordx4 v[124:127], v14, s[4:7], s75 offen offset:2304 sc1
s_add_u32 s75, s52, 73728
buffer_load_dwordx4 v[128:131], v14, s[4:7], s75 offen offset:0 sc1
buffer_load_dwordx4 v[132:135], v14, s[4:7], s75 offen offset:256 sc1
buffer_load_dwordx4 v[136:139], v14, s[4:7], s75 offen offset:2048 sc1
buffer_load_dwordx4 v[140:143], v14, s[4:7], s75 offen offset:2304 sc1
s_add_u32 s75, s52, 77824
buffer_load_dwordx4 v[144:147], v14, s[4:7], s75 offen offset:0 sc1
buffer_load_dwordx4 v[148:151], v14, s[4:7], s75 offen offset:256 sc1
buffer_load_dwordx4 v[152:155], v14, s[4:7], s75 offen offset:2048 sc1
buffer_load_dwordx4 v[156:159], v14, s[4:7], s75 offen offset:2304 sc1
s_waitcnt vmcnt(16)
v_mfma_f32_16x16x32_bf16 v[160:163], a[64:67], v[32:35], 0
v_mfma_f32_16x16x32_bf16 v[176:179], v[32:35], a[128:131], 0
s_add_u32 s75, s52, 131072
buffer_load_dwordx4 a[0:3], v14, s[4:7], s75 offen offset:0 sc1
v_mfma_f32_16x16x32_bf16 v[164:167], a[72:75], v[32:35], 0
v_mfma_f32_16x16x32_bf16 v[184:187], v[32:35], a[136:139], 0
buffer_load_dwordx4 a[4:7], v14, s[4:7], s75 offen offset:256 sc1
v_mfma_f32_16x16x32_bf16 v[168:171], a[64:67], v[36:39], 0
v_mfma_f32_16x16x32_bf16 v[180:183], v[36:39], a[128:131], 0
buffer_load_dwordx4 a[8:11], v14, s[4:7], s75 offen offset:2048 sc1
v_mfma_f32_16x16x32_bf16 v[172:175], a[72:75], v[36:39], 0
v_mfma_f32_16x16x32_bf16 v[188:191], v[36:39], a[136:139], 0
buffer_load_dwordx4 a[12:15], v14, s[4:7], s75 offen offset:2304 sc1
v_mfma_f32_16x16x32_bf16 v[160:163], a[68:71], v[40:43], v[160:163]
v_mfma_f32_16x16x32_bf16 v[176:179], v[40:43], a[132:135], v[176:179]
s_add_u32 s75, s52, 135168
buffer_load_dwordx4 a[16:19], v14, s[4:7], s75 offen offset:0 sc1
v_mfma_f32_16x16x32_bf16 v[164:167], a[76:79], v[40:43], v[164:167]
v_mfma_f32_16x16x32_bf16 v[184:187], v[40:43], a[140:143], v[184:187]
buffer_load_dwordx4 a[20:23], v14, s[4:7], s75 offen offset:256 sc1
v_mfma_f32_16x16x32_bf16 v[168:171], a[68:71], v[44:47], v[168:171]
v_mfma_f32_16x16x32_bf16 v[180:183], v[44:47], a[132:135], v[180:183]
buffer_load_dwordx4 a[24:27], v14, s[4:7], s75 offen offset:2048 sc1
v_mfma_f32_16x16x32_bf16 v[172:175], a[76:79], v[44:47], v[172:175]
v_mfma_f32_16x16x32_bf16 v[188:191], v[44:47], a[140:143], v[188:191]
buffer_load_dwordx4 a[28:31], v14, s[4:7], s75 offen offset:2304 sc1
v_mfma_f32_16x16x32_bf16 v[160:163], a[80:83], v[48:51], v[160:163]
v_mfma_f32_16x16x32_bf16 v[176:179], v[48:51], a[144:147], v[176:179]
s_add_u32 s75, s52, 139264
buffer_load_dwordx4 a[32:35], v14, s[4:7], s75 offen offset:0 sc1
v_mfma_f32_16x16x32_bf16 v[164:167], a[88:91], v[48:51], v[164:167]
v_mfma_f32_16x16x32_bf16 v[184:187], v[48:51], a[152:155], v[184:187]
buffer_load_dwordx4 a[36:39], v14, s[4:7], s75 offen offset:256 sc1
v_mfma_f32_16x16x32_bf16 v[168:171], a[80:83], v[52:55], v[168:171]
v_mfma_f32_16x16x32_bf16 v[180:183], v[52:55], a[144:147], v[180:183]
buffer_load_dwordx4 a[40:43], v14, s[4:7], s75 offen offset:2048 sc1
v_mfma_f32_16x16x32_bf16 v[172:175], a[88:91], v[52:55], v[172:175]
v_mfma_f32_16x16x32_bf16 v[188:191], v[52:55], a[152:155], v[188:191]
buffer_load_dwordx4 a[44:47], v14, s[4:7], s75 offen offset:2304 sc1
v_mfma_f32_16x16x32_bf16 v[160:163], a[84:87], v[56:59], v[160:163]
v_mfma_f32_16x16x32_bf16 v[176:179], v[56:59], a[148:151], v[176:179]
s_add_u32 s75, s52, 143360
buffer_load_dwordx4 a[48:51], v14, s[4:7], s75 offen offset:0 sc1
v_mfma_f32_16x16x32_bf16 v[164:167], a[92:95], v[56:59], v[164:167]
v_mfma_f32_16x16x32_bf16 v[184:187], v[56:59], a[156:159], v[184:187]
buffer_load_dwordx4 a[52:55], v14, s[4:7], s75 offen offset:256 sc1
v_mfma_f32_16x16x32_bf16 v[168:171], a[84:87], v[60:63], v[168:171]
v_mfma_f32_16x16x32_bf16 v[180:183], v[60:63], a[148:151], v[180:183]
buffer_load_dwordx4 a[56:59], v14, s[4:7], s75 offen offset:2048 sc1
v_mfma_f32_16x16x32_bf16 v[172:175], a[92:95], v[60:63], v[172:175]
v_mfma_f32_16x16x32_bf16 v[188:191], v[60:63], a[156:159], v[188:191]
buffer_load_dwordx4 a[60:63], v14, s[4:7], s75 offen offset:2304 sc1
v_mfma_f32_16x16x32_bf16 v[160:163], a[96:99], v[64:67], v[160:163]
v_mfma_f32_16x16x32_bf16 v[176:179], v[64:67], a[160:163], v[176:179]
s_add_u32 s75, s52, 196608
buffer_load_dwordx4 a[192:195], v14, s[4:7], s75 offen offset:0 sc1
v_mfma_f32_16x16x32_bf16 v[164:167], a[104:107], v[64:67], v[164:167]
v_mfma_f32_16x16x32_bf16 v[184:187], v[64:67], a[168:171], v[184:187]
buffer_load_dwordx4 a[196:199], v14, s[4:7], s75 offen offset:256 sc1
v_mfma_f32_16x16x32_bf16 v[168:171], a[96:99], v[68:71], v[168:171]
v_mfma_f32_16x16x32_bf16 v[180:183], v[68:71], a[160:163], v[180:183]
buffer_load_dwordx4 a[200:203], v14, s[4:7], s75 offen offset:2048 sc1
v_mfma_f32_16x16x32_bf16 v[172:175], a[104:107], v[68:71], v[172:175]
v_mfma_f32_16x16x32_bf16 v[188:191], v[68:71], a[168:171], v[188:191]
buffer_load_dwordx4 a[204:207], v14, s[4:7], s75 offen offset:2304 sc1
v_mfma_f32_16x16x32_bf16 v[160:163], a[100:103], v[72:75], v[160:163]
v_mfma_f32_16x16x32_bf16 v[176:179], v[72:75], a[164:167], v[176:179]
s_add_u32 s75, s52, 200704
buffer_load_dwordx4 a[208:211], v14, s[4:7], s75 offen offset:0 sc1
v_mfma_f32_16x16x32_bf16 v[164:167], a[108:111], v[72:75], v[164:167]
v_mfma_f32_16x16x32_bf16 v[184:187], v[72:75], a[172:175], v[184:187]
buffer_load_dwordx4 a[212:215], v14, s[4:7], s75 offen offset:256 sc1
v_mfma_f32_16x16x32_bf16 v[168:171], a[100:103], v[76:79], v[168:171]
v_mfma_f32_16x16x32_bf16 v[180:183], v[76:79], a[164:167], v[180:183]
buffer_load_dwordx4 a[216:219], v14, s[4:7], s75 offen offset:2048 sc1
v_mfma_f32_16x16x32_bf16 v[172:175], a[108:111], v[76:79], v[172:175]
v_mfma_f32_16x16x32_bf16 v[188:191], v[76:79], a[172:175], v[188:191]
buffer_load_dwordx4 a[220:223], v14, s[4:7], s75 offen offset:2304 sc1
v_mfma_f32_16x16x32_bf16 v[160:163], a[112:115], v[80:83], v[160:163]
v_mfma_f32_16x16x32_bf16 v[176:179], v[80:83], a[176:179], v[176:179]
s_add_u32 s75, s52, 204800
buffer_load_dwordx4 a[224:227], v14, s[4:7], s75 offen offset:0 sc1
v_mfma_f32_16x16x32_bf16 v[164:167], a[120:123], v[80:83], v[164:167]
v_mfma_f32_16x16x32_bf16 v[184:187], v[80:83], a[184:187], v[184:187]
buffer_load_dwordx4 a[228:231], v14, s[4:7], s75 offen offset:256 sc1
v_mfma_f32_16x16x32_bf16 v[168:171], a[112:115], v[84:87], v[168:171]
v_mfma_f32_16x16x32_bf16 v[180:183], v[84:87], a[176:179], v[180:183]
buffer_load_dwordx4 a[232:235], v14, s[4:7], s75 offen offset:2048 sc1
v_mfma_f32_16x16x32_bf16 v[172:175], a[120:123], v[84:87], v[172:175]
v_mfma_f32_16x16x32_bf16 v[188:191], v[84:87], a[184:187], v[188:191]
buffer_load_dwordx4 a[236:239], v14, s[4:7], s75 offen offset:2304 sc1
v_mfma_f32_16x16x32_bf16 v[160:163], a[116:119], v[88:91], v[160:163]
v_mfma_f32_16x16x32_bf16 v[176:179], v[88:91], a[180:183], v[176:179]
s_add_u32 s75, s52, 208896
buffer_load_dwordx4 a[240:243], v14, s[4:7], s75 offen offset:0 sc1
v_mfma_f32_16x16x32_bf16 v[164:167], a[124:127], v[88:91], v[164:167]
v_mfma_f32_16x16x32_bf16 v[184:187], v[88:91], a[188:191], v[184:187]
buffer_load_dwordx4 a[244:247], v14, s[4:7], s75 offen offset:256 sc1
v_mfma_f32_16x16x32_bf16 v[168:171], a[116:119], v[92:95], v[168:171]
v_mfma_f32_16x16x32_bf16 v[180:183], v[92:95], a[180:183], v[180:183]
buffer_load_dwordx4 a[248:251], v14, s[4:7], s75 offen offset:2048 sc1
v_mfma_f32_16x16x32_bf16 v[172:175], a[124:127], v[92:95], v[172:175]
v_mfma_f32_16x16x32_bf16 v[188:191], v[92:95], a[188:191], v[188:191]
buffer_load_dwordx4 a[252:255], v14, s[4:7], s75 offen offset:2304 sc1
s_nop 7
ds_write_b128 v224, v[160:163] offset:0
ds_write_b128 v224, v[164:167] offset:1024
ds_write_b128 v224, v[168:171] offset:2048
ds_write_b128 v224, v[172:175] offset:3072
ds_write_b128 v224, v[176:179] offset:4096
ds_write_b128 v224, v[180:183] offset:5120
ds_write_b128 v224, v[184:187] offset:6144
ds_write_b128 v224, v[188:191] offset:7168
s_waitcnt lgkmcnt(0)
s_barrier
ds_read_b128 v[192:195], v15 offset:0
ds_read_b128 v[196:199], v15 offset:8192
ds_read_b128 v[200:203], v15 offset:16384
ds_read_b128 v[204:207], v15 offset:24576
ds_read_b128 v[208:211], v15 offset:1024
ds_read_b128 v[212:215], v15 offset:9216
ds_read_b128 v[216:219], v15 offset:17408
ds_read_b128 v[220:223], v15 offset:25600
s_cmp_lg_u32 s3, 0
s_cbranch_scc1 L_arr_19
s_getreg_b32 s56, hwreg(HW_REG_XCC_ID)
s_and_b32 s56, s56, 7
s_mul_i32 s57, s56, s56
s_lshl_b32 s57, s57, 16
s_lshl_b32 s56, s56, 8
s_add_u32 s56, s56, s57
s_add_u32 s56, s56, 1
v_mov_b32 v226, s56
v_mov_b32 v227, 0
s_lshl_b32 s57, s60, 8
s_add_u32 s57, s57, 98580480
s_mov_b64 exec, 1
buffer_atomic_add v226, v227, s[4:7], s57 offen sc1
s_mov_b64 exec, -1
L_arr_19:
s_waitcnt lgkmcnt(0)
v_pk_add_f32 v[192:193], v[192:193], v[196:197]
v_pk_add_f32 v[194:195], v[194:195], v[198:199]
v_pk_add_f32 v[200:201], v[200:201], v[204:205]
v_pk_add_f32 v[202:203], v[202:203], v[206:207]
v_pk_add_f32 v[192:193], v[192:193], v[200:201]
v_pk_add_f32 v[194:195], v[194:195], v[202:203]
v_pk_add_f32 v[208:209], v[208:209], v[212:213]
v_pk_add_f32 v[210:211], v[210:211], v[214:215]
v_pk_add_f32 v[216:217], v[216:217], v[220:221]
v_pk_add_f32 v[218:219], v[218:219], v[222:223]
v_pk_add_f32 v[208:209], v[208:209], v[216:217]
v_pk_add_f32 v[210:211], v[210:211], v[218:219]
v_cvt_pk_bf16_f32 v32, v192, v193
v_cvt_pk_bf16_f32 v33, v194, v195
v_cvt_pk_bf16_f32 v34, v208, v209
v_cvt_pk_bf16_f32 v35, v210, v211
s_cmp_lt_u32 s3, 2
s_cbranch_scc1 L_rns_20
s_nop 0
v_permlane32_swap_b32 v32, v34
v_permlane32_swap_b32 v33, v35
L_rns_20:
s_waitcnt vmcnt(32)
v_mfma_f32_16x16x32_bf16 v[160:163], a[64:67], v[96:99], 0
v_mfma_f32_16x16x32_bf16 v[176:179], v[96:99], a[128:131], 0
v_mfma_f32_16x16x32_bf16 v[164:167], a[72:75], v[96:99], 0
v_mfma_f32_16x16x32_bf16 v[184:187], v[96:99], a[136:139], 0
v_mfma_f32_16x16x32_bf16 v[168:171], a[64:67], v[100:103], 0
v_mfma_f32_16x16x32_bf16 v[180:183], v[100:103], a[128:131], 0
v_mfma_f32_16x16x32_bf16 v[172:175], a[72:75], v[100:103], 0
v_mfma_f32_16x16x32_bf16 v[188:191], v[100:103], a[136:139], 0
s_mov_b32 s8, s24
s_and_b32 s9, s25, 0xffff
s_mov_b32 s10, 8388608
s_mov_b32 s11, 0x20000
s_lshl_b32 s49, s63, 8
s_lshl_b32 s74, s62, 6
s_add_u32 s49, s49, s74
s_add_u32 s49, s49, 1048576
s_add_u32 m0, s50, 8192
s_nop 0
buffer_load_dwordx4 v240, s[8:11], s49 offen offset:0 lds
v_mfma_f32_16x16x32_bf16 v[160:163], a[68:71], v[104:107], v[160:163]
v_mfma_f32_16x16x32_bf16 v[176:179], v[104:107], a[132:135], v[176:179]
v_mfma_f32_16x16x32_bf16 v[164:167], a[76:79], v[104:107], v[164:167]
v_mfma_f32_16x16x32_bf16 v[184:187], v[104:107], a[140:143], v[184:187]
v_mfma_f32_16x16x32_bf16 v[168:171], a[68:71], v[108:111], v[168:171]
v_mfma_f32_16x16x32_bf16 v[180:183], v[108:111], a[132:135], v[180:183]
v_mfma_f32_16x16x32_bf16 v[172:175], a[76:79], v[108:111], v[172:175]
v_mfma_f32_16x16x32_bf16 v[188:191], v[108:111], a[140:143], v[188:191]
buffer_load_dwordx4 v241, s[8:11], s49 offen offset:1024 lds
v_mfma_f32_16x16x32_bf16 v[160:163], a[80:83], v[112:115], v[160:163]
v_mfma_f32_16x16x32_bf16 v[176:179], v[112:115], a[144:147], v[176:179]
v_mfma_f32_16x16x32_bf16 v[164:167], a[88:91], v[112:115], v[164:167]
v_mfma_f32_16x16x32_bf16 v[184:187], v[112:115], a[152:155], v[184:187]
v_mfma_f32_16x16x32_bf16 v[168:171], a[80:83], v[116:119], v[168:171]
v_mfma_f32_16x16x32_bf16 v[180:183], v[116:119], a[144:147], v[180:183]
v_mfma_f32_16x16x32_bf16 v[172:175], a[88:91], v[116:119], v[172:175]
v_mfma_f32_16x16x32_bf16 v[188:191], v[116:119], a[152:155], v[188:191]
buffer_load_dwordx4 v242, s[8:11], s49 offen offset:2048 lds
v_mfma_f32_16x16x32_bf16 v[160:163], a[84:87], v[120:123], v[160:163]
v_mfma_f32_16x16x32_bf16 v[176:179], v[120:123], a[148:151], v[176:179]
v_mfma_f32_16x16x32_bf16 v[164:167], a[92:95], v[120:123], v[164:167]
v_mfma_f32_16x16x32_bf16 v[184:187], v[120:123], a[156:159], v[184:187]
v_mfma_f32_16x16x32_bf16 v[168:171], a[84:87], v[124:127], v[168:171]
v_mfma_f32_16x16x32_bf16 v[180:183], v[124:127], a[148:151], v[180:183]
v_mfma_f32_16x16x32_bf16 v[172:175], a[92:95], v[124:127], v[172:175]
v_mfma_f32_16x16x32_bf16 v[188:191], v[124:127], a[156:159], v[188:191]
buffer_load_dwordx4 v243, s[8:11], s49 offen offset:3072 lds
v_mfma_f32_16x16x32_bf16 v[160:163], a[96:99], v[128:131], v[160:163]
v_mfma_f32_16x16x32_bf16 v[176:179], v[128:131], a[160:163], v[176:179]
v_mfma_f32_16x16x32_bf16 v[164:167], a[104:107], v[128:131], v[164:167]
v_mfma_f32_16x16x32_bf16 v[184:187], v[128:131], a[168:171], v[184:187]
v_mfma_f32_16x16x32_bf16 v[168:171], a[96:99], v[132:135], v[168:171]
v_mfma_f32_16x16x32_bf16 v[180:183], v[132:135], a[160:163], v[180:183]
v_mfma_f32_16x16x32_bf16 v[172:175], a[104:107], v[132:135], v[172:175]
v_mfma_f32_16x16x32_bf16 v[188:191], v[132:135], a[168:171], v[188:191]
s_add_u32 s49, s49, 524288
s_add_u32 m0, s50, 12288
s_nop 0
buffer_load_dwordx4 v240, s[8:11], s49 offen offset:0 lds
v_mfma_f32_16x16x32_bf16 v[160:163], a[100:103], v[136:139], v[160:163]
v_mfma_f32_16x16x32_bf16 v[176:179], v[136:139], a[164:167], v[176:179]
v_mfma_f32_16x16x32_bf16 v[164:167], a[108:111], v[136:139], v[164:167]
v_mfma_f32_16x16x32_bf16 v[184:187], v[136:139], a[172:175], v[184:187]
v_mfma_f32_16x16x32_bf16 v[168:171], a[100:103], v[140:143], v[168:171]
v_mfma_f32_16x16x32_bf16 v[180:183], v[140:143], a[164:167], v[180:183]
v_mfma_f32_16x16x32_bf16 v[172:175], a[108:111], v[140:143], v[172:175]
v_mfma_f32_16x16x32_bf16 v[188:191], v[140:143], a[172:175], v[188:191]
buffer_load_dwordx4 v241, s[8:11], s49 offen offset:1024 lds
v_mfma_f32_16x16x32_bf16 v[160:163], a[112:115], v[144:147], v[160:163]
v_mfma_f32_16x16x32_bf16 v[176:179], v[144:147], a[176:179], v[176:179]
v_mfma_f32_16x16x32_bf16 v[164:167], a[120:123], v[144:147], v[164:167]
v_mfma_f32_16x16x32_bf16 v[184:187], v[144:147], a[184:187], v[184:187]
v_mfma_f32_16x16x32_bf16 v[168:171], a[112:115], v[148:151], v[168:171]
v_mfma_f32_16x16x32_bf16 v[180:183], v[148:151], a[176:179], v[180:183]
v_mfma_f32_16x16x32_bf16 v[172:175], a[120:123], v[148:151], v[172:175]
v_mfma_f32_16x16x32_bf16 v[188:191], v[148:151], a[184:187], v[188:191]
buffer_load_dwordx4 v242, s[8:11], s49 offen offset:2048 lds
v_mfma_f32_16x16x32_bf16 v[160:163], a[116:119], v[152:155], v[160:163]
v_mfma_f32_16x16x32_bf16 v[176:179], v[152:155], a[180:183], v[176:179]
v_mfma_f32_16x16x32_bf16 v[164:167], a[124:127], v[152:155], v[164:167]
v_mfma_f32_16x16x32_bf16 v[184:187], v[152:155], a[188:191], v[184:187]
v_mfma_f32_16x16x32_bf16 v[168:171], a[116:119], v[156:159], v[168:171]
v_mfma_f32_16x16x32_bf16 v[180:183], v[156:159], a[180:183], v[180:183]
v_mfma_f32_16x16x32_bf16 v[172:175], a[124:127], v[156:159], v[172:175]
v_mfma_f32_16x16x32_bf16 v[188:191], v[156:159], a[188:191], v[188:191]
buffer_load_dwordx4 v243, s[8:11], s49 offen offset:3072 lds
s_barrier
s_nop 7
ds_write_b128 v224, v[160:163] offset:0
ds_write_b128 v224, v[164:167] offset:1024
ds_write_b128 v224, v[168:171] offset:2048
ds_write_b128 v224, v[172:175] offset:3072
ds_write_b128 v224, v[176:179] offset:4096
ds_write_b128 v224, v[180:183] offset:5120
ds_write_b128 v224, v[184:187] offset:6144
ds_write_b128 v224, v[188:191] offset:7168
s_waitcnt lgkmcnt(0)
s_barrier
ds_read_b128 v[192:195], v15 offset:0
ds_read_b128 v[196:199], v15 offset:8192
ds_read_b128 v[200:203], v15 offset:16384
ds_read_b128 v[204:207], v15 offset:24576
ds_read_b128 v[208:211], v15 offset:1024
ds_read_b128 v[212:215], v15 offset:9216
ds_read_b128 v[216:219], v15 offset:17408
ds_read_b128 v[220:223], v15 offset:25600
s_waitcnt lgkmcnt(0)
v_pk_add_f32 v[192:193], v[192:193], v[196:197]
v_pk_add_f32 v[194:195], v[194:195], v[198:199]
v_pk_add_f32 v[200:201], v[200:201], v[204:205]
v_pk_add_f32 v[202:203], v[202:203], v[206:207]
v_pk_add_f32 v[192:193], v[192:193], v[200:201]
v_pk_add_f32 v[194:195], v[194:195], v[202:203]
v_pk_add_f32 v[208:209], v[208:209], v[212:213]
v_pk_add_f32 v[210:211], v[210:211], v[214:215]
v_pk_add_f32 v[216:217], v[216:217], v[220:221]
v_pk_add_f32 v[218:219], v[218:219], v[222:223]
v_pk_add_f32 v[208:209], v[208:209], v[216:217]
v_pk_add_f32 v[210:211], v[210:211], v[218:219]
v_cvt_pk_bf16_f32 v36, v192, v193
v_cvt_pk_bf16_f32 v37, v194, v195
v_cvt_pk_bf16_f32 v38, v208, v209
v_cvt_pk_bf16_f32 v39, v210, v211
s_cmp_lt_u32 s3, 2
s_cbranch_scc1 L_rns_21
s_nop 0
v_permlane32_swap_b32 v36, v38
v_permlane32_swap_b32 v37, v39
L_rns_21:
buffer_store_dwordx4 v[32:35], v14, s[4:7], s53 offen sc1
s_add_u32 s53, s53, 262144
buffer_store_dwordx4 v[36:39], v14, s[4:7], s53 offen sc1
s_add_u32 s53, s53, 262144
s_waitcnt vmcnt(26)
v_mfma_f32_16x16x32_bf16 v[160:163], a[64:67], a[0:3], 0
v_mfma_f32_16x16x32_bf16 v[176:179], a[0:3], a[128:131], 0
v_mfma_f32_16x16x32_bf16 v[164:167], a[72:75], a[0:3], 0
v_mfma_f32_16x16x32_bf16 v[184:187], a[0:3], a[136:139], 0
v_mfma_f32_16x16x32_bf16 v[168:171], a[64:67], a[4:7], 0
v_mfma_f32_16x16x32_bf16 v[180:183], a[4:7], a[128:131], 0
v_mfma_f32_16x16x32_bf16 v[172:175], a[72:75], a[4:7], 0
v_mfma_f32_16x16x32_bf16 v[188:191], a[4:7], a[136:139], 0
s_add_u32 s49, s49, 524288
s_mov_b32 s8, s30
s_and_b32 s9, s31, 0xffff
s_mov_b32 s10, 8388608
s_mov_b32 s11, 0x20000
s_lshl_b32 s49, s60, 21
s_lshl_b32 s74, s61, 6
s_add_u32 s49, s49, s74
s_add_u32 m0, s50, 16384
s_nop 0
buffer_load_dwordx4 v244, s[8:11], s49 offen offset:0 lds
v_mfma_f32_16x16x32_bf16 v[160:163], a[68:71], a[8:11], v[160:163]
v_mfma_f32_16x16x32_bf16 v[176:179], a[8:11], a[132:135], v[176:179]
v_mfma_f32_16x16x32_bf16 v[164:167], a[76:79], a[8:11], v[164:167]
v_mfma_f32_16x16x32_bf16 v[184:187], a[8:11], a[140:143], v[184:187]
v_mfma_f32_16x16x32_bf16 v[168:171], a[68:71], a[12:15], v[168:171]
v_mfma_f32_16x16x32_bf16 v[180:183], a[12:15], a[132:135], v[180:183]
v_mfma_f32_16x16x32_bf16 v[172:175], a[76:79], a[12:15], v[172:175]
v_mfma_f32_16x16x32_bf16 v[188:191], a[12:15], a[140:143], v[188:191]
buffer_load_dwordx4 v245, s[8:11], s49 offen offset:1024 lds
v_mfma_f32_16x16x32_bf16 v[160:163], a[80:83], a[16:19], v[160:163]
v_mfma_f32_16x16x32_bf16 v[176:179], a[16:19], a[144:147], v[176:179]
v_mfma_f32_16x16x32_bf16 v[164:167], a[88:91], a[16:19], v[164:167]
v_mfma_f32_16x16x32_bf16 v[184:187], a[16:19], a[152:155], v[184:187]
v_mfma_f32_16x16x32_bf16 v[168:171], a[80:83], a[20:23], v[168:171]
v_mfma_f32_16x16x32_bf16 v[180:183], a[20:23], a[144:147], v[180:183]
v_mfma_f32_16x16x32_bf16 v[172:175], a[88:91], a[20:23], v[172:175]
v_mfma_f32_16x16x32_bf16 v[188:191], a[20:23], a[152:155], v[188:191]
buffer_load_dwordx4 v246, s[8:11], s49 offen offset:2048 lds
v_mfma_f32_16x16x32_bf16 v[160:163], a[84:87], a[24:27], v[160:163]
v_mfma_f32_16x16x32_bf16 v[176:179], a[24:27], a[148:151], v[176:179]
v_mfma_f32_16x16x32_bf16 v[164:167], a[92:95], a[24:27], v[164:167]
v_mfma_f32_16x16x32_bf16 v[184:187], a[24:27], a[156:159], v[184:187]
v_mfma_f32_16x16x32_bf16 v[168:171], a[84:87], a[28:31], v[168:171]
v_mfma_f32_16x16x32_bf16 v[180:183], a[28:31], a[148:151], v[180:183]
v_mfma_f32_16x16x32_bf16 v[172:175], a[92:95], a[28:31], v[172:175]
v_mfma_f32_16x16x32_bf16 v[188:191], a[28:31], a[156:159], v[188:191]
buffer_load_dwordx4 v247, s[8:11], s49 offen offset:3072 lds
v_mfma_f32_16x16x32_bf16 v[160:163], a[96:99], a[32:35], v[160:163]
v_mfma_f32_16x16x32_bf16 v[176:179], a[32:35], a[160:163], v[176:179]
v_mfma_f32_16x16x32_bf16 v[164:167], a[104:107], a[32:35], v[164:167]
v_mfma_f32_16x16x32_bf16 v[184:187], a[32:35], a[168:171], v[184:187]
v_mfma_f32_16x16x32_bf16 v[168:171], a[96:99], a[36:39], v[168:171]
v_mfma_f32_16x16x32_bf16 v[180:183], a[36:39], a[160:163], v[180:183]
v_mfma_f32_16x16x32_bf16 v[172:175], a[104:107], a[36:39], v[172:175]
v_mfma_f32_16x16x32_bf16 v[188:191], a[36:39], a[168:171], v[188:191]
s_add_u32 s49, s49, 131072
s_add_u32 m0, s50, 20480
s_nop 0
buffer_load_dwordx4 v244, s[8:11], s49 offen offset:0 lds
v_mfma_f32_16x16x32_bf16 v[160:163], a[100:103], a[40:43], v[160:163]
v_mfma_f32_16x16x32_bf16 v[176:179], a[40:43], a[164:167], v[176:179]
v_mfma_f32_16x16x32_bf16 v[164:167], a[108:111], a[40:43], v[164:167]
v_mfma_f32_16x16x32_bf16 v[184:187], a[40:43], a[172:175], v[184:187]
v_mfma_f32_16x16x32_bf16 v[168:171], a[100:103], a[44:47], v[168:171]
v_mfma_f32_16x16x32_bf16 v[180:183], a[44:47], a[164:167], v[180:183]
v_mfma_f32_16x16x32_bf16 v[172:175], a[108:111], a[44:47], v[172:175]
v_mfma_f32_16x16x32_bf16 v[188:191], a[44:47], a[172:175], v[188:191]
buffer_load_dwordx4 v245, s[8:11], s49 offen offset:1024 lds
v_mfma_f32_16x16x32_bf16 v[160:163], a[112:115], a[48:51], v[160:163]
v_mfma_f32_16x16x32_bf16 v[176:179], a[48:51], a[176:179], v[176:179]
v_mfma_f32_16x16x32_bf16 v[164:167], a[120:123], a[48:51], v[164:167]
v_mfma_f32_16x16x32_bf16 v[184:187], a[48:51], a[184:187], v[184:187]
v_mfma_f32_16x16x32_bf16 v[168:171], a[112:115], a[52:55], v[168:171]
v_mfma_f32_16x16x32_bf16 v[180:183], a[52:55], a[176:179], v[180:183]
v_mfma_f32_16x16x32_bf16 v[172:175], a[120:123], a[52:55], v[172:175]
v_mfma_f32_16x16x32_bf16 v[188:191], a[52:55], a[184:187], v[188:191]
buffer_load_dwordx4 v246, s[8:11], s49 offen offset:2048 lds
v_mfma_f32_16x16x32_bf16 v[160:163], a[116:119], a[56:59], v[160:163]
v_mfma_f32_16x16x32_bf16 v[176:179], a[56:59], a[180:183], v[176:179]
v_mfma_f32_16x16x32_bf16 v[164:167], a[124:127], a[56:59], v[164:167]
v_mfma_f32_16x16x32_bf16 v[184:187], a[56:59], a[188:191], v[184:187]
v_mfma_f32_16x16x32_bf16 v[168:171], a[116:119], a[60:63], v[168:171]
v_mfma_f32_16x16x32_bf16 v[180:183], a[60:63], a[180:183], v[180:183]
v_mfma_f32_16x16x32_bf16 v[172:175], a[124:127], a[60:63], v[172:175]
v_mfma_f32_16x16x32_bf16 v[188:191], a[60:63], a[188:191], v[188:191]
buffer_load_dwordx4 v247, s[8:11], s49 offen offset:3072 lds
s_barrier
s_nop 7
ds_write_b128 v224, v[160:163] offset:0
ds_write_b128 v224, v[164:167] offset:1024
ds_write_b128 v224, v[168:171] offset:2048
ds_write_b128 v224, v[172:175] offset:3072
ds_write_b128 v224, v[176:179] offset:4096
ds_write_b128 v224, v[180:183] offset:5120
ds_write_b128 v224, v[184:187] offset:6144
ds_write_b128 v224, v[188:191] offset:7168
s_waitcnt lgkmcnt(0)
s_barrier
ds_read_b128 v[192:195], v15 offset:0
ds_read_b128 v[196:199], v15 offset:8192
ds_read_b128 v[200:203], v15 offset:16384
ds_read_b128 v[204:207], v15 offset:24576
ds_read_b128 v[208:211], v15 offset:1024
ds_read_b128 v[212:215], v15 offset:9216
ds_read_b128 v[216:219], v15 offset:17408
ds_read_b128 v[220:223], v15 offset:25600
s_waitcnt lgkmcnt(0)
v_pk_add_f32 v[192:193], v[192:193], v[196:197]
v_pk_add_f32 v[194:195], v[194:195], v[198:199]
v_pk_add_f32 v[200:201], v[200:201], v[204:205]
v_pk_add_f32 v[202:203], v[202:203], v[206:207]
v_pk_add_f32 v[192:193], v[192:193], v[200:201]
v_pk_add_f32 v[194:195], v[194:195], v[202:203]
v_pk_add_f32 v[208:209], v[208:209], v[212:213]
v_pk_add_f32 v[210:211], v[210:211], v[214:215]
v_pk_add_f32 v[216:217], v[216:217], v[220:221]
v_pk_add_f32 v[218:219], v[218:219], v[222:223]
v_pk_add_f32 v[208:209], v[208:209], v[216:217]
v_pk_add_f32 v[210:211], v[210:211], v[218:219]
v_cvt_pk_bf16_f32 v40, v192, v193
v_cvt_pk_bf16_f32 v41, v194, v195
v_cvt_pk_bf16_f32 v42, v208, v209
v_cvt_pk_bf16_f32 v43, v210, v211
s_cmp_lt_u32 s3, 2
s_cbranch_scc1 L_rns_22
s_nop 0
v_permlane32_swap_b32 v40, v42
v_permlane32_swap_b32 v41, v43
L_rns_22:
s_waitcnt vmcnt(18)
v_mfma_f32_16x16x32_bf16 v[160:163], a[64:67], a[192:195], 0
v_mfma_f32_16x16x32_bf16 v[176:179], a[192:195], a[128:131], 0
v_mfma_f32_16x16x32_bf16 v[164:167], a[72:75], a[192:195], 0
v_mfma_f32_16x16x32_bf16 v[184:187], a[192:195], a[136:139], 0
v_mfma_f32_16x16x32_bf16 v[168:171], a[64:67], a[196:199], 0
v_mfma_f32_16x16x32_bf16 v[180:183], a[196:199], a[128:131], 0
v_mfma_f32_16x16x32_bf16 v[172:175], a[72:75], a[196:199], 0
v_mfma_f32_16x16x32_bf16 v[188:191], a[196:199], a[136:139], 0
s_add_u32 s49, s49, 131072
s_add_u32 m0, s50, 24576
s_nop 0
buffer_load_dwordx4 v244, s[8:11], s49 offen offset:0 lds
v_mfma_f32_16x16x32_bf16 v[160:163], a[68:71], a[200:203], v[160:163]
v_mfma_f32_16x16x32_bf16 v[176:179], a[200:203], a[132:135], v[176:179]
v_mfma_f32_16x16x32_bf16 v[164:167], a[76:79], a[200:203], v[164:167]
v_mfma_f32_16x16x32_bf16 v[184:187], a[200:203], a[140:143], v[184:187]
v_mfma_f32_16x16x32_bf16 v[168:171], a[68:71], a[204:207], v[168:171]
v_mfma_f32_16x16x32_bf16 v[180:183], a[204:207], a[132:135], v[180:183]
v_mfma_f32_16x16x32_bf16 v[172:175], a[76:79], a[204:207], v[172:175]
v_mfma_f32_16x16x32_bf16 v[188:191], a[204:207], a[140:143], v[188:191]
buffer_load_dwordx4 v245, s[8:11], s49 offen offset:1024 lds
v_mfma_f32_16x16x32_bf16 v[160:163], a[80:83], a[208:211], v[160:163]
v_mfma_f32_16x16x32_bf16 v[176:179], a[208:211], a[144:147], v[176:179]
v_mfma_f32_16x16x32_bf16 v[164:167], a[88:91], a[208:211], v[164:167]
v_mfma_f32_16x16x32_bf16 v[184:187], a[208:211], a[152:155], v[184:187]
v_mfma_f32_16x16x32_bf16 v[168:171], a[80:83], a[212:215], v[168:171]
v_mfma_f32_16x16x32_bf16 v[180:183], a[212:215], a[144:147], v[180:183]
v_mfma_f32_16x16x32_bf16 v[172:175], a[88:91], a[212:215], v[172:175]
v_mfma_f32_16x16x32_bf16 v[188:191], a[212:215], a[152:155], v[188:191]
buffer_load_dwordx4 v246, s[8:11], s49 offen offset:2048 lds
v_mfma_f32_16x16x32_bf16 v[160:163], a[84:87], a[216:219], v[160:163]
v_mfma_f32_16x16x32_bf16 v[176:179], a[216:219], a[148:151], v[176:179]
v_mfma_f32_16x16x32_bf16 v[164:167], a[92:95], a[216:219], v[164:167]
v_mfma_f32_16x16x32_bf16 v[184:187], a[216:219], a[156:159], v[184:187]
v_mfma_f32_16x16x32_bf16 v[168:171], a[84:87], a[220:223], v[168:171]
v_mfma_f32_16x16x32_bf16 v[180:183], a[220:223], a[148:151], v[180:183]
v_mfma_f32_16x16x32_bf16 v[172:175], a[92:95], a[220:223], v[172:175]
v_mfma_f32_16x16x32_bf16 v[188:191], a[220:223], a[156:159], v[188:191]
buffer_load_dwordx4 v247, s[8:11], s49 offen offset:3072 lds
v_mfma_f32_16x16x32_bf16 v[160:163], a[96:99], a[224:227], v[160:163]
v_mfma_f32_16x16x32_bf16 v[176:179], a[224:227], a[160:163], v[176:179]
v_mfma_f32_16x16x32_bf16 v[164:167], a[104:107], a[224:227], v[164:167]
v_mfma_f32_16x16x32_bf16 v[184:187], a[224:227], a[168:171], v[184:187]
v_mfma_f32_16x16x32_bf16 v[168:171], a[96:99], a[228:231], v[168:171]
v_mfma_f32_16x16x32_bf16 v[180:183], a[228:231], a[160:163], v[180:183]
v_mfma_f32_16x16x32_bf16 v[172:175], a[104:107], a[228:231], v[172:175]
v_mfma_f32_16x16x32_bf16 v[188:191], a[228:231], a[168:171], v[188:191]
s_add_u32 s49, s49, 131072
s_add_u32 m0, s50, 28672
s_nop 0
buffer_load_dwordx4 v244, s[8:11], s49 offen offset:0 lds
v_mfma_f32_16x16x32_bf16 v[160:163], a[100:103], a[232:235], v[160:163]
v_mfma_f32_16x16x32_bf16 v[176:179], a[232:235], a[164:167], v[176:179]
v_mfma_f32_16x16x32_bf16 v[164:167], a[108:111], a[232:235], v[164:167]
v_mfma_f32_16x16x32_bf16 v[184:187], a[232:235], a[172:175], v[184:187]
v_mfma_f32_16x16x32_bf16 v[168:171], a[100:103], a[236:239], v[168:171]
v_mfma_f32_16x16x32_bf16 v[180:183], a[236:239], a[164:167], v[180:183]
v_mfma_f32_16x16x32_bf16 v[172:175], a[108:111], a[236:239], v[172:175]
v_mfma_f32_16x16x32_bf16 v[188:191], a[236:239], a[172:175], v[188:191]
buffer_load_dwordx4 v245, s[8:11], s49 offen offset:1024 lds
v_mfma_f32_16x16x32_bf16 v[160:163], a[112:115], a[240:243], v[160:163]
v_mfma_f32_16x16x32_bf16 v[176:179], a[240:243], a[176:179], v[176:179]
v_mfma_f32_16x16x32_bf16 v[164:167], a[120:123], a[240:243], v[164:167]
v_mfma_f32_16x16x32_bf16 v[184:187], a[240:243], a[184:187], v[184:187]
v_mfma_f32_16x16x32_bf16 v[168:171], a[112:115], a[244:247], v[168:171]
v_mfma_f32_16x16x32_bf16 v[180:183], a[244:247], a[176:179], v[180:183]
v_mfma_f32_16x16x32_bf16 v[172:175], a[120:123], a[244:247], v[172:175]
v_mfma_f32_16x16x32_bf16 v[188:191], a[244:247], a[184:187], v[188:191]
buffer_load_dwordx4 v246, s[8:11], s49 offen offset:2048 lds
v_mfma_f32_16x16x32_bf16 v[160:163], a[116:119], a[248:251], v[160:163]
v_mfma_f32_16x16x32_bf16 v[176:179], a[248:251], a[180:183], v[176:179]
v_mfma_f32_16x16x32_bf16 v[164:167], a[124:127], a[248:251], v[164:167]
v_mfma_f32_16x16x32_bf16 v[184:187], a[248:251], a[188:191], v[184:187]
v_mfma_f32_16x16x32_bf16 v[168:171], a[116:119], a[252:255], v[168:171]
v_mfma_f32_16x16x32_bf16 v[180:183], a[252:255], a[180:183], v[180:183]
v_mfma_f32_16x16x32_bf16 v[172:175], a[124:127], a[252:255], v[172:175]
v_mfma_f32_16x16x32_bf16 v[188:191], a[252:255], a[188:191], v[188:191]
buffer_load_dwordx4 v247, s[8:11], s49 offen offset:3072 lds
s_barrier
s_nop 7
ds_write_b128 v224, v[160:163] offset:0
ds_write_b128 v224, v[164:167] offset:1024
ds_write_b128 v224, v[168:171] offset:2048
ds_write_b128 v224, v[172:175] offset:3072
ds_write_b128 v224, v[176:179] offset:4096
ds_write_b128 v224, v[180:183] offset:5120
ds_write_b128 v224, v[184:187] offset:6144
ds_write_b128 v224, v[188:191] offset:7168
s_waitcnt lgkmcnt(0)
s_barrier
ds_read_b128 v[192:195], v15 offset:0
ds_read_b128 v[196:199], v15 offset:8192
ds_read_b128 v[200:203], v15 offset:16384
ds_read_b128 v[204:207], v15 offset:24576
ds_read_b128 v[208:211], v15 offset:1024
ds_read_b128 v[212:215], v15 offset:9216
ds_read_b128 v[216:219], v15 offset:17408
ds_read_b128 v[220:223], v15 offset:25600
s_waitcnt lgkmcnt(0)
v_pk_add_f32 v[192:193], v[192:193], v[196:197]
v_pk_add_f32 v[194:195], v[194:195], v[198:199]
v_pk_add_f32 v[200:201], v[200:201], v[204:205]
v_pk_add_f32 v[202:203], v[202:203], v[206:207]
v_pk_add_f32 v[192:193], v[192:193], v[200:201]
v_pk_add_f32 v[194:195], v[194:195], v[202:203]
v_pk_add_f32 v[208:209], v[208:209], v[212:213]
v_pk_add_f32 v[210:211], v[210:211], v[214:215]
v_pk_add_f32 v[216:217], v[216:217], v[220:221]
v_pk_add_f32 v[218:219], v[218:219], v[222:223]
v_pk_add_f32 v[208:209], v[208:209], v[216:217]
v_pk_add_f32 v[210:211], v[210:211], v[218:219]
v_cvt_pk_bf16_f32 v44, v192, v193
v_cvt_pk_bf16_f32 v45, v194, v195
v_cvt_pk_bf16_f32 v46, v208, v209
v_cvt_pk_bf16_f32 v47, v210, v211
s_cmp_lt_u32 s3, 2
s_cbranch_scc1 L_rns_23
s_nop 0
v_permlane32_swap_b32 v44, v46
v_permlane32_swap_b32 v45, v47
L_rns_23:
buffer_store_dwordx4 v[40:43], v14, s[4:7], s53 offen sc1
s_add_u32 s53, s53, 262144
buffer_store_dwordx4 v[44:47], v14, s[4:7], s53 offen sc1
s_add_u32 s53, s53, 262144
s_waitcnt vmcnt(18)
s_barrier
s_cmp_lg_u32 s3, 1
s_cbranch_scc1 L_sk1_24
s_add_u32 s56, s63, 64
s_lshl_b32 s74, s56, 8
s_add_u32 s74, s74, 98566144
v_mov_b32 v226, 0
v_mov_b32 v227, 1
s_mov_b64 exec, 1
buffer_atomic_add v227, v226, s[4:7], s74 offen sc1
s_mov_b64 exec, -1
L_sk1_24:
s_waitcnt vmcnt(16)
ds_read_b64_tr_b16 v[64:65], v248 offset:0
ds_read_b64_tr_b16 v[66:67], v236 offset:512
ds_read_b64_tr_b16 v[68:69], v248 offset:2048
ds_read_b64_tr_b16 v[70:71], v236 offset:2560
ds_read_b64_tr_b16 v[72:73], v249 offset:0
ds_read_b64_tr_b16 v[74:75], v237 offset:512
ds_read_b64_tr_b16 v[76:77], v249 offset:2048
ds_read_b64_tr_b16 v[78:79], v237 offset:2560
ds_read_b64_tr_b16 v[80:81], v248 offset:4096
ds_read_b64_tr_b16 v[82:83], v236 offset:4608
ds_read_b64_tr_b16 v[84:85], v248 offset:6144
ds_read_b64_tr_b16 v[86:87], v236 offset:6656
ds_read_b64_tr_b16 v[88:89], v249 offset:4096
ds_read_b64_tr_b16 v[90:91], v237 offset:4608
ds_read_b64_tr_b16 v[92:93], v249 offset:6144
ds_read_b64_tr_b16 v[94:95], v237 offset:6656
s_waitcnt lgkmcnt(0)
v_accvgpr_write_b32 a0, v64
v_accvgpr_write_b32 a1, v66
v_accvgpr_write_b32 a2, v65
v_accvgpr_write_b32 a3, v67
v_accvgpr_write_b32 a4, v68
v_accvgpr_write_b32 a5, v70
v_accvgpr_write_b32 a6, v69
v_accvgpr_write_b32 a7, v71
v_accvgpr_write_b32 a8, v72
v_accvgpr_write_b32 a9, v74
v_accvgpr_write_b32 a10, v73
v_accvgpr_write_b32 a11, v75
v_accvgpr_write_b32 a12, v76
v_accvgpr_write_b32 a13, v78
v_accvgpr_write_b32 a14, v77
v_accvgpr_write_b32 a15, v79
v_accvgpr_write_b32 a16, v80
v_accvgpr_write_b32 a17, v82
v_accvgpr_write_b32 a18, v81
v_accvgpr_write_b32 a19, v83
v_accvgpr_write_b32 a20, v84
v_accvgpr_write_b32 a21, v86
v_accvgpr_write_b32 a22, v85
v_accvgpr_write_b32 a23, v87
v_accvgpr_write_b32 a24, v88
v_accvgpr_write_b32 a25, v90
v_accvgpr_write_b32 a26, v89
v_accvgpr_write_b32 a27, v91
v_accvgpr_write_b32 a28, v92
v_accvgpr_write_b32 a29, v94
v_accvgpr_write_b32 a30, v93
v_accvgpr_write_b32 a31, v95
ds_read_b64_tr_b16 v[64:65], v248 offset:8192
ds_read_b64_tr_b16 v[66:67], v236 offset:8704
ds_read_b64_tr_b16 v[68:69], v248 offset:10240
ds_read_b64_tr_b16 v[70:71], v236 offset:10752
ds_read_b64_tr_b16 v[72:73], v249 offset:8192
ds_read_b64_tr_b16 v[74:75], v237 offset:8704
ds_read_b64_tr_b16 v[76:77], v249 offset:10240
ds_read_b64_tr_b16 v[78:79], v237 offset:10752
ds_read_b64_tr_b16 v[80:81], v248 offset:12288
ds_read_b64_tr_b16 v[82:83], v236 offset:12800
ds_read_b64_tr_b16 v[84:85], v248 offset:14336
ds_read_b64_tr_b16 v[86:87], v236 offset:14848
ds_read_b64_tr_b16 v[88:89], v249 offset:12288
ds_read_b64_tr_b16 v[90:91], v237 offset:12800
ds_read_b64_tr_b16 v[92:93], v249 offset:14336
ds_read_b64_tr_b16 v[94:95], v237 offset:14848
s_waitcnt lgkmcnt(0)
v_accvgpr_write_b32 a32, v64
v_accvgpr_write_b32 a33, v66
v_accvgpr_write_b32 a34, v65
v_accvgpr_write_b32 a35, v67
v_accvgpr_write_b32 a36, v68
v_accvgpr_write_b32 a37, v70
v_accvgpr_write_b32 a38, v69
v_accvgpr_write_b32 a39, v71
v_accvgpr_write_b32 a40, v72
v_accvgpr_write_b32 a41, v74
v_accvgpr_write_b32 a42, v73
v_accvgpr_write_b32 a43, v75
v_accvgpr_write_b32 a44, v76
v_accvgpr_write_b32 a45, v78
v_accvgpr_write_b32 a46, v77
v_accvgpr_write_b32 a47, v79
v_accvgpr_write_b32 a48, v80
v_accvgpr_write_b32 a49, v82
v_accvgpr_write_b32 a50, v81
v_accvgpr_write_b32 a51, v83
v_accvgpr_write_b32 a52, v84
v_accvgpr_write_b32 a53, v86
v_accvgpr_write_b32 a54, v85
v_accvgpr_write_b32 a55, v87
v_accvgpr_write_b32 a56, v88
v_accvgpr_write_b32 a57, v90
v_accvgpr_write_b32 a58, v89
v_accvgpr_write_b32 a59, v91
v_accvgpr_write_b32 a60, v92
v_accvgpr_write_b32 a61, v94
v_accvgpr_write_b32 a62, v93
v_accvgpr_write_b32 a63, v95
s_waitcnt vmcnt(2)
ds_read_b64_tr_b16 v[64:65], v250 offset:16384
ds_read_b64_tr_b16 v[66:67], v238 offset:16896
ds_read_b64_tr_b16 v[68:69], v250 offset:18432
ds_read_b64_tr_b16 v[70:71], v238 offset:18944
ds_read_b64_tr_b16 v[72:73], v251 offset:16384
ds_read_b64_tr_b16 v[74:75], v239 offset:16896
ds_read_b64_tr_b16 v[76:77], v251 offset:18432
ds_read_b64_tr_b16 v[78:79], v239 offset:18944
ds_read_b64_tr_b16 v[80:81], v250 offset:20480
ds_read_b64_tr_b16 v[82:83], v238 offset:20992
ds_read_b64_tr_b16 v[84:85], v250 offset:22528
ds_read_b64_tr_b16 v[86:87], v238 offset:23040
ds_read_b64_tr_b16 v[88:89], v251 offset:20480
ds_read_b64_tr_b16 v[90:91], v239 offset:20992
ds_read_b64_tr_b16 v[92:93], v251 offset:22528
ds_read_b64_tr_b16 v[94:95], v239 offset:23040
s_waitcnt lgkmcnt(0)
v_accvgpr_write_b32 a192, v64
v_accvgpr_write_b32 a193, v66
v_accvgpr_write_b32 a194, v65
v_accvgpr_write_b32 a195, v67
v_accvgpr_write_b32 a196, v68
v_accvgpr_write_b32 a197, v70
v_accvgpr_write_b32 a198, v69
v_accvgpr_write_b32 a199, v71
v_accvgpr_write_b32 a200, v72
v_accvgpr_write_b32 a201, v74
v_accvgpr_write_b32 a202, v73
v_accvgpr_write_b32 a203, v75
v_accvgpr_write_b32 a204, v76
v_accvgpr_write_b32 a205, v78
v_accvgpr_write_b32 a206, v77
v_accvgpr_write_b32 a207, v79
v_accvgpr_write_b32 a208, v80
v_accvgpr_write_b32 a209, v82
v_accvgpr_write_b32 a210, v81
v_accvgpr_write_b32 a211, v83
v_accvgpr_write_b32 a212, v84
v_accvgpr_write_b32 a213, v86
v_accvgpr_write_b32 a214, v85
v_accvgpr_write_b32 a215, v87
v_accvgpr_write_b32 a216, v88
v_accvgpr_write_b32 a217, v90
v_accvgpr_write_b32 a218, v89
v_accvgpr_write_b32 a219, v91
v_accvgpr_write_b32 a220, v92
v_accvgpr_write_b32 a221, v94
v_accvgpr_write_b32 a222, v93
v_accvgpr_write_b32 a223, v95
ds_read_b64_tr_b16 v[64:65], v250 offset:24576
ds_read_b64_tr_b16 v[66:67], v238 offset:25088
ds_read_b64_tr_b16 v[68:69], v250 offset:26624
ds_read_b64_tr_b16 v[70:71], v238 offset:27136
ds_read_b64_tr_b16 v[72:73], v251 offset:24576
ds_read_b64_tr_b16 v[74:75], v239 offset:25088
ds_read_b64_tr_b16 v[76:77], v251 offset:26624
ds_read_b64_tr_b16 v[78:79], v239 offset:27136
ds_read_b64_tr_b16 v[80:81], v250 offset:28672
ds_read_b64_tr_b16 v[82:83], v238 offset:29184
ds_read_b64_tr_b16 v[84:85], v250 offset:30720
ds_read_b64_tr_b16 v[86:87], v238 offset:31232
ds_read_b64_tr_b16 v[88:89], v251 offset:28672
ds_read_b64_tr_b16 v[90:91], v239 offset:29184
ds_read_b64_tr_b16 v[92:93], v251 offset:30720
ds_read_b64_tr_b16 v[94:95], v239 offset:31232
s_waitcnt lgkmcnt(0)
v_accvgpr_write_b32 a224, v64
v_accvgpr_write_b32 a225, v66
v_accvgpr_write_b32 a226, v65
v_accvgpr_write_b32 a227, v67
v_accvgpr_write_b32 a228, v68
v_accvgpr_write_b32 a229, v70
v_accvgpr_write_b32 a230, v69
v_accvgpr_write_b32 a231, v71
v_accvgpr_write_b32 a232, v72
v_accvgpr_write_b32 a233, v74
v_accvgpr_write_b32 a234, v73
v_accvgpr_write_b32 a235, v75
v_accvgpr_write_b32 a236, v76
v_accvgpr_write_b32 a237, v78
v_accvgpr_write_b32 a238, v77
v_accvgpr_write_b32 a239, v79
v_accvgpr_write_b32 a240, v80
v_accvgpr_write_b32 a241, v82
v_accvgpr_write_b32 a242, v81
v_accvgpr_write_b32 a243, v83
v_accvgpr_write_b32 a244, v84
v_accvgpr_write_b32 a245, v86
v_accvgpr_write_b32 a246, v85
v_accvgpr_write_b32 a247, v87
v_accvgpr_write_b32 a248, v88
v_accvgpr_write_b32 a249, v90
v_accvgpr_write_b32 a250, v89
v_accvgpr_write_b32 a251, v91
v_accvgpr_write_b32 a252, v92
v_accvgpr_write_b32 a253, v94
v_accvgpr_write_b32 a254, v93
v_accvgpr_write_b32 a255, v95
s_waitcnt vmcnt(0)
s_barrier
s_cmp_lg_u32 s3, 1
s_cbranch_scc1 L_sk1_25
s_add_u32 s56, s63, 64
s_lshl_b32 s74, s56, 8
s_add_u32 s74, s74, 98566144
v_mov_b32 v226, 0
v_mov_b32 v227, 256
s_mov_b64 exec, 1
buffer_atomic_add v227, v226, s[4:7], s74 offen sc1
s_mov_b64 exec, -1
L_sk1_25:
s_mov_b32 s48, 0
s_and_b32 s74, s48, 3
s_lshl_b32 s75, s74, 14
s_lshl_b32 s76, s3, 12
s_andn2_b32 s49, s65, 0x3fff
s_add_u32 s49, s49, s75
s_add_u32 s49, s49, s76
s_add_u32 s54, s67, s75
s_andn2_b32 s55, s54, 0x3fff
s_add_u32 s55, s55, s76
s_lshl_b32 s75, s74, 15
s_add_u32 s50, s66, s75
s_xor_b32 s51, s50, 1024
s_xor_b32 s52, s50, 2048
s_xor_b32 s53, s50, 3072
s_add_u32 s77, s48, 2
s_and_b32 s77, s77, 3
s_and_b32 s78, s48, 1
s_mul_i32 s78, s78, 10240
v_mov_b32 v186, 0
v_and_b32 v187, 3, v0
v_lshlrev_b32 v187, 8, v187
s_mov_b32 s55, 98580480
s_cmp_lg_u32 s3, 0
s_cbranch_scc1 L_warrok_27
s_add_u32 s52, s63, 64
s_mov_b32 s53, 4
s_lshl_b32 s74, s52, 8
s_add_u32 s74, s74, 98566144
v_mov_b32 v184, 0
L_pc_28:
buffer_load_dword v185, v184, s[4:7], s74 offen sc1
s_waitcnt vmcnt(0)
v_readfirstlane_b32 s75, v185
s_and_b32 s75, s75, 255
s_cmp_ge_u32 s75, s53
s_cbranch_scc1 L_pcok_29
s_sleep 2
s_sub_u32 s73, s73, 1
s_cmp_lg_u32 s73, 0
s_cbranch_scc1 L_pc_28
s_branch L_chexit_2
L_pcok_29:
L_warr_26:
buffer_load_dword v188, v187, s[4:7], s55 offen sc1
global_load_dwordx2 v[190:191], v186, s[44:45] offset:24 sc1
s_waitcnt vmcnt(0)
v_min_u32 v189, v190, v191
v_and_b32 v188, 63, v188
v_cmp_ne_u32 vcc, 32, v188
v_readfirstlane_b32 s53, v189
s_cmp_eq_u32 s53, 0
s_cselect_b32 s52, 1, vcc_lo
s_cmp_eq_u32 s52, 0
s_cbranch_scc1 L_warrok_27
s_sleep 2
s_sub_u32 s73, s73, 1
s_cmp_lg_u32 s73, 0
s_cbranch_scc1 L_warr_26
s_branch L_chexit_2
L_warrok_27:
s_barrier
s_lshl_b32 s52, s61, 2
s_add_u32 s52, s52, s3
v_and_b32 v192, 3, v0
v_lshlrev_b32 v192, 7, v192
s_lshl_b32 s53, s52, 9
s_lshl_b32 s54, s60, 16
s_add_u32 s53, s53, s54
s_mov_b64 exec, 15
s_add_u32 s54, s53, 94371840
buffer_load_dword v193, v192, s[4:7], s54 offen sc1
s_add_u32 s54, s53, 95158272
buffer_load_dword v193, v192, s[4:7], s54 offen sc1
s_lshl_b32 s53, s53, 1
s_add_u32 s54, s53, 94633984
buffer_load_dword v193, v192, s[4:7], s54 offen sc1
s_add_u32 s54, s53, 94634496
buffer_load_dword v193, v192, s[4:7], s54 offen sc1
s_mov_b64 exec, -1
s_cmp_eq_u32 s3, 1
s_cbranch_scc1 L_pw_31
s_cmp_eq_u32 s3, 2
s_cbranch_scc1 L_pw_32
s_cmp_eq_u32 s3, 3
s_cbranch_scc1 L_pw_33
L_pw_30:
s_branch L_pwd_34
L_pw_31:
s_branch L_pwd_34
L_pw_32:
s_xor_b32 s74, s62, 0
s_lshl_b32 s74, s74, 11
s_add_u32 s74, s74, s69
s_add_u32 m0, s78, 20480
s_nop 0
buffer_load_dwordx4 v1, s[4:7], s74 offen offset:0 sc1 lds
buffer_load_dwordx4 v1, s[4:7], s74 offen offset:1024 sc1 lds
s_xor_b32 s74, s62, 1
s_lshl_b32 s74, s74, 11
s_add_u32 s74, s74, s69
s_add_u32 m0, s78, 22528
s_nop 0
buffer_load_dwordx4 v1, s[4:7], s74 offen offset:0 sc1 lds
buffer_load_dwordx4 v1, s[4:7], s74 offen offset:1024 sc1 lds
s_xor_b32 s74, s62, 2
s_lshl_b32 s74, s74, 11
s_add_u32 s74, s74, s69
s_add_u32 m0, s78, 24576
s_nop 0
buffer_load_dwordx4 v1, s[4:7], s74 offen offset:0 sc1 lds
buffer_load_dwordx4 v1, s[4:7], s74 offen offset:1024 sc1 lds
s_xor_b32 s74, s62, 3
s_lshl_b32 s74, s74, 11
s_add_u32 s74, s74, s69
s_add_u32 m0, s78, 26624
s_nop 0
buffer_load_dwordx4 v1, s[4:7], s74 offen offset:0 sc1 lds
buffer_load_dwordx4 v1, s[4:7], s74 offen offset:1024 sc1 lds
s_add_u32 s69, s69, 262144
s_mov_b32 s52, 10240
s_xor_b32 s74, s62, 0
s_lshl_b32 s74, s74, 11
s_add_u32 s74, s74, s69
s_add_u32 m0, s52, 20480
s_nop 0
buffer_load_dwordx4 v1, s[4:7], s74 offen offset:0 sc1 lds
buffer_load_dwordx4 v1, s[4:7], s74 offen offset:1024 sc1 lds
s_xor_b32 s74, s62, 1
s_lshl_b32 s74, s74, 11
s_add_u32 s74, s74, s69
s_add_u32 m0, s52, 22528
s_nop 0
buffer_load_dwordx4 v1, s[4:7], s74 offen offset:0 sc1 lds
buffer_load_dwordx4 v1, s[4:7], s74 offen offset:1024 sc1 lds
s_xor_b32 s74, s62, 2
s_lshl_b32 s74, s74, 11
s_add_u32 s74, s74, s69
s_add_u32 m0, s52, 24576
s_nop 0
buffer_load_dwordx4 v1, s[4:7], s74 offen offset:0 sc1 lds
buffer_load_dwordx4 v1, s[4:7], s74 offen offset:1024 sc1 lds
s_xor_b32 s74, s62, 3
s_lshl_b32 s74, s74, 11
s_add_u32 s74, s74, s69
s_add_u32 m0, s52, 26624
s_nop 0
buffer_load_dwordx4 v1, s[4:7], s74 offen offset:0 sc1 lds
buffer_load_dwordx4 v1, s[4:7], s74 offen offset:1024 sc1 lds
s_add_u32 s69, s69, 262144
s_branch L_pwd_34
L_pw_33:
s_add_u32 m0, s78, 28672
s_nop 0
buffer_load_dwordx4 v1, s[4:7], s70 offen offset:0 sc1 lds
buffer_load_dwordx4 v1, s[4:7], s70 offen offset:1024 sc1 lds
s_add_u32 s70, s70, 262144
s_mov_b32 s52, 10240
s_add_u32 m0, s52, 28672
s_nop 0
buffer_load_dwordx4 v1, s[4:7], s70 offen offset:0 sc1 lds
buffer_load_dwordx4 v1, s[4:7], s70 offen offset:1024 sc1 lds
s_add_u32 s70, s70, 262144
L_pwd_34:
global_load_dwordx2 v[184:185], v186, s[44:45] offset:24 sc1
s_lshl_b32 s54, s60, 8
s_add_u32 s54, s54, 98580480
buffer_load_dword v188, v186, s[4:7], s54 offen sc1
s_waitcnt vmcnt(0)
v_readfirstlane_b32 s52, v184
v_readfirstlane_b32 s53, v185
v_readfirstlane_b32 s54, v188
s_cmp_lt_u32 s53, s52
s_cselect_b32 s52, 8192, 0
s_add_u32 s68, s68, s52
s_bfe_u32 s52, s54, 0x80008
s_mul_i32 s52, s52, s52
s_lshr_b32 s54, s54, 16
s_lshl_b32 s54, s54, 5
s_cmp_eq_u32 s52, s54
s_cselect_b32 s8, 1, 0
s_and_b32 s74, s48, 3
s_lshl_b32 s75, s74, 14
s_lshl_b32 s76, s3, 12
s_andn2_b32 s49, s65, 0x3fff
s_add_u32 s49, s49, s75
s_add_u32 s49, s49, s76
s_add_u32 s54, s67, s75
s_andn2_b32 s55, s54, 0x3fff
s_add_u32 s55, s55, s76
s_lshl_b32 s75, s74, 15
s_add_u32 s50, s66, s75
s_xor_b32 s51, s50, 1024
s_xor_b32 s52, s50, 2048
s_xor_b32 s53, s50, 3072
s_add_u32 s77, s48, 2
s_and_b32 s77, s77, 3
s_and_b32 s78, s48, 1
s_mul_i32 s78, s78, 10240
v_mov_b32 v48, 0
v_mov_b32 v49, 0
v_mov_b32 v50, 0
v_mov_b32 v51, 0
v_mov_b32 v52, 0
v_mov_b32 v53, 0
v_mov_b32 v54, 0
v_mov_b32 v55, 0
v_mov_b32 v56, 0
v_mov_b32 v57, 0
v_mov_b32 v58, 0
v_mov_b32 v59, 0
v_mov_b32 v60, 0
v_mov_b32 v61, 0
v_mov_b32 v62, 0
v_mov_b32 v63, 0
v_mov_b32 v64, 0
v_mov_b32 v65, 0
v_mov_b32 v66, 0
v_mov_b32 v67, 0
v_mov_b32 v68, 0
v_mov_b32 v69, 0
v_mov_b32 v70, 0
v_mov_b32 v71, 0
s_barrier
s_mov_b32 s90, 0
s_mov_b32 s96, 0
s_cmp_lg_u32 s8, 1
s_cbranch_scc1 L_slow_35
L_loop_37:
s_sleep 2
s_nop 7
buffer_load_dwordx4 v[32:35], v1, s[4:7], s49 offen offset:0 sc1
buffer_load_dwordx4 v[36:39], v1, s[4:7], s49 offen offset:1024 sc1
buffer_load_dwordx4 v[40:43], v1, s[4:7], s49 offen offset:2048 sc1
buffer_load_dwordx4 v[44:47], v1, s[4:7], s49 offen offset:3072 sc1
s_cmp_ge_u32 s3, 2
s_cbranch_scc1 L_nokx_38
v_add_u32 v184, s78, v5
v_add_u32 v185, s78, v6
ds_read_b128 v[120:123], v184 offset:20480
ds_read_b128 v[124:127], v184 offset:20608
ds_read_b128 v[128:131], v184 offset:22528
ds_read_b128 v[132:135], v184 offset:22656
ds_read_b128 v[136:139], v184 offset:24576
ds_read_b128 v[140:143], v184 offset:24704
ds_read_b128 v[144:147], v184 offset:26624
ds_read_b128 v[148:151], v184 offset:26752
ds_read_b128 v[152:155], v185 offset:28672
L_nokx_38:
s_waitcnt vmcnt(3)
L_gc_39:
v_max_u32 v199, v32, v34
v_cmp_eq_u32 vcc, -1, v199
s_cbranch_vccnz L_gs_40
L_gp_41:
v_smfmac_f32_16x16x64_bf16 v[48:51], v[32:35], a[0:7], v2
v_smfmac_f32_16x16x64_bf16 v[52:55], v[32:35], a[64:71], v2
v_smfmac_f32_16x16x64_bf16 v[56:59], v[32:35], a[8:15], v2
v_smfmac_f32_16x16x64_bf16 v[60:63], v[32:35], a[72:79], v2
s_waitcnt vmcnt(2)
L_gc_42:
v_max_u32 v199, v36, v38
v_cmp_eq_u32 vcc, -1, v199
s_cbranch_vccnz L_gs_43
L_gp_44:
v_smfmac_f32_16x16x64_bf16 v[48:51], v[36:39], a[16:23], v2
v_smfmac_f32_16x16x64_bf16 v[52:55], v[36:39], a[80:87], v2
v_smfmac_f32_16x16x64_bf16 v[56:59], v[36:39], a[24:31], v2
v_smfmac_f32_16x16x64_bf16 v[60:63], v[36:39], a[88:95], v2
s_waitcnt vmcnt(1)
L_gc_45:
v_max_u32 v199, v40, v42
v_cmp_eq_u32 vcc, -1, v199
s_cbranch_vccnz L_gs_46
L_gp_47:
v_smfmac_f32_16x16x64_bf16 v[48:51], v[40:43], a[32:39], v2
v_smfmac_f32_16x16x64_bf16 v[52:55], v[40:43], a[96:103], v2
v_smfmac_f32_16x16x64_bf16 v[56:59], v[40:43], a[40:47], v2
v_smfmac_f32_16x16x64_bf16 v[60:63], v[40:43], a[104:111], v2
s_waitcnt vmcnt(0)
L_gc_48:
v_max_u32 v199, v44, v46
v_cmp_eq_u32 vcc, -1, v199
s_cbranch_vccnz L_gs_49
L_gp_50:
v_smfmac_f32_16x16x64_bf16 v[48:51], v[44:47], a[48:55], v2
v_smfmac_f32_16x16x64_bf16 v[52:55], v[44:47], a[112:119], v2
v_smfmac_f32_16x16x64_bf16 v[56:59], v[44:47], a[56:63], v2
v_smfmac_f32_16x16x64_bf16 v[60:63], v[44:47], a[120:127], v2
s_nop 5
v_permlane32_swap_b32 v48, v52
v_permlane32_swap_b32 v49, v53
v_permlane32_swap_b32 v50, v54
v_permlane32_swap_b32 v51, v55
v_pk_add_f32 v[48:49], v[48:49], v[52:53]
v_pk_add_f32 v[50:51], v[50:51], v[54:55]
ds_write_b128 v4, v[48:51] offset:0
v_permlane32_swap_b32 v56, v60
v_permlane32_swap_b32 v57, v61
v_permlane32_swap_b32 v58, v62
v_permlane32_swap_b32 v59, v63
v_pk_add_f32 v[56:57], v[56:57], v[60:61]
v_pk_add_f32 v[58:59], v[58:59], v[62:63]
ds_write_b128 v4, v[56:59] offset:1024
v_smfmac_f32_16x16x64_bf16 v[64:67], v[32:35], a[128:135], v2
v_smfmac_f32_16x16x64_bf16 v[68:71], v[32:35], a[136:143], v2
s_cmp_ge_u32 s3, 2
s_waitcnt lgkmcnt(0)
s_barrier
s_memtime s[90:91]
s_cbranch_scc1 L_b23_51
ds_read_b128 v[72:75], v1 offset:0
ds_read_b128 v[76:79], v1 offset:2048
ds_read_b128 v[80:83], v1 offset:4096
ds_read_b128 v[84:87], v1 offset:6144
ds_read_b128 v[88:91], v1 offset:1024
ds_read_b128 v[92:95], v1 offset:3072
ds_read_b128 v[96:99], v1 offset:5120
ds_read_b128 v[100:103], v1 offset:7168
v_smfmac_f32_16x16x64_bf16 v[64:67], v[36:39], a[144:151], v2
v_smfmac_f32_16x16x64_bf16 v[68:71], v[36:39], a[152:159], v2
v_smfmac_f32_16x16x64_bf16 v[64:67], v[40:43], a[160:167], v2
v_smfmac_f32_16x16x64_bf16 v[68:71], v[40:43], a[168:175], v2
s_waitcnt lgkmcnt(6)
v_pk_add_f32 v[72:73], v[72:73], v[76:77]
v_pk_add_f32 v[74:75], v[74:75], v[78:79]
s_waitcnt lgkmcnt(4)
v_pk_add_f32 v[80:81], v[80:81], v[84:85]
v_pk_add_f32 v[82:83], v[82:83], v[86:87]
v_pk_add_f32 v[72:73], v[72:73], v[80:81]
v_pk_add_f32 v[74:75], v[74:75], v[82:83]
v_cvt_pk_bf16_f32 v184, v72, v73
v_cvt_pk_bf16_f32 v185, v74, v75
s_waitcnt lgkmcnt(2)
v_pk_add_f32 v[88:89], v[88:89], v[92:93]
v_pk_add_f32 v[90:91], v[90:91], v[94:95]
s_waitcnt lgkmcnt(0)
v_pk_add_f32 v[96:97], v[96:97], v[100:101]
v_pk_add_f32 v[98:99], v[98:99], v[102:103]
v_pk_add_f32 v[88:89], v[88:89], v[96:97]
v_pk_add_f32 v[90:91], v[90:91], v[98:99]
v_cvt_pk_bf16_f32 v186, v88, v89
v_cvt_pk_bf16_f32 v187, v90, v91
s_nop 0
v_mfma_f32_16x16x16_bf16 v[156:159], v[184:185], v[16:17], 0
v_mfma_f32_16x16x16_bf16 v[160:163], v[186:187], v[16:17], 0
v_smfmac_f32_16x16x64_bf16 v[64:67], v[44:47], a[176:183], v2
v_smfmac_f32_16x16x64_bf16 v[68:71], v[44:47], a[184:191], v2
s_nop 4
v_cvt_pk_bf16_f32 v104, v156, v157
v_cvt_pk_bf16_f32 v105, v158, v159
v_cvt_pk_bf16_f32 v106, v160, v161
v_cvt_pk_bf16_f32 v107, v162, v163
s_cmp_eq_u32 s3, 1
s_cbranch_scc1 L_nost_53
buffer_store_dwordx4 v[104:107], v1, s[4:7], s50 offen
ds_write_b128 v1, v[104:107] offset:17408
L_nost_53:
v_mfma_f32_16x16x32_bf16 v[156:159], v[120:123], v[104:107], 0
v_mfma_f32_16x16x32_bf16 v[160:163], v[124:127], v[104:107], 0
v_mfma_f32_16x16x32_bf16 v[164:167], v[104:107], v[104:107], v[20:23]
v_permlane32_swap_b32 v64, v68
v_permlane32_swap_b32 v65, v69
v_permlane32_swap_b32 v66, v70
v_permlane32_swap_b32 v67, v71
v_pk_add_f32 v[64:65], v[64:65], v[68:69]
v_pk_add_f32 v[66:67], v[66:67], v[70:71]
ds_write_b128 v11, v[64:67] offset:8192
s_sleep 2
buffer_load_dwordx4 v[108:111], v1, s[4:7], s51 offen sc1
buffer_load_dwordx4 v[112:115], v1, s[4:7], s52 offen sc1
buffer_load_dwordx4 v[116:119], v1, s[4:7], s53 offen sc1
s_waitcnt lgkmcnt(0)
s_barrier
ds_read_b128 v[72:75], v12 offset:8192
ds_read_b128 v[76:79], v12 offset:9216
ds_read_b128 v[80:83], v12 offset:10240
ds_read_b128 v[84:87], v12 offset:11264
s_and_b32 s74, s48, 3
s_lshl_b32 s75, s74, 16
s_add_u32 s56, s68, s75
s_xor_b32 s57, s56, 262144
s_xor_b32 s58, s56, 524288
s_xor_b32 s59, s56, 786432
s_add_u32 s74, s48, 1
s_and_b32 s74, s74, 3
s_lshl_b32 s75, s74, 14
s_add_u32 s64, s65, s75
s_waitcnt lgkmcnt(0)
v_pk_add_f32 v[72:73], v[72:73], v[76:77]
v_pk_add_f32 v[74:75], v[74:75], v[78:79]
v_pk_add_f32 v[80:81], v[80:81], v[84:85]
v_pk_add_f32 v[82:83], v[82:83], v[86:87]
v_pk_add_f32 v[72:73], v[72:73], v[80:81]
v_pk_add_f32 v[74:75], v[74:75], v[82:83]
v_cvt_pk_bf16_f32 v188, v72, v73
v_cvt_pk_bf16_f32 v189, v74, v75
ds_write_b64 v13, v[188:189] offset:18432
s_cmp_eq_u32 s48, 63
s_cbranch_scc1 L_D_52
s_waitcnt vmcnt(2)
L_gc_54:
v_cmp_eq_u32 vcc, -1, v108
s_cbranch_vccnz L_gs_55
L_gp_56:
v_mfma_f32_16x16x32_bf16 v[164:167], v[108:111], v[108:111], v[164:167]
v_mfma_f32_16x16x32_bf16 v[156:159], v[128:131], v[108:111], v[156:159]
v_mfma_f32_16x16x32_bf16 v[160:163], v[132:135], v[108:111], v[160:163]
s_waitcnt vmcnt(1)
L_gc_57:
v_cmp_eq_u32 vcc, -1, v112
s_cbranch_vccnz L_gs_58
L_gp_59:
v_mfma_f32_16x16x32_bf16 v[164:167], v[112:115], v[112:115], v[164:167]
v_mfma_f32_16x16x32_bf16 v[156:159], v[136:139], v[112:115], v[156:159]
v_mfma_f32_16x16x32_bf16 v[160:163], v[140:143], v[112:115], v[160:163]
s_waitcnt vmcnt(0)
L_gc_60:
v_cmp_eq_u32 vcc, -1, v116
s_cbranch_vccnz L_gs_61
L_gp_62:
v_mfma_f32_16x16x32_bf16 v[164:167], v[116:119], v[116:119], v[164:167]
v_mfma_f32_16x16x32_bf16 v[156:159], v[144:147], v[116:119], v[156:159]
v_mfma_f32_16x16x32_bf16 v[160:163], v[148:151], v[116:119], v[160:163]
s_nop 5
v_max3_f32 v184, v164, v165, v166
v_max3_f32 v185, v167, v156, v157
v_max3_f32 v184, v184, v158, v159
v_max3_f32 v185, v185, v160, v161
v_max3_f32 v184, v184, v162, v163
v_max_f32 v184, v184, v185
v_mov_b32 v185, v184
s_nop 1
v_permlane32_swap_b32 v184, v185
v_max_f32 v184, v184, v185
v_mov_b32 v185, v184
s_nop 1
v_permlane16_swap_b32 v184, v185
v_max_f32 v184, v184, v185
v_mul_f32 v184, s79, v184
v_pk_fma_f32 v[164:165], v[164:165], s[34:35], v[184:185] op_sel_hi:[1,1,0] neg_lo:[0,0,1] neg_hi:[0,0,1]
v_pk_fma_f32 v[166:167], v[166:167], s[34:35], v[184:185] op_sel_hi:[1,1,0] neg_lo:[0,0,1] neg_hi:[0,0,1]
v_pk_fma_f32 v[156:157], v[156:157], s[34:35], v[184:185] op_sel_hi:[1,1,0] neg_lo:[0,0,1] neg_hi:[0,0,1]
v_pk_fma_f32 v[158:159], v[158:159], s[34:35], v[184:185] op_sel_hi:[1,1,0] neg_lo:[0,0,1] neg_hi:[0,0,1]
v_pk_fma_f32 v[160:161], v[160:161], s[34:35], v[184:185] op_sel_hi:[1,1,0] neg_lo:[0,0,1] neg_hi:[0,0,1]
v_pk_fma_f32 v[162:163], v[162:163], s[34:35], v[184:185] op_sel_hi:[1,1,0] neg_lo:[0,0,1] neg_hi:[0,0,1]
v_exp_f32 v164, v164
v_exp_f32 v165, v165
v_exp_f32 v166, v166
v_exp_f32 v167, v167
v_exp_f32 v156, v156
v_cvt_pk_bf16_f32 v172, v164, v165
v_cvt_pk_bf16_f32 v173, v166, v167
v_exp_f32 v157, v157
v_exp_f32 v158, v158
v_mfma_f32_16x16x16_bf16 v[180:183], v[24:25], v[172:173], 0
v_exp_f32 v159, v159
v_mfma_f32_16x16x16_bf16 v[176:179], v[188:189], v[172:173], 0
v_exp_f32 v160, v160
v_exp_f32 v161, v161
v_exp_f32 v162, v162
v_exp_f32 v163, v163
v_cvt_pk_bf16_f32 v168, v156, v157
v_cvt_pk_bf16_f32 v169, v158, v159
v_cvt_pk_bf16_f32 v170, v160, v161
v_cvt_pk_bf16_f32 v171, v162, v163
s_nop 1
v_mfma_f32_16x16x32_bf16 v[180:183], v[24:27], v[168:171], v[180:183]
v_mfma_f32_16x16x32_bf16 v[176:179], v[152:155], v[168:171], v[176:179]
s_nop 6
v_rcp_f32 v184, v180
s_mov_b64 exec, s[100:101]
v_pk_mul_f32 v[176:177], v[176:177], v[184:185] op_sel_hi:[1,0]
v_pk_mul_f32 v[178:179], v[178:179], v[184:185] op_sel_hi:[1,0]
v_cvt_pk_bf16_f32 v186, v176, v177
v_cvt_pk_bf16_f32 v187, v178, v179
buffer_store_dwordx2 v[186:187], v8, s[4:7], s54 offen
s_mov_b64 exec, -1
s_branch L_D_52
L_b23_51:
v_smfmac_f32_16x16x64_bf16 v[64:67], v[36:39], a[144:151], v2
v_smfmac_f32_16x16x64_bf16 v[68:71], v[36:39], a[152:159], v2
v_smfmac_f32_16x16x64_bf16 v[64:67], v[40:43], a[160:167], v2
v_smfmac_f32_16x16x64_bf16 v[68:71], v[40:43], a[168:175], v2
v_smfmac_f32_16x16x64_bf16 v[64:67], v[44:47], a[176:183], v2
v_smfmac_f32_16x16x64_bf16 v[68:71], v[44:47], a[184:191], v2
s_nop 7
v_permlane32_swap_b32 v64, v68
v_permlane32_swap_b32 v65, v69
v_permlane32_swap_b32 v66, v70
v_permlane32_swap_b32 v67, v71
v_pk_add_f32 v[64:65], v[64:65], v[68:69]
v_pk_add_f32 v[66:67], v[66:67], v[70:71]
ds_write_b128 v11, v[64:67] offset:8192
s_waitcnt lgkmcnt(0)
s_barrier
s_cmp_eq_u32 s3, 2
s_cbranch_scc1 L_D_52
s_lshl_b32 s75, s77, 15
s_add_u32 s75, s75, s66
buffer_store_dwordx4 v[28:31], v1, s[4:7], s75 offen
s_lshl_b32 s76, s77, 14
s_add_u32 s75, s76, s67
buffer_store_dwordx2 v[28:29], v3, s[4:7], s75 offen
s_add_u32 s75, s76, s65
buffer_store_dwordx2 v[28:29], v3, s[4:7], s75 offen
s_cmp_lg_u32 s48, 63
s_cbranch_scc1 L_npg_64
s_cmp_lt_u32 s48, 57
s_cbranch_scc1 L_n62_65
s_lshr_b32 s75, s63, 2
s_lshl_b32 s74, s48, 3
s_add_u32 s75, s75, s74
s_sub_u32 s75, s75, 328
s_lshl_b32 s74, s75, 8
s_add_u32 s74, s74, 98566144
v_mov_b32 v192, 0
v_mov_b32 v193, 1
s_mov_b64 exec, 1
buffer_atomic_add v193, v192, s[4:7], s74 offen sc1
s_mov_b64 exec, -1
L_n62_65:
s_cmp_lg_u32 s2, 0
s_cbranch_scc1 L_npg_64
s_cmp_lt_u32 s48, 2
s_cbranch_scc1 L_npg_64
s_sub_u32 s74, s48, 1
v_mov_b32 v192, 0
v_mov_b32 v193, s74
s_mov_b32 s74, 98578432
s_mov_b64 exec, 1
buffer_store_dword v193, v192, s[4:7], s74 offen sc1
s_mov_b64 exec, -1
L_npg_64:
L_D_52:
s_cmp_eq_u32 s48, 63
s_waitcnt lgkmcnt(0)
s_barrier
s_cbranch_scc1 L_fin_36
s_sleep 3
buffer_load_dwordx4 v[32:35], v1, s[4:7], s55 offen offset:0 sc1
buffer_load_dwordx4 v[36:39], v1, s[4:7], s55 offen offset:1024 sc1
buffer_load_dwordx4 v[40:43], v1, s[4:7], s55 offen offset:2048 sc1
buffer_load_dwordx4 v[44:47], v1, s[4:7], s55 offen offset:3072 sc1
v_mov_b32 v176, 0
v_mov_b32 v177, 0
v_mov_b32 v178, 0
v_mov_b32 v179, 0
v_mov_b32 v180, 0
v_mov_b32 v181, 0
v_mov_b32 v182, 0
v_mov_b32 v183, 0
s_waitcnt vmcnt(3)
L_gc_66:
v_max_u32 v199, v32, v34
v_cmp_eq_u32 vcc, -1, v199
s_cbranch_vccnz L_gs_67
L_gp_68:
v_smfmac_f32_16x16x64_bf16 v[176:179], v[32:35], a[192:199], v2
v_smfmac_f32_16x16x64_bf16 v[180:183], v[32:35], a[200:207], v2
s_waitcnt vmcnt(2)
L_gc_69:
v_max_u32 v199, v36, v38
v_cmp_eq_u32 vcc, -1, v199
s_cbranch_vccnz L_gs_70
L_gp_71:
v_smfmac_f32_16x16x64_bf16 v[176:179], v[36:39], a[208:215], v2
v_smfmac_f32_16x16x64_bf16 v[180:183], v[36:39], a[216:223], v2
s_waitcnt vmcnt(1)
L_gc_72:
v_max_u32 v199, v40, v42
v_cmp_eq_u32 vcc, -1, v199
s_cbranch_vccnz L_gs_73
L_gp_74:
v_smfmac_f32_16x16x64_bf16 v[176:179], v[40:43], a[224:231], v2
v_smfmac_f32_16x16x64_bf16 v[180:183], v[40:43], a[232:239], v2
s_waitcnt vmcnt(0)
L_gc_75:
v_max_u32 v199, v44, v46
v_cmp_eq_u32 vcc, -1, v199
s_cbranch_vccnz L_gs_76
L_gp_77:
v_smfmac_f32_16x16x64_bf16 v[176:179], v[44:47], a[240:247], v2
v_smfmac_f32_16x16x64_bf16 v[180:183], v[44:47], a[248:255], v2
s_nop 7
v_permlane32_swap_b32 v176, v180
v_permlane32_swap_b32 v177, v181
v_permlane32_swap_b32 v178, v182
v_permlane32_swap_b32 v179, v183
v_pk_add_f32 v[176:177], v[176:177], v[180:181]
v_pk_add_f32 v[178:179], v[178:179], v[182:183]
ds_write_b32 v9, v176 offset:12288
ds_write_b32 v9, v177 offset:12448
ds_write_b32 v9, v178 offset:12608
ds_write_b32 v9, v179 offset:12768
s_cmp_lg_u32 s3, 0
s_waitcnt lgkmcnt(0)
s_barrier
s_memtime s[96:97]
s_cbranch_scc1 L_wt_78
ds_read_b128 v[72:75], v10 offset:12288
ds_read_b128 v[76:79], v10 offset:13568
ds_read_b128 v[80:83], v10 offset:14848
ds_read_b128 v[84:87], v10 offset:16128
s_bfe_u32 s74, s48, 0x10002
v_mov_b32 v190, s74
s_waitcnt lgkmcnt(2)
v_pk_add_f32 v[72:73], v[72:73], v[76:77]
v_pk_add_f32 v[74:75], v[74:75], v[78:79]
s_waitcnt lgkmcnt(0)
v_pk_add_f32 v[80:81], v[80:81], v[84:85]
v_pk_add_f32 v[82:83], v[82:83], v[86:87]
v_pk_add_f32 v[72:73], v[72:73], v[80:81]
v_pk_add_f32 v[74:75], v[74:75], v[82:83]
v_bfi_b32 v72, 1, v190, v72
buffer_store_dwordx4 v[72:75], v1, s[4:7], s56 offen sc1
s_add_u32 s48, s48, 1
s_and_b32 s74, s48, 3
s_lshl_b32 s75, s74, 14
s_lshl_b32 s76, s3, 12
s_andn2_b32 s49, s65, 0x3fff
s_add_u32 s49, s49, s75
s_add_u32 s49, s49, s76
s_add_u32 s54, s67, s75
s_andn2_b32 s55, s54, 0x3fff
s_add_u32 s55, s55, s76
s_lshl_b32 s75, s74, 15
s_add_u32 s50, s66, s75
s_xor_b32 s51, s50, 1024
s_xor_b32 s52, s50, 2048
s_xor_b32 s53, s50, 3072
s_add_u32 s77, s48, 2
s_and_b32 s77, s77, 3
s_and_b32 s78, s48, 1
s_mul_i32 s78, s78, 10240
v_mov_b32 v48, 0
v_mov_b32 v49, 0
v_mov_b32 v50, 0
v_mov_b32 v51, 0
v_mov_b32 v52, 0
v_mov_b32 v53, 0
v_mov_b32 v54, 0
v_mov_b32 v55, 0
v_mov_b32 v56, 0
v_mov_b32 v57, 0
v_mov_b32 v58, 0
v_mov_b32 v59, 0
v_mov_b32 v60, 0
v_mov_b32 v61, 0
v_mov_b32 v62, 0
v_mov_b32 v63, 0
v_mov_b32 v64, 0
v_mov_b32 v65, 0
v_mov_b32 v66, 0
v_mov_b32 v67, 0
v_mov_b32 v68, 0
v_mov_b32 v69, 0
v_mov_b32 v70, 0
v_mov_b32 v71, 0
s_sleep 9
buffer_load_dwordx4 v[76:79], v1, s[4:7], s57 offen sc1
buffer_load_dwordx4 v[80:83], v1, s[4:7], s58 offen sc1
buffer_load_dwordx4 v[84:87], v1, s[4:7], s59 offen sc1
s_waitcnt vmcnt(2)
L_gc_79:
v_xor_b32 v199, v76, v190
v_and_b32 v199, 1, v199
v_cmp_ne_u32 vcc, 0, v199
s_cbranch_vccnz L_gs_80
L_gp_81:
v_pk_add_f32 v[88:89], v[72:73], v[76:77]
v_pk_add_f32 v[90:91], v[74:75], v[78:79]
s_waitcnt vmcnt(1)
L_gc_82:
v_xor_b32 v199, v80, v190
v_and_b32 v199, 1, v199
v_cmp_ne_u32 vcc, 0, v199
s_cbranch_vccnz L_gs_83
L_gp_84:
s_waitcnt vmcnt(0)
L_gc_85:
v_xor_b32 v199, v84, v190
v_and_b32 v199, 1, v199
v_cmp_ne_u32 vcc, 0, v199
s_cbranch_vccnz L_gs_86
L_gp_87:
v_pk_add_f32 v[92:93], v[80:81], v[84:85]
v_pk_add_f32 v[94:95], v[82:83], v[86:87]
v_pk_add_f32 v[88:89], v[88:89], v[92:93]
v_pk_add_f32 v[90:91], v[90:91], v[94:95]
v_cvt_pk_bf16_f32 v188, v88, v89
v_cvt_pk_bf16_f32 v189, v90, v91
buffer_store_dwordx2 v[188:189], v3, s[4:7], s64 offen
s_barrier
s_branch L_loop_37
L_wt_78:
s_cmp_eq_u32 s3, 1
s_cbranch_scc1 L_wd_89
s_cmp_lg_u32 s48, 0
s_cbranch_scc1 L_kv0_91
s_add_u32 s52, s63, 64
s_mov_b32 s53, 1024
s_lshl_b32 s74, s52, 8
s_add_u32 s74, s74, 98566144
v_mov_b32 v192, 0
L_pc_92:
buffer_load_dword v193, v192, s[4:7], s74 offen sc1
s_waitcnt vmcnt(0)
v_readfirstlane_b32 s75, v193
s_cmp_ge_u32 s75, s53
s_cbranch_scc1 L_pcok_93
s_sleep 1
s_sub_u32 s73, s73, 1
s_cmp_lg_u32 s73, 0
s_cbranch_scc1 L_pc_92
s_branch L_chexit_2
L_pcok_93:
L_kv0_91:
s_add_u32 s52, s48, 2
s_and_b32 s53, s52, 7
s_cmp_eq_u32 s52, 4
s_cselect_b32 s53, 0, s53
s_cmp_lg_u32 s53, 0
s_cbranch_scc1 L_kvok_90
s_cmp_ge_u32 s52, 64
s_cbranch_scc1 L_kvok_90
s_lshr_b32 s52, s52, 3
s_cmp_lt_u32 s52, 2
s_cselect_b32 s53, 64, 32
s_cmp_eq_u32 s52, 0
s_cselect_b32 s53, 32, s53
s_add_u32 s52, s52, 8
v_readfirstlane_b32 s74, v196
s_cmp_ge_u32 s74, s53
s_cbranch_scc1 L_kvok_90
s_lshl_b32 s74, s52, 8
s_add_u32 s74, s74, 98566144
v_mov_b32 v192, 0
L_pc_94:
buffer_load_dword v193, v192, s[4:7], s74 offen sc1
s_waitcnt vmcnt(0)
v_readfirstlane_b32 s75, v193
s_cmp_ge_u32 s75, s53
s_cbranch_scc1 L_pcok_95
s_sleep 2
s_sub_u32 s73, s73, 1
s_cmp_lg_u32 s73, 0
s_cbranch_scc1 L_pc_94
s_branch L_chexit_2
L_pcok_95:
L_kvok_90:
s_add_u32 s52, s48, 3
s_and_b32 s53, s52, 7
s_cmp_eq_u32 s52, 4
s_cselect_b32 s53, 0, s53
s_cmp_lg_u32 s53, 0
s_cbranch_scc1 L_kva_96
s_cmp_ge_u32 s52, 64
s_cbranch_scc1 L_kva_96
s_lshr_b32 s52, s52, 3
s_cmp_lt_u32 s52, 2
s_cselect_b32 s53, 64, 32
s_cmp_eq_u32 s52, 0
s_cselect_b32 s53, 32, s53
s_add_u32 s52, s52, 8
s_lshl_b32 s52, s52, 8
s_add_u32 s52, s52, 98566144
v_mov_b32 v197, 0
buffer_load_dword v196, v197, s[4:7], s52 offen sc1
L_kva_96:
s_cmp_eq_u32 s3, 2
s_cbranch_scc1 L_w2_88
s_add_u32 m0, s78, 28672
s_nop 0
buffer_load_dwordx4 v1, s[4:7], s70 offen offset:0 sc1 lds
buffer_load_dwordx4 v1, s[4:7], s70 offen offset:1024 sc1 lds
s_add_u32 s70, s70, 262144
ds_read_b128 v[184:187], v1 offset:17408
ds_read_b64 v[188:189], v3 offset:18432
s_waitcnt lgkmcnt(0)
buffer_store_dwordx4 v[184:187], v7, s[4:7], s71 offen sc1
buffer_store_dwordx2 v[188:189], v3, s[4:7], s72 offen sc1
s_add_u32 s71, s71, 65536
s_add_u32 s72, s72, 65536
s_cmp_lt_u32 s48, 57
s_cbranch_scc1 L_n62_98
s_lshr_b32 s75, s63, 2
s_lshl_b32 s74, s48, 3
s_add_u32 s75, s75, s74
s_sub_u32 s75, s75, 328
s_lshl_b32 s74, s75, 8
s_add_u32 s74, s74, 98566144
v_mov_b32 v192, 0
v_mov_b32 v193, 1
s_mov_b64 exec, 1
buffer_atomic_add v193, v192, s[4:7], s74 offen sc1
s_mov_b64 exec, -1
L_n62_98:
s_cmp_lg_u32 s2, 0
s_cbranch_scc1 L_npg_97
s_cmp_lt_u32 s48, 2
s_cbranch_scc1 L_npg_97
s_sub_u32 s74, s48, 1
v_mov_b32 v192, 0
v_mov_b32 v193, s74
s_mov_b32 s74, 98578432
s_mov_b64 exec, 1
buffer_store_dword v193, v192, s[4:7], s74 offen sc1
s_mov_b64 exec, -1
L_npg_97:
s_branch L_wd_89
L_w2_88:
s_xor_b32 s74, s62, 0
s_lshl_b32 s74, s74, 11
s_add_u32 s74, s74, s69
s_add_u32 m0, s78, 20480
s_nop 0
buffer_load_dwordx4 v1, s[4:7], s74 offen offset:0 sc1 lds
buffer_load_dwordx4 v1, s[4:7], s74 offen offset:1024 sc1 lds
s_xor_b32 s74, s62, 1
s_lshl_b32 s74, s74, 11
s_add_u32 s74, s74, s69
s_add_u32 m0, s78, 22528
s_nop 0
buffer_load_dwordx4 v1, s[4:7], s74 offen offset:0 sc1 lds
buffer_load_dwordx4 v1, s[4:7], s74 offen offset:1024 sc1 lds
s_xor_b32 s74, s62, 2
s_lshl_b32 s74, s74, 11
s_add_u32 s74, s74, s69
s_add_u32 m0, s78, 24576
s_nop 0
buffer_load_dwordx4 v1, s[4:7], s74 offen offset:0 sc1 lds
buffer_load_dwordx4 v1, s[4:7], s74 offen offset:1024 sc1 lds
s_xor_b32 s74, s62, 3
s_lshl_b32 s74, s74, 11
s_add_u32 s74, s74, s69
s_add_u32 m0, s78, 26624
s_nop 0
buffer_load_dwordx4 v1, s[4:7], s74 offen offset:0 sc1 lds
buffer_load_dwordx4 v1, s[4:7], s74 offen offset:1024 sc1 lds
s_add_u32 s69, s69, 262144
L_wd_89:
s_add_u32 s48, s48, 1
s_and_b32 s74, s48, 3
s_lshl_b32 s75, s74, 14
s_lshl_b32 s76, s3, 12
s_andn2_b32 s49, s65, 0x3fff
s_add_u32 s49, s49, s75
s_add_u32 s49, s49, s76
s_add_u32 s54, s67, s75
s_andn2_b32 s55, s54, 0x3fff
s_add_u32 s55, s55, s76
s_lshl_b32 s75, s74, 15
s_add_u32 s50, s66, s75
s_xor_b32 s51, s50, 1024
s_xor_b32 s52, s50, 2048
s_xor_b32 s53, s50, 3072
s_add_u32 s77, s48, 2
s_and_b32 s77, s77, 3
s_and_b32 s78, s48, 1
s_mul_i32 s78, s78, 10240
v_mov_b32 v48, 0
v_mov_b32 v49, 0
v_mov_b32 v50, 0
v_mov_b32 v51, 0
v_mov_b32 v52, 0
v_mov_b32 v53, 0
v_mov_b32 v54, 0
v_mov_b32 v55, 0
v_mov_b32 v56, 0
v_mov_b32 v57, 0
v_mov_b32 v58, 0
v_mov_b32 v59, 0
v_mov_b32 v60, 0
v_mov_b32 v61, 0
v_mov_b32 v62, 0
v_mov_b32 v63, 0
v_mov_b32 v64, 0
v_mov_b32 v65, 0
v_mov_b32 v66, 0
v_mov_b32 v67, 0
v_mov_b32 v68, 0
v_mov_b32 v69, 0
v_mov_b32 v70, 0
v_mov_b32 v71, 0
s_barrier
s_branch L_loop_37
L_gs_40:
s_waitcnt vmcnt(0)
buffer_load_dwordx4 v[32:35], v1, s[4:7], s49 offen offset:0 sc1
v_max_u32 v199, v36, v38
v_cmp_eq_u32 vcc, -1, v199
s_cbranch_vccz L_gk_99
buffer_load_dwordx4 v[36:39], v1, s[4:7], s49 offen offset:1024 sc1
L_gk_99:
v_max_u32 v199, v40, v42
v_cmp_eq_u32 vcc, -1, v199
s_cbranch_vccz L_gk_100
buffer_load_dwordx4 v[40:43], v1, s[4:7], s49 offen offset:2048 sc1
L_gk_100:
v_max_u32 v199, v44, v46
v_cmp_eq_u32 vcc, -1, v199
s_cbranch_vccz L_gk_101
buffer_load_dwordx4 v[44:47], v1, s[4:7], s49 offen offset:3072 sc1
L_gk_101:
s_waitcnt vmcnt(0)
s_sub_u32 s73, s73, 1
s_cmp_lg_u32 s73, 0
s_cbranch_scc1 L_gc_39
s_branch L_chexit_2
L_gs_43:
s_waitcnt vmcnt(0)
buffer_load_dwordx4 v[36:39], v1, s[4:7], s49 offen offset:1024 sc1
v_max_u32 v199, v40, v42
v_cmp_eq_u32 vcc, -1, v199
s_cbranch_vccz L_gk_102
buffer_load_dwordx4 v[40:43], v1, s[4:7], s49 offen offset:2048 sc1
L_gk_102:
v_max_u32 v199, v44, v46
v_cmp_eq_u32 vcc, -1, v199
s_cbranch_vccz L_gk_103
buffer_load_dwordx4 v[44:47], v1, s[4:7], s49 offen offset:3072 sc1
L_gk_103:
s_waitcnt vmcnt(0)
s_sub_u32 s73, s73, 1
s_cmp_lg_u32 s73, 0
s_cbranch_scc1 L_gc_42
s_branch L_chexit_2
L_gs_46:
s_waitcnt vmcnt(0)
buffer_load_dwordx4 v[40:43], v1, s[4:7], s49 offen offset:2048 sc1
v_max_u32 v199, v44, v46
v_cmp_eq_u32 vcc, -1, v199
s_cbranch_vccz L_gk_104
buffer_load_dwordx4 v[44:47], v1, s[4:7], s49 offen offset:3072 sc1
L_gk_104:
s_waitcnt vmcnt(0)
s_sub_u32 s73, s73, 1
s_cmp_lg_u32 s73, 0
s_cbranch_scc1 L_gc_45
s_branch L_chexit_2
L_gs_49:
s_waitcnt vmcnt(0)
buffer_load_dwordx4 v[44:47], v1, s[4:7], s49 offen offset:3072 sc1
s_waitcnt vmcnt(0)
s_sub_u32 s73, s73, 1
s_cmp_lg_u32 s73, 0
s_cbranch_scc1 L_gc_48
s_branch L_chexit_2
L_gs_55:
s_waitcnt vmcnt(0)
buffer_load_dwordx4 v[108:111], v1, s[4:7], s51 offen sc1
v_cmp_eq_u32 vcc, -1, v112
s_cbranch_vccz L_gk_105
buffer_load_dwordx4 v[112:115], v1, s[4:7], s52 offen sc1
L_gk_105:
v_cmp_eq_u32 vcc, -1, v116
s_cbranch_vccz L_gk_106
buffer_load_dwordx4 v[116:119], v1, s[4:7], s53 offen sc1
L_gk_106:
s_waitcnt vmcnt(0)
s_sub_u32 s73, s73, 1
s_cmp_lg_u32 s73, 0
s_cbranch_scc1 L_gc_54
s_branch L_chexit_2
L_gs_58:
s_waitcnt vmcnt(0)
buffer_load_dwordx4 v[112:115], v1, s[4:7], s52 offen sc1
v_cmp_eq_u32 vcc, -1, v116
s_cbranch_vccz L_gk_107
buffer_load_dwordx4 v[116:119], v1, s[4:7], s53 offen sc1
L_gk_107:
s_waitcnt vmcnt(0)
s_sub_u32 s73, s73, 1
s_cmp_lg_u32 s73, 0
s_cbranch_scc1 L_gc_57
s_branch L_chexit_2
L_gs_61:
s_waitcnt vmcnt(0)
buffer_load_dwordx4 v[116:119], v1, s[4:7], s53 offen sc1
s_waitcnt vmcnt(0)
s_sub_u32 s73, s73, 1
s_cmp_lg_u32 s73, 0
s_cbranch_scc1 L_gc_60
s_branch L_chexit_2
L_gs_67:
s_waitcnt vmcnt(0)
buffer_load_dwordx4 v[32:35], v1, s[4:7], s55 offen offset:0 sc1
v_max_u32 v199, v36, v38
v_cmp_eq_u32 vcc, -1, v199
s_cbranch_vccz L_gk_108
buffer_load_dwordx4 v[36:39], v1, s[4:7], s55 offen offset:1024 sc1
L_gk_108:
v_max_u32 v199, v40, v42
v_cmp_eq_u32 vcc, -1, v199
s_cbranch_vccz L_gk_109
buffer_load_dwordx4 v[40:43], v1, s[4:7], s55 offen offset:2048 sc1
L_gk_109:
v_max_u32 v199, v44, v46
v_cmp_eq_u32 vcc, -1, v199
s_cbranch_vccz L_gk_110
buffer_load_dwordx4 v[44:47], v1, s[4:7], s55 offen offset:3072 sc1
L_gk_110:
s_waitcnt vmcnt(0)
s_sub_u32 s73, s73, 1
s_cmp_lg_u32 s73, 0
s_cbranch_scc1 L_gc_66
s_branch L_chexit_2
L_gs_70:
s_waitcnt vmcnt(0)
buffer_load_dwordx4 v[36:39], v1, s[4:7], s55 offen offset:1024 sc1
v_max_u32 v199, v40, v42
v_cmp_eq_u32 vcc, -1, v199
s_cbranch_vccz L_gk_111
buffer_load_dwordx4 v[40:43], v1, s[4:7], s55 offen offset:2048 sc1
L_gk_111:
v_max_u32 v199, v44, v46
v_cmp_eq_u32 vcc, -1, v199
s_cbranch_vccz L_gk_112
buffer_load_dwordx4 v[44:47], v1, s[4:7], s55 offen offset:3072 sc1
L_gk_112:
s_waitcnt vmcnt(0)
s_sub_u32 s73, s73, 1
s_cmp_lg_u32 s73, 0
s_cbranch_scc1 L_gc_69
s_branch L_chexit_2
L_gs_73:
s_waitcnt vmcnt(0)
buffer_load_dwordx4 v[40:43], v1, s[4:7], s55 offen offset:2048 sc1
v_max_u32 v199, v44, v46
v_cmp_eq_u32 vcc, -1, v199
s_cbranch_vccz L_gk_113
buffer_load_dwordx4 v[44:47], v1, s[4:7], s55 offen offset:3072 sc1
L_gk_113:
s_waitcnt vmcnt(0)
s_sub_u32 s73, s73, 1
s_cmp_lg_u32 s73, 0
s_cbranch_scc1 L_gc_72
s_branch L_chexit_2
L_gs_76:
s_waitcnt vmcnt(0)
buffer_load_dwordx4 v[44:47], v1, s[4:7], s55 offen offset:3072 sc1
s_waitcnt vmcnt(0)
s_sub_u32 s73, s73, 1
s_cmp_lg_u32 s73, 0
s_cbranch_scc1 L_gc_75
s_branch L_chexit_2
L_gs_80:
s_waitcnt vmcnt(0)
buffer_load_dwordx4 v[76:79], v1, s[4:7], s57 offen sc1
v_xor_b32 v199, v80, v190
v_and_b32 v199, 1, v199
v_cmp_ne_u32 vcc, 0, v199
s_cbranch_vccz L_gk_114
buffer_load_dwordx4 v[80:83], v1, s[4:7], s58 offen sc1
L_gk_114:
v_xor_b32 v199, v84, v190
v_and_b32 v199, 1, v199
v_cmp_ne_u32 vcc, 0, v199
s_cbranch_vccz L_gk_115
buffer_load_dwordx4 v[84:87], v1, s[4:7], s59 offen sc1
L_gk_115:
s_waitcnt vmcnt(0)
s_sub_u32 s73, s73, 1
s_cmp_lg_u32 s73, 0
s_cbranch_scc1 L_gc_79
s_branch L_chexit_2
L_gs_83:
s_waitcnt vmcnt(0)
buffer_load_dwordx4 v[80:83], v1, s[4:7], s58 offen sc1
v_xor_b32 v199, v84, v190
v_and_b32 v199, 1, v199
v_cmp_ne_u32 vcc, 0, v199
s_cbranch_vccz L_gk_116
buffer_load_dwordx4 v[84:87], v1, s[4:7], s59 offen sc1
L_gk_116:
s_waitcnt vmcnt(0)
s_sub_u32 s73, s73, 1
s_cmp_lg_u32 s73, 0
s_cbranch_scc1 L_gc_82
s_branch L_chexit_2
L_gs_86:
s_waitcnt vmcnt(0)
buffer_load_dwordx4 v[84:87], v1, s[4:7], s59 offen sc1
s_waitcnt vmcnt(0)
s_sub_u32 s73, s73, 1
s_cmp_lg_u32 s73, 0
s_cbranch_scc1 L_gc_85
s_branch L_chexit_2
L_slow_35:
L_loop_117:
s_sleep 2
s_nop 7
buffer_load_dwordx4 v[32:35], v1, s[4:7], s49 offen offset:0 sc1
buffer_load_dwordx4 v[36:39], v1, s[4:7], s49 offen offset:1024 sc1
buffer_load_dwordx4 v[40:43], v1, s[4:7], s49 offen offset:2048 sc1
buffer_load_dwordx4 v[44:47], v1, s[4:7], s49 offen offset:3072 sc1
s_cmp_ge_u32 s3, 2
s_cbranch_scc1 L_nokx_118
v_add_u32 v184, s78, v5
v_add_u32 v185, s78, v6
ds_read_b128 v[120:123], v184 offset:20480
ds_read_b128 v[124:127], v184 offset:20608
ds_read_b128 v[128:131], v184 offset:22528
ds_read_b128 v[132:135], v184 offset:22656
ds_read_b128 v[136:139], v184 offset:24576
ds_read_b128 v[140:143], v184 offset:24704
ds_read_b128 v[144:147], v184 offset:26624
ds_read_b128 v[148:151], v184 offset:26752
ds_read_b128 v[152:155], v185 offset:28672
L_nokx_118:
s_waitcnt vmcnt(3)
L_gc_119:
v_max_u32 v199, v32, v34
v_cmp_eq_u32 vcc, -1, v199
s_cbranch_vccnz L_gs_120
L_gp_121:
v_smfmac_f32_16x16x64_bf16 v[48:51], v[32:35], a[0:7], v2
v_smfmac_f32_16x16x64_bf16 v[52:55], v[32:35], a[64:71], v2
v_smfmac_f32_16x16x64_bf16 v[56:59], v[32:35], a[8:15], v2
v_smfmac_f32_16x16x64_bf16 v[60:63], v[32:35], a[72:79], v2
s_waitcnt vmcnt(2)
L_gc_122:
v_max_u32 v199, v36, v38
v_cmp_eq_u32 vcc, -1, v199
s_cbranch_vccnz L_gs_123
L_gp_124:
v_smfmac_f32_16x16x64_bf16 v[48:51], v[36:39], a[16:23], v2
v_smfmac_f32_16x16x64_bf16 v[52:55], v[36:39], a[80:87], v2
v_smfmac_f32_16x16x64_bf16 v[56:59], v[36:39], a[24:31], v2
v_smfmac_f32_16x16x64_bf16 v[60:63], v[36:39], a[88:95], v2
s_waitcnt vmcnt(1)
L_gc_125:
v_max_u32 v199, v40, v42
v_cmp_eq_u32 vcc, -1, v199
s_cbranch_vccnz L_gs_126
L_gp_127:
v_smfmac_f32_16x16x64_bf16 v[48:51], v[40:43], a[32:39], v2
v_smfmac_f32_16x16x64_bf16 v[52:55], v[40:43], a[96:103], v2
v_smfmac_f32_16x16x64_bf16 v[56:59], v[40:43], a[40:47], v2
v_smfmac_f32_16x16x64_bf16 v[60:63], v[40:43], a[104:111], v2
s_waitcnt vmcnt(0)
L_gc_128:
v_max_u32 v199, v44, v46
v_cmp_eq_u32 vcc, -1, v199
s_cbranch_vccnz L_gs_129
L_gp_130:
v_smfmac_f32_16x16x64_bf16 v[48:51], v[44:47], a[48:55], v2
v_smfmac_f32_16x16x64_bf16 v[52:55], v[44:47], a[112:119], v2
v_smfmac_f32_16x16x64_bf16 v[56:59], v[44:47], a[56:63], v2
v_smfmac_f32_16x16x64_bf16 v[60:63], v[44:47], a[120:127], v2
s_nop 5
v_permlane32_swap_b32 v48, v52
v_permlane32_swap_b32 v49, v53
v_permlane32_swap_b32 v50, v54
v_permlane32_swap_b32 v51, v55
v_pk_add_f32 v[48:49], v[48:49], v[52:53]
v_pk_add_f32 v[50:51], v[50:51], v[54:55]
ds_write_b128 v4, v[48:51] offset:0
v_permlane32_swap_b32 v56, v60
v_permlane32_swap_b32 v57, v61
v_permlane32_swap_b32 v58, v62
v_permlane32_swap_b32 v59, v63
v_pk_add_f32 v[56:57], v[56:57], v[60:61]
v_pk_add_f32 v[58:59], v[58:59], v[62:63]
ds_write_b128 v4, v[56:59] offset:1024
v_smfmac_f32_16x16x64_bf16 v[64:67], v[32:35], a[128:135], v2
v_smfmac_f32_16x16x64_bf16 v[68:71], v[32:35], a[136:143], v2
s_cmp_ge_u32 s3, 2
s_waitcnt lgkmcnt(0)
s_barrier
s_memtime s[90:91]
s_cbranch_scc1 L_b23_131
ds_read_b128 v[72:75], v1 offset:0
ds_read_b128 v[76:79], v1 offset:2048
ds_read_b128 v[80:83], v1 offset:4096
ds_read_b128 v[84:87], v1 offset:6144
ds_read_b128 v[88:91], v1 offset:1024
ds_read_b128 v[92:95], v1 offset:3072
ds_read_b128 v[96:99], v1 offset:5120
ds_read_b128 v[100:103], v1 offset:7168
v_smfmac_f32_16x16x64_bf16 v[64:67], v[36:39], a[144:151], v2
v_smfmac_f32_16x16x64_bf16 v[68:71], v[36:39], a[152:159], v2
v_smfmac_f32_16x16x64_bf16 v[64:67], v[40:43], a[160:167], v2
v_smfmac_f32_16x16x64_bf16 v[68:71], v[40:43], a[168:175], v2
s_waitcnt lgkmcnt(6)
v_pk_add_f32 v[72:73], v[72:73], v[76:77]
v_pk_add_f32 v[74:75], v[74:75], v[78:79]
s_waitcnt lgkmcnt(4)
v_pk_add_f32 v[80:81], v[80:81], v[84:85]
v_pk_add_f32 v[82:83], v[82:83], v[86:87]
v_pk_add_f32 v[72:73], v[72:73], v[80:81]
v_pk_add_f32 v[74:75], v[74:75], v[82:83]
v_cvt_pk_bf16_f32 v184, v72, v73
v_cvt_pk_bf16_f32 v185, v74, v75
s_waitcnt lgkmcnt(2)
v_pk_add_f32 v[88:89], v[88:89], v[92:93]
v_pk_add_f32 v[90:91], v[90:91], v[94:95]
s_waitcnt lgkmcnt(0)
v_pk_add_f32 v[96:97], v[96:97], v[100:101]
v_pk_add_f32 v[98:99], v[98:99], v[102:103]
v_pk_add_f32 v[88:89], v[88:89], v[96:97]
v_pk_add_f32 v[90:91], v[90:91], v[98:99]
v_cvt_pk_bf16_f32 v186, v88, v89
v_cvt_pk_bf16_f32 v187, v90, v91
s_nop 0
v_mfma_f32_16x16x16_bf16 v[156:159], v[184:185], v[16:17], 0
v_mfma_f32_16x16x16_bf16 v[160:163], v[186:187], v[16:17], 0
v_smfmac_f32_16x16x64_bf16 v[64:67], v[44:47], a[176:183], v2
v_smfmac_f32_16x16x64_bf16 v[68:71], v[44:47], a[184:191], v2
s_nop 4
v_cvt_pk_bf16_f32 v104, v156, v157
v_cvt_pk_bf16_f32 v105, v158, v159
v_cvt_pk_bf16_f32 v106, v160, v161
v_cvt_pk_bf16_f32 v107, v162, v163
s_cmp_eq_u32 s3, 1
s_cbranch_scc1 L_nost_133
buffer_store_dwordx4 v[104:107], v1, s[4:7], s50 offen sc1
ds_write_b128 v1, v[104:107] offset:17408
L_nost_133:
v_mfma_f32_16x16x32_bf16 v[156:159], v[120:123], v[104:107], 0
v_mfma_f32_16x16x32_bf16 v[160:163], v[124:127], v[104:107], 0
v_mfma_f32_16x16x32_bf16 v[164:167], v[104:107], v[104:107], v[20:23]
v_permlane32_swap_b32 v64, v68
v_permlane32_swap_b32 v65, v69
v_permlane32_swap_b32 v66, v70
v_permlane32_swap_b32 v67, v71
v_pk_add_f32 v[64:65], v[64:65], v[68:69]
v_pk_add_f32 v[66:67], v[66:67], v[70:71]
ds_write_b128 v11, v[64:67] offset:8192
s_sleep 2
buffer_load_dwordx4 v[108:111], v1, s[4:7], s51 offen sc1
buffer_load_dwordx4 v[112:115], v1, s[4:7], s52 offen sc1
buffer_load_dwordx4 v[116:119], v1, s[4:7], s53 offen sc1
s_waitcnt lgkmcnt(0)
s_barrier
ds_read_b128 v[72:75], v12 offset:8192
ds_read_b128 v[76:79], v12 offset:9216
ds_read_b128 v[80:83], v12 offset:10240
ds_read_b128 v[84:87], v12 offset:11264
s_and_b32 s74, s48, 3
s_lshl_b32 s75, s74, 16
s_add_u32 s56, s68, s75
s_xor_b32 s57, s56, 262144
s_xor_b32 s58, s56, 524288
s_xor_b32 s59, s56, 786432
s_add_u32 s74, s48, 1
s_and_b32 s74, s74, 3
s_lshl_b32 s75, s74, 14
s_add_u32 s64, s65, s75
s_waitcnt lgkmcnt(0)
v_pk_add_f32 v[72:73], v[72:73], v[76:77]
v_pk_add_f32 v[74:75], v[74:75], v[78:79]
v_pk_add_f32 v[80:81], v[80:81], v[84:85]
v_pk_add_f32 v[82:83], v[82:83], v[86:87]
v_pk_add_f32 v[72:73], v[72:73], v[80:81]
v_pk_add_f32 v[74:75], v[74:75], v[82:83]
v_cvt_pk_bf16_f32 v188, v72, v73
v_cvt_pk_bf16_f32 v189, v74, v75
ds_write_b64 v13, v[188:189] offset:18432
s_cmp_eq_u32 s48, 63
s_cbranch_scc1 L_D_132
s_waitcnt vmcnt(2)
L_gc_134:
v_cmp_eq_u32 vcc, -1, v108
s_cbranch_vccnz L_gs_135
L_gp_136:
v_mfma_f32_16x16x32_bf16 v[164:167], v[108:111], v[108:111], v[164:167]
v_mfma_f32_16x16x32_bf16 v[156:159], v[128:131], v[108:111], v[156:159]
v_mfma_f32_16x16x32_bf16 v[160:163], v[132:135], v[108:111], v[160:163]
s_waitcnt vmcnt(1)
L_gc_137:
v_cmp_eq_u32 vcc, -1, v112
s_cbranch_vccnz L_gs_138
L_gp_139:
v_mfma_f32_16x16x32_bf16 v[164:167], v[112:115], v[112:115], v[164:167]
v_mfma_f32_16x16x32_bf16 v[156:159], v[136:139], v[112:115], v[156:159]
v_mfma_f32_16x16x32_bf16 v[160:163], v[140:143], v[112:115], v[160:163]
s_waitcnt vmcnt(0)
L_gc_140:
v_cmp_eq_u32 vcc, -1, v116
s_cbranch_vccnz L_gs_141
L_gp_142:
v_mfma_f32_16x16x32_bf16 v[164:167], v[116:119], v[116:119], v[164:167]
v_mfma_f32_16x16x32_bf16 v[156:159], v[144:147], v[116:119], v[156:159]
v_mfma_f32_16x16x32_bf16 v[160:163], v[148:151], v[116:119], v[160:163]
s_nop 5
v_max3_f32 v184, v164, v165, v166
v_max3_f32 v185, v167, v156, v157
v_max3_f32 v184, v184, v158, v159
v_max3_f32 v185, v185, v160, v161
v_max3_f32 v184, v184, v162, v163
v_max_f32 v184, v184, v185
v_mov_b32 v185, v184
s_nop 1
v_permlane32_swap_b32 v184, v185
v_max_f32 v184, v184, v185
v_mov_b32 v185, v184
s_nop 1
v_permlane16_swap_b32 v184, v185
v_max_f32 v184, v184, v185
v_mul_f32 v184, s79, v184
v_pk_fma_f32 v[164:165], v[164:165], s[34:35], v[184:185] op_sel_hi:[1,1,0] neg_lo:[0,0,1] neg_hi:[0,0,1]
v_pk_fma_f32 v[166:167], v[166:167], s[34:35], v[184:185] op_sel_hi:[1,1,0] neg_lo:[0,0,1] neg_hi:[0,0,1]
v_pk_fma_f32 v[156:157], v[156:157], s[34:35], v[184:185] op_sel_hi:[1,1,0] neg_lo:[0,0,1] neg_hi:[0,0,1]
v_pk_fma_f32 v[158:159], v[158:159], s[34:35], v[184:185] op_sel_hi:[1,1,0] neg_lo:[0,0,1] neg_hi:[0,0,1]
v_pk_fma_f32 v[160:161], v[160:161], s[34:35], v[184:185] op_sel_hi:[1,1,0] neg_lo:[0,0,1] neg_hi:[0,0,1]
v_pk_fma_f32 v[162:163], v[162:163], s[34:35], v[184:185] op_sel_hi:[1,1,0] neg_lo:[0,0,1] neg_hi:[0,0,1]
v_exp_f32 v164, v164
v_exp_f32 v165, v165
v_exp_f32 v166, v166
v_exp_f32 v167, v167
v_exp_f32 v156, v156
v_cvt_pk_bf16_f32 v172, v164, v165
v_cvt_pk_bf16_f32 v173, v166, v167
v_exp_f32 v157, v157
v_exp_f32 v158, v158
v_mfma_f32_16x16x16_bf16 v[180:183], v[24:25], v[172:173], 0
v_exp_f32 v159, v159
v_mfma_f32_16x16x16_bf16 v[176:179], v[188:189], v[172:173], 0
v_exp_f32 v160, v160
v_exp_f32 v161, v161
v_exp_f32 v162, v162
v_exp_f32 v163, v163
v_cvt_pk_bf16_f32 v168, v156, v157
v_cvt_pk_bf16_f32 v169, v158, v159
v_cvt_pk_bf16_f32 v170, v160, v161
v_cvt_pk_bf16_f32 v171, v162, v163
s_nop 1
v_mfma_f32_16x16x32_bf16 v[180:183], v[24:27], v[168:171], v[180:183]
v_mfma_f32_16x16x32_bf16 v[176:179], v[152:155], v[168:171], v[176:179]
s_nop 6
v_rcp_f32 v184, v180
s_mov_b64 exec, s[100:101]
v_pk_mul_f32 v[176:177], v[176:177], v[184:185] op_sel_hi:[1,0]
v_pk_mul_f32 v[178:179], v[178:179], v[184:185] op_sel_hi:[1,0]
v_cvt_pk_bf16_f32 v186, v176, v177
v_cvt_pk_bf16_f32 v187, v178, v179
buffer_store_dwordx2 v[186:187], v8, s[4:7], s54 offen sc1
s_mov_b64 exec, -1
s_branch L_D_132
L_b23_131:
v_smfmac_f32_16x16x64_bf16 v[64:67], v[36:39], a[144:151], v2
v_smfmac_f32_16x16x64_bf16 v[68:71], v[36:39], a[152:159], v2
v_smfmac_f32_16x16x64_bf16 v[64:67], v[40:43], a[160:167], v2
v_smfmac_f32_16x16x64_bf16 v[68:71], v[40:43], a[168:175], v2
v_smfmac_f32_16x16x64_bf16 v[64:67], v[44:47], a[176:183], v2
v_smfmac_f32_16x16x64_bf16 v[68:71], v[44:47], a[184:191], v2
s_nop 7
v_permlane32_swap_b32 v64, v68
v_permlane32_swap_b32 v65, v69
v_permlane32_swap_b32 v66, v70
v_permlane32_swap_b32 v67, v71
v_pk_add_f32 v[64:65], v[64:65], v[68:69]
v_pk_add_f32 v[66:67], v[66:67], v[70:71]
ds_write_b128 v11, v[64:67] offset:8192
s_waitcnt lgkmcnt(0)
s_barrier
s_cmp_eq_u32 s3, 2
s_cbranch_scc1 L_D_132
s_lshl_b32 s75, s77, 15
s_add_u32 s75, s75, s66
buffer_store_dwordx4 v[28:31], v1, s[4:7], s75 offen sc1
s_lshl_b32 s76, s77, 14
s_add_u32 s75, s76, s67
buffer_store_dwordx2 v[28:29], v3, s[4:7], s75 offen sc1
s_add_u32 s75, s76, s65
buffer_store_dwordx2 v[28:29], v3, s[4:7], s75 offen sc1
s_cmp_lg_u32 s48, 63
s_cbranch_scc1 L_npg_144
s_cmp_lt_u32 s48, 57
s_cbranch_scc1 L_n62_145
s_lshr_b32 s75, s63, 2
s_lshl_b32 s74, s48, 3
s_add_u32 s75, s75, s74
s_sub_u32 s75, s75, 328
s_lshl_b32 s74, s75, 8
s_add_u32 s74, s74, 98566144
v_mov_b32 v192, 0
v_mov_b32 v193, 1
s_mov_b64 exec, 1
buffer_atomic_add v193, v192, s[4:7], s74 offen sc1
s_mov_b64 exec, -1
L_n62_145:
s_cmp_lg_u32 s2, 0
s_cbranch_scc1 L_npg_144
s_cmp_lt_u32 s48, 2
s_cbranch_scc1 L_npg_144
s_sub_u32 s74, s48, 1
v_mov_b32 v192, 0
v_mov_b32 v193, s74
s_mov_b32 s74, 98578432
s_mov_b64 exec, 1
buffer_store_dword v193, v192, s[4:7], s74 offen sc1
s_mov_b64 exec, -1
L_npg_144:
L_D_132:
s_cmp_eq_u32 s48, 63
s_waitcnt lgkmcnt(0)
s_barrier
s_cbranch_scc1 L_fin_36
s_sleep 3
buffer_load_dwordx4 v[32:35], v1, s[4:7], s55 offen offset:0 sc1
buffer_load_dwordx4 v[36:39], v1, s[4:7], s55 offen offset:1024 sc1
buffer_load_dwordx4 v[40:43], v1, s[4:7], s55 offen offset:2048 sc1
buffer_load_dwordx4 v[44:47], v1, s[4:7], s55 offen offset:3072 sc1
v_mov_b32 v176, 0
v_mov_b32 v177, 0
v_mov_b32 v178, 0
v_mov_b32 v179, 0
v_mov_b32 v180, 0
v_mov_b32 v181, 0
v_mov_b32 v182, 0
v_mov_b32 v183, 0
s_waitcnt vmcnt(3)
L_gc_146:
v_max_u32 v199, v32, v34
v_cmp_eq_u32 vcc, -1, v199
s_cbranch_vccnz L_gs_147
L_gp_148:
v_smfmac_f32_16x16x64_bf16 v[176:179], v[32:35], a[192:199], v2
v_smfmac_f32_16x16x64_bf16 v[180:183], v[32:35], a[200:207], v2
s_waitcnt vmcnt(2)
L_gc_149:
v_max_u32 v199, v36, v38
v_cmp_eq_u32 vcc, -1, v199
s_cbranch_vccnz L_gs_150
L_gp_151:
v_smfmac_f32_16x16x64_bf16 v[176:179], v[36:39], a[208:215], v2
v_smfmac_f32_16x16x64_bf16 v[180:183], v[36:39], a[216:223], v2
s_waitcnt vmcnt(1)
L_gc_152:
v_max_u32 v199, v40, v42
v_cmp_eq_u32 vcc, -1, v199
s_cbranch_vccnz L_gs_153
L_gp_154:
v_smfmac_f32_16x16x64_bf16 v[176:179], v[40:43], a[224:231], v2
v_smfmac_f32_16x16x64_bf16 v[180:183], v[40:43], a[232:239], v2
s_waitcnt vmcnt(0)
L_gc_155:
v_max_u32 v199, v44, v46
v_cmp_eq_u32 vcc, -1, v199
s_cbranch_vccnz L_gs_156
L_gp_157:
v_smfmac_f32_16x16x64_bf16 v[176:179], v[44:47], a[240:247], v2
v_smfmac_f32_16x16x64_bf16 v[180:183], v[44:47], a[248:255], v2
s_nop 7
v_permlane32_swap_b32 v176, v180
v_permlane32_swap_b32 v177, v181
v_permlane32_swap_b32 v178, v182
v_permlane32_swap_b32 v179, v183
v_pk_add_f32 v[176:177], v[176:177], v[180:181]
v_pk_add_f32 v[178:179], v[178:179], v[182:183]
ds_write_b32 v9, v176 offset:12288
ds_write_b32 v9, v177 offset:12448
ds_write_b32 v9, v178 offset:12608
ds_write_b32 v9, v179 offset:12768
s_cmp_lg_u32 s3, 0
s_waitcnt lgkmcnt(0)
s_barrier
s_memtime s[96:97]
s_cbranch_scc1 L_wt_158
ds_read_b128 v[72:75], v10 offset:12288
ds_read_b128 v[76:79], v10 offset:13568
ds_read_b128 v[80:83], v10 offset:14848
ds_read_b128 v[84:87], v10 offset:16128
s_bfe_u32 s74, s48, 0x10002
v_mov_b32 v190, s74
s_waitcnt lgkmcnt(2)
v_pk_add_f32 v[72:73], v[72:73], v[76:77]
v_pk_add_f32 v[74:75], v[74:75], v[78:79]
s_waitcnt lgkmcnt(0)
v_pk_add_f32 v[80:81], v[80:81], v[84:85]
v_pk_add_f32 v[82:83], v[82:83], v[86:87]
v_pk_add_f32 v[72:73], v[72:73], v[80:81]
v_pk_add_f32 v[74:75], v[74:75], v[82:83]
v_bfi_b32 v72, 1, v190, v72
buffer_store_dwordx4 v[72:75], v1, s[4:7], s56 offen sc1
s_add_u32 s48, s48, 1
s_and_b32 s74, s48, 3
s_lshl_b32 s75, s74, 14
s_lshl_b32 s76, s3, 12
s_andn2_b32 s49, s65, 0x3fff
s_add_u32 s49, s49, s75
s_add_u32 s49, s49, s76
s_add_u32 s54, s67, s75
s_andn2_b32 s55, s54, 0x3fff
s_add_u32 s55, s55, s76
s_lshl_b32 s75, s74, 15
s_add_u32 s50, s66, s75
s_xor_b32 s51, s50, 1024
s_xor_b32 s52, s50, 2048
s_xor_b32 s53, s50, 3072
s_add_u32 s77, s48, 2
s_and_b32 s77, s77, 3
s_and_b32 s78, s48, 1
s_mul_i32 s78, s78, 10240
v_mov_b32 v48, 0
v_mov_b32 v49, 0
v_mov_b32 v50, 0
v_mov_b32 v51, 0
v_mov_b32 v52, 0
v_mov_b32 v53, 0
v_mov_b32 v54, 0
v_mov_b32 v55, 0
v_mov_b32 v56, 0
v_mov_b32 v57, 0
v_mov_b32 v58, 0
v_mov_b32 v59, 0
v_mov_b32 v60, 0
v_mov_b32 v61, 0
v_mov_b32 v62, 0
v_mov_b32 v63, 0
v_mov_b32 v64, 0
v_mov_b32 v65, 0
v_mov_b32 v66, 0
v_mov_b32 v67, 0
v_mov_b32 v68, 0
v_mov_b32 v69, 0
v_mov_b32 v70, 0
v_mov_b32 v71, 0
s_sleep 9
buffer_load_dwordx4 v[76:79], v1, s[4:7], s57 offen sc1
buffer_load_dwordx4 v[80:83], v1, s[4:7], s58 offen sc1
buffer_load_dwordx4 v[84:87], v1, s[4:7], s59 offen sc1
s_waitcnt vmcnt(2)
L_gc_159:
v_xor_b32 v199, v76, v190
v_and_b32 v199, 1, v199
v_cmp_ne_u32 vcc, 0, v199
s_cbranch_vccnz L_gs_160
L_gp_161:
v_pk_add_f32 v[88:89], v[72:73], v[76:77]
v_pk_add_f32 v[90:91], v[74:75], v[78:79]
s_waitcnt vmcnt(1)
L_gc_162:
v_xor_b32 v199, v80, v190
v_and_b32 v199, 1, v199
v_cmp_ne_u32 vcc, 0, v199
s_cbranch_vccnz L_gs_163
L_gp_164:
s_waitcnt vmcnt(0)
L_gc_165:
v_xor_b32 v199, v84, v190
v_and_b32 v199, 1, v199
v_cmp_ne_u32 vcc, 0, v199
s_cbranch_vccnz L_gs_166
L_gp_167:
v_pk_add_f32 v[92:93], v[80:81], v[84:85]
v_pk_add_f32 v[94:95], v[82:83], v[86:87]
v_pk_add_f32 v[88:89], v[88:89], v[92:93]
v_pk_add_f32 v[90:91], v[90:91], v[94:95]
v_cvt_pk_bf16_f32 v188, v88, v89
v_cvt_pk_bf16_f32 v189, v90, v91
buffer_store_dwordx2 v[188:189], v3, s[4:7], s64 offen sc1
s_barrier
s_branch L_loop_117
L_wt_158:
s_cmp_eq_u32 s3, 1
s_cbranch_scc1 L_wd_169
s_cmp_lg_u32 s48, 0
s_cbranch_scc1 L_kv0_171
s_add_u32 s52, s63, 64
s_mov_b32 s53, 1024
s_lshl_b32 s74, s52, 8
s_add_u32 s74, s74, 98566144
v_mov_b32 v192, 0
L_pc_172:
buffer_load_dword v193, v192, s[4:7], s74 offen sc1
s_waitcnt vmcnt(0)
v_readfirstlane_b32 s75, v193
s_cmp_ge_u32 s75, s53
s_cbranch_scc1 L_pcok_173
s_sleep 1
s_sub_u32 s73, s73, 1
s_cmp_lg_u32 s73, 0
s_cbranch_scc1 L_pc_172
s_branch L_chexit_2
L_pcok_173:
L_kv0_171:
s_add_u32 s52, s48, 2
s_and_b32 s53, s52, 7
s_cmp_eq_u32 s52, 4
s_cselect_b32 s53, 0, s53
s_cmp_lg_u32 s53, 0
s_cbranch_scc1 L_kvok_170
s_cmp_ge_u32 s52, 64
s_cbranch_scc1 L_kvok_170
s_lshr_b32 s52, s52, 3
s_cmp_lt_u32 s52, 2
s_cselect_b32 s53, 64, 32
s_cmp_eq_u32 s52, 0
s_cselect_b32 s53, 32, s53
s_add_u32 s52, s52, 8
v_readfirstlane_b32 s74, v196
s_cmp_ge_u32 s74, s53
s_cbranch_scc1 L_kvok_170
s_lshl_b32 s74, s52, 8
s_add_u32 s74, s74, 98566144
v_mov_b32 v192, 0
L_pc_174:
buffer_load_dword v193, v192, s[4:7], s74 offen sc1
s_waitcnt vmcnt(0)
v_readfirstlane_b32 s75, v193
s_cmp_ge_u32 s75, s53
s_cbranch_scc1 L_pcok_175
s_sleep 2
s_sub_u32 s73, s73, 1
s_cmp_lg_u32 s73, 0
s_cbranch_scc1 L_pc_174
s_branch L_chexit_2
L_pcok_175:
L_kvok_170:
s_add_u32 s52, s48, 3
s_and_b32 s53, s52, 7
s_cmp_eq_u32 s52, 4
s_cselect_b32 s53, 0, s53
s_cmp_lg_u32 s53, 0
s_cbranch_scc1 L_kva_176
s_cmp_ge_u32 s52, 64
s_cbranch_scc1 L_kva_176
s_lshr_b32 s52, s52, 3
s_cmp_lt_u32 s52, 2
s_cselect_b32 s53, 64, 32
s_cmp_eq_u32 s52, 0
s_cselect_b32 s53, 32, s53
s_add_u32 s52, s52, 8
s_lshl_b32 s52, s52, 8
s_add_u32 s52, s52, 98566144
v_mov_b32 v197, 0
buffer_load_dword v196, v197, s[4:7], s52 offen sc1
L_kva_176:
s_cmp_eq_u32 s3, 2
s_cbranch_scc1 L_w2_168
s_add_u32 m0, s78, 28672
s_nop 0
buffer_load_dwordx4 v1, s[4:7], s70 offen offset:0 sc1 lds
buffer_load_dwordx4 v1, s[4:7], s70 offen offset:1024 sc1 lds
s_add_u32 s70, s70, 262144
ds_read_b128 v[184:187], v1 offset:17408
ds_read_b64 v[188:189], v3 offset:18432
s_waitcnt lgkmcnt(0)
buffer_store_dwordx4 v[184:187], v7, s[4:7], s71 offen sc1
buffer_store_dwordx2 v[188:189], v3, s[4:7], s72 offen sc1
s_add_u32 s71, s71, 65536
s_add_u32 s72, s72, 65536
s_cmp_lt_u32 s48, 57
s_cbranch_scc1 L_n62_178
s_lshr_b32 s75, s63, 2
s_lshl_b32 s74, s48, 3
s_add_u32 s75, s75, s74
s_sub_u32 s75, s75, 328
s_lshl_b32 s74, s75, 8
s_add_u32 s74, s74, 98566144
v_mov_b32 v192, 0
v_mov_b32 v193, 1
s_mov_b64 exec, 1
buffer_atomic_add v193, v192, s[4:7], s74 offen sc1
s_mov_b64 exec, -1
L_n62_178:
s_cmp_lg_u32 s2, 0
s_cbranch_scc1 L_npg_177
s_cmp_lt_u32 s48, 2
s_cbranch_scc1 L_npg_177
s_sub_u32 s74, s48, 1
v_mov_b32 v192, 0
v_mov_b32 v193, s74
s_mov_b32 s74, 98578432
s_mov_b64 exec, 1
buffer_store_dword v193, v192, s[4:7], s74 offen sc1
s_mov_b64 exec, -1
L_npg_177:
s_branch L_wd_169
L_w2_168:
s_xor_b32 s74, s62, 0
s_lshl_b32 s74, s74, 11
s_add_u32 s74, s74, s69
s_add_u32 m0, s78, 20480
s_nop 0
buffer_load_dwordx4 v1, s[4:7], s74 offen offset:0 sc1 lds
buffer_load_dwordx4 v1, s[4:7], s74 offen offset:1024 sc1 lds
s_xor_b32 s74, s62, 1
s_lshl_b32 s74, s74, 11
s_add_u32 s74, s74, s69
s_add_u32 m0, s78, 22528
s_nop 0
buffer_load_dwordx4 v1, s[4:7], s74 offen offset:0 sc1 lds
buffer_load_dwordx4 v1, s[4:7], s74 offen offset:1024 sc1 lds
s_xor_b32 s74, s62, 2
s_lshl_b32 s74, s74, 11
s_add_u32 s74, s74, s69
s_add_u32 m0, s78, 24576
s_nop 0
buffer_load_dwordx4 v1, s[4:7], s74 offen offset:0 sc1 lds
buffer_load_dwordx4 v1, s[4:7], s74 offen offset:1024 sc1 lds
s_xor_b32 s74, s62, 3
s_lshl_b32 s74, s74, 11
s_add_u32 s74, s74, s69
s_add_u32 m0, s78, 26624
s_nop 0
buffer_load_dwordx4 v1, s[4:7], s74 offen offset:0 sc1 lds
buffer_load_dwordx4 v1, s[4:7], s74 offen offset:1024 sc1 lds
s_add_u32 s69, s69, 262144
L_wd_169:
s_add_u32 s48, s48, 1
s_and_b32 s74, s48, 3
s_lshl_b32 s75, s74, 14
s_lshl_b32 s76, s3, 12
s_andn2_b32 s49, s65, 0x3fff
s_add_u32 s49, s49, s75
s_add_u32 s49, s49, s76
s_add_u32 s54, s67, s75
s_andn2_b32 s55, s54, 0x3fff
s_add_u32 s55, s55, s76
s_lshl_b32 s75, s74, 15
s_add_u32 s50, s66, s75
s_xor_b32 s51, s50, 1024
s_xor_b32 s52, s50, 2048
s_xor_b32 s53, s50, 3072
s_add_u32 s77, s48, 2
s_and_b32 s77, s77, 3
s_and_b32 s78, s48, 1
s_mul_i32 s78, s78, 10240
v_mov_b32 v48, 0
v_mov_b32 v49, 0
v_mov_b32 v50, 0
v_mov_b32 v51, 0
v_mov_b32 v52, 0
v_mov_b32 v53, 0
v_mov_b32 v54, 0
v_mov_b32 v55, 0
v_mov_b32 v56, 0
v_mov_b32 v57, 0
v_mov_b32 v58, 0
v_mov_b32 v59, 0
v_mov_b32 v60, 0
v_mov_b32 v61, 0
v_mov_b32 v62, 0
v_mov_b32 v63, 0
v_mov_b32 v64, 0
v_mov_b32 v65, 0
v_mov_b32 v66, 0
v_mov_b32 v67, 0
v_mov_b32 v68, 0
v_mov_b32 v69, 0
v_mov_b32 v70, 0
v_mov_b32 v71, 0
s_barrier
s_branch L_loop_117
L_gs_120:
s_waitcnt vmcnt(0)
buffer_load_dwordx4 v[32:35], v1, s[4:7], s49 offen offset:0 sc1
v_max_u32 v199, v36, v38
v_cmp_eq_u32 vcc, -1, v199
s_cbranch_vccz L_gk_179
buffer_load_dwordx4 v[36:39], v1, s[4:7], s49 offen offset:1024 sc1
L_gk_179:
v_max_u32 v199, v40, v42
v_cmp_eq_u32 vcc, -1, v199
s_cbranch_vccz L_gk_180
buffer_load_dwordx4 v[40:43], v1, s[4:7], s49 offen offset:2048 sc1
L_gk_180:
v_max_u32 v199, v44, v46
v_cmp_eq_u32 vcc, -1, v199
s_cbranch_vccz L_gk_181
buffer_load_dwordx4 v[44:47], v1, s[4:7], s49 offen offset:3072 sc1
L_gk_181:
s_waitcnt vmcnt(0)
s_sub_u32 s73, s73, 1
s_cmp_lg_u32 s73, 0
s_cbranch_scc1 L_gc_119
s_branch L_chexit_2
L_gs_123:
s_waitcnt vmcnt(0)
buffer_load_dwordx4 v[36:39], v1, s[4:7], s49 offen offset:1024 sc1
v_max_u32 v199, v40, v42
v_cmp_eq_u32 vcc, -1, v199
s_cbranch_vccz L_gk_182
buffer_load_dwordx4 v[40:43], v1, s[4:7], s49 offen offset:2048 sc1
L_gk_182:
v_max_u32 v199, v44, v46
v_cmp_eq_u32 vcc, -1, v199
s_cbranch_vccz L_gk_183
buffer_load_dwordx4 v[44:47], v1, s[4:7], s49 offen offset:3072 sc1
L_gk_183:
s_waitcnt vmcnt(0)
s_sub_u32 s73, s73, 1
s_cmp_lg_u32 s73, 0
s_cbranch_scc1 L_gc_122
s_branch L_chexit_2
L_gs_126:
s_waitcnt vmcnt(0)
buffer_load_dwordx4 v[40:43], v1, s[4:7], s49 offen offset:2048 sc1
v_max_u32 v199, v44, v46
v_cmp_eq_u32 vcc, -1, v199
s_cbranch_vccz L_gk_184
buffer_load_dwordx4 v[44:47], v1, s[4:7], s49 offen offset:3072 sc1
L_gk_184:
s_waitcnt vmcnt(0)
s_sub_u32 s73, s73, 1
s_cmp_lg_u32 s73, 0
s_cbranch_scc1 L_gc_125
s_branch L_chexit_2
L_gs_129:
s_waitcnt vmcnt(0)
buffer_load_dwordx4 v[44:47], v1, s[4:7], s49 offen offset:3072 sc1
s_waitcnt vmcnt(0)
s_sub_u32 s73, s73, 1
s_cmp_lg_u32 s73, 0
s_cbranch_scc1 L_gc_128
s_branch L_chexit_2
L_gs_135:
s_waitcnt vmcnt(0)
buffer_load_dwordx4 v[108:111], v1, s[4:7], s51 offen sc1
v_cmp_eq_u32 vcc, -1, v112
s_cbranch_vccz L_gk_185
buffer_load_dwordx4 v[112:115], v1, s[4:7], s52 offen sc1
L_gk_185:
v_cmp_eq_u32 vcc, -1, v116
s_cbranch_vccz L_gk_186
buffer_load_dwordx4 v[116:119], v1, s[4:7], s53 offen sc1
L_gk_186:
s_waitcnt vmcnt(0)
s_sub_u32 s73, s73, 1
s_cmp_lg_u32 s73, 0
s_cbranch_scc1 L_gc_134
s_branch L_chexit_2
L_gs_138:
s_waitcnt vmcnt(0)
buffer_load_dwordx4 v[112:115], v1, s[4:7], s52 offen sc1
v_cmp_eq_u32 vcc, -1, v116
s_cbranch_vccz L_gk_187
buffer_load_dwordx4 v[116:119], v1, s[4:7], s53 offen sc1
L_gk_187:
s_waitcnt vmcnt(0)
s_sub_u32 s73, s73, 1
s_cmp_lg_u32 s73, 0
s_cbranch_scc1 L_gc_137
s_branch L_chexit_2
L_gs_141:
s_waitcnt vmcnt(0)
buffer_load_dwordx4 v[116:119], v1, s[4:7], s53 offen sc1
s_waitcnt vmcnt(0)
s_sub_u32 s73, s73, 1
s_cmp_lg_u32 s73, 0
s_cbranch_scc1 L_gc_140
s_branch L_chexit_2
L_gs_147:
s_waitcnt vmcnt(0)
buffer_load_dwordx4 v[32:35], v1, s[4:7], s55 offen offset:0 sc1
v_max_u32 v199, v36, v38
v_cmp_eq_u32 vcc, -1, v199
s_cbranch_vccz L_gk_188
buffer_load_dwordx4 v[36:39], v1, s[4:7], s55 offen offset:1024 sc1
L_gk_188:
v_max_u32 v199, v40, v42
v_cmp_eq_u32 vcc, -1, v199
s_cbranch_vccz L_gk_189
buffer_load_dwordx4 v[40:43], v1, s[4:7], s55 offen offset:2048 sc1
L_gk_189:
v_max_u32 v199, v44, v46
v_cmp_eq_u32 vcc, -1, v199
s_cbranch_vccz L_gk_190
buffer_load_dwordx4 v[44:47], v1, s[4:7], s55 offen offset:3072 sc1
L_gk_190:
s_waitcnt vmcnt(0)
s_sub_u32 s73, s73, 1
s_cmp_lg_u32 s73, 0
s_cbranch_scc1 L_gc_146
s_branch L_chexit_2
L_gs_150:
s_waitcnt vmcnt(0)
buffer_load_dwordx4 v[36:39], v1, s[4:7], s55 offen offset:1024 sc1
v_max_u32 v199, v40, v42
v_cmp_eq_u32 vcc, -1, v199
s_cbranch_vccz L_gk_191
buffer_load_dwordx4 v[40:43], v1, s[4:7], s55 offen offset:2048 sc1
L_gk_191:
v_max_u32 v199, v44, v46
v_cmp_eq_u32 vcc, -1, v199
s_cbranch_vccz L_gk_192
buffer_load_dwordx4 v[44:47], v1, s[4:7], s55 offen offset:3072 sc1
L_gk_192:
s_waitcnt vmcnt(0)
s_sub_u32 s73, s73, 1
s_cmp_lg_u32 s73, 0
s_cbranch_scc1 L_gc_149
s_branch L_chexit_2
L_gs_153:
s_waitcnt vmcnt(0)
buffer_load_dwordx4 v[40:43], v1, s[4:7], s55 offen offset:2048 sc1
v_max_u32 v199, v44, v46
v_cmp_eq_u32 vcc, -1, v199
s_cbranch_vccz L_gk_193
buffer_load_dwordx4 v[44:47], v1, s[4:7], s55 offen offset:3072 sc1
L_gk_193:
s_waitcnt vmcnt(0)
s_sub_u32 s73, s73, 1
s_cmp_lg_u32 s73, 0
s_cbranch_scc1 L_gc_152
s_branch L_chexit_2
L_gs_156:
s_waitcnt vmcnt(0)
buffer_load_dwordx4 v[44:47], v1, s[4:7], s55 offen offset:3072 sc1
s_waitcnt vmcnt(0)
s_sub_u32 s73, s73, 1
s_cmp_lg_u32 s73, 0
s_cbranch_scc1 L_gc_155
s_branch L_chexit_2
L_gs_160:
s_waitcnt vmcnt(0)
buffer_load_dwordx4 v[76:79], v1, s[4:7], s57 offen sc1
v_xor_b32 v199, v80, v190
v_and_b32 v199, 1, v199
v_cmp_ne_u32 vcc, 0, v199
s_cbranch_vccz L_gk_194
buffer_load_dwordx4 v[80:83], v1, s[4:7], s58 offen sc1
L_gk_194:
v_xor_b32 v199, v84, v190
v_and_b32 v199, 1, v199
v_cmp_ne_u32 vcc, 0, v199
s_cbranch_vccz L_gk_195
buffer_load_dwordx4 v[84:87], v1, s[4:7], s59 offen sc1
L_gk_195:
s_waitcnt vmcnt(0)
s_sub_u32 s73, s73, 1
s_cmp_lg_u32 s73, 0
s_cbranch_scc1 L_gc_159
s_branch L_chexit_2
L_gs_163:
s_waitcnt vmcnt(0)
buffer_load_dwordx4 v[80:83], v1, s[4:7], s58 offen sc1
v_xor_b32 v199, v84, v190
v_and_b32 v199, 1, v199
v_cmp_ne_u32 vcc, 0, v199
s_cbranch_vccz L_gk_196
buffer_load_dwordx4 v[84:87], v1, s[4:7], s59 offen sc1
L_gk_196:
s_waitcnt vmcnt(0)
s_sub_u32 s73, s73, 1
s_cmp_lg_u32 s73, 0
s_cbranch_scc1 L_gc_162
s_branch L_chexit_2
L_gs_166:
s_waitcnt vmcnt(0)
buffer_load_dwordx4 v[84:87], v1, s[4:7], s59 offen sc1
s_waitcnt vmcnt(0)
s_sub_u32 s73, s73, 1
s_cmp_lg_u32 s73, 0
s_cbranch_scc1 L_gc_165
s_branch L_chexit_2
L_chexit_2:
v_mov_b32 v184, 0
v_mov_b32 v185, s48
v_add_u32 v185, 0x100, v185
global_store_dword v184, v185, s[44:45] offset:20
s_branch L_chend_3
L_fin_36:
s_cmp_lg_u32 s3, 3
s_cbranch_scc1 L_chend_3
ds_read_b128 v[184:187], v1 offset:17408
ds_read_b64 v[188:189], v3 offset:18432
s_waitcnt lgkmcnt(0)
buffer_store_dwordx4 v[184:187], v7, s[4:7], s71 offen sc1
buffer_store_dwordx2 v[188:189], v3, s[4:7], s72 offen sc1
s_add_u32 s71, s71, 65536
s_add_u32 s72, s72, 65536
L_chend_3:
s_waitcnt vmcnt(0)
s_cmp_lg_u32 s3, 3
s_cbranch_scc1 L_nf_197
s_lshr_b32 s52, s63, 2
s_add_u32 s52, s52, 184
s_lshl_b32 s74, s52, 8
s_add_u32 s74, s74, 98566144
v_mov_b32 v184, 0
v_mov_b32 v185, 1
s_mov_b64 exec, 1
buffer_atomic_add v185, v184, s[4:7], s74 offen sc1
s_mov_b64 exec, -1
L_nf_197:
v_mbcnt_lo_u32_b32 v0, -1, 0
v_mbcnt_hi_u32_b32 v0, -1, v0
s_lshl_b32 s48, s3, 6
v_add_u32 v0, s48, v0
s_mov_b32 s73, 1000000
s_lshl_b32 s52, s60, 16
s_lshl_b32 s53, s3, 14
s_add_u32 s52, s52, s53
s_add_u32 s52, s52, 84934656
s_lshl_b32 s53, s60, 22
s_lshl_b32 s54, s61, 11
s_add_u32 s53, s53, s54
s_and_b32 s54, s3, 1
s_lshl_b32 s54, s54, 8
s_add_u32 s53, s53, s54
s_add_u32 s53, s53, 112984064
s_lshl_b32 s57, s61, 2
s_add_u32 s57, s57, s3
s_lshl_b32 s57, s57, 9
s_lshl_b32 s58, s60, 16
s_add_u32 s57, s57, s58
s_add_u32 s57, s57, 84934656
v_bfe_u32 v250, v0, 2, 3
v_lshlrev_b32 v250, 18, v250
v_and_b32 v251, 3, v0
v_lshl_add_u32 v250, v251, 7, v250
s_mov_b64 exec, 0xff
buffer_load_dword v252, v250, s[4:7], s57 offen sc1
s_mov_b64 exec, -1
v_and_b32 v250, 3, v0
v_lshlrev_b32 v250, 8, v250
s_mov_b32 s55, 0
s_mov_b32 s58, 0
s_mov_b32 s56, 4
v_and_b32 v14, 15, v0
v_lshlrev_b32 v14, 4, v14
v_bfe_u32 v15, v0, 4, 2
v_lshl_add_u32 v14, v15, 9, v14
s_mul_i32 s74, s3, 24576
v_add_u32 v13, s74, v1
s_lshl_b32 s74, s3, 11
v_add_u32 v15, s74, v1
s_cmp_ge_u32 s55, s56
s_cbranch_scc1 L_ps_198
L_psl_199:
s_cmp_lt_u32 s55, s58
s_cbranch_scc1 L_pso_200
s_mov_b32 s57, 98593792
buffer_load_dword v251, v250, s[4:7], s57 offen sc1
s_waitcnt vmcnt(0)
v_cmp_le_u32 vcc, 8, v251
s_nop 1
s_and_b32 s58, vcc_lo, 15
s_ff0_i32_b32 s58, s58
s_sub_u32 s73, s73, 1
s_cmp_lg_u32 s73, 0
s_cbranch_scc1 L_psl_199
s_branch L_fail
L_pso_200:
s_add_u32 s55, s55, 1
L_ps_198:
s_add_u32 s74, s52, 0
buffer_load_dwordx4 v[32:35], v14, s[4:7], s74 offen offset:0 sc1
buffer_load_dwordx4 v[36:39], v14, s[4:7], s74 offen offset:256 sc1
buffer_load_dwordx4 v[40:43], v14, s[4:7], s74 offen offset:2048 sc1
buffer_load_dwordx4 v[44:47], v14, s[4:7], s74 offen offset:2304 sc1
s_add_u32 s74, s52, 4096
buffer_load_dwordx4 v[48:51], v14, s[4:7], s74 offen offset:0 sc1
buffer_load_dwordx4 v[52:55], v14, s[4:7], s74 offen offset:256 sc1
buffer_load_dwordx4 v[56:59], v14, s[4:7], s74 offen offset:2048 sc1
buffer_load_dwordx4 v[60:63], v14, s[4:7], s74 offen offset:2304 sc1
s_add_u32 s74, s52, 8192
buffer_load_dwordx4 v[64:67], v14, s[4:7], s74 offen offset:0 sc1
buffer_load_dwordx4 v[68:71], v14, s[4:7], s74 offen offset:256 sc1
buffer_load_dwordx4 v[72:75], v14, s[4:7], s74 offen offset:2048 sc1
buffer_load_dwordx4 v[76:79], v14, s[4:7], s74 offen offset:2304 sc1
s_add_u32 s74, s52, 12288
buffer_load_dwordx4 v[80:83], v14, s[4:7], s74 offen offset:0 sc1
buffer_load_dwordx4 v[84:87], v14, s[4:7], s74 offen offset:256 sc1
buffer_load_dwordx4 v[88:91], v14, s[4:7], s74 offen offset:2048 sc1
buffer_load_dwordx4 v[92:95], v14, s[4:7], s74 offen offset:2304 sc1
s_add_u32 s52, s52, 262144
s_cmp_ge_u32 s55, s56
s_cbranch_scc1 L_ps_201
L_psl_202:
s_cmp_lt_u32 s55, s58
s_cbranch_scc1 L_pso_203
s_mov_b32 s57, 98593792
buffer_load_dword v251, v250, s[4:7], s57 offen sc1
s_waitcnt vmcnt(0)
v_cmp_le_u32 vcc, 8, v251
s_nop 1
s_and_b32 s58, vcc_lo, 15
s_ff0_i32_b32 s58, s58
s_sub_u32 s73, s73, 1
s_cmp_lg_u32 s73, 0
s_cbranch_scc1 L_psl_202
s_branch L_fail
L_pso_203:
s_add_u32 s55, s55, 1
L_ps_201:
s_waitcnt vmcnt(14)
v_swap_b32 v33, v34
v_swap_b32 v37, v38
s_nop 0
v_mfma_f32_16x16x32_bf16 a[0:3], a[192:195], v[32:35], 0
s_waitcnt vmcnt(13)
v_swap_b32 v41, v42
s_add_u32 s74, s52, 0
buffer_load_dwordx4 v[96:99], v14, s[4:7], s74 offen offset:0 sc1
v_mfma_f32_16x16x32_bf16 a[4:7], a[200:203], v[32:35], 0
v_mfma_f32_16x16x32_bf16 a[8:11], a[192:195], v[36:39], 0
s_waitcnt vmcnt(13)
v_swap_b32 v45, v46
buffer_load_dwordx4 v[100:103], v14, s[4:7], s74 offen offset:256 sc1
v_mfma_f32_16x16x32_bf16 a[12:15], a[200:203], v[36:39], 0
v_mfma_f32_16x16x32_bf16 a[0:3], a[196:199], v[40:43], a[0:3]
s_waitcnt vmcnt(13)
v_swap_b32 v49, v50
buffer_load_dwordx4 v[104:107], v14, s[4:7], s74 offen offset:2048 sc1
v_mfma_f32_16x16x32_bf16 a[4:7], a[204:207], v[40:43], a[4:7]
v_mfma_f32_16x16x32_bf16 a[8:11], a[196:199], v[44:47], a[8:11]
s_waitcnt vmcnt(13)
v_swap_b32 v53, v54
buffer_load_dwordx4 v[108:111], v14, s[4:7], s74 offen offset:2304 sc1
v_mfma_f32_16x16x32_bf16 a[12:15], a[204:207], v[44:47], a[12:15]
v_mfma_f32_16x16x32_bf16 a[0:3], a[208:211], v[48:51], a[0:3]
s_waitcnt vmcnt(13)
v_swap_b32 v57, v58
s_add_u32 s74, s52, 4096
buffer_load_dwordx4 v[112:115], v14, s[4:7], s74 offen offset:0 sc1
v_mfma_f32_16x16x32_bf16 a[4:7], a[216:219], v[48:51], a[4:7]
v_mfma_f32_16x16x32_bf16 a[8:11], a[208:211], v[52:55], a[8:11]
s_waitcnt vmcnt(13)
v_swap_b32 v61, v62
buffer_load_dwordx4 v[116:119], v14, s[4:7], s74 offen offset:256 sc1
v_mfma_f32_16x16x32_bf16 a[12:15], a[216:219], v[52:55], a[12:15]
v_mfma_f32_16x16x32_bf16 a[0:3], a[212:215], v[56:59], a[0:3]
s_waitcnt vmcnt(13)
v_swap_b32 v65, v66
buffer_load_dwordx4 v[120:123], v14, s[4:7], s74 offen offset:2048 sc1
v_mfma_f32_16x16x32_bf16 a[4:7], a[220:223], v[56:59], a[4:7]
v_mfma_f32_16x16x32_bf16 a[8:11], a[212:215], v[60:63], a[8:11]
s_waitcnt vmcnt(13)
v_swap_b32 v69, v70
buffer_load_dwordx4 v[124:127], v14, s[4:7], s74 offen offset:2304 sc1
v_mfma_f32_16x16x32_bf16 a[12:15], a[220:223], v[60:63], a[12:15]
v_mfma_f32_16x16x32_bf16 a[0:3], a[224:227], v[64:67], a[0:3]
s_waitcnt vmcnt(13)
v_swap_b32 v73, v74
s_add_u32 s74, s52, 8192
buffer_load_dwordx4 v[128:131], v14, s[4:7], s74 offen offset:0 sc1
v_mfma_f32_16x16x32_bf16 a[4:7], a[232:235], v[64:67], a[4:7]
v_mfma_f32_16x16x32_bf16 a[8:11], a[224:227], v[68:71], a[8:11]
s_waitcnt vmcnt(13)
v_swap_b32 v77, v78
buffer_load_dwordx4 v[132:135], v14, s[4:7], s74 offen offset:256 sc1
v_mfma_f32_16x16x32_bf16 a[12:15], a[232:235], v[68:71], a[12:15]
v_mfma_f32_16x16x32_bf16 a[0:3], a[228:231], v[72:75], a[0:3]
s_waitcnt vmcnt(13)
v_swap_b32 v81, v82
buffer_load_dwordx4 v[136:139], v14, s[4:7], s74 offen offset:2048 sc1
v_mfma_f32_16x16x32_bf16 a[4:7], a[236:239], v[72:75], a[4:7]
v_mfma_f32_16x16x32_bf16 a[8:11], a[228:231], v[76:79], a[8:11]
s_waitcnt vmcnt(13)
v_swap_b32 v85, v86
buffer_load_dwordx4 v[140:143], v14, s[4:7], s74 offen offset:2304 sc1
v_mfma_f32_16x16x32_bf16 a[12:15], a[236:239], v[76:79], a[12:15]
v_mfma_f32_16x16x32_bf16 a[0:3], a[240:243], v[80:83], a[0:3]
s_waitcnt vmcnt(13)
v_swap_b32 v89, v90
s_add_u32 s74, s52, 12288
buffer_load_dwordx4 v[144:147], v14, s[4:7], s74 offen offset:0 sc1
v_mfma_f32_16x16x32_bf16 a[4:7], a[248:251], v[80:83], a[4:7]
v_mfma_f32_16x16x32_bf16 a[8:11], a[240:243], v[84:87], a[8:11]
s_waitcnt vmcnt(13)
v_swap_b32 v93, v94
buffer_load_dwordx4 v[148:151], v14, s[4:7], s74 offen offset:256 sc1
v_mfma_f32_16x16x32_bf16 a[12:15], a[248:251], v[84:87], a[12:15]
v_mfma_f32_16x16x32_bf16 a[0:3], a[244:247], v[88:91], a[0:3]
buffer_load_dwordx4 v[152:155], v14, s[4:7], s74 offen offset:2048 sc1
v_mfma_f32_16x16x32_bf16 a[4:7], a[252:255], v[88:91], a[4:7]
v_mfma_f32_16x16x32_bf16 a[8:11], a[244:247], v[92:95], a[8:11]
buffer_load_dwordx4 v[156:159], v14, s[4:7], s74 offen offset:2304 sc1
v_mfma_f32_16x16x32_bf16 a[12:15], a[252:255], v[92:95], a[12:15]
s_add_u32 s52, s52, 262144
s_cmp_ge_u32 s55, s56
s_cbranch_scc1 L_ps_204
L_psl_205:
s_cmp_lt_u32 s55, s58
s_cbranch_scc1 L_pso_206
s_mov_b32 s57, 98593792
buffer_load_dword v251, v250, s[4:7], s57 offen sc1
s_waitcnt vmcnt(0)
v_cmp_le_u32 vcc, 8, v251
s_nop 1
s_and_b32 s58, vcc_lo, 15
s_ff0_i32_b32 s58, s58
s_sub_u32 s73, s73, 1
s_cmp_lg_u32 s73, 0
s_cbranch_scc1 L_psl_205
s_branch L_fail
L_pso_206:
s_add_u32 s55, s55, 1
L_ps_204:
s_waitcnt vmcnt(14)
v_swap_b32 v97, v98
v_swap_b32 v101, v102
s_nop 0
v_mfma_f32_16x16x32_bf16 a[16:19], a[192:195], v[96:99], 0
s_waitcnt vmcnt(13)
v_swap_b32 v105, v106
s_add_u32 s74, s52, 0
buffer_load_dwordx4 v[32:35], v14, s[4:7], s74 offen offset:0 sc1
v_mfma_f32_16x16x32_bf16 a[20:23], a[200:203], v[96:99], 0
v_mfma_f32_16x16x32_bf16 a[24:27], a[192:195], v[100:103], 0
s_waitcnt vmcnt(13)
v_swap_b32 v109, v110
buffer_load_dwordx4 v[36:39], v14, s[4:7], s74 offen offset:256 sc1
v_mfma_f32_16x16x32_bf16 a[28:31], a[200:203], v[100:103], 0
v_mfma_f32_16x16x32_bf16 a[16:19], a[196:199], v[104:107], a[16:19]
s_waitcnt vmcnt(13)
v_swap_b32 v113, v114
buffer_load_dwordx4 v[40:43], v14, s[4:7], s74 offen offset:2048 sc1
v_mfma_f32_16x16x32_bf16 a[20:23], a[204:207], v[104:107], a[20:23]
v_mfma_f32_16x16x32_bf16 a[24:27], a[196:199], v[108:111], a[24:27]
s_waitcnt vmcnt(13)
v_swap_b32 v117, v118
buffer_load_dwordx4 v[44:47], v14, s[4:7], s74 offen offset:2304 sc1
v_mfma_f32_16x16x32_bf16 a[28:31], a[204:207], v[108:111], a[28:31]
v_mfma_f32_16x16x32_bf16 a[16:19], a[208:211], v[112:115], a[16:19]
s_waitcnt vmcnt(13)
v_swap_b32 v121, v122
s_add_u32 s74, s52, 4096
buffer_load_dwordx4 v[48:51], v14, s[4:7], s74 offen offset:0 sc1
v_mfma_f32_16x16x32_bf16 a[20:23], a[216:219], v[112:115], a[20:23]
v_mfma_f32_16x16x32_bf16 a[24:27], a[208:211], v[116:119], a[24:27]
s_waitcnt vmcnt(13)
v_swap_b32 v125, v126
buffer_load_dwordx4 v[52:55], v14, s[4:7], s74 offen offset:256 sc1
v_mfma_f32_16x16x32_bf16 a[28:31], a[216:219], v[116:119], a[28:31]
v_mfma_f32_16x16x32_bf16 a[16:19], a[212:215], v[120:123], a[16:19]
s_waitcnt vmcnt(13)
v_swap_b32 v129, v130
buffer_load_dwordx4 v[56:59], v14, s[4:7], s74 offen offset:2048 sc1
v_mfma_f32_16x16x32_bf16 a[20:23], a[220:223], v[120:123], a[20:23]
v_mfma_f32_16x16x32_bf16 a[24:27], a[212:215], v[124:127], a[24:27]
s_waitcnt vmcnt(13)
v_swap_b32 v133, v134
buffer_load_dwordx4 v[60:63], v14, s[4:7], s74 offen offset:2304 sc1
v_mfma_f32_16x16x32_bf16 a[28:31], a[220:223], v[124:127], a[28:31]
v_mfma_f32_16x16x32_bf16 a[16:19], a[224:227], v[128:131], a[16:19]
s_waitcnt vmcnt(13)
v_swap_b32 v137, v138
s_add_u32 s74, s52, 8192
buffer_load_dwordx4 v[64:67], v14, s[4:7], s74 offen offset:0 sc1
v_mfma_f32_16x16x32_bf16 a[20:23], a[232:235], v[128:131], a[20:23]
v_mfma_f32_16x16x32_bf16 a[24:27], a[224:227], v[132:135], a[24:27]
s_waitcnt vmcnt(13)
v_swap_b32 v141, v142
buffer_load_dwordx4 v[68:71], v14, s[4:7], s74 offen offset:256 sc1
v_mfma_f32_16x16x32_bf16 a[28:31], a[232:235], v[132:135], a[28:31]
v_mfma_f32_16x16x32_bf16 a[16:19], a[228:231], v[136:139], a[16:19]
s_waitcnt vmcnt(13)
v_swap_b32 v145, v146
buffer_load_dwordx4 v[72:75], v14, s[4:7], s74 offen offset:2048 sc1
v_mfma_f32_16x16x32_bf16 a[20:23], a[236:239], v[136:139], a[20:23]
v_mfma_f32_16x16x32_bf16 a[24:27], a[228:231], v[140:143], a[24:27]
s_waitcnt vmcnt(13)
v_swap_b32 v149, v150
buffer_load_dwordx4 v[76:79], v14, s[4:7], s74 offen offset:2304 sc1
v_mfma_f32_16x16x32_bf16 a[28:31], a[236:239], v[140:143], a[28:31]
v_mfma_f32_16x16x32_bf16 a[16:19], a[240:243], v[144:147], a[16:19]
s_waitcnt vmcnt(13)
v_swap_b32 v153, v154
s_add_u32 s74, s52, 12288
buffer_load_dwordx4 v[80:83], v14, s[4:7], s74 offen offset:0 sc1
v_mfma_f32_16x16x32_bf16 a[20:23], a[248:251], v[144:147], a[20:23]
v_mfma_f32_16x16x32_bf16 a[24:27], a[240:243], v[148:151], a[24:27]
s_waitcnt vmcnt(13)
v_swap_b32 v157, v158
buffer_load_dwordx4 v[84:87], v14, s[4:7], s74 offen offset:256 sc1
v_mfma_f32_16x16x32_bf16 a[28:31], a[248:251], v[148:151], a[28:31]
v_mfma_f32_16x16x32_bf16 a[16:19], a[244:247], v[152:155], a[16:19]
buffer_load_dwordx4 v[88:91], v14, s[4:7], s74 offen offset:2048 sc1
v_mfma_f32_16x16x32_bf16 a[20:23], a[252:255], v[152:155], a[20:23]
v_mfma_f32_16x16x32_bf16 a[24:27], a[244:247], v[156:159], a[24:27]
buffer_load_dwordx4 v[92:95], v14, s[4:7], s74 offen offset:2304 sc1
v_mfma_f32_16x16x32_bf16 a[28:31], a[252:255], v[156:159], a[28:31]
s_add_u32 s52, s52, 262144
s_cmp_ge_u32 s55, s56
s_cbranch_scc1 L_ps_207
L_psl_208:
s_cmp_lt_u32 s55, s58
s_cbranch_scc1 L_pso_209
s_mov_b32 s57, 98593792
buffer_load_dword v251, v250, s[4:7], s57 offen sc1
s_waitcnt vmcnt(0)
v_cmp_le_u32 vcc, 8, v251
s_nop 1
s_and_b32 s58, vcc_lo, 15
s_ff0_i32_b32 s58, s58
s_sub_u32 s73, s73, 1
s_cmp_lg_u32 s73, 0
s_cbranch_scc1 L_psl_208
s_branch L_fail
L_pso_209:
s_add_u32 s55, s55, 1
L_ps_207:
s_waitcnt vmcnt(14)
v_swap_b32 v33, v34
v_swap_b32 v37, v38
s_nop 0
v_mfma_f32_16x16x32_bf16 a[32:35], a[192:195], v[32:35], 0
s_waitcnt vmcnt(13)
v_swap_b32 v41, v42
s_add_u32 s74, s52, 0
buffer_load_dwordx4 v[96:99], v14, s[4:7], s74 offen offset:0 sc1
v_mfma_f32_16x16x32_bf16 a[36:39], a[200:203], v[32:35], 0
v_mfma_f32_16x16x32_bf16 a[40:43], a[192:195], v[36:39], 0
s_waitcnt vmcnt(13)
v_swap_b32 v45, v46
buffer_load_dwordx4 v[100:103], v14, s[4:7], s74 offen offset:256 sc1
v_mfma_f32_16x16x32_bf16 a[44:47], a[200:203], v[36:39], 0
v_mfma_f32_16x16x32_bf16 a[32:35], a[196:199], v[40:43], a[32:35]
s_waitcnt vmcnt(13)
v_swap_b32 v49, v50
buffer_load_dwordx4 v[104:107], v14, s[4:7], s74 offen offset:2048 sc1
v_mfma_f32_16x16x32_bf16 a[36:39], a[204:207], v[40:43], a[36:39]
v_mfma_f32_16x16x32_bf16 a[40:43], a[196:199], v[44:47], a[40:43]
s_waitcnt vmcnt(13)
v_swap_b32 v53, v54
buffer_load_dwordx4 v[108:111], v14, s[4:7], s74 offen offset:2304 sc1
v_mfma_f32_16x16x32_bf16 a[44:47], a[204:207], v[44:47], a[44:47]
v_mfma_f32_16x16x32_bf16 a[32:35], a[208:211], v[48:51], a[32:35]
s_waitcnt vmcnt(13)
v_swap_b32 v57, v58
s_add_u32 s74, s52, 4096
buffer_load_dwordx4 v[112:115], v14, s[4:7], s74 offen offset:0 sc1
v_mfma_f32_16x16x32_bf16 a[36:39], a[216:219], v[48:51], a[36:39]
v_mfma_f32_16x16x32_bf16 a[40:43], a[208:211], v[52:55], a[40:43]
s_waitcnt vmcnt(13)
v_swap_b32 v61, v62
buffer_load_dwordx4 v[116:119], v14, s[4:7], s74 offen offset:256 sc1
v_mfma_f32_16x16x32_bf16 a[44:47], a[216:219], v[52:55], a[44:47]
v_mfma_f32_16x16x32_bf16 a[32:35], a[212:215], v[56:59], a[32:35]
s_waitcnt vmcnt(13)
v_swap_b32 v65, v66
buffer_load_dwordx4 v[120:123], v14, s[4:7], s74 offen offset:2048 sc1
v_mfma_f32_16x16x32_bf16 a[36:39], a[220:223], v[56:59], a[36:39]
v_mfma_f32_16x16x32_bf16 a[40:43], a[212:215], v[60:63], a[40:43]
s_waitcnt vmcnt(13)
v_swap_b32 v69, v70
buffer_load_dwordx4 v[124:127], v14, s[4:7], s74 offen offset:2304 sc1
v_mfma_f32_16x16x32_bf16 a[44:47], a[220:223], v[60:63], a[44:47]
v_mfma_f32_16x16x32_bf16 a[32:35], a[224:227], v[64:67], a[32:35]
s_waitcnt vmcnt(13)
v_swap_b32 v73, v74
s_add_u32 s74, s52, 8192
buffer_load_dwordx4 v[128:131], v14, s[4:7], s74 offen offset:0 sc1
v_mfma_f32_16x16x32_bf16 a[36:39], a[232:235], v[64:67], a[36:39]
v_mfma_f32_16x16x32_bf16 a[40:43], a[224:227], v[68:71], a[40:43]
s_waitcnt vmcnt(13)
v_swap_b32 v77, v78
buffer_load_dwordx4 v[132:135], v14, s[4:7], s74 offen offset:256 sc1
v_mfma_f32_16x16x32_bf16 a[44:47], a[232:235], v[68:71], a[44:47]
v_mfma_f32_16x16x32_bf16 a[32:35], a[228:231], v[72:75], a[32:35]
s_waitcnt vmcnt(13)
v_swap_b32 v81, v82
buffer_load_dwordx4 v[136:139], v14, s[4:7], s74 offen offset:2048 sc1
v_mfma_f32_16x16x32_bf16 a[36:39], a[236:239], v[72:75], a[36:39]
v_mfma_f32_16x16x32_bf16 a[40:43], a[228:231], v[76:79], a[40:43]
s_waitcnt vmcnt(13)
v_swap_b32 v85, v86
buffer_load_dwordx4 v[140:143], v14, s[4:7], s74 offen offset:2304 sc1
v_mfma_f32_16x16x32_bf16 a[44:47], a[236:239], v[76:79], a[44:47]
v_mfma_f32_16x16x32_bf16 a[32:35], a[240:243], v[80:83], a[32:35]
s_waitcnt vmcnt(13)
v_swap_b32 v89, v90
s_add_u32 s74, s52, 12288
buffer_load_dwordx4 v[144:147], v14, s[4:7], s74 offen offset:0 sc1
v_mfma_f32_16x16x32_bf16 a[36:39], a[248:251], v[80:83], a[36:39]
v_mfma_f32_16x16x32_bf16 a[40:43], a[240:243], v[84:87], a[40:43]
s_waitcnt vmcnt(13)
v_swap_b32 v93, v94
buffer_load_dwordx4 v[148:151], v14, s[4:7], s74 offen offset:256 sc1
v_mfma_f32_16x16x32_bf16 a[44:47], a[248:251], v[84:87], a[44:47]
v_mfma_f32_16x16x32_bf16 a[32:35], a[244:247], v[88:91], a[32:35]
buffer_load_dwordx4 v[152:155], v14, s[4:7], s74 offen offset:2048 sc1
v_mfma_f32_16x16x32_bf16 a[36:39], a[252:255], v[88:91], a[36:39]
v_mfma_f32_16x16x32_bf16 a[40:43], a[244:247], v[92:95], a[40:43]
buffer_load_dwordx4 v[156:159], v14, s[4:7], s74 offen offset:2304 sc1
v_mfma_f32_16x16x32_bf16 a[44:47], a[252:255], v[92:95], a[44:47]
s_add_u32 s52, s52, 262144
s_waitcnt vmcnt(14)
v_swap_b32 v97, v98
v_swap_b32 v101, v102
s_nop 0
v_mfma_f32_16x16x32_bf16 a[48:51], a[192:195], v[96:99], 0
s_waitcnt vmcnt(13)
v_swap_b32 v105, v106
v_mfma_f32_16x16x32_bf16 a[52:55], a[200:203], v[96:99], 0
v_mfma_f32_16x16x32_bf16 a[56:59], a[192:195], v[100:103], 0
s_waitcnt vmcnt(12)
v_swap_b32 v109, v110
v_mfma_f32_16x16x32_bf16 a[60:63], a[200:203], v[100:103], 0
v_mfma_f32_16x16x32_bf16 a[48:51], a[196:199], v[104:107], a[48:51]
s_waitcnt vmcnt(11)
v_swap_b32 v113, v114
v_mfma_f32_16x16x32_bf16 a[52:55], a[204:207], v[104:107], a[52:55]
v_mfma_f32_16x16x32_bf16 a[56:59], a[196:199], v[108:111], a[56:59]
s_waitcnt vmcnt(10)
v_swap_b32 v117, v118
v_mfma_f32_16x16x32_bf16 a[60:63], a[204:207], v[108:111], a[60:63]
v_mfma_f32_16x16x32_bf16 a[48:51], a[208:211], v[112:115], a[48:51]
s_waitcnt vmcnt(9)
v_swap_b32 v121, v122
v_mfma_f32_16x16x32_bf16 a[52:55], a[216:219], v[112:115], a[52:55]
v_mfma_f32_16x16x32_bf16 a[56:59], a[208:211], v[116:119], a[56:59]
s_waitcnt vmcnt(8)
v_swap_b32 v125, v126
v_mfma_f32_16x16x32_bf16 a[60:63], a[216:219], v[116:119], a[60:63]
v_mfma_f32_16x16x32_bf16 a[48:51], a[212:215], v[120:123], a[48:51]
s_waitcnt vmcnt(7)
v_swap_b32 v129, v130
v_mfma_f32_16x16x32_bf16 a[52:55], a[220:223], v[120:123], a[52:55]
v_mfma_f32_16x16x32_bf16 a[56:59], a[212:215], v[124:127], a[56:59]
s_waitcnt vmcnt(6)
v_swap_b32 v133, v134
v_mfma_f32_16x16x32_bf16 a[60:63], a[220:223], v[124:127], a[60:63]
v_mfma_f32_16x16x32_bf16 a[48:51], a[224:227], v[128:131], a[48:51]
s_waitcnt vmcnt(5)
v_swap_b32 v137, v138
v_mfma_f32_16x16x32_bf16 a[52:55], a[232:235], v[128:131], a[52:55]
v_mfma_f32_16x16x32_bf16 a[56:59], a[224:227], v[132:135], a[56:59]
s_waitcnt vmcnt(4)
v_swap_b32 v141, v142
v_mfma_f32_16x16x32_bf16 a[60:63], a[232:235], v[132:135], a[60:63]
v_mfma_f32_16x16x32_bf16 a[48:51], a[228:231], v[136:139], a[48:51]
s_waitcnt vmcnt(3)
v_swap_b32 v145, v146
v_mfma_f32_16x16x32_bf16 a[52:55], a[236:239], v[136:139], a[52:55]
v_mfma_f32_16x16x32_bf16 a[56:59], a[228:231], v[140:143], a[56:59]
s_waitcnt vmcnt(2)
v_swap_b32 v149, v150
v_mfma_f32_16x16x32_bf16 a[60:63], a[236:239], v[140:143], a[60:63]
v_mfma_f32_16x16x32_bf16 a[48:51], a[240:243], v[144:147], a[48:51]
s_waitcnt vmcnt(1)
v_swap_b32 v153, v154
v_mfma_f32_16x16x32_bf16 a[52:55], a[248:251], v[144:147], a[52:55]
v_mfma_f32_16x16x32_bf16 a[56:59], a[240:243], v[148:151], a[56:59]
s_waitcnt vmcnt(0)
v_swap_b32 v157, v158
v_mfma_f32_16x16x32_bf16 a[60:63], a[248:251], v[148:151], a[60:63]
v_mfma_f32_16x16x32_bf16 a[48:51], a[244:247], v[152:155], a[48:51]
v_mfma_f32_16x16x32_bf16 a[52:55], a[252:255], v[152:155], a[52:55]
v_mfma_f32_16x16x32_bf16 a[56:59], a[244:247], v[156:159], a[56:59]
v_mfma_f32_16x16x32_bf16 a[60:63], a[252:255], v[156:159], a[60:63]
s_nop 7
ds_write_b128 v13, a[0:3] offset:0
ds_write_b128 v13, a[4:7] offset:1024
ds_write_b128 v13, a[8:11] offset:2048
ds_write_b128 v13, a[12:15] offset:3072
ds_write_b128 v13, a[16:19] offset:4096
ds_write_b128 v13, a[20:23] offset:5120
ds_write_b128 v13, a[24:27] offset:6144
ds_write_b128 v13, a[28:31] offset:7168
ds_write_b128 v13, a[32:35] offset:8192
ds_write_b128 v13, a[36:39] offset:9216
ds_write_b128 v13, a[40:43] offset:10240
ds_write_b128 v13, a[44:47] offset:11264
ds_write_b128 v13, a[48:51] offset:12288
ds_write_b128 v13, a[52:55] offset:13312
ds_write_b128 v13, a[56:59] offset:14336
ds_write_b128 v13, a[60:63] offset:15360
s_waitcnt lgkmcnt(0)
s_barrier
s_lshr_b32 s74, s3, 1
s_lshl_b32 s74, s74, 16
s_add_u32 s75, s53, s74
ds_read_b128 v[32:35], v15 offset:0
ds_read_b128 v[36:39], v15 offset:24576
ds_read_b128 v[40:43], v15 offset:49152
v_add_u32 v13, 73728, v15
ds_read_b128 v[44:47], v13 offset:0
ds_read_b128 v[48:51], v15 offset:1024
ds_read_b128 v[52:55], v15 offset:25600
ds_read_b128 v[56:59], v15 offset:50176
v_add_u32 v13, 73728, v15
ds_read_b128 v[60:63], v13 offset:1024
ds_read_b128 v[64:67], v15 offset:8192
ds_read_b128 v[68:71], v15 offset:32768
ds_read_b128 v[72:75], v15 offset:57344
v_add_u32 v13, 73728, v15
ds_read_b128 v[76:79], v13 offset:8192
ds_read_b128 v[80:83], v15 offset:9216
ds_read_b128 v[84:87], v15 offset:33792
ds_read_b128 v[88:91], v15 offset:58368
v_add_u32 v13, 73728, v15
ds_read_b128 v[92:95], v13 offset:9216
s_waitcnt lgkmcnt(8)
v_pk_add_f32 v[32:33], v[32:33], v[36:37]
v_pk_add_f32 v[34:35], v[34:35], v[38:39]
v_pk_add_f32 v[40:41], v[40:41], v[44:45]
v_pk_add_f32 v[42:43], v[42:43], v[46:47]
v_pk_add_f32 v[32:33], v[32:33], v[40:41]
v_pk_add_f32 v[34:35], v[34:35], v[42:43]
v_pk_add_f32 v[48:49], v[48:49], v[52:53]
v_pk_add_f32 v[50:51], v[50:51], v[54:55]
v_pk_add_f32 v[56:57], v[56:57], v[60:61]
v_pk_add_f32 v[58:59], v[58:59], v[62:63]
v_pk_add_f32 v[48:49], v[48:49], v[56:57]
v_pk_add_f32 v[50:51], v[50:51], v[58:59]
v_cvt_pk_bf16_f32 v140, v32, v33
v_cvt_pk_bf16_f32 v141, v34, v35
v_cvt_pk_bf16_f32 v142, v48, v49
v_cvt_pk_bf16_f32 v143, v50, v51
s_nop 1
v_permlane32_swap_b32 v140, v142
v_permlane32_swap_b32 v141, v143
buffer_store_dwordx4 v[140:143], v14, s[4:7], s75 offen sc1
s_add_u32 s75, s75, 131072
s_waitcnt lgkmcnt(0)
v_pk_add_f32 v[64:65], v[64:65], v[68:69]
v_pk_add_f32 v[66:67], v[66:67], v[70:71]
v_pk_add_f32 v[72:73], v[72:73], v[76:77]
v_pk_add_f32 v[74:75], v[74:75], v[78:79]
v_pk_add_f32 v[64:65], v[64:65], v[72:73]
v_pk_add_f32 v[66:67], v[66:67], v[74:75]
v_pk_add_f32 v[80:81], v[80:81], v[84:85]
v_pk_add_f32 v[82:83], v[82:83], v[86:87]
v_pk_add_f32 v[88:89], v[88:89], v[92:93]
v_pk_add_f32 v[90:91], v[90:91], v[94:95]
v_pk_add_f32 v[80:81], v[80:81], v[88:89]
v_pk_add_f32 v[82:83], v[82:83], v[90:91]
v_cvt_pk_bf16_f32 v144, v64, v65
v_cvt_pk_bf16_f32 v145, v66, v67
v_cvt_pk_bf16_f32 v146, v80, v81
v_cvt_pk_bf16_f32 v147, v82, v83
s_nop 1
v_permlane32_swap_b32 v144, v146
v_permlane32_swap_b32 v145, v147
buffer_store_dwordx4 v[144:147], v14, s[4:7], s75 offen sc1
s_add_u32 s75, s75, 131072
s_add_u32 s53, s53, 262144
s_waitcnt vmcnt(0)
s_barrier
s_cmp_lg_u32 s3, 0
s_cbranch_scc1 L_nts_210
s_lshr_b32 s57, s61, 1
s_add_u32 s57, s57, 112
s_lshl_b32 s94, s57, 8
s_add_u32 s94, s94, 98566144
v_mov_b32 v40, 0
v_mov_b32 v41, 1
s_mov_b64 exec, 1
buffer_atomic_add v41, v40, s[4:7], s94 offen sc1
s_mov_b64 exec, -1
L_nts_210:
v_mbcnt_lo_u32_b32 v0, -1, 0
v_mbcnt_hi_u32_b32 v0, -1, v0
s_lshl_b32 s48, s3, 6
v_add_u32 v0, s48, v0
s_mov_b32 s78, 1000000
s_branch L_pool
L_ln:
s_lshl_b32 s48, s61, 2
s_add_u32 s48, s48, s60
s_sub_u32 s48, s48, 4
s_lshr_b32 s53, s48, 4
s_getpc_b64 s[56:57]
L_pc_211:
s_sub_u32 s56, s56, L_pc_211-parallel_sum__memory_aug_recurrent_mem_tr__glu_gated_geglu__prompt_kernel
s_subb_u32 s57, s57, 0
s_lshr_b32 s58, s2, 3
s_lshl_b32 s58, s58, 2
s_add_u32 s58, s58, s3
s_lshl_b32 s58, s58, 10
v_and_b32 v230, 7, v0
v_lshl_add_u32 v230, v230, 7, s58
s_mov_b32 s58, L_tend-parallel_sum__memory_aug_recurrent_mem_tr__glu_gated_geglu__prompt_kernel-4
v_min_u32 v230, s58, v230
global_load_dword v231, v230, s[56:57]
v_and_b32 v4, 7, v0
v_bfe_u32 v5, v0, 3, 3
s_lshl_b32 s49, s48, 15
s_lshl_b32 s50, s3, 9
s_add_u32 s49, s49, s50
s_add_u32 s52, s49, 16384
v_lshlrev_b32 v6, 11, v4
v_lshl_add_u32 v6, v5, 5, v6
buffer_load_dwordx4 v[32:35], v6, s[12:15], s49 offen offset:0
buffer_load_dwordx4 v[36:39], v6, s[12:15], s49 offen offset:16
buffer_load_dwordx4 v[40:43], v6, s[12:15], s49 offen offset:256
buffer_load_dwordx4 v[44:47], v6, s[12:15], s49 offen offset:272
buffer_load_dwordx4 v[48:51], v6, s[12:15], s52 offen offset:0
buffer_load_dwordx4 v[52:55], v6, s[12:15], s52 offen offset:16
buffer_load_dwordx4 v[56:59], v6, s[12:15], s52 offen offset:256
buffer_load_dwordx4 v[60:63], v6, s[12:15], s52 offen offset:272
s_lshl_b32 s50, s3, 5
v_lshlrev_b32 v7, 2, v4
v_add_u32 v8, s50, v7
s_lshr_b32 s50, s48, 1
s_lshl_b32 s50, s50, 16
s_and_b32 s51, s48, 1
s_lshl_b32 s51, s51, 8
s_add_u32 s50, s50, s51
s_lshl_b32 s51, s3, 14
s_add_u32 s50, s50, s51
s_add_u32 s50, s50, 0
s_add_u32 s51, s50, 8192
v_lshlrev_b32 v9, 4, v4
v_lshl_add_u32 v9, v5, 10, v9
v_mov_b32 v234, 0
L_vw_213:
global_load_dword v235, v234, s[44:45] offset:48 sc1
s_waitcnt vmcnt(0)
v_readfirstlane_b32 s97, v235
s_cmp_lg_u32 s97, 0
s_cbranch_scc1 L_vk_214
s_sleep 2
s_add_u32 s98, s98, 1
s_cmp_lt_u32 s98, 1000000
s_cbranch_scc1 L_vw_213
s_branch L_fail
L_vk_214:
s_add_u32 s97, s97, s99
s_and_b32 s97, s97, 7
s_andn2_b32 s98, s99, 7
s_or_b32 s97, s97, s98
s_cmp_eq_u32 s97, s2
s_cbranch_scc1 L_vok_212
s_mov_b32 s2, s97
s_waitcnt vmcnt(0) lgkmcnt(0)
s_barrier
s_branch L_role
L_vok_212:
v_lshlrev_b32 v64, 16, v32
v_and_b32 v65, 0xffff0000, v32
v_lshlrev_b32 v66, 16, v33
v_and_b32 v67, 0xffff0000, v33
v_lshlrev_b32 v68, 16, v34
v_and_b32 v69, 0xffff0000, v34
v_lshlrev_b32 v70, 16, v35
v_and_b32 v71, 0xffff0000, v35
v_lshlrev_b32 v72, 16, v36
v_and_b32 v73, 0xffff0000, v36
v_lshlrev_b32 v74, 16, v37
v_and_b32 v75, 0xffff0000, v37
v_lshlrev_b32 v76, 16, v38
v_and_b32 v77, 0xffff0000, v38
v_lshlrev_b32 v78, 16, v39
v_and_b32 v79, 0xffff0000, v39
v_lshlrev_b32 v80, 16, v40
v_and_b32 v81, 0xffff0000, v40
v_lshlrev_b32 v82, 16, v41
v_and_b32 v83, 0xffff0000, v41
v_lshlrev_b32 v84, 16, v42
v_and_b32 v85, 0xffff0000, v42
v_lshlrev_b32 v86, 16, v43
v_and_b32 v87, 0xffff0000, v43
v_lshlrev_b32 v88, 16, v44
v_and_b32 v89, 0xffff0000, v44
v_lshlrev_b32 v90, 16, v45
v_and_b32 v91, 0xffff0000, v45
v_lshlrev_b32 v92, 16, v46
v_and_b32 v93, 0xffff0000, v46
v_lshlrev_b32 v94, 16, v47
v_and_b32 v95, 0xffff0000, v47
v_pk_add_f32 v[14:15], v[64:65], v[66:67]
v_pk_add_f32 v[14:15], v[14:15], v[68:69]
v_pk_add_f32 v[14:15], v[14:15], v[70:71]
v_pk_add_f32 v[14:15], v[14:15], v[72:73]
v_pk_add_f32 v[14:15], v[14:15], v[74:75]
v_pk_add_f32 v[14:15], v[14:15], v[76:77]
v_pk_add_f32 v[14:15], v[14:15], v[78:79]
v_pk_add_f32 v[14:15], v[14:15], v[80:81]
v_pk_add_f32 v[14:15], v[14:15], v[82:83]
v_pk_add_f32 v[14:15], v[14:15], v[84:85]
v_pk_add_f32 v[14:15], v[14:15], v[86:87]
v_pk_add_f32 v[14:15], v[14:15], v[88:89]
v_pk_add_f32 v[14:15], v[14:15], v[90:91]
v_pk_add_f32 v[14:15], v[14:15], v[92:93]
v_pk_add_f32 v[14:15], v[14:15], v[94:95]
v_add_f32 v10, v14, v15
s_nop 1
v_add_f32_dpp v10, v10, v10 row_ror:8 row_mask:0xf bank_mask:0xf
v_mov_b32 v14, v10
s_nop 1
v_permlane16_swap_b32 v10, v14
s_nop 1
v_add_f32 v10, v10, v14
v_mov_b32 v14, v10
s_nop 1
v_permlane32_swap_b32 v10, v14
s_nop 1
v_add_f32 v10, v10, v14
ds_write_b32 v8, v10 offset:0
v_lshlrev_b32 v96, 16, v48
v_and_b32 v97, 0xffff0000, v48
v_lshlrev_b32 v98, 16, v49
v_and_b32 v99, 0xffff0000, v49
v_lshlrev_b32 v100, 16, v50
v_and_b32 v101, 0xffff0000, v50
v_lshlrev_b32 v102, 16, v51
v_and_b32 v103, 0xffff0000, v51
v_lshlrev_b32 v104, 16, v52
v_and_b32 v105, 0xffff0000, v52
v_lshlrev_b32 v106, 16, v53
v_and_b32 v107, 0xffff0000, v53
v_lshlrev_b32 v108, 16, v54
v_and_b32 v109, 0xffff0000, v54
v_lshlrev_b32 v110, 16, v55
v_and_b32 v111, 0xffff0000, v55
v_lshlrev_b32 v112, 16, v56
v_and_b32 v113, 0xffff0000, v56
v_lshlrev_b32 v114, 16, v57
v_and_b32 v115, 0xffff0000, v57
v_lshlrev_b32 v116, 16, v58
v_and_b32 v117, 0xffff0000, v58
v_lshlrev_b32 v118, 16, v59
v_and_b32 v119, 0xffff0000, v59
v_lshlrev_b32 v120, 16, v60
v_and_b32 v121, 0xffff0000, v60
v_lshlrev_b32 v122, 16, v61
v_and_b32 v123, 0xffff0000, v61
v_lshlrev_b32 v124, 16, v62
v_and_b32 v125, 0xffff0000, v62
v_lshlrev_b32 v126, 16, v63
v_and_b32 v127, 0xffff0000, v63
v_pk_add_f32 v[14:15], v[96:97], v[98:99]
v_pk_add_f32 v[14:15], v[14:15], v[100:101]
v_pk_add_f32 v[14:15], v[14:15], v[102:103]
v_pk_add_f32 v[14:15], v[14:15], v[104:105]
v_pk_add_f32 v[14:15], v[14:15], v[106:107]
v_pk_add_f32 v[14:15], v[14:15], v[108:109]
v_pk_add_f32 v[14:15], v[14:15], v[110:111]
v_pk_add_f32 v[14:15], v[14:15], v[112:113]
v_pk_add_f32 v[14:15], v[14:15], v[114:115]
v_pk_add_f32 v[14:15], v[14:15], v[116:117]
v_pk_add_f32 v[14:15], v[14:15], v[118:119]
v_pk_add_f32 v[14:15], v[14:15], v[120:121]
v_pk_add_f32 v[14:15], v[14:15], v[122:123]
v_pk_add_f32 v[14:15], v[14:15], v[124:125]
v_pk_add_f32 v[14:15], v[14:15], v[126:127]
v_add_f32 v11, v14, v15
s_nop 1
v_add_f32_dpp v11, v11, v11 row_ror:8 row_mask:0xf bank_mask:0xf
v_mov_b32 v14, v11
s_nop 1
v_permlane16_swap_b32 v11, v14
s_nop 1
v_add_f32 v11, v11, v14
v_mov_b32 v14, v11
s_nop 1
v_permlane32_swap_b32 v11, v14
s_nop 1
v_add_f32 v11, v11, v14
ds_write_b32 v8, v11 offset:128
s_waitcnt lgkmcnt(0)
s_barrier
ds_read2_b32 v[14:15], v7 offset0:0 offset1:8
ds_read2_b32 v[16:17], v7 offset0:16 offset1:24
s_waitcnt lgkmcnt(0)
v_add_f32 v14, v14, v15
v_add_f32 v16, v16, v17
v_add_f32 v10, v14, v16
v_mul_f32 v10, 0x3a800000, v10
v_mov_b32 v16, 0
v_mov_b32 v17, 0
v_pk_add_f32 v[14:15], v[64:65], v[10:11] op_sel:[0,0] op_sel_hi:[1,0] neg_lo:[0,1] neg_hi:[0,1]
v_pk_fma_f32 v[16:17], v[14:15], v[14:15], v[16:17]
v_pk_add_f32 v[14:15], v[66:67], v[10:11] op_sel:[0,0] op_sel_hi:[1,0] neg_lo:[0,1] neg_hi:[0,1]
v_pk_fma_f32 v[16:17], v[14:15], v[14:15], v[16:17]
v_pk_add_f32 v[14:15], v[68:69], v[10:11] op_sel:[0,0] op_sel_hi:[1,0] neg_lo:[0,1] neg_hi:[0,1]
v_pk_fma_f32 v[16:17], v[14:15], v[14:15], v[16:17]
v_pk_add_f32 v[14:15], v[70:71], v[10:11] op_sel:[0,0] op_sel_hi:[1,0] neg_lo:[0,1] neg_hi:[0,1]
v_pk_fma_f32 v[16:17], v[14:15], v[14:15], v[16:17]
v_pk_add_f32 v[14:15], v[72:73], v[10:11] op_sel:[0,0] op_sel_hi:[1,0] neg_lo:[0,1] neg_hi:[0,1]
v_pk_fma_f32 v[16:17], v[14:15], v[14:15], v[16:17]
v_pk_add_f32 v[14:15], v[74:75], v[10:11] op_sel:[0,0] op_sel_hi:[1,0] neg_lo:[0,1] neg_hi:[0,1]
v_pk_fma_f32 v[16:17], v[14:15], v[14:15], v[16:17]
v_pk_add_f32 v[14:15], v[76:77], v[10:11] op_sel:[0,0] op_sel_hi:[1,0] neg_lo:[0,1] neg_hi:[0,1]
v_pk_fma_f32 v[16:17], v[14:15], v[14:15], v[16:17]
v_pk_add_f32 v[14:15], v[78:79], v[10:11] op_sel:[0,0] op_sel_hi:[1,0] neg_lo:[0,1] neg_hi:[0,1]
v_pk_fma_f32 v[16:17], v[14:15], v[14:15], v[16:17]
v_pk_add_f32 v[14:15], v[80:81], v[10:11] op_sel:[0,0] op_sel_hi:[1,0] neg_lo:[0,1] neg_hi:[0,1]
v_pk_fma_f32 v[16:17], v[14:15], v[14:15], v[16:17]
v_pk_add_f32 v[14:15], v[82:83], v[10:11] op_sel:[0,0] op_sel_hi:[1,0] neg_lo:[0,1] neg_hi:[0,1]
v_pk_fma_f32 v[16:17], v[14:15], v[14:15], v[16:17]
v_pk_add_f32 v[14:15], v[84:85], v[10:11] op_sel:[0,0] op_sel_hi:[1,0] neg_lo:[0,1] neg_hi:[0,1]
v_pk_fma_f32 v[16:17], v[14:15], v[14:15], v[16:17]
v_pk_add_f32 v[14:15], v[86:87], v[10:11] op_sel:[0,0] op_sel_hi:[1,0] neg_lo:[0,1] neg_hi:[0,1]
v_pk_fma_f32 v[16:17], v[14:15], v[14:15], v[16:17]
v_pk_add_f32 v[14:15], v[88:89], v[10:11] op_sel:[0,0] op_sel_hi:[1,0] neg_lo:[0,1] neg_hi:[0,1]
v_pk_fma_f32 v[16:17], v[14:15], v[14:15], v[16:17]
v_pk_add_f32 v[14:15], v[90:91], v[10:11] op_sel:[0,0] op_sel_hi:[1,0] neg_lo:[0,1] neg_hi:[0,1]
v_pk_fma_f32 v[16:17], v[14:15], v[14:15], v[16:17]
v_pk_add_f32 v[14:15], v[92:93], v[10:11] op_sel:[0,0] op_sel_hi:[1,0] neg_lo:[0,1] neg_hi:[0,1]
v_pk_fma_f32 v[16:17], v[14:15], v[14:15], v[16:17]
v_pk_add_f32 v[14:15], v[94:95], v[10:11] op_sel:[0,0] op_sel_hi:[1,0] neg_lo:[0,1] neg_hi:[0,1]
v_pk_fma_f32 v[16:17], v[14:15], v[14:15], v[16:17]
v_add_f32 v12, v16, v17
s_nop 1
v_add_f32_dpp v12, v12, v12 row_ror:8 row_mask:0xf bank_mask:0xf
v_mov_b32 v14, v12
s_nop 1
v_permlane16_swap_b32 v12, v14
s_nop 1
v_add_f32 v12, v12, v14
v_mov_b32 v14, v12
s_nop 1
v_permlane32_swap_b32 v12, v14
s_nop 1
v_add_f32 v12, v12, v14
ds_write_b32 v8, v12 offset:256
ds_read2_b32 v[14:15], v7 offset0:32 offset1:40
ds_read2_b32 v[16:17], v7 offset0:48 offset1:56
s_waitcnt lgkmcnt(0)
v_add_f32 v14, v14, v15
v_add_f32 v16, v16, v17
v_add_f32 v11, v14, v16
v_mul_f32 v11, 0x3a800000, v11
v_mov_b32 v16, 0
v_mov_b32 v17, 0
v_pk_add_f32 v[14:15], v[96:97], v[10:11] op_sel:[0,1] op_sel_hi:[1,1] neg_lo:[0,1] neg_hi:[0,1]
v_pk_fma_f32 v[16:17], v[14:15], v[14:15], v[16:17]
v_pk_add_f32 v[14:15], v[98:99], v[10:11] op_sel:[0,1] op_sel_hi:[1,1] neg_lo:[0,1] neg_hi:[0,1]
v_pk_fma_f32 v[16:17], v[14:15], v[14:15], v[16:17]
v_pk_add_f32 v[14:15], v[100:101], v[10:11] op_sel:[0,1] op_sel_hi:[1,1] neg_lo:[0,1] neg_hi:[0,1]
v_pk_fma_f32 v[16:17], v[14:15], v[14:15], v[16:17]
v_pk_add_f32 v[14:15], v[102:103], v[10:11] op_sel:[0,1] op_sel_hi:[1,1] neg_lo:[0,1] neg_hi:[0,1]
v_pk_fma_f32 v[16:17], v[14:15], v[14:15], v[16:17]
v_pk_add_f32 v[14:15], v[104:105], v[10:11] op_sel:[0,1] op_sel_hi:[1,1] neg_lo:[0,1] neg_hi:[0,1]
v_pk_fma_f32 v[16:17], v[14:15], v[14:15], v[16:17]
v_pk_add_f32 v[14:15], v[106:107], v[10:11] op_sel:[0,1] op_sel_hi:[1,1] neg_lo:[0,1] neg_hi:[0,1]
v_pk_fma_f32 v[16:17], v[14:15], v[14:15], v[16:17]
v_pk_add_f32 v[14:15], v[108:109], v[10:11] op_sel:[0,1] op_sel_hi:[1,1] neg_lo:[0,1] neg_hi:[0,1]
v_pk_fma_f32 v[16:17], v[14:15], v[14:15], v[16:17]
v_pk_add_f32 v[14:15], v[110:111], v[10:11] op_sel:[0,1] op_sel_hi:[1,1] neg_lo:[0,1] neg_hi:[0,1]
v_pk_fma_f32 v[16:17], v[14:15], v[14:15], v[16:17]
v_pk_add_f32 v[14:15], v[112:113], v[10:11] op_sel:[0,1] op_sel_hi:[1,1] neg_lo:[0,1] neg_hi:[0,1]
v_pk_fma_f32 v[16:17], v[14:15], v[14:15], v[16:17]
v_pk_add_f32 v[14:15], v[114:115], v[10:11] op_sel:[0,1] op_sel_hi:[1,1] neg_lo:[0,1] neg_hi:[0,1]
v_pk_fma_f32 v[16:17], v[14:15], v[14:15], v[16:17]
v_pk_add_f32 v[14:15], v[116:117], v[10:11] op_sel:[0,1] op_sel_hi:[1,1] neg_lo:[0,1] neg_hi:[0,1]
v_pk_fma_f32 v[16:17], v[14:15], v[14:15], v[16:17]
v_pk_add_f32 v[14:15], v[118:119], v[10:11] op_sel:[0,1] op_sel_hi:[1,1] neg_lo:[0,1] neg_hi:[0,1]
v_pk_fma_f32 v[16:17], v[14:15], v[14:15], v[16:17]
v_pk_add_f32 v[14:15], v[120:121], v[10:11] op_sel:[0,1] op_sel_hi:[1,1] neg_lo:[0,1] neg_hi:[0,1]
v_pk_fma_f32 v[16:17], v[14:15], v[14:15], v[16:17]
v_pk_add_f32 v[14:15], v[122:123], v[10:11] op_sel:[0,1] op_sel_hi:[1,1] neg_lo:[0,1] neg_hi:[0,1]
v_pk_fma_f32 v[16:17], v[14:15], v[14:15], v[16:17]
v_pk_add_f32 v[14:15], v[124:125], v[10:11] op_sel:[0,1] op_sel_hi:[1,1] neg_lo:[0,1] neg_hi:[0,1]
v_pk_fma_f32 v[16:17], v[14:15], v[14:15], v[16:17]
v_pk_add_f32 v[14:15], v[126:127], v[10:11] op_sel:[0,1] op_sel_hi:[1,1] neg_lo:[0,1] neg_hi:[0,1]
v_pk_fma_f32 v[16:17], v[14:15], v[14:15], v[16:17]
v_add_f32 v13, v16, v17
s_nop 1
v_add_f32_dpp v13, v13, v13 row_ror:8 row_mask:0xf bank_mask:0xf
v_mov_b32 v14, v13
s_nop 1
v_permlane16_swap_b32 v13, v14
s_nop 1
v_add_f32 v13, v13, v14
v_mov_b32 v14, v13
s_nop 1
v_permlane32_swap_b32 v13, v14
s_nop 1
v_add_f32 v13, v13, v14
ds_write_b32 v8, v13 offset:384
s_waitcnt lgkmcnt(0)
s_barrier
ds_read2_b32 v[14:15], v7 offset0:64 offset1:72
ds_read2_b32 v[16:17], v7 offset0:80 offset1:88
s_waitcnt lgkmcnt(0)
v_add_f32 v14, v14, v15
v_add_f32 v16, v16, v17
v_add_f32 v12, v14, v16
v_mul_f32 v12, 0x3a800000, v12
v_cvt_pk_bf16_f32 v10, v10, v10
v_and_b32 v10, 0xffff0000, v10
v_cvt_pk_bf16_f32 v12, v12, v12
v_and_b32 v12, 0xffff0000, v12
v_add_f32 v12, 0x3727c5ac, v12
v_cvt_pk_bf16_f32 v12, v12, v12
v_and_b32 v12, 0xffff0000, v12
v_sqrt_f32 v12, v12
s_nop 0
v_cvt_pk_bf16_f32 v12, v12, v12
v_and_b32 v12, 0xffff0000, v12
v_rcp_f32 v12, v12
v_pk_add_f32 v[14:15], v[64:65], v[10:11] op_sel:[0,0] op_sel_hi:[1,0] neg_lo:[0,1] neg_hi:[0,1]
v_cvt_pk_bf16_f32 v14, v14, v15
v_and_b32 v15, 0xffff0000, v14
v_lshlrev_b32 v14, 16, v14
v_pk_mul_f32 v[14:15], v[14:15], v[12:13] op_sel:[0,0] op_sel_hi:[1,0]
v_cvt_pk_bf16_f32 v128, v14, v15
v_pk_add_f32 v[14:15], v[66:67], v[10:11] op_sel:[0,0] op_sel_hi:[1,0] neg_lo:[0,1] neg_hi:[0,1]
v_cvt_pk_bf16_f32 v14, v14, v15
v_and_b32 v15, 0xffff0000, v14
v_lshlrev_b32 v14, 16, v14
v_pk_mul_f32 v[14:15], v[14:15], v[12:13] op_sel:[0,0] op_sel_hi:[1,0]
v_cvt_pk_bf16_f32 v129, v14, v15
v_pk_add_f32 v[14:15], v[68:69], v[10:11] op_sel:[0,0] op_sel_hi:[1,0] neg_lo:[0,1] neg_hi:[0,1]
v_cvt_pk_bf16_f32 v14, v14, v15
v_and_b32 v15, 0xffff0000, v14
v_lshlrev_b32 v14, 16, v14
v_pk_mul_f32 v[14:15], v[14:15], v[12:13] op_sel:[0,0] op_sel_hi:[1,0]
v_cvt_pk_bf16_f32 v132, v14, v15
v_pk_add_f32 v[14:15], v[70:71], v[10:11] op_sel:[0,0] op_sel_hi:[1,0] neg_lo:[0,1] neg_hi:[0,1]
v_cvt_pk_bf16_f32 v14, v14, v15
v_and_b32 v15, 0xffff0000, v14
v_lshlrev_b32 v14, 16, v14
v_pk_mul_f32 v[14:15], v[14:15], v[12:13] op_sel:[0,0] op_sel_hi:[1,0]
v_cvt_pk_bf16_f32 v133, v14, v15
v_pk_add_f32 v[14:15], v[72:73], v[10:11] op_sel:[0,0] op_sel_hi:[1,0] neg_lo:[0,1] neg_hi:[0,1]
v_cvt_pk_bf16_f32 v14, v14, v15
v_and_b32 v15, 0xffff0000, v14
v_lshlrev_b32 v14, 16, v14
v_pk_mul_f32 v[14:15], v[14:15], v[12:13] op_sel:[0,0] op_sel_hi:[1,0]
v_cvt_pk_bf16_f32 v130, v14, v15
v_pk_add_f32 v[14:15], v[74:75], v[10:11] op_sel:[0,0] op_sel_hi:[1,0] neg_lo:[0,1] neg_hi:[0,1]
v_cvt_pk_bf16_f32 v14, v14, v15
v_and_b32 v15, 0xffff0000, v14
v_lshlrev_b32 v14, 16, v14
v_pk_mul_f32 v[14:15], v[14:15], v[12:13] op_sel:[0,0] op_sel_hi:[1,0]
v_cvt_pk_bf16_f32 v131, v14, v15
v_pk_add_f32 v[14:15], v[76:77], v[10:11] op_sel:[0,0] op_sel_hi:[1,0] neg_lo:[0,1] neg_hi:[0,1]
v_cvt_pk_bf16_f32 v14, v14, v15
v_and_b32 v15, 0xffff0000, v14
v_lshlrev_b32 v14, 16, v14
v_pk_mul_f32 v[14:15], v[14:15], v[12:13] op_sel:[0,0] op_sel_hi:[1,0]
v_cvt_pk_bf16_f32 v134, v14, v15
v_pk_add_f32 v[14:15], v[78:79], v[10:11] op_sel:[0,0] op_sel_hi:[1,0] neg_lo:[0,1] neg_hi:[0,1]
v_cvt_pk_bf16_f32 v14, v14, v15
v_and_b32 v15, 0xffff0000, v14
v_lshlrev_b32 v14, 16, v14
v_pk_mul_f32 v[14:15], v[14:15], v[12:13] op_sel:[0,0] op_sel_hi:[1,0]
v_cvt_pk_bf16_f32 v135, v14, v15
v_pk_add_f32 v[14:15], v[80:81], v[10:11] op_sel:[0,0] op_sel_hi:[1,0] neg_lo:[0,1] neg_hi:[0,1]
v_cvt_pk_bf16_f32 v14, v14, v15
v_and_b32 v15, 0xffff0000, v14
v_lshlrev_b32 v14, 16, v14
v_pk_mul_f32 v[14:15], v[14:15], v[12:13] op_sel:[0,0] op_sel_hi:[1,0]
v_cvt_pk_bf16_f32 v136, v14, v15
v_pk_add_f32 v[14:15], v[82:83], v[10:11] op_sel:[0,0] op_sel_hi:[1,0] neg_lo:[0,1] neg_hi:[0,1]
v_cvt_pk_bf16_f32 v14, v14, v15
v_and_b32 v15, 0xffff0000, v14
v_lshlrev_b32 v14, 16, v14
v_pk_mul_f32 v[14:15], v[14:15], v[12:13] op_sel:[0,0] op_sel_hi:[1,0]
v_cvt_pk_bf16_f32 v137, v14, v15
v_pk_add_f32 v[14:15], v[84:85], v[10:11] op_sel:[0,0] op_sel_hi:[1,0] neg_lo:[0,1] neg_hi:[0,1]
v_cvt_pk_bf16_f32 v14, v14, v15
v_and_b32 v15, 0xffff0000, v14
v_lshlrev_b32 v14, 16, v14
v_pk_mul_f32 v[14:15], v[14:15], v[12:13] op_sel:[0,0] op_sel_hi:[1,0]
v_cvt_pk_bf16_f32 v140, v14, v15
v_pk_add_f32 v[14:15], v[86:87], v[10:11] op_sel:[0,0] op_sel_hi:[1,0] neg_lo:[0,1] neg_hi:[0,1]
v_cvt_pk_bf16_f32 v14, v14, v15
v_and_b32 v15, 0xffff0000, v14
v_lshlrev_b32 v14, 16, v14
v_pk_mul_f32 v[14:15], v[14:15], v[12:13] op_sel:[0,0] op_sel_hi:[1,0]
v_cvt_pk_bf16_f32 v141, v14, v15
v_pk_add_f32 v[14:15], v[88:89], v[10:11] op_sel:[0,0] op_sel_hi:[1,0] neg_lo:[0,1] neg_hi:[0,1]
v_cvt_pk_bf16_f32 v14, v14, v15
v_and_b32 v15, 0xffff0000, v14
v_lshlrev_b32 v14, 16, v14
v_pk_mul_f32 v[14:15], v[14:15], v[12:13] op_sel:[0,0] op_sel_hi:[1,0]
v_cvt_pk_bf16_f32 v138, v14, v15
v_pk_add_f32 v[14:15], v[90:91], v[10:11] op_sel:[0,0] op_sel_hi:[1,0] neg_lo:[0,1] neg_hi:[0,1]
v_cvt_pk_bf16_f32 v14, v14, v15
v_and_b32 v15, 0xffff0000, v14
v_lshlrev_b32 v14, 16, v14
v_pk_mul_f32 v[14:15], v[14:15], v[12:13] op_sel:[0,0] op_sel_hi:[1,0]
v_cvt_pk_bf16_f32 v139, v14, v15
v_pk_add_f32 v[14:15], v[92:93], v[10:11] op_sel:[0,0] op_sel_hi:[1,0] neg_lo:[0,1] neg_hi:[0,1]
v_cvt_pk_bf16_f32 v14, v14, v15
v_and_b32 v15, 0xffff0000, v14
v_lshlrev_b32 v14, 16, v14
v_pk_mul_f32 v[14:15], v[14:15], v[12:13] op_sel:[0,0] op_sel_hi:[1,0]
v_cvt_pk_bf16_f32 v142, v14, v15
v_pk_add_f32 v[14:15], v[94:95], v[10:11] op_sel:[0,0] op_sel_hi:[1,0] neg_lo:[0,1] neg_hi:[0,1]
v_cvt_pk_bf16_f32 v14, v14, v15
v_and_b32 v15, 0xffff0000, v14
v_lshlrev_b32 v14, 16, v14
v_pk_mul_f32 v[14:15], v[14:15], v[12:13] op_sel:[0,0] op_sel_hi:[1,0]
v_cvt_pk_bf16_f32 v143, v14, v15
buffer_store_dwordx4 v[128:131], v9, s[4:7], s50 offen offset:0 sc1
buffer_store_dwordx4 v[132:135], v9, s[4:7], s50 offen offset:512 sc1
buffer_store_dwordx4 v[136:139], v9, s[4:7], s51 offen offset:0 sc1
buffer_store_dwordx4 v[140:143], v9, s[4:7], s51 offen offset:512 sc1
ds_read2_b32 v[14:15], v7 offset0:96 offset1:104
ds_read2_b32 v[16:17], v7 offset0:112 offset1:120
s_waitcnt lgkmcnt(0)
v_add_f32 v14, v14, v15
v_add_f32 v16, v16, v17
v_add_f32 v13, v14, v16
v_mul_f32 v13, 0x3a800000, v13
v_cvt_pk_bf16_f32 v11, v11, v11
v_and_b32 v11, 0xffff0000, v11
v_cvt_pk_bf16_f32 v13, v13, v13
v_and_b32 v13, 0xffff0000, v13
v_add_f32 v13, 0x3727c5ac, v13
v_cvt_pk_bf16_f32 v13, v13, v13
v_and_b32 v13, 0xffff0000, v13
v_sqrt_f32 v13, v13
s_nop 0
v_cvt_pk_bf16_f32 v13, v13, v13
v_and_b32 v13, 0xffff0000, v13
v_rcp_f32 v13, v13
v_pk_add_f32 v[14:15], v[96:97], v[10:11] op_sel:[0,1] op_sel_hi:[1,1] neg_lo:[0,1] neg_hi:[0,1]
v_cvt_pk_bf16_f32 v14, v14, v15
v_and_b32 v15, 0xffff0000, v14
v_lshlrev_b32 v14, 16, v14
v_pk_mul_f32 v[14:15], v[14:15], v[12:13] op_sel:[0,1] op_sel_hi:[1,1]
v_cvt_pk_bf16_f32 v144, v14, v15
v_pk_add_f32 v[14:15], v[98:99], v[10:11] op_sel:[0,1] op_sel_hi:[1,1] neg_lo:[0,1] neg_hi:[0,1]
v_cvt_pk_bf16_f32 v14, v14, v15
v_and_b32 v15, 0xffff0000, v14
v_lshlrev_b32 v14, 16, v14
v_pk_mul_f32 v[14:15], v[14:15], v[12:13] op_sel:[0,1] op_sel_hi:[1,1]
v_cvt_pk_bf16_f32 v145, v14, v15
v_pk_add_f32 v[14:15], v[100:101], v[10:11] op_sel:[0,1] op_sel_hi:[1,1] neg_lo:[0,1] neg_hi:[0,1]
v_cvt_pk_bf16_f32 v14, v14, v15
v_and_b32 v15, 0xffff0000, v14
v_lshlrev_b32 v14, 16, v14
v_pk_mul_f32 v[14:15], v[14:15], v[12:13] op_sel:[0,1] op_sel_hi:[1,1]
v_cvt_pk_bf16_f32 v148, v14, v15
v_pk_add_f32 v[14:15], v[102:103], v[10:11] op_sel:[0,1] op_sel_hi:[1,1] neg_lo:[0,1] neg_hi:[0,1]
v_cvt_pk_bf16_f32 v14, v14, v15
v_and_b32 v15, 0xffff0000, v14
v_lshlrev_b32 v14, 16, v14
v_pk_mul_f32 v[14:15], v[14:15], v[12:13] op_sel:[0,1] op_sel_hi:[1,1]
v_cvt_pk_bf16_f32 v149, v14, v15
v_pk_add_f32 v[14:15], v[104:105], v[10:11] op_sel:[0,1] op_sel_hi:[1,1] neg_lo:[0,1] neg_hi:[0,1]
v_cvt_pk_bf16_f32 v14, v14, v15
v_and_b32 v15, 0xffff0000, v14
v_lshlrev_b32 v14, 16, v14
v_pk_mul_f32 v[14:15], v[14:15], v[12:13] op_sel:[0,1] op_sel_hi:[1,1]
v_cvt_pk_bf16_f32 v146, v14, v15
v_pk_add_f32 v[14:15], v[106:107], v[10:11] op_sel:[0,1] op_sel_hi:[1,1] neg_lo:[0,1] neg_hi:[0,1]
v_cvt_pk_bf16_f32 v14, v14, v15
v_and_b32 v15, 0xffff0000, v14
v_lshlrev_b32 v14, 16, v14
v_pk_mul_f32 v[14:15], v[14:15], v[12:13] op_sel:[0,1] op_sel_hi:[1,1]
v_cvt_pk_bf16_f32 v147, v14, v15
v_pk_add_f32 v[14:15], v[108:109], v[10:11] op_sel:[0,1] op_sel_hi:[1,1] neg_lo:[0,1] neg_hi:[0,1]
v_cvt_pk_bf16_f32 v14, v14, v15
v_and_b32 v15, 0xffff0000, v14
v_lshlrev_b32 v14, 16, v14
v_pk_mul_f32 v[14:15], v[14:15], v[12:13] op_sel:[0,1] op_sel_hi:[1,1]
v_cvt_pk_bf16_f32 v150, v14, v15
v_pk_add_f32 v[14:15], v[110:111], v[10:11] op_sel:[0,1] op_sel_hi:[1,1] neg_lo:[0,1] neg_hi:[0,1]
v_cvt_pk_bf16_f32 v14, v14, v15
v_and_b32 v15, 0xffff0000, v14
v_lshlrev_b32 v14, 16, v14
v_pk_mul_f32 v[14:15], v[14:15], v[12:13] op_sel:[0,1] op_sel_hi:[1,1]
v_cvt_pk_bf16_f32 v151, v14, v15
v_pk_add_f32 v[14:15], v[112:113], v[10:11] op_sel:[0,1] op_sel_hi:[1,1] neg_lo:[0,1] neg_hi:[0,1]
v_cvt_pk_bf16_f32 v14, v14, v15
v_and_b32 v15, 0xffff0000, v14
v_lshlrev_b32 v14, 16, v14
v_pk_mul_f32 v[14:15], v[14:15], v[12:13] op_sel:[0,1] op_sel_hi:[1,1]
v_cvt_pk_bf16_f32 v152, v14, v15
v_pk_add_f32 v[14:15], v[114:115], v[10:11] op_sel:[0,1] op_sel_hi:[1,1] neg_lo:[0,1] neg_hi:[0,1]
v_cvt_pk_bf16_f32 v14, v14, v15
v_and_b32 v15, 0xffff0000, v14
v_lshlrev_b32 v14, 16, v14
v_pk_mul_f32 v[14:15], v[14:15], v[12:13] op_sel:[0,1] op_sel_hi:[1,1]
v_cvt_pk_bf16_f32 v153, v14, v15
v_pk_add_f32 v[14:15], v[116:117], v[10:11] op_sel:[0,1] op_sel_hi:[1,1] neg_lo:[0,1] neg_hi:[0,1]
v_cvt_pk_bf16_f32 v14, v14, v15
v_and_b32 v15, 0xffff0000, v14
v_lshlrev_b32 v14, 16, v14
v_pk_mul_f32 v[14:15], v[14:15], v[12:13] op_sel:[0,1] op_sel_hi:[1,1]
v_cvt_pk_bf16_f32 v156, v14, v15
v_pk_add_f32 v[14:15], v[118:119], v[10:11] op_sel:[0,1] op_sel_hi:[1,1] neg_lo:[0,1] neg_hi:[0,1]
v_cvt_pk_bf16_f32 v14, v14, v15
v_and_b32 v15, 0xffff0000, v14
v_lshlrev_b32 v14, 16, v14
v_pk_mul_f32 v[14:15], v[14:15], v[12:13] op_sel:[0,1] op_sel_hi:[1,1]
v_cvt_pk_bf16_f32 v157, v14, v15
v_pk_add_f32 v[14:15], v[120:121], v[10:11] op_sel:[0,1] op_sel_hi:[1,1] neg_lo:[0,1] neg_hi:[0,1]
v_cvt_pk_bf16_f32 v14, v14, v15
v_and_b32 v15, 0xffff0000, v14
v_lshlrev_b32 v14, 16, v14
v_pk_mul_f32 v[14:15], v[14:15], v[12:13] op_sel:[0,1] op_sel_hi:[1,1]
v_cvt_pk_bf16_f32 v154, v14, v15
v_pk_add_f32 v[14:15], v[122:123], v[10:11] op_sel:[0,1] op_sel_hi:[1,1] neg_lo:[0,1] neg_hi:[0,1]
v_cvt_pk_bf16_f32 v14, v14, v15
v_and_b32 v15, 0xffff0000, v14
v_lshlrev_b32 v14, 16, v14
v_pk_mul_f32 v[14:15], v[14:15], v[12:13] op_sel:[0,1] op_sel_hi:[1,1]
v_cvt_pk_bf16_f32 v155, v14, v15
v_pk_add_f32 v[14:15], v[124:125], v[10:11] op_sel:[0,1] op_sel_hi:[1,1] neg_lo:[0,1] neg_hi:[0,1]
v_cvt_pk_bf16_f32 v14, v14, v15
v_and_b32 v15, 0xffff0000, v14
v_lshlrev_b32 v14, 16, v14
v_pk_mul_f32 v[14:15], v[14:15], v[12:13] op_sel:[0,1] op_sel_hi:[1,1]
v_cvt_pk_bf16_f32 v158, v14, v15
v_pk_add_f32 v[14:15], v[126:127], v[10:11] op_sel:[0,1] op_sel_hi:[1,1] neg_lo:[0,1] neg_hi:[0,1]
v_cvt_pk_bf16_f32 v14, v14, v15
v_and_b32 v15, 0xffff0000, v14
v_lshlrev_b32 v14, 16, v14
v_pk_mul_f32 v[14:15], v[14:15], v[12:13] op_sel:[0,1] op_sel_hi:[1,1]
v_cvt_pk_bf16_f32 v159, v14, v15
buffer_store_dwordx4 v[144:147], v9, s[4:7], s50 offen offset:128 sc1
buffer_store_dwordx4 v[148:151], v9, s[4:7], s50 offen offset:640 sc1
buffer_store_dwordx4 v[152:155], v9, s[4:7], s51 offen offset:128 sc1
buffer_store_dwordx4 v[156:159], v9, s[4:7], s51 offen offset:640 sc1
s_cmp_ge_u32 s48, 8
s_cbranch_scc1 L_nxs_215
s_add_u32 s50, s50, 155189248
s_add_u32 s51, s51, 155189248
v_mov_b32 v64, v128
v_mov_b32 v65, v130
v_mov_b32 v66, v129
v_mov_b32 v67, v131
buffer_store_dwordx4 v[64:67], v9, s[4:7], s50 offen offset:0 sc1
v_mov_b32 v68, v132
v_mov_b32 v69, v134
v_mov_b32 v70, v133
v_mov_b32 v71, v135
buffer_store_dwordx4 v[68:71], v9, s[4:7], s50 offen offset:512 sc1
v_mov_b32 v72, v136
v_mov_b32 v73, v138
v_mov_b32 v74, v137
v_mov_b32 v75, v139
buffer_store_dwordx4 v[72:75], v9, s[4:7], s51 offen offset:0 sc1
v_mov_b32 v76, v140
v_mov_b32 v77, v142
v_mov_b32 v78, v141
v_mov_b32 v79, v143
buffer_store_dwordx4 v[76:79], v9, s[4:7], s51 offen offset:512 sc1
v_mov_b32 v80, v144
v_mov_b32 v81, v146
v_mov_b32 v82, v145
v_mov_b32 v83, v147
buffer_store_dwordx4 v[80:83], v9, s[4:7], s50 offen offset:128 sc1
v_mov_b32 v84, v148
v_mov_b32 v85, v150
v_mov_b32 v86, v149
v_mov_b32 v87, v151
buffer_store_dwordx4 v[84:87], v9, s[4:7], s50 offen offset:640 sc1
v_mov_b32 v88, v152
v_mov_b32 v89, v154
v_mov_b32 v90, v153
v_mov_b32 v91, v155
buffer_store_dwordx4 v[88:91], v9, s[4:7], s51 offen offset:128 sc1
v_mov_b32 v92, v156
v_mov_b32 v93, v158
v_mov_b32 v94, v157
v_mov_b32 v95, v159
buffer_store_dwordx4 v[92:95], v9, s[4:7], s51 offen offset:640 sc1
L_nxs_215:
v_mov_b32 v30, 0
L_zw_216:
global_load_dword v31, v30, s[44:45] offset:40 sc1
s_waitcnt vmcnt(0)
v_readfirstlane_b32 s54, v31
s_cmp_lg_u32 s54, 0
s_cbranch_scc1 L_zok_217
s_sleep 2
s_sub_u32 s78, s78, 1
s_cmp_lg_u32 s78, 0
s_cbranch_scc1 L_zw_216
s_branch L_fail
L_zok_217:
s_barrier
s_cmp_lg_u32 s3, 0
s_cbranch_scc1 L_lns_218
s_lshl_b32 s94, s53, 8
s_add_u32 s94, s94, 98566144
v_mov_b32 v16, 0
v_mov_b32 v17, 1
s_mov_b64 exec, 1
buffer_atomic_add v17, v16, s[4:7], s94 offen sc1
s_mov_b64 exec, -1
L_lns_218:
L_pool:
s_getpc_b64 s[64:65]
L_pc:
s_add_u32 s64, s64, L_table-L_pc
s_addc_u32 s65, s65, 0
s_mul_i32 s48, s2, 224
s_add_u32 s64, s64, s48
s_addc_u32 s65, s65, 0
s_mov_b32 s80, s26
s_and_b32 s81, s27, 0xffff
s_mov_b32 s82, 0x800000
s_mov_b32 s83, 0x20000
v_mov_b32 v20, v1
v_mov_b32 v21, v1
v_mov_b32 v22, v1
v_mov_b32 v23, v1
v_mov_b32 v24, v1
v_mov_b32 v25, v1
s_mov_b32 s84, 0
s_mov_b32 s85, 0
s_mov_b32 s86, 0
s_mov_b32 s87, 0
s_mov_b32 s88, 0
s_mov_b32 s89, 0
s_mov_b32 s90, 0
s_mov_b32 s100, 0
s_lshl_b32 s54, s3, 12
v_and_b32 v18, 15, v0
v_lshlrev_b32 v18, 4, v18
v_bfe_u32 v29, v0, 4, 2
v_lshl_add_u32 v18, v29, 9, v18
s_lshr_b32 s56, s3, 1
s_lshl_b32 s57, s56, 13
v_add_u32 v8, s57, v18
v_add_u32 v9, 0x10000, v8
s_lshl_b32 s57, s56, 12
v_add_u32 v26, s57, v18
v_add_u32 v27, 0x10000, v26
v_and_b32 v19, 3, v0
v_bfe_u32 v30, v0, 2, 1
v_lshl_add_u32 v19, v30, 2, v19
v_bfe_u32 v30, v0, 3, 1
v_lshl_add_u32 v19, v30, 4, v19
v_lshlrev_b32 v19, 4, v19
v_lshl_add_u32 v19, v29, 9, v19
v_and_b32 v28, 15, v0
v_lshlrev_b32 v28, 4, v28
v_bfe_u32 v30, v0, 4, 1
v_lshl_add_u32 v28, v30, 9, v28
v_bfe_u32 v30, v0, 5, 1
v_lshl_add_u32 v28, v30, 11, v28
v_bfe_u32 v32, v0, 2, 2
v_bfe_u32 v33, v0, 4, 1
v_bfe_u32 v34, v0, 5, 1
v_lshl_add_u32 v35, v33, 2, v32
v_lshl_add_u32 v35, v34, 4, v35
v_lshlrev_b32 v35, 8, v35
v_and_b32 v36, 1, v0
v_lshl_add_u32 v35, v36, 3, v35
v_add_u32 v35, 16384, v35
v_lshl_add_u32 v36, v32, 2, v33
v_and_b32 v37, 2, v0
v_xor_b32 v36, v36, v37
s_and_b32 s56, s3, 1
s_lshl_b32 s56, s56, 3
s_add_u32 s57, s56, 0
v_xor_b32 v37, s57, v36
v_lshl_add_u32 v10, v37, 4, v35
v_add_u32 v11, 0x10000, v10
s_add_u32 s57, s56, 1
v_xor_b32 v37, s57, v36
v_lshl_add_u32 v12, v37, 4, v35
v_add_u32 v13, 0x10000, v12
s_add_u32 s57, s56, 4
v_xor_b32 v37, s57, v36
v_lshl_add_u32 v14, v37, 4, v35
v_add_u32 v15, 0x10000, v14
s_add_u32 s57, s56, 5
v_xor_b32 v37, s57, v36
v_lshl_add_u32 v16, v37, 4, v35
v_add_u32 v17, 0x10000, v16
s_mov_b32 s8, s80
s_mov_b32 s9, s81
s_mov_b32 s10, s82
s_mov_b32 s11, 0x20000
s_mov_b32 s48, s84
s_mov_b32 s49, s85
s_mov_b32 s50, s86
s_mov_b32 s52, s88
s_mov_b32 s53, s89
s_mov_b32 s55, s87
s_mov_b32 s93, s90
s_mov_b32 s51, s100
v_mov_b32 v2, v20
v_mov_b32 v3, v21
v_mov_b32 v4, v22
v_mov_b32 v5, v23
v_mov_b32 v6, v24
v_mov_b32 v7, v25
s_mov_b32 s91, 0
s_mov_b32 s33, 0
s_mov_b32 s46, 0
s_mov_b32 s34, s36
s_mov_b32 s35, s37
v_mov_b32 v248, 0
s_mov_b32 s92, 255
L_next:
s_load_dwordx8 s[68:75], s[64:65], 0
s_add_u32 s64, s64, 16
s_addc_u32 s65, s65, 0
s_waitcnt lgkmcnt(0)
s_cmp_lg_u32 s91, 0
s_cbranch_scc1 L_warm
s_and_b32 s66, s68, 15
s_cmp_eq_u32 s66, 0
s_cbranch_scc1 L_done
s_bfe_u32 s60, s68, 0x80004
s_bfe_u32 s61, s68, 0x8000c
s_bfe_u32 s62, s68, 0x60014
s_lshr_b32 s63, s68, 26
s_cmp_ge_u32 s66, 3
s_cbranch_scc1 L_poll
s_lshl_b32 s54, s3, 12
v_and_b32 v18, 15, v0
v_lshlrev_b32 v18, 4, v18
v_bfe_u32 v29, v0, 4, 2
v_lshl_add_u32 v18, v29, 9, v18
s_lshr_b32 s56, s3, 1
s_lshl_b32 s57, s56, 13
v_add_u32 v8, s57, v18
v_add_u32 v9, 0x10000, v8
s_lshl_b32 s57, s56, 12
v_add_u32 v26, s57, v18
v_add_u32 v27, 0x10000, v26
v_and_b32 v19, 3, v0
v_bfe_u32 v30, v0, 2, 1
v_lshl_add_u32 v19, v30, 2, v19
v_bfe_u32 v30, v0, 3, 1
v_lshl_add_u32 v19, v30, 4, v19
v_lshlrev_b32 v19, 4, v19
v_lshl_add_u32 v19, v29, 9, v19
v_and_b32 v28, 15, v0
v_lshlrev_b32 v28, 4, v28
v_bfe_u32 v30, v0, 4, 1
v_lshl_add_u32 v28, v30, 9, v28
v_bfe_u32 v30, v0, 5, 1
v_lshl_add_u32 v28, v30, 11, v28
v_bfe_u32 v32, v0, 2, 2
v_bfe_u32 v33, v0, 4, 1
v_bfe_u32 v34, v0, 5, 1
v_lshl_add_u32 v35, v33, 2, v32
v_lshl_add_u32 v35, v34, 4, v35
v_lshlrev_b32 v35, 8, v35
v_and_b32 v36, 1, v0
v_lshl_add_u32 v35, v36, 3, v35
v_add_u32 v35, 16384, v35
v_lshl_add_u32 v36, v32, 2, v33
v_and_b32 v37, 2, v0
v_xor_b32 v36, v36, v37
s_and_b32 s56, s3, 1
s_lshl_b32 s56, s56, 3
s_add_u32 s57, s56, 0
v_xor_b32 v37, s57, v36
v_lshl_add_u32 v10, v37, 4, v35
v_add_u32 v11, 0x10000, v10
s_add_u32 s57, s56, 1
v_xor_b32 v37, s57, v36
v_lshl_add_u32 v12, v37, 4, v35
v_add_u32 v13, 0x10000, v12
s_add_u32 s57, s56, 4
v_xor_b32 v37, s57, v36
v_lshl_add_u32 v14, v37, 4, v35
v_add_u32 v15, 0x10000, v14
s_add_u32 s57, s56, 5
v_xor_b32 v37, s57, v36
v_lshl_add_u32 v16, v37, 4, v35
v_add_u32 v17, 0x10000, v16
s_cmp_eq_u32 s66, 2
s_cbranch_scc1 L_g2
s_lshl_b32 s58, s60, 3
s_cmp_eq_u32 s62, 2
s_cselect_b32 s59, 4, 0
s_add_u32 s58, s58, s59
s_lshl_b32 s84, s58, 16
s_add_u32 s84, s84, 0
s_lshr_b32 s59, s3, 1
s_mov_b32 s83, 0x20000
s_cmp_ge_u32 s61, 48
s_cbranch_scc1 L_gu_220
s_lshr_b32 s56, s61, 4
s_cmp_eq_u32 s56, 1
s_cselect_b32 s80, s28, s26
s_cselect_b32 s81, s29, s27
s_cselect_b32 s90, 1, 0
s_mov_b32 s88, 20971520
s_cselect_b32 s88, 37748736, s88
s_cmp_eq_u32 s56, 2
s_cselect_b32 s80, s24, s80
s_cselect_b32 s81, s25, s81
s_cselect_b32 s88, 4194304, s88
s_mov_b32 s82, 8388608
s_and_b32 s56, s61, 15
s_lshl_b32 s85, s56, 9
s_lshl_b32 s59, s59, 8
s_add_u32 s85, s85, s59
s_lshl_b32 s58, s58, 18
s_add_u32 s88, s88, s58
s_lshl_b32 s56, s56, 14
s_add_u32 s88, s88, s56
s_mov_b32 s89, 262144
s_mov_b32 s59, 8192
s_branch L_pd_221
L_gu_220:
s_cmp_eq_u32 s59, 1
s_cselect_b32 s80, s38, s36
s_cselect_b32 s81, s39, s37
s_mov_b32 s82, 7340032
s_mov_b32 s90, 2
s_sub_u32 s56, s61, 48
s_lshl_b32 s85, s56, 8
s_mul_i32 s88, s58, 229376
s_lshl_b32 s56, s56, 13
s_add_u32 s88, s88, s56
s_add_u32 s88, s88, 54525952
s_mov_b32 s89, 229376
s_mov_b32 s59, 7168
L_pd_221:
s_and_b32 s81, s81, 0xffff
s_min_u32 s62, s62, 1
s_lshl_b32 s58, s62, 2
s_add_u32 s90, s90, s58
s_mov_b32 s58, 65536
s_mov_b32 s100, 8
s_sub_u32 s56, 1, s62
s_lshl_b32 s57, s3, s56
s_mul_i32 s57, s57, s58
v_add_u32 v20, s57, v1
s_sub_u32 s57, s58, 2048
v_add_u32 v21, s57, v20
s_lshr_b32 s87, s54, s62
v_bfe_u32 v29, v0, 4, 2
v_and_b32 v30, 15, v0
v_lshlrev_b32 v31, 2, v29
v_xor_b32 v30, v30, v31
s_and_b32 s57, s3, 1
s_lshl_b32 s57, s57, 4
v_add_u32 v29, s57, v29
v_mul_lo_u32 v29, v29, s59
s_lshl_b32 s57, s59, 2
s_sub_u32 s57, s57, 1024
v_mov_b32 v31, v30
v_lshl_add_u32 v22, v31, 4, v29
v_add_u32 v29, s57, v29
v_xor_b32 v31, 1, v30
v_lshl_add_u32 v23, v31, 4, v29
v_add_u32 v29, s57, v29
v_mov_b32 v31, v30
v_lshl_add_u32 v24, v31, 4, v29
v_add_u32 v29, s57, v29
v_xor_b32 v31, 1, v30
v_lshl_add_u32 v25, v31, 4, v29
s_lshl_b32 s86, s59, 5
s_branch L_cold
L_g2:
s_lshr_b32 s67, s61, 2
s_and_b32 s61, s61, 3
s_lshl_b32 s58, s60, 3
s_cmp_eq_u32 s67, 2
s_cselect_b32 s59, 4, 0
s_add_u32 s58, s58, s59
s_lshr_b32 s59, s3, 1
s_lshl_b32 s59, s59, 8
s_lshl_b32 s85, s61, 9
s_add_u32 s85, s85, s59
s_mov_b32 s83, 0x20000
s_lshl_b32 s88, s62, 22
s_lshl_b32 s59, s58, 16
s_add_u32 s88, s88, s59
s_lshl_b32 s59, s61, 14
s_add_u32 s88, s88, s59
s_add_u32 s88, s88, 100663296
s_mov_b32 s89, 65536
s_cmp_ge_u32 s62, 2
s_cbranch_scc1 L_o_222
s_mov_b32 s80, s40
s_and_b32 s81, s41, 0xffff
s_mov_b32 s82, 7340032
s_mul_i32 s59, s62, 3670016
s_add_u32 s85, s85, s59
s_mul_i32 s84, s58, 229376
s_mul_i32 s59, s62, 114688
s_add_u32 s84, s84, s59
s_add_u32 s84, s84, 54525952
s_mov_b32 s58, 229376
s_mov_b32 s100, 14
s_branch L_go_223
L_o_222:
s_mov_b32 s80, s30
s_and_b32 s81, s31, 0xffff
s_mov_b32 s82, 8388608
s_lshr_b32 s100, 32, s63
s_sub_u32 s56, s62, 2
s_lshl_b32 s59, s56, 23
s_lshr_b32 s59, s59, s63
s_add_u32 s85, s85, s59
s_lshl_b32 s84, s58, 18
s_lshl_b32 s59, s56, 18
s_lshr_b32 s59, s59, s63
s_add_u32 s84, s84, s59
s_add_u32 s84, s84, 69206016
s_mov_b32 s58, 262144
L_go_223:
s_min_u32 s67, s67, 1
s_lshl_b32 s90, s67, 2
s_mov_b32 s59, 2048
s_sub_u32 s56, 1, s67
s_lshl_b32 s57, s3, s56
s_mul_i32 s57, s57, s58
v_add_u32 v20, s57, v1
s_sub_u32 s57, s58, 2048
v_add_u32 v21, s57, v20
s_lshr_b32 s87, s54, s67
v_bfe_u32 v29, v0, 4, 2
v_and_b32 v30, 15, v0
v_lshlrev_b32 v31, 2, v29
v_xor_b32 v30, v30, v31
s_and_b32 s57, s3, 1
s_lshl_b32 s57, s57, 4
v_add_u32 v29, s57, v29
v_mul_lo_u32 v29, v29, s59
s_lshl_b32 s57, s59, 2
s_sub_u32 s57, s57, 1024
v_mov_b32 v31, v30
v_lshl_add_u32 v22, v31, 4, v29
v_add_u32 v29, s57, v29
v_xor_b32 v31, 1, v30
v_lshl_add_u32 v23, v31, 4, v29
v_add_u32 v29, s57, v29
v_mov_b32 v31, v30
v_lshl_add_u32 v24, v31, 4, v29
v_add_u32 v29, s57, v29
v_xor_b32 v31, 1, v30
v_lshl_add_u32 v25, v31, 4, v29
s_lshl_b32 s86, s59, 5
L_cold:
s_mov_b32 s8, s80
s_mov_b32 s9, s81
s_mov_b32 s10, s82
s_mov_b32 s11, 0x20000
s_mov_b32 s48, s84
s_mov_b32 s49, s85
s_mov_b32 s50, s86
s_mov_b32 s52, s88
s_mov_b32 s53, s89
s_mov_b32 s55, s87
s_mov_b32 s93, s90
s_mov_b32 s51, s100
v_mov_b32 v2, v20
v_mov_b32 v3, v21
v_mov_b32 v4, v22
v_mov_b32 v5, v23
v_mov_b32 v6, v24
v_mov_b32 v7, v25
s_add_u32 m0, s54, 16384
s_nop 0
buffer_load_dwordx4 v4, s[8:11], s49 offen lds
buffer_load_dwordx4 v5, s[8:11], s49 offen offset:1024 lds
buffer_load_dwordx4 v6, s[8:11], s49 offen offset:2048 lds
buffer_load_dwordx4 v7, s[8:11], s49 offen offset:3072 lds
s_add_u32 s49, s49, s50
s_add_u32 m0, s54, 49152
s_nop 0
buffer_load_dwordx4 v4, s[8:11], s49 offen lds
buffer_load_dwordx4 v5, s[8:11], s49 offen offset:1024 lds
buffer_load_dwordx4 v6, s[8:11], s49 offen offset:2048 lds
buffer_load_dwordx4 v7, s[8:11], s49 offen offset:3072 lds
s_add_u32 s49, s49, s50
s_add_u32 m0, s54, 81920
s_nop 0
buffer_load_dwordx4 v4, s[8:11], s49 offen lds
buffer_load_dwordx4 v5, s[8:11], s49 offen offset:1024 lds
buffer_load_dwordx4 v6, s[8:11], s49 offen offset:2048 lds
buffer_load_dwordx4 v7, s[8:11], s49 offen offset:3072 lds
s_add_u32 s49, s49, s50
s_add_u32 m0, s54, 114688
s_nop 0
buffer_load_dwordx4 v4, s[8:11], s49 offen lds
buffer_load_dwordx4 v5, s[8:11], s49 offen offset:1024 lds
buffer_load_dwordx4 v6, s[8:11], s49 offen offset:2048 lds
buffer_load_dwordx4 v7, s[8:11], s49 offen offset:3072 lds
s_add_u32 s49, s49, s50
L_poll:
s_cmp_lg_u32 s3, 0
s_cbranch_scc1 L_nw_219
s_cmp_lg_u32 s66, 1
s_cbranch_scc1 L_notg1_224
v_and_b32 v29, 7, v0
v_lshlrev_b32 v29, 8, v29
s_mov_b32 s94, 98566144
L_lnp_225:
buffer_load_dword v30, v29, s[4:7], s94 offen sc1
s_waitcnt vmcnt(0)
v_cmp_gt_u32 vcc, 16, v30
s_cbranch_vccz L_nw_219
s_sleep 2
s_sub_u32 s78, s78, 1
s_cmp_lg_u32 s78, 0
s_cbranch_scc1 L_lnp_225
s_branch L_fail
L_notg1_224:
s_and_b32 s97, s69, 255
s_bfe_u32 s98, s69, 0x80008
s_lshl_b32 s94, s97, 8
s_add_u32 s94, s94, 98566144
v_mov_b32 v29, 0
L_pc_226:
buffer_load_dword v30, v29, s[4:7], s94 offen sc1
s_waitcnt vmcnt(0)
v_readfirstlane_b32 s95, v30
s_cmp_ge_u32 s95, s98
s_cbranch_scc1 L_pcok_227
s_sleep 4
s_sub_u32 s78, s78, 1
s_cmp_lg_u32 s78, 0
s_cbranch_scc1 L_pc_226
s_branch L_fail
L_pcok_227:
s_bfe_u32 s97, s69, 0x80010
s_lshr_b32 s98, s69, 24
s_cmp_eq_u32 s98, 0
s_cbranch_scc1 L_nw_219
s_and_b32 s95, s71, 128
s_cbranch_scc1 L_nw_219
s_lshl_b32 s94, s97, 8
s_add_u32 s94, s94, 98566144
v_mov_b32 v29, 0
L_pc_228:
buffer_load_dword v30, v29, s[4:7], s94 offen sc1
s_waitcnt vmcnt(0)
v_readfirstlane_b32 s95, v30
s_cmp_ge_u32 s95, s98
s_cbranch_scc1 L_pcok_229
s_sleep 4
s_sub_u32 s78, s78, 1
s_cmp_lg_u32 s78, 0
s_cbranch_scc1 L_pc_228
s_branch L_fail
L_pcok_229:
L_nw_219:
s_barrier
s_cmp_eq_u32 s66, 3
s_cbranch_scc1 L_at
s_cmp_eq_u32 s66, 4
s_cbranch_scc1 L_fin
s_cmp_ge_u32 s93, 4
s_cbranch_scc1 L_ih_230
s_add_u32 m0, s55, 0
s_nop 0
buffer_load_dwordx4 v2, s[4:7], s48 offen sc1 lds
buffer_load_dwordx4 v2, s[4:7], s48 offen offset:1024 sc1 lds
buffer_load_dwordx4 v3, s[4:7], s48 offen offset:2048 sc1 lds
buffer_load_dwordx4 v3, s[4:7], s48 offen offset:3072 sc1 lds
s_add_u32 s48, s48, 2048
s_add_u32 m0, s55, 32768
s_nop 0
buffer_load_dwordx4 v2, s[4:7], s48 offen sc1 lds
buffer_load_dwordx4 v2, s[4:7], s48 offen offset:1024 sc1 lds
buffer_load_dwordx4 v3, s[4:7], s48 offen offset:2048 sc1 lds
buffer_load_dwordx4 v3, s[4:7], s48 offen offset:3072 sc1 lds
s_add_u32 s48, s48, 2048
s_add_u32 m0, s55, 65536
s_nop 0
buffer_load_dwordx4 v2, s[4:7], s48 offen sc1 lds
buffer_load_dwordx4 v2, s[4:7], s48 offen offset:1024 sc1 lds
buffer_load_dwordx4 v3, s[4:7], s48 offen offset:2048 sc1 lds
buffer_load_dwordx4 v3, s[4:7], s48 offen offset:3072 sc1 lds
s_add_u32 s48, s48, 2048
s_add_u32 m0, s55, 98304
s_nop 0
buffer_load_dwordx4 v2, s[4:7], s48 offen sc1 lds
buffer_load_dwordx4 v2, s[4:7], s48 offen offset:1024 sc1 lds
buffer_load_dwordx4 v3, s[4:7], s48 offen offset:2048 sc1 lds
buffer_load_dwordx4 v3, s[4:7], s48 offen offset:3072 sc1 lds
s_add_u32 s48, s48, 2048
s_branch L_id_231
L_ih_230:
s_add_u32 m0, s55, 0
s_nop 0
buffer_load_dwordx4 v2, s[4:7], s48 offen sc1 lds
buffer_load_dwordx4 v2, s[4:7], s48 offen offset:1024 sc1 lds
s_add_u32 s48, s48, 2048
s_add_u32 m0, s55, 32768
s_nop 0
buffer_load_dwordx4 v2, s[4:7], s48 offen sc1 lds
buffer_load_dwordx4 v2, s[4:7], s48 offen offset:1024 sc1 lds
s_add_u32 s48, s48, 2048
s_add_u32 m0, s55, 65536
s_nop 0
buffer_load_dwordx4 v2, s[4:7], s48 offen sc1 lds
buffer_load_dwordx4 v2, s[4:7], s48 offen offset:1024 sc1 lds
s_add_u32 s48, s48, 2048
s_add_u32 m0, s55, 98304
s_nop 0
buffer_load_dwordx4 v2, s[4:7], s48 offen sc1 lds
buffer_load_dwordx4 v2, s[4:7], s48 offen offset:1024 sc1 lds
s_add_u32 s48, s48, 2048
L_id_231:
s_mov_b32 s96, 0
s_branch L_go
L_warm:
s_mov_b32 s8, s80
s_mov_b32 s9, s81
s_mov_b32 s10, s82
s_mov_b32 s11, 0x20000
s_mov_b32 s48, s84
s_mov_b32 s49, s85
s_mov_b32 s50, s86
s_mov_b32 s52, s88
s_mov_b32 s53, s89
s_mov_b32 s55, s87
s_mov_b32 s93, s90
s_mov_b32 s51, s100
v_mov_b32 v2, v20
v_mov_b32 v3, v21
v_mov_b32 v4, v22
v_mov_b32 v5, v23
v_mov_b32 v6, v24
v_mov_b32 v7, v25
L_go:
s_bfe_u32 s33, s71, 0x20004
s_cmp_eq_u32 s33, 0
s_cbranch_scc1 L_nw_232
s_bfe_u32 s60, s2, 0x20003
s_lshl_b32 s60, s60, 2
s_and_b32 s61, s2, 3
s_add_u32 s60, s60, s61
s_lshl_b32 s60, s60, 2
s_add_u32 s60, s60, s3
s_mul_i32 s60, s60, 114688
v_lshl_add_u32 v248, v1, 3, s60
s_cmp_eq_u32 s33, 2
s_cselect_b32 s34, s38, s36
s_cselect_b32 s35, s39, s37
s_cmp_eq_u32 s33, 3
s_cselect_b32 s34, s40, s34
s_cselect_b32 s35, s41, s35
global_load_dword v249, v248, s[34:35]
v_add_u32 v248, 8192, v248
global_load_dword v249, v248, s[34:35]
v_add_u32 v248, 8192, v248
global_load_dword v249, v248, s[34:35]
v_add_u32 v248, 8192, v248
global_load_dword v249, v248, s[34:35]
v_add_u32 v248, 8192, v248
global_load_dword v249, v248, s[34:35]
v_add_u32 v248, 8192, v248
global_load_dword v249, v248, s[34:35]
v_add_u32 v248, 8192, v248
global_load_dword v249, v248, s[34:35]
v_add_u32 v248, 8192, v248
global_load_dword v249, v248, s[34:35]
v_add_u32 v248, 8192, v248
global_load_dword v249, v248, s[34:35]
v_add_u32 v248, 8192, v248
global_load_dword v249, v248, s[34:35]
v_add_u32 v248, 8192, v248
global_load_dword v249, v248, s[34:35]
v_add_u32 v248, 8192, v248
global_load_dword v249, v248, s[34:35]
v_add_u32 v248, 8192, v248
global_load_dword v249, v248, s[34:35]
v_add_u32 v248, 8192, v248
global_load_dword v249, v248, s[34:35]
L_nw_232:
s_and_b32 s91, s75, 1
s_cmp_eq_u32 s91, 0
s_cbranch_scc1 L_run
s_bfe_u32 s60, s72, 0x80004
s_bfe_u32 s61, s72, 0x8000c
s_bfe_u32 s62, s72, 0x60014
s_and_b32 s63, s72, 15
s_cmp_eq_u32 s63, 2
s_cbranch_scc1 L_n2
s_lshl_b32 s58, s60, 3
s_cmp_eq_u32 s62, 2
s_cselect_b32 s59, 4, 0
s_add_u32 s58, s58, s59
s_lshl_b32 s84, s58, 16
s_add_u32 s84, s84, 0
s_lshr_b32 s59, s3, 1
s_mov_b32 s83, 0x20000
s_cmp_ge_u32 s61, 48
s_cbranch_scc1 L_gu_233
s_lshr_b32 s56, s61, 4
s_cmp_eq_u32 s56, 1
s_cselect_b32 s80, s28, s26
s_cselect_b32 s81, s29, s27
s_cselect_b32 s90, 1, 0
s_mov_b32 s88, 20971520
s_cselect_b32 s88, 37748736, s88
s_cmp_eq_u32 s56, 2
s_cselect_b32 s80, s24, s80
s_cselect_b32 s81, s25, s81
s_cselect_b32 s88, 4194304, s88
s_mov_b32 s82, 8388608
s_and_b32 s56, s61, 15
s_lshl_b32 s85, s56, 9
s_lshl_b32 s59, s59, 8
s_add_u32 s85, s85, s59
s_lshl_b32 s58, s58, 18
s_add_u32 s88, s88, s58
s_lshl_b32 s56, s56, 14
s_add_u32 s88, s88, s56
s_mov_b32 s89, 262144
s_mov_b32 s59, 8192
s_branch L_pd_234
L_gu_233:
s_cmp_eq_u32 s59, 1
s_cselect_b32 s80, s38, s36
s_cselect_b32 s81, s39, s37
s_mov_b32 s82, 7340032
s_mov_b32 s90, 2
s_sub_u32 s56, s61, 48
s_lshl_b32 s85, s56, 8
s_mul_i32 s88, s58, 229376
s_lshl_b32 s56, s56, 13
s_add_u32 s88, s88, s56
s_add_u32 s88, s88, 54525952
s_mov_b32 s89, 229376
s_mov_b32 s59, 7168
L_pd_234:
s_and_b32 s81, s81, 0xffff
s_min_u32 s62, s62, 1
s_lshl_b32 s58, s62, 2
s_add_u32 s90, s90, s58
s_mov_b32 s58, 65536
s_mov_b32 s100, 8
s_sub_u32 s56, 1, s62
s_lshl_b32 s57, s3, s56
s_mul_i32 s57, s57, s58
v_add_u32 v20, s57, v1
s_sub_u32 s57, s58, 2048
v_add_u32 v21, s57, v20
s_lshr_b32 s87, s54, s62
v_bfe_u32 v29, v0, 4, 2
v_and_b32 v30, 15, v0
v_lshlrev_b32 v31, 2, v29
v_xor_b32 v30, v30, v31
s_and_b32 s57, s3, 1
s_lshl_b32 s57, s57, 4
v_add_u32 v29, s57, v29
v_mul_lo_u32 v29, v29, s59
s_lshl_b32 s57, s59, 2
s_sub_u32 s57, s57, 1024
v_mov_b32 v31, v30
v_lshl_add_u32 v22, v31, 4, v29
v_add_u32 v29, s57, v29
v_xor_b32 v31, 1, v30
v_lshl_add_u32 v23, v31, 4, v29
v_add_u32 v29, s57, v29
v_mov_b32 v31, v30
v_lshl_add_u32 v24, v31, 4, v29
v_add_u32 v29, s57, v29
v_xor_b32 v31, 1, v30
v_lshl_add_u32 v25, v31, 4, v29
s_lshl_b32 s86, s59, 5
s_branch L_run
L_n2:
s_lshr_b32 s63, s72, 26
s_lshr_b32 s67, s61, 2
s_and_b32 s61, s61, 3
s_lshl_b32 s58, s60, 3
s_cmp_eq_u32 s67, 2
s_cselect_b32 s59, 4, 0
s_add_u32 s58, s58, s59
s_lshr_b32 s59, s3, 1
s_lshl_b32 s59, s59, 8
s_lshl_b32 s85, s61, 9
s_add_u32 s85, s85, s59
s_mov_b32 s83, 0x20000
s_lshl_b32 s88, s62, 22
s_lshl_b32 s59, s58, 16
s_add_u32 s88, s88, s59
s_lshl_b32 s59, s61, 14
s_add_u32 s88, s88, s59
s_add_u32 s88, s88, 100663296
s_mov_b32 s89, 65536
s_cmp_ge_u32 s62, 2
s_cbranch_scc1 L_o_235
s_mov_b32 s80, s40
s_and_b32 s81, s41, 0xffff
s_mov_b32 s82, 7340032
s_mul_i32 s59, s62, 3670016
s_add_u32 s85, s85, s59
s_mul_i32 s84, s58, 229376
s_mul_i32 s59, s62, 114688
s_add_u32 s84, s84, s59
s_add_u32 s84, s84, 54525952
s_mov_b32 s58, 229376
s_mov_b32 s100, 14
s_branch L_go_236
L_o_235:
s_mov_b32 s80, s30
s_and_b32 s81, s31, 0xffff
s_mov_b32 s82, 8388608
s_lshr_b32 s100, 32, s63
s_sub_u32 s56, s62, 2
s_lshl_b32 s59, s56, 23
s_lshr_b32 s59, s59, s63
s_add_u32 s85, s85, s59
s_lshl_b32 s84, s58, 18
s_lshl_b32 s59, s56, 18
s_lshr_b32 s59, s59, s63
s_add_u32 s84, s84, s59
s_add_u32 s84, s84, 69206016
s_mov_b32 s58, 262144
L_go_236:
s_min_u32 s67, s67, 1
s_lshl_b32 s90, s67, 2
s_mov_b32 s59, 2048
s_sub_u32 s56, 1, s67
s_lshl_b32 s57, s3, s56
s_mul_i32 s57, s57, s58
v_add_u32 v20, s57, v1
s_sub_u32 s57, s58, 2048
v_add_u32 v21, s57, v20
s_lshr_b32 s87, s54, s67
v_bfe_u32 v29, v0, 4, 2
v_and_b32 v30, 15, v0
v_lshlrev_b32 v31, 2, v29
v_xor_b32 v30, v30, v31
s_and_b32 s57, s3, 1
s_lshl_b32 s57, s57, 4
v_add_u32 v29, s57, v29
v_mul_lo_u32 v29, v29, s59
s_lshl_b32 s57, s59, 2
s_sub_u32 s57, s57, 1024
v_mov_b32 v31, v30
v_lshl_add_u32 v22, v31, 4, v29
v_add_u32 v29, s57, v29
v_xor_b32 v31, 1, v30
v_lshl_add_u32 v23, v31, 4, v29
v_add_u32 v29, s57, v29
v_mov_b32 v31, v30
v_lshl_add_u32 v24, v31, 4, v29
v_add_u32 v29, s57, v29
v_xor_b32 v31, 1, v30
v_lshl_add_u32 v25, v31, 4, v29
s_lshl_b32 s86, s59, 5
s_mov_b32 s91, 2
L_run:
s_cmp_eq_u32 s93, 1
s_cbranch_scc1 L_mv_237
s_cmp_eq_u32 s93, 5
s_cbranch_scc1 L_mhv_239
s_cmp_ge_u32 s93, 4
s_cbranch_scc1 L_mh_238
s_cmp_eq_u32 s96, 1
s_cbranch_scc1 L_w1_243
s_cmp_eq_u32 s96, 2
s_cbranch_scc1 L_w2_244
s_cmp_eq_u32 s96, 3
s_cbranch_scc1 L_w3_245
s_waitcnt vmcnt(12)
s_branch L_wg_246
L_w1_243:
s_waitcnt vmcnt(16)
s_branch L_wg_246
L_w2_244:
s_waitcnt vmcnt(32)
s_branch L_wg_246
L_w3_245:
s_waitcnt vmcnt(63)
L_wg_246:
s_barrier
ds_read_b64_tr_b16 a[32:33], v10 offset:0
ds_read_b64_tr_b16 a[34:35], v10 offset:2048
ds_read_b128 a[0:3], v8 offset:0
ds_read_b128 a[4:7], v8 offset:256
ds_read_b128 a[8:11], v8 offset:2048
ds_read_b128 a[12:15], v8 offset:2304
ds_read_b128 a[16:19], v8 offset:4096
ds_read_b128 a[20:23], v8 offset:4352
ds_read_b128 a[24:27], v8 offset:6144
ds_read_b128 a[28:31], v8 offset:6400
ds_read_b64_tr_b16 a[36:37], v12 offset:0
ds_read_b64_tr_b16 a[38:39], v12 offset:2048
ds_read_b64_tr_b16 a[40:41], v14 offset:0
ds_read_b64_tr_b16 a[42:43], v14 offset:2048
ds_read_b64_tr_b16 a[44:45], v16 offset:0
ds_read_b64_tr_b16 a[46:47], v16 offset:2048
ds_read_b64_tr_b16 a[48:49], v10 offset:8192
ds_read_b64_tr_b16 a[50:51], v10 offset:10240
ds_read_b64_tr_b16 a[52:53], v12 offset:8192
ds_read_b64_tr_b16 a[54:55], v12 offset:10240
ds_read_b64_tr_b16 a[56:57], v14 offset:8192
ds_read_b64_tr_b16 a[58:59], v14 offset:10240
ds_read_b64_tr_b16 a[60:61], v16 offset:8192
ds_read_b64_tr_b16 a[62:63], v16 offset:10240
s_waitcnt lgkmcnt(0)
v_mfma_f32_16x16x32_bf16 v[32:35], a[32:35], a[0:3], 0
s_cmp_lg_u32 s96, 0
s_cbranch_scc1 L_cw_1247
s_waitcnt vmcnt(8)
L_cw_1247:
s_barrier
v_mfma_f32_16x16x32_bf16 v[36:39], a[32:35], a[4:7], 0
v_mfma_f32_16x16x32_bf16 v[96:99], a[32:35], a[8:11], 0
ds_read_b64_tr_b16 a[96:97], v10 offset:32768
v_mfma_f32_16x16x32_bf16 v[100:103], a[32:35], a[12:15], 0
s_add_u32 m0, s55, 0
s_nop 0
buffer_load_dwordx4 v2, s[4:7], s48 offen sc1 lds
v_mfma_f32_16x16x32_bf16 v[160:163], a[32:35], a[16:19], 0
ds_read_b64_tr_b16 a[98:99], v10 offset:34816
v_mfma_f32_16x16x32_bf16 v[164:167], a[32:35], a[20:23], 0
v_mfma_f32_16x16x32_bf16 v[224:227], a[32:35], a[24:27], 0
ds_read_b128 a[64:67], v8 offset:32768
v_mfma_f32_16x16x32_bf16 v[228:231], a[32:35], a[28:31], 0
buffer_load_dwordx4 v2, s[4:7], s48 offen offset:1024 sc1 lds
v_mfma_f32_16x16x32_bf16 v[40:43], a[36:39], a[0:3], 0
ds_read_b128 a[68:71], v8 offset:33024
v_mfma_f32_16x16x32_bf16 v[44:47], a[36:39], a[4:7], 0
v_mfma_f32_16x16x32_bf16 v[104:107], a[36:39], a[8:11], 0
ds_read_b128 a[72:75], v8 offset:34816
v_mfma_f32_16x16x32_bf16 v[108:111], a[36:39], a[12:15], 0
buffer_load_dwordx4 v3, s[4:7], s48 offen offset:2048 sc1 lds
v_mfma_f32_16x16x32_bf16 v[168:171], a[36:39], a[16:19], 0
ds_read_b128 a[76:79], v8 offset:35072
v_mfma_f32_16x16x32_bf16 v[172:175], a[36:39], a[20:23], 0
v_mfma_f32_16x16x32_bf16 v[232:235], a[36:39], a[24:27], 0
ds_read_b128 a[80:83], v8 offset:36864
v_mfma_f32_16x16x32_bf16 v[236:239], a[36:39], a[28:31], 0
buffer_load_dwordx4 v3, s[4:7], s48 offen offset:3072 sc1 lds
s_add_u32 s48, s48, 2048
v_mfma_f32_16x16x32_bf16 v[48:51], a[40:43], a[0:3], 0
ds_read_b128 a[84:87], v8 offset:37120
v_mfma_f32_16x16x32_bf16 v[52:55], a[40:43], a[4:7], 0
v_mfma_f32_16x16x32_bf16 v[112:115], a[40:43], a[8:11], 0
ds_read_b128 a[88:91], v8 offset:38912
v_mfma_f32_16x16x32_bf16 v[116:119], a[40:43], a[12:15], 0
s_add_u32 m0, s54, 16384
s_nop 0
buffer_load_dwordx4 v4, s[8:11], s49 offen lds
v_mfma_f32_16x16x32_bf16 v[176:179], a[40:43], a[16:19], 0
ds_read_b128 a[92:95], v8 offset:39168
v_mfma_f32_16x16x32_bf16 v[180:183], a[40:43], a[20:23], 0
v_mfma_f32_16x16x32_bf16 a[128:131], a[40:43], a[24:27], 0
ds_read_b64_tr_b16 a[100:101], v12 offset:32768
v_mfma_f32_16x16x32_bf16 a[132:135], a[40:43], a[28:31], 0
buffer_load_dwordx4 v5, s[8:11], s49 offen offset:1024 lds
v_mfma_f32_16x16x32_bf16 v[56:59], a[44:47], a[0:3], 0
ds_read_b64_tr_b16 a[102:103], v12 offset:34816
v_mfma_f32_16x16x32_bf16 v[60:63], a[44:47], a[4:7], 0
v_mfma_f32_16x16x32_bf16 v[120:123], a[44:47], a[8:11], 0
ds_read_b64_tr_b16 a[104:105], v14 offset:32768
v_mfma_f32_16x16x32_bf16 v[124:127], a[44:47], a[12:15], 0
buffer_load_dwordx4 v6, s[8:11], s49 offen offset:2048 lds
v_mfma_f32_16x16x32_bf16 v[184:187], a[44:47], a[16:19], 0
ds_read_b64_tr_b16 a[106:107], v14 offset:34816
v_mfma_f32_16x16x32_bf16 v[188:191], a[44:47], a[20:23], 0
v_mfma_f32_16x16x32_bf16 a[136:139], a[44:47], a[24:27], 0
ds_read_b64_tr_b16 a[108:109], v16 offset:32768
v_mfma_f32_16x16x32_bf16 a[140:143], a[44:47], a[28:31], 0
buffer_load_dwordx4 v7, s[8:11], s49 offen offset:3072 lds
s_add_u32 s49, s49, s50
v_mfma_f32_16x16x32_bf16 v[64:67], a[48:51], a[0:3], 0
ds_read_b64_tr_b16 a[110:111], v16 offset:34816
v_mfma_f32_16x16x32_bf16 v[68:71], a[48:51], a[4:7], 0
v_mfma_f32_16x16x32_bf16 v[128:131], a[48:51], a[8:11], 0
ds_read_b64_tr_b16 a[112:113], v10 offset:40960
v_mfma_f32_16x16x32_bf16 v[132:135], a[48:51], a[12:15], 0
v_mfma_f32_16x16x32_bf16 v[192:195], a[48:51], a[16:19], 0
ds_read_b64_tr_b16 a[114:115], v10 offset:43008
v_mfma_f32_16x16x32_bf16 v[196:199], a[48:51], a[20:23], 0
v_mfma_f32_16x16x32_bf16 a[144:147], a[48:51], a[24:27], 0
ds_read_b64_tr_b16 a[116:117], v12 offset:40960
v_mfma_f32_16x16x32_bf16 a[148:151], a[48:51], a[28:31], 0
v_mfma_f32_16x16x32_bf16 v[72:75], a[52:55], a[0:3], 0
ds_read_b64_tr_b16 a[118:119], v12 offset:43008
v_mfma_f32_16x16x32_bf16 v[76:79], a[52:55], a[4:7], 0
v_mfma_f32_16x16x32_bf16 v[136:139], a[52:55], a[8:11], 0
ds_read_b64_tr_b16 a[120:121], v14 offset:40960
v_mfma_f32_16x16x32_bf16 v[140:143], a[52:55], a[12:15], 0
v_mfma_f32_16x16x32_bf16 v[200:203], a[52:55], a[16:19], 0
ds_read_b64_tr_b16 a[122:123], v14 offset:43008
v_mfma_f32_16x16x32_bf16 v[204:207], a[52:55], a[20:23], 0
v_mfma_f32_16x16x32_bf16 a[152:155], a[52:55], a[24:27], 0
ds_read_b64_tr_b16 a[124:125], v16 offset:40960
v_mfma_f32_16x16x32_bf16 a[156:159], a[52:55], a[28:31], 0
v_mfma_f32_16x16x32_bf16 v[80:83], a[56:59], a[0:3], 0
ds_read_b64_tr_b16 a[126:127], v16 offset:43008
v_mfma_f32_16x16x32_bf16 v[84:87], a[56:59], a[4:7], 0
v_mfma_f32_16x16x32_bf16 v[144:147], a[56:59], a[8:11], 0
v_mfma_f32_16x16x32_bf16 v[148:151], a[56:59], a[12:15], 0
v_mfma_f32_16x16x32_bf16 v[208:211], a[56:59], a[16:19], 0
v_mfma_f32_16x16x32_bf16 v[212:215], a[56:59], a[20:23], 0
v_mfma_f32_16x16x32_bf16 a[160:163], a[56:59], a[24:27], 0
v_mfma_f32_16x16x32_bf16 a[164:167], a[56:59], a[28:31], 0
v_mfma_f32_16x16x32_bf16 v[88:91], a[60:63], a[0:3], 0
v_mfma_f32_16x16x32_bf16 v[92:95], a[60:63], a[4:7], 0
v_mfma_f32_16x16x32_bf16 v[152:155], a[60:63], a[8:11], 0
v_mfma_f32_16x16x32_bf16 v[156:159], a[60:63], a[12:15], 0
v_mfma_f32_16x16x32_bf16 v[216:219], a[60:63], a[16:19], 0
v_mfma_f32_16x16x32_bf16 v[220:223], a[60:63], a[20:23], 0
v_mfma_f32_16x16x32_bf16 a[168:171], a[60:63], a[24:27], 0
v_mfma_f32_16x16x32_bf16 a[172:175], a[60:63], a[28:31], 0
s_waitcnt lgkmcnt(0)
v_mfma_f32_16x16x32_bf16 v[32:35], a[96:99], a[64:67], v[32:35]
s_cmp_lg_u32 s96, 0
s_cbranch_scc1 L_cw_2248
s_waitcnt vmcnt(12)
L_cw_2248:
s_barrier
v_mfma_f32_16x16x32_bf16 v[36:39], a[96:99], a[68:71], v[36:39]
v_mfma_f32_16x16x32_bf16 v[96:99], a[96:99], a[72:75], v[96:99]
ds_read_b64_tr_b16 a[32:33], v11 offset:0
v_mfma_f32_16x16x32_bf16 v[100:103], a[96:99], a[76:79], v[100:103]
s_add_u32 m0, s55, 32768
s_nop 0
buffer_load_dwordx4 v2, s[4:7], s48 offen sc1 lds
v_mfma_f32_16x16x32_bf16 v[160:163], a[96:99], a[80:83], v[160:163]
ds_read_b64_tr_b16 a[34:35], v11 offset:2048
v_mfma_f32_16x16x32_bf16 v[164:167], a[96:99], a[84:87], v[164:167]
v_mfma_f32_16x16x32_bf16 v[224:227], a[96:99], a[88:91], v[224:227]
ds_read_b128 a[0:3], v9 offset:0
v_mfma_f32_16x16x32_bf16 v[228:231], a[96:99], a[92:95], v[228:231]
buffer_load_dwordx4 v2, s[4:7], s48 offen offset:1024 sc1 lds
v_mfma_f32_16x16x32_bf16 v[40:43], a[100:103], a[64:67], v[40:43]
ds_read_b128 a[4:7], v9 offset:256
v_mfma_f32_16x16x32_bf16 v[44:47], a[100:103], a[68:71], v[44:47]
v_mfma_f32_16x16x32_bf16 v[104:107], a[100:103], a[72:75], v[104:107]
ds_read_b128 a[8:11], v9 offset:2048
v_mfma_f32_16x16x32_bf16 v[108:111], a[100:103], a[76:79], v[108:111]
buffer_load_dwordx4 v3, s[4:7], s48 offen offset:2048 sc1 lds
v_mfma_f32_16x16x32_bf16 v[168:171], a[100:103], a[80:83], v[168:171]
ds_read_b128 a[12:15], v9 offset:2304
v_mfma_f32_16x16x32_bf16 v[172:175], a[100:103], a[84:87], v[172:175]
v_mfma_f32_16x16x32_bf16 v[232:235], a[100:103], a[88:91], v[232:235]
ds_read_b128 a[16:19], v9 offset:4096
v_mfma_f32_16x16x32_bf16 v[236:239], a[100:103], a[92:95], v[236:239]
buffer_load_dwordx4 v3, s[4:7], s48 offen offset:3072 sc1 lds
s_add_u32 s48, s48, 2048
v_mfma_f32_16x16x32_bf16 v[48:51], a[104:107], a[64:67], v[48:51]
ds_read_b128 a[20:23], v9 offset:4352
v_mfma_f32_16x16x32_bf16 v[52:55], a[104:107], a[68:71], v[52:55]
v_mfma_f32_16x16x32_bf16 v[112:115], a[104:107], a[72:75], v[112:115]
ds_read_b128 a[24:27], v9 offset:6144
v_mfma_f32_16x16x32_bf16 v[116:119], a[104:107], a[76:79], v[116:119]
s_add_u32 m0, s54, 49152
s_nop 0
buffer_load_dwordx4 v4, s[8:11], s49 offen lds
v_mfma_f32_16x16x32_bf16 v[176:179], a[104:107], a[80:83], v[176:179]
ds_read_b128 a[28:31], v9 offset:6400
v_mfma_f32_16x16x32_bf16 v[180:183], a[104:107], a[84:87], v[180:183]
v_mfma_f32_16x16x32_bf16 a[128:131], a[104:107], a[88:91], a[128:131]
ds_read_b64_tr_b16 a[36:37], v13 offset:0
v_mfma_f32_16x16x32_bf16 a[132:135], a[104:107], a[92:95], a[132:135]
buffer_load_dwordx4 v5, s[8:11], s49 offen offset:1024 lds
v_mfma_f32_16x16x32_bf16 v[56:59], a[108:111], a[64:67], v[56:59]
ds_read_b64_tr_b16 a[38:39], v13 offset:2048
v_mfma_f32_16x16x32_bf16 v[60:63], a[108:111], a[68:71], v[60:63]
v_mfma_f32_16x16x32_bf16 v[120:123], a[108:111], a[72:75], v[120:123]
ds_read_b64_tr_b16 a[40:41], v15 offset:0
v_mfma_f32_16x16x32_bf16 v[124:127], a[108:111], a[76:79], v[124:127]
buffer_load_dwordx4 v6, s[8:11], s49 offen offset:2048 lds
v_mfma_f32_16x16x32_bf16 v[184:187], a[108:111], a[80:83], v[184:187]
ds_read_b64_tr_b16 a[42:43], v15 offset:2048
v_mfma_f32_16x16x32_bf16 v[188:191], a[108:111], a[84:87], v[188:191]
v_mfma_f32_16x16x32_bf16 a[136:139], a[108:111], a[88:91], a[136:139]
ds_read_b64_tr_b16 a[44:45], v17 offset:0
v_mfma_f32_16x16x32_bf16 a[140:143], a[108:111], a[92:95], a[140:143]
buffer_load_dwordx4 v7, s[8:11], s49 offen offset:3072 lds
s_add_u32 s49, s49, s50
v_mfma_f32_16x16x32_bf16 v[64:67], a[112:115], a[64:67], v[64:67]
ds_read_b64_tr_b16 a[46:47], v17 offset:2048
v_mfma_f32_16x16x32_bf16 v[68:71], a[112:115], a[68:71], v[68:71]
v_mfma_f32_16x16x32_bf16 v[128:131], a[112:115], a[72:75], v[128:131]
ds_read_b64_tr_b16 a[48:49], v11 offset:8192
v_mfma_f32_16x16x32_bf16 v[132:135], a[112:115], a[76:79], v[132:135]
v_mfma_f32_16x16x32_bf16 v[192:195], a[112:115], a[80:83], v[192:195]
ds_read_b64_tr_b16 a[50:51], v11 offset:10240
v_mfma_f32_16x16x32_bf16 v[196:199], a[112:115], a[84:87], v[196:199]
v_mfma_f32_16x16x32_bf16 a[144:147], a[112:115], a[88:91], a[144:147]
ds_read_b64_tr_b16 a[52:53], v13 offset:8192
v_mfma_f32_16x16x32_bf16 a[148:151], a[112:115], a[92:95], a[148:151]
v_mfma_f32_16x16x32_bf16 v[72:75], a[116:119], a[64:67], v[72:75]
ds_read_b64_tr_b16 a[54:55], v13 offset:10240
v_mfma_f32_16x16x32_bf16 v[76:79], a[116:119], a[68:71], v[76:79]
v_mfma_f32_16x16x32_bf16 v[136:139], a[116:119], a[72:75], v[136:139]
ds_read_b64_tr_b16 a[56:57], v15 offset:8192
v_mfma_f32_16x16x32_bf16 v[140:143], a[116:119], a[76:79], v[140:143]
v_mfma_f32_16x16x32_bf16 v[200:203], a[116:119], a[80:83], v[200:203]
ds_read_b64_tr_b16 a[58:59], v15 offset:10240
v_mfma_f32_16x16x32_bf16 v[204:207], a[116:119], a[84:87], v[204:207]
v_mfma_f32_16x16x32_bf16 a[152:155], a[116:119], a[88:91], a[152:155]
ds_read_b64_tr_b16 a[60:61], v17 offset:8192
v_mfma_f32_16x16x32_bf16 a[156:159], a[116:119], a[92:95], a[156:159]
v_mfma_f32_16x16x32_bf16 v[80:83], a[120:123], a[64:67], v[80:83]
ds_read_b64_tr_b16 a[62:63], v17 offset:10240
v_mfma_f32_16x16x32_bf16 v[84:87], a[120:123], a[68:71], v[84:87]
v_mfma_f32_16x16x32_bf16 v[144:147], a[120:123], a[72:75], v[144:147]
v_mfma_f32_16x16x32_bf16 v[148:151], a[120:123], a[76:79], v[148:151]
v_mfma_f32_16x16x32_bf16 v[208:211], a[120:123], a[80:83], v[208:211]
v_mfma_f32_16x16x32_bf16 v[212:215], a[120:123], a[84:87], v[212:215]
v_mfma_f32_16x16x32_bf16 a[160:163], a[120:123], a[88:91], a[160:163]
v_mfma_f32_16x16x32_bf16 a[164:167], a[120:123], a[92:95], a[164:167]
v_mfma_f32_16x16x32_bf16 v[88:91], a[124:127], a[64:67], v[88:91]
v_mfma_f32_16x16x32_bf16 v[92:95], a[124:127], a[68:71], v[92:95]
v_mfma_f32_16x16x32_bf16 v[152:155], a[124:127], a[72:75], v[152:155]
v_mfma_f32_16x16x32_bf16 v[156:159], a[124:127], a[76:79], v[156:159]
v_mfma_f32_16x16x32_bf16 v[216:219], a[124:127], a[80:83], v[216:219]
v_mfma_f32_16x16x32_bf16 v[220:223], a[124:127], a[84:87], v[220:223]
v_mfma_f32_16x16x32_bf16 a[168:171], a[124:127], a[88:91], a[168:171]
v_mfma_f32_16x16x32_bf16 a[172:175], a[124:127], a[92:95], a[172:175]
s_waitcnt lgkmcnt(0)
v_mfma_f32_16x16x32_bf16 v[32:35], a[32:35], a[0:3], v[32:35]
s_cmp_lg_u32 s96, 0
s_cbranch_scc1 L_cw_3249
s_waitcnt vmcnt(16)
L_cw_3249:
s_barrier
v_mfma_f32_16x16x32_bf16 v[36:39], a[32:35], a[4:7], v[36:39]
v_mfma_f32_16x16x32_bf16 v[96:99], a[32:35], a[8:11], v[96:99]
ds_read_b64_tr_b16 a[96:97], v11 offset:32768
v_mfma_f32_16x16x32_bf16 v[100:103], a[32:35], a[12:15], v[100:103]
s_add_u32 m0, s55, 65536
s_nop 0
buffer_load_dwordx4 v2, s[4:7], s48 offen sc1 lds
v_mfma_f32_16x16x32_bf16 v[160:163], a[32:35], a[16:19], v[160:163]
ds_read_b64_tr_b16 a[98:99], v11 offset:34816
v_mfma_f32_16x16x32_bf16 v[164:167], a[32:35], a[20:23], v[164:167]
v_mfma_f32_16x16x32_bf16 v[224:227], a[32:35], a[24:27], v[224:227]
ds_read_b128 a[64:67], v9 offset:32768
v_mfma_f32_16x16x32_bf16 v[228:231], a[32:35], a[28:31], v[228:231]
buffer_load_dwordx4 v2, s[4:7], s48 offen offset:1024 sc1 lds
v_mfma_f32_16x16x32_bf16 v[40:43], a[36:39], a[0:3], v[40:43]
ds_read_b128 a[68:71], v9 offset:33024
v_mfma_f32_16x16x32_bf16 v[44:47], a[36:39], a[4:7], v[44:47]
v_mfma_f32_16x16x32_bf16 v[104:107], a[36:39], a[8:11], v[104:107]
ds_read_b128 a[72:75], v9 offset:34816
v_mfma_f32_16x16x32_bf16 v[108:111], a[36:39], a[12:15], v[108:111]
buffer_load_dwordx4 v3, s[4:7], s48 offen offset:2048 sc1 lds
v_mfma_f32_16x16x32_bf16 v[168:171], a[36:39], a[16:19], v[168:171]
ds_read_b128 a[76:79], v9 offset:35072
v_mfma_f32_16x16x32_bf16 v[172:175], a[36:39], a[20:23], v[172:175]
v_mfma_f32_16x16x32_bf16 v[232:235], a[36:39], a[24:27], v[232:235]
ds_read_b128 a[80:83], v9 offset:36864
v_mfma_f32_16x16x32_bf16 v[236:239], a[36:39], a[28:31], v[236:239]
buffer_load_dwordx4 v3, s[4:7], s48 offen offset:3072 sc1 lds
s_add_u32 s48, s48, 2048
v_mfma_f32_16x16x32_bf16 v[48:51], a[40:43], a[0:3], v[48:51]
ds_read_b128 a[84:87], v9 offset:37120
v_mfma_f32_16x16x32_bf16 v[52:55], a[40:43], a[4:7], v[52:55]
v_mfma_f32_16x16x32_bf16 v[112:115], a[40:43], a[8:11], v[112:115]
ds_read_b128 a[88:91], v9 offset:38912
v_mfma_f32_16x16x32_bf16 v[116:119], a[40:43], a[12:15], v[116:119]
s_add_u32 m0, s54, 81920
s_nop 0
buffer_load_dwordx4 v4, s[8:11], s49 offen lds
v_mfma_f32_16x16x32_bf16 v[176:179], a[40:43], a[16:19], v[176:179]
ds_read_b128 a[92:95], v9 offset:39168
v_mfma_f32_16x16x32_bf16 v[180:183], a[40:43], a[20:23], v[180:183]
v_mfma_f32_16x16x32_bf16 a[128:131], a[40:43], a[24:27], a[128:131]
ds_read_b64_tr_b16 a[100:101], v13 offset:32768
v_mfma_f32_16x16x32_bf16 a[132:135], a[40:43], a[28:31], a[132:135]
buffer_load_dwordx4 v5, s[8:11], s49 offen offset:1024 lds
v_mfma_f32_16x16x32_bf16 v[56:59], a[44:47], a[0:3], v[56:59]
ds_read_b64_tr_b16 a[102:103], v13 offset:34816
v_mfma_f32_16x16x32_bf16 v[60:63], a[44:47], a[4:7], v[60:63]
v_mfma_f32_16x16x32_bf16 v[120:123], a[44:47], a[8:11], v[120:123]
ds_read_b64_tr_b16 a[104:105], v15 offset:32768
v_mfma_f32_16x16x32_bf16 v[124:127], a[44:47], a[12:15], v[124:127]
buffer_load_dwordx4 v6, s[8:11], s49 offen offset:2048 lds
v_mfma_f32_16x16x32_bf16 v[184:187], a[44:47], a[16:19], v[184:187]
ds_read_b64_tr_b16 a[106:107], v15 offset:34816
v_mfma_f32_16x16x32_bf16 v[188:191], a[44:47], a[20:23], v[188:191]
v_mfma_f32_16x16x32_bf16 a[136:139], a[44:47], a[24:27], a[136:139]
ds_read_b64_tr_b16 a[108:109], v17 offset:32768
v_mfma_f32_16x16x32_bf16 a[140:143], a[44:47], a[28:31], a[140:143]
buffer_load_dwordx4 v7, s[8:11], s49 offen offset:3072 lds
s_add_u32 s49, s49, s50
v_mfma_f32_16x16x32_bf16 v[64:67], a[48:51], a[0:3], v[64:67]
ds_read_b64_tr_b16 a[110:111], v17 offset:34816
v_mfma_f32_16x16x32_bf16 v[68:71], a[48:51], a[4:7], v[68:71]
v_mfma_f32_16x16x32_bf16 v[128:131], a[48:51], a[8:11], v[128:131]
ds_read_b64_tr_b16 a[112:113], v11 offset:40960
v_mfma_f32_16x16x32_bf16 v[132:135], a[48:51], a[12:15], v[132:135]
v_mfma_f32_16x16x32_bf16 v[192:195], a[48:51], a[16:19], v[192:195]
ds_read_b64_tr_b16 a[114:115], v11 offset:43008
v_mfma_f32_16x16x32_bf16 v[196:199], a[48:51], a[20:23], v[196:199]
v_mfma_f32_16x16x32_bf16 a[144:147], a[48:51], a[24:27], a[144:147]
ds_read_b64_tr_b16 a[116:117], v13 offset:40960
v_mfma_f32_16x16x32_bf16 a[148:151], a[48:51], a[28:31], a[148:151]
v_mfma_f32_16x16x32_bf16 v[72:75], a[52:55], a[0:3], v[72:75]
ds_read_b64_tr_b16 a[118:119], v13 offset:43008
v_mfma_f32_16x16x32_bf16 v[76:79], a[52:55], a[4:7], v[76:79]
v_mfma_f32_16x16x32_bf16 v[136:139], a[52:55], a[8:11], v[136:139]
ds_read_b64_tr_b16 a[120:121], v15 offset:40960
v_mfma_f32_16x16x32_bf16 v[140:143], a[52:55], a[12:15], v[140:143]
v_mfma_f32_16x16x32_bf16 v[200:203], a[52:55], a[16:19], v[200:203]
ds_read_b64_tr_b16 a[122:123], v15 offset:43008
v_mfma_f32_16x16x32_bf16 v[204:207], a[52:55], a[20:23], v[204:207]
v_mfma_f32_16x16x32_bf16 a[152:155], a[52:55], a[24:27], a[152:155]
ds_read_b64_tr_b16 a[124:125], v17 offset:40960
v_mfma_f32_16x16x32_bf16 a[156:159], a[52:55], a[28:31], a[156:159]
v_mfma_f32_16x16x32_bf16 v[80:83], a[56:59], a[0:3], v[80:83]
ds_read_b64_tr_b16 a[126:127], v17 offset:43008
v_mfma_f32_16x16x32_bf16 v[84:87], a[56:59], a[4:7], v[84:87]
v_mfma_f32_16x16x32_bf16 v[144:147], a[56:59], a[8:11], v[144:147]
v_mfma_f32_16x16x32_bf16 v[148:151], a[56:59], a[12:15], v[148:151]
v_mfma_f32_16x16x32_bf16 v[208:211], a[56:59], a[16:19], v[208:211]
v_mfma_f32_16x16x32_bf16 v[212:215], a[56:59], a[20:23], v[212:215]
v_mfma_f32_16x16x32_bf16 a[160:163], a[56:59], a[24:27], a[160:163]
v_mfma_f32_16x16x32_bf16 a[164:167], a[56:59], a[28:31], a[164:167]
v_mfma_f32_16x16x32_bf16 v[88:91], a[60:63], a[0:3], v[88:91]
v_mfma_f32_16x16x32_bf16 v[92:95], a[60:63], a[4:7], v[92:95]
v_mfma_f32_16x16x32_bf16 v[152:155], a[60:63], a[8:11], v[152:155]
v_mfma_f32_16x16x32_bf16 v[156:159], a[60:63], a[12:15], v[156:159]
v_mfma_f32_16x16x32_bf16 v[216:219], a[60:63], a[16:19], v[216:219]
v_mfma_f32_16x16x32_bf16 v[220:223], a[60:63], a[20:23], v[220:223]
v_mfma_f32_16x16x32_bf16 a[168:171], a[60:63], a[24:27], a[168:171]
v_mfma_f32_16x16x32_bf16 a[172:175], a[60:63], a[28:31], a[172:175]
s_waitcnt lgkmcnt(0)
v_mfma_f32_16x16x32_bf16 v[32:35], a[96:99], a[64:67], v[32:35]
s_waitcnt vmcnt(16)
s_barrier
s_cmp_eq_u32 s92, 255
s_cbranch_scc1 L_nsig_3250
s_cmp_lg_u32 s3, 0
s_cbranch_scc1 L_nsig_3250
s_lshl_b32 s94, s92, 8
s_add_u32 s94, s94, 98566144
v_mov_b32 v29, 0
v_mov_b32 v30, 1
s_mov_b64 exec, 1
buffer_atomic_add v30, v29, s[4:7], s94 offen sc1
s_mov_b64 exec, -1
L_nsig_3250:
v_mfma_f32_16x16x32_bf16 v[36:39], a[96:99], a[68:71], v[36:39]
v_mfma_f32_16x16x32_bf16 v[96:99], a[96:99], a[72:75], v[96:99]
ds_read_b64_tr_b16 a[32:33], v10 offset:0
v_mfma_f32_16x16x32_bf16 v[100:103], a[96:99], a[76:79], v[100:103]
s_add_u32 m0, s55, 98304
s_nop 0
buffer_load_dwordx4 v2, s[4:7], s48 offen sc1 lds
v_mfma_f32_16x16x32_bf16 v[160:163], a[96:99], a[80:83], v[160:163]
ds_read_b64_tr_b16 a[34:35], v10 offset:2048
v_mfma_f32_16x16x32_bf16 v[164:167], a[96:99], a[84:87], v[164:167]
v_mfma_f32_16x16x32_bf16 v[224:227], a[96:99], a[88:91], v[224:227]
ds_read_b128 a[0:3], v8 offset:0
v_mfma_f32_16x16x32_bf16 v[228:231], a[96:99], a[92:95], v[228:231]
buffer_load_dwordx4 v2, s[4:7], s48 offen offset:1024 sc1 lds
v_mfma_f32_16x16x32_bf16 v[40:43], a[100:103], a[64:67], v[40:43]
ds_read_b128 a[4:7], v8 offset:256
v_mfma_f32_16x16x32_bf16 v[44:47], a[100:103], a[68:71], v[44:47]
v_mfma_f32_16x16x32_bf16 v[104:107], a[100:103], a[72:75], v[104:107]
ds_read_b128 a[8:11], v8 offset:2048
v_mfma_f32_16x16x32_bf16 v[108:111], a[100:103], a[76:79], v[108:111]
buffer_load_dwordx4 v3, s[4:7], s48 offen offset:2048 sc1 lds
v_mfma_f32_16x16x32_bf16 v[168:171], a[100:103], a[80:83], v[168:171]
ds_read_b128 a[12:15], v8 offset:2304
v_mfma_f32_16x16x32_bf16 v[172:175], a[100:103], a[84:87], v[172:175]
v_mfma_f32_16x16x32_bf16 v[232:235], a[100:103], a[88:91], v[232:235]
ds_read_b128 a[16:19], v8 offset:4096
v_mfma_f32_16x16x32_bf16 v[236:239], a[100:103], a[92:95], v[236:239]
buffer_load_dwordx4 v3, s[4:7], s48 offen offset:3072 sc1 lds
s_add_u32 s48, s48, 2048
v_mfma_f32_16x16x32_bf16 v[48:51], a[104:107], a[64:67], v[48:51]
ds_read_b128 a[20:23], v8 offset:4352
v_mfma_f32_16x16x32_bf16 v[52:55], a[104:107], a[68:71], v[52:55]
v_mfma_f32_16x16x32_bf16 v[112:115], a[104:107], a[72:75], v[112:115]
ds_read_b128 a[24:27], v8 offset:6144
v_mfma_f32_16x16x32_bf16 v[116:119], a[104:107], a[76:79], v[116:119]
s_add_u32 m0, s54, 114688
s_nop 0
buffer_load_dwordx4 v4, s[8:11], s49 offen lds
v_mfma_f32_16x16x32_bf16 v[176:179], a[104:107], a[80:83], v[176:179]
ds_read_b128 a[28:31], v8 offset:6400
v_mfma_f32_16x16x32_bf16 v[180:183], a[104:107], a[84:87], v[180:183]
v_mfma_f32_16x16x32_bf16 a[128:131], a[104:107], a[88:91], a[128:131]
ds_read_b64_tr_b16 a[36:37], v12 offset:0
v_mfma_f32_16x16x32_bf16 a[132:135], a[104:107], a[92:95], a[132:135]
buffer_load_dwordx4 v5, s[8:11], s49 offen offset:1024 lds
v_mfma_f32_16x16x32_bf16 v[56:59], a[108:111], a[64:67], v[56:59]
ds_read_b64_tr_b16 a[38:39], v12 offset:2048
v_mfma_f32_16x16x32_bf16 v[60:63], a[108:111], a[68:71], v[60:63]
v_mfma_f32_16x16x32_bf16 v[120:123], a[108:111], a[72:75], v[120:123]
ds_read_b64_tr_b16 a[40:41], v14 offset:0
v_mfma_f32_16x16x32_bf16 v[124:127], a[108:111], a[76:79], v[124:127]
buffer_load_dwordx4 v6, s[8:11], s49 offen offset:2048 lds
v_mfma_f32_16x16x32_bf16 v[184:187], a[108:111], a[80:83], v[184:187]
ds_read_b64_tr_b16 a[42:43], v14 offset:2048
v_mfma_f32_16x16x32_bf16 v[188:191], a[108:111], a[84:87], v[188:191]
v_mfma_f32_16x16x32_bf16 a[136:139], a[108:111], a[88:91], a[136:139]
ds_read_b64_tr_b16 a[44:45], v16 offset:0
v_mfma_f32_16x16x32_bf16 a[140:143], a[108:111], a[92:95], a[140:143]
buffer_load_dwordx4 v7, s[8:11], s49 offen offset:3072 lds
s_add_u32 s49, s49, s50
v_mfma_f32_16x16x32_bf16 v[64:67], a[112:115], a[64:67], v[64:67]
ds_read_b64_tr_b16 a[46:47], v16 offset:2048
v_mfma_f32_16x16x32_bf16 v[68:71], a[112:115], a[68:71], v[68:71]
v_mfma_f32_16x16x32_bf16 v[128:131], a[112:115], a[72:75], v[128:131]
ds_read_b64_tr_b16 a[48:49], v10 offset:8192
v_mfma_f32_16x16x32_bf16 v[132:135], a[112:115], a[76:79], v[132:135]
v_mfma_f32_16x16x32_bf16 v[192:195], a[112:115], a[80:83], v[192:195]
ds_read_b64_tr_b16 a[50:51], v10 offset:10240
v_mfma_f32_16x16x32_bf16 v[196:199], a[112:115], a[84:87], v[196:199]
v_mfma_f32_16x16x32_bf16 a[144:147], a[112:115], a[88:91], a[144:147]
ds_read_b64_tr_b16 a[52:53], v12 offset:8192
v_mfma_f32_16x16x32_bf16 a[148:151], a[112:115], a[92:95], a[148:151]
v_mfma_f32_16x16x32_bf16 v[72:75], a[116:119], a[64:67], v[72:75]
ds_read_b64_tr_b16 a[54:55], v12 offset:10240
v_mfma_f32_16x16x32_bf16 v[76:79], a[116:119], a[68:71], v[76:79]
v_mfma_f32_16x16x32_bf16 v[136:139], a[116:119], a[72:75], v[136:139]
ds_read_b64_tr_b16 a[56:57], v14 offset:8192
v_mfma_f32_16x16x32_bf16 v[140:143], a[116:119], a[76:79], v[140:143]
v_mfma_f32_16x16x32_bf16 v[200:203], a[116:119], a[80:83], v[200:203]
ds_read_b64_tr_b16 a[58:59], v14 offset:10240
v_mfma_f32_16x16x32_bf16 v[204:207], a[116:119], a[84:87], v[204:207]
v_mfma_f32_16x16x32_bf16 a[152:155], a[116:119], a[88:91], a[152:155]
ds_read_b64_tr_b16 a[60:61], v16 offset:8192
v_mfma_f32_16x16x32_bf16 a[156:159], a[116:119], a[92:95], a[156:159]
v_mfma_f32_16x16x32_bf16 v[80:83], a[120:123], a[64:67], v[80:83]
ds_read_b64_tr_b16 a[62:63], v16 offset:10240
v_mfma_f32_16x16x32_bf16 v[84:87], a[120:123], a[68:71], v[84:87]
v_mfma_f32_16x16x32_bf16 v[144:147], a[120:123], a[72:75], v[144:147]
v_mfma_f32_16x16x32_bf16 v[148:151], a[120:123], a[76:79], v[148:151]
v_mfma_f32_16x16x32_bf16 v[208:211], a[120:123], a[80:83], v[208:211]
v_mfma_f32_16x16x32_bf16 v[212:215], a[120:123], a[84:87], v[212:215]
v_mfma_f32_16x16x32_bf16 a[160:163], a[120:123], a[88:91], a[160:163]
v_mfma_f32_16x16x32_bf16 a[164:167], a[120:123], a[92:95], a[164:167]
v_mfma_f32_16x16x32_bf16 v[88:91], a[124:127], a[64:67], v[88:91]
v_mfma_f32_16x16x32_bf16 v[92:95], a[124:127], a[68:71], v[92:95]
v_mfma_f32_16x16x32_bf16 v[152:155], a[124:127], a[72:75], v[152:155]
v_mfma_f32_16x16x32_bf16 v[156:159], a[124:127], a[76:79], v[156:159]
v_mfma_f32_16x16x32_bf16 v[216:219], a[124:127], a[80:83], v[216:219]
v_mfma_f32_16x16x32_bf16 v[220:223], a[124:127], a[84:87], v[220:223]
v_mfma_f32_16x16x32_bf16 a[168:171], a[124:127], a[88:91], a[168:171]
v_mfma_f32_16x16x32_bf16 a[172:175], a[124:127], a[92:95], a[172:175]
s_sub_u32 s51, s51, 2
s_cmp_eq_u32 s51, 0
s_cbranch_scc1 L_gl_end_3251
L_gl_3252:
s_waitcnt lgkmcnt(0)
v_mfma_f32_16x16x32_bf16 v[32:35], a[32:35], a[0:3], v[32:35]
s_waitcnt vmcnt(16)
s_barrier
v_mfma_f32_16x16x32_bf16 v[36:39], a[32:35], a[4:7], v[36:39]
v_mfma_f32_16x16x32_bf16 v[96:99], a[32:35], a[8:11], v[96:99]
ds_read_b64_tr_b16 a[96:97], v10 offset:32768
v_mfma_f32_16x16x32_bf16 v[100:103], a[32:35], a[12:15], v[100:103]
s_add_u32 m0, s55, 0
s_nop 0
buffer_load_dwordx4 v2, s[4:7], s48 offen sc1 lds
v_mfma_f32_16x16x32_bf16 v[160:163], a[32:35], a[16:19], v[160:163]
ds_read_b64_tr_b16 a[98:99], v10 offset:34816
v_mfma_f32_16x16x32_bf16 v[164:167], a[32:35], a[20:23], v[164:167]
v_mfma_f32_16x16x32_bf16 v[224:227], a[32:35], a[24:27], v[224:227]
ds_read_b128 a[64:67], v8 offset:32768
v_mfma_f32_16x16x32_bf16 v[228:231], a[32:35], a[28:31], v[228:231]
buffer_load_dwordx4 v2, s[4:7], s48 offen offset:1024 sc1 lds
v_mfma_f32_16x16x32_bf16 v[40:43], a[36:39], a[0:3], v[40:43]
ds_read_b128 a[68:71], v8 offset:33024
v_mfma_f32_16x16x32_bf16 v[44:47], a[36:39], a[4:7], v[44:47]
v_mfma_f32_16x16x32_bf16 v[104:107], a[36:39], a[8:11], v[104:107]
ds_read_b128 a[72:75], v8 offset:34816
v_mfma_f32_16x16x32_bf16 v[108:111], a[36:39], a[12:15], v[108:111]
buffer_load_dwordx4 v3, s[4:7], s48 offen offset:2048 sc1 lds
v_mfma_f32_16x16x32_bf16 v[168:171], a[36:39], a[16:19], v[168:171]
ds_read_b128 a[76:79], v8 offset:35072
v_mfma_f32_16x16x32_bf16 v[172:175], a[36:39], a[20:23], v[172:175]
v_mfma_f32_16x16x32_bf16 v[232:235], a[36:39], a[24:27], v[232:235]
ds_read_b128 a[80:83], v8 offset:36864
v_mfma_f32_16x16x32_bf16 v[236:239], a[36:39], a[28:31], v[236:239]
buffer_load_dwordx4 v3, s[4:7], s48 offen offset:3072 sc1 lds
s_add_u32 s48, s48, 2048
v_mfma_f32_16x16x32_bf16 v[48:51], a[40:43], a[0:3], v[48:51]
ds_read_b128 a[84:87], v8 offset:37120
v_mfma_f32_16x16x32_bf16 v[52:55], a[40:43], a[4:7], v[52:55]
v_mfma_f32_16x16x32_bf16 v[112:115], a[40:43], a[8:11], v[112:115]
ds_read_b128 a[88:91], v8 offset:38912
v_mfma_f32_16x16x32_bf16 v[116:119], a[40:43], a[12:15], v[116:119]
s_add_u32 m0, s54, 16384
s_nop 0
buffer_load_dwordx4 v4, s[8:11], s49 offen lds
v_mfma_f32_16x16x32_bf16 v[176:179], a[40:43], a[16:19], v[176:179]
ds_read_b128 a[92:95], v8 offset:39168
v_mfma_f32_16x16x32_bf16 v[180:183], a[40:43], a[20:23], v[180:183]
v_mfma_f32_16x16x32_bf16 a[128:131], a[40:43], a[24:27], a[128:131]
ds_read_b64_tr_b16 a[100:101], v12 offset:32768
v_mfma_f32_16x16x32_bf16 a[132:135], a[40:43], a[28:31], a[132:135]
buffer_load_dwordx4 v5, s[8:11], s49 offen offset:1024 lds
v_mfma_f32_16x16x32_bf16 v[56:59], a[44:47], a[0:3], v[56:59]
ds_read_b64_tr_b16 a[102:103], v12 offset:34816
v_mfma_f32_16x16x32_bf16 v[60:63], a[44:47], a[4:7], v[60:63]
v_mfma_f32_16x16x32_bf16 v[120:123], a[44:47], a[8:11], v[120:123]
ds_read_b64_tr_b16 a[104:105], v14 offset:32768
v_mfma_f32_16x16x32_bf16 v[124:127], a[44:47], a[12:15], v[124:127]
buffer_load_dwordx4 v6, s[8:11], s49 offen offset:2048 lds
v_mfma_f32_16x16x32_bf16 v[184:187], a[44:47], a[16:19], v[184:187]
ds_read_b64_tr_b16 a[106:107], v14 offset:34816
v_mfma_f32_16x16x32_bf16 v[188:191], a[44:47], a[20:23], v[188:191]
v_mfma_f32_16x16x32_bf16 a[136:139], a[44:47], a[24:27], a[136:139]
ds_read_b64_tr_b16 a[108:109], v16 offset:32768
v_mfma_f32_16x16x32_bf16 a[140:143], a[44:47], a[28:31], a[140:143]
buffer_load_dwordx4 v7, s[8:11], s49 offen offset:3072 lds
s_add_u32 s49, s49, s50
v_mfma_f32_16x16x32_bf16 v[64:67], a[48:51], a[0:3], v[64:67]
ds_read_b64_tr_b16 a[110:111], v16 offset:34816
v_mfma_f32_16x16x32_bf16 v[68:71], a[48:51], a[4:7], v[68:71]
v_mfma_f32_16x16x32_bf16 v[128:131], a[48:51], a[8:11], v[128:131]
ds_read_b64_tr_b16 a[112:113], v10 offset:40960
v_mfma_f32_16x16x32_bf16 v[132:135], a[48:51], a[12:15], v[132:135]
v_mfma_f32_16x16x32_bf16 v[192:195], a[48:51], a[16:19], v[192:195]
ds_read_b64_tr_b16 a[114:115], v10 offset:43008
v_mfma_f32_16x16x32_bf16 v[196:199], a[48:51], a[20:23], v[196:199]
v_mfma_f32_16x16x32_bf16 a[144:147], a[48:51], a[24:27], a[144:147]
ds_read_b64_tr_b16 a[116:117], v12 offset:40960
v_mfma_f32_16x16x32_bf16 a[148:151], a[48:51], a[28:31], a[148:151]
v_mfma_f32_16x16x32_bf16 v[72:75], a[52:55], a[0:3], v[72:75]
ds_read_b64_tr_b16 a[118:119], v12 offset:43008
v_mfma_f32_16x16x32_bf16 v[76:79], a[52:55], a[4:7], v[76:79]
v_mfma_f32_16x16x32_bf16 v[136:139], a[52:55], a[8:11], v[136:139]
ds_read_b64_tr_b16 a[120:121], v14 offset:40960
v_mfma_f32_16x16x32_bf16 v[140:143], a[52:55], a[12:15], v[140:143]
v_mfma_f32_16x16x32_bf16 v[200:203], a[52:55], a[16:19], v[200:203]
ds_read_b64_tr_b16 a[122:123], v14 offset:43008
v_mfma_f32_16x16x32_bf16 v[204:207], a[52:55], a[20:23], v[204:207]
v_mfma_f32_16x16x32_bf16 a[152:155], a[52:55], a[24:27], a[152:155]
ds_read_b64_tr_b16 a[124:125], v16 offset:40960
v_mfma_f32_16x16x32_bf16 a[156:159], a[52:55], a[28:31], a[156:159]
v_mfma_f32_16x16x32_bf16 v[80:83], a[56:59], a[0:3], v[80:83]
ds_read_b64_tr_b16 a[126:127], v16 offset:43008
v_mfma_f32_16x16x32_bf16 v[84:87], a[56:59], a[4:7], v[84:87]
v_mfma_f32_16x16x32_bf16 v[144:147], a[56:59], a[8:11], v[144:147]
v_mfma_f32_16x16x32_bf16 v[148:151], a[56:59], a[12:15], v[148:151]
v_mfma_f32_16x16x32_bf16 v[208:211], a[56:59], a[16:19], v[208:211]
v_mfma_f32_16x16x32_bf16 v[212:215], a[56:59], a[20:23], v[212:215]
v_mfma_f32_16x16x32_bf16 a[160:163], a[56:59], a[24:27], a[160:163]
v_mfma_f32_16x16x32_bf16 a[164:167], a[56:59], a[28:31], a[164:167]
v_mfma_f32_16x16x32_bf16 v[88:91], a[60:63], a[0:3], v[88:91]
v_mfma_f32_16x16x32_bf16 v[92:95], a[60:63], a[4:7], v[92:95]
v_mfma_f32_16x16x32_bf16 v[152:155], a[60:63], a[8:11], v[152:155]
v_mfma_f32_16x16x32_bf16 v[156:159], a[60:63], a[12:15], v[156:159]
v_mfma_f32_16x16x32_bf16 v[216:219], a[60:63], a[16:19], v[216:219]
v_mfma_f32_16x16x32_bf16 v[220:223], a[60:63], a[20:23], v[220:223]
v_mfma_f32_16x16x32_bf16 a[168:171], a[60:63], a[24:27], a[168:171]
v_mfma_f32_16x16x32_bf16 a[172:175], a[60:63], a[28:31], a[172:175]
s_waitcnt lgkmcnt(0)
v_mfma_f32_16x16x32_bf16 v[32:35], a[96:99], a[64:67], v[32:35]
s_waitcnt vmcnt(16)
s_barrier
v_mfma_f32_16x16x32_bf16 v[36:39], a[96:99], a[68:71], v[36:39]
v_mfma_f32_16x16x32_bf16 v[96:99], a[96:99], a[72:75], v[96:99]
ds_read_b64_tr_b16 a[32:33], v11 offset:0
v_mfma_f32_16x16x32_bf16 v[100:103], a[96:99], a[76:79], v[100:103]
s_add_u32 m0, s55, 32768
s_nop 0
buffer_load_dwordx4 v2, s[4:7], s48 offen sc1 lds
v_mfma_f32_16x16x32_bf16 v[160:163], a[96:99], a[80:83], v[160:163]
ds_read_b64_tr_b16 a[34:35], v11 offset:2048
v_mfma_f32_16x16x32_bf16 v[164:167], a[96:99], a[84:87], v[164:167]
v_mfma_f32_16x16x32_bf16 v[224:227], a[96:99], a[88:91], v[224:227]
ds_read_b128 a[0:3], v9 offset:0
v_mfma_f32_16x16x32_bf16 v[228:231], a[96:99], a[92:95], v[228:231]
buffer_load_dwordx4 v2, s[4:7], s48 offen offset:1024 sc1 lds
v_mfma_f32_16x16x32_bf16 v[40:43], a[100:103], a[64:67], v[40:43]
ds_read_b128 a[4:7], v9 offset:256
v_mfma_f32_16x16x32_bf16 v[44:47], a[100:103], a[68:71], v[44:47]
v_mfma_f32_16x16x32_bf16 v[104:107], a[100:103], a[72:75], v[104:107]
ds_read_b128 a[8:11], v9 offset:2048
v_mfma_f32_16x16x32_bf16 v[108:111], a[100:103], a[76:79], v[108:111]
buffer_load_dwordx4 v3, s[4:7], s48 offen offset:2048 sc1 lds
v_mfma_f32_16x16x32_bf16 v[168:171], a[100:103], a[80:83], v[168:171]
ds_read_b128 a[12:15], v9 offset:2304
v_mfma_f32_16x16x32_bf16 v[172:175], a[100:103], a[84:87], v[172:175]
v_mfma_f32_16x16x32_bf16 v[232:235], a[100:103], a[88:91], v[232:235]
ds_read_b128 a[16:19], v9 offset:4096
v_mfma_f32_16x16x32_bf16 v[236:239], a[100:103], a[92:95], v[236:239]
buffer_load_dwordx4 v3, s[4:7], s48 offen offset:3072 sc1 lds
s_add_u32 s48, s48, 2048
v_mfma_f32_16x16x32_bf16 v[48:51], a[104:107], a[64:67], v[48:51]
ds_read_b128 a[20:23], v9 offset:4352
v_mfma_f32_16x16x32_bf16 v[52:55], a[104:107], a[68:71], v[52:55]
v_mfma_f32_16x16x32_bf16 v[112:115], a[104:107], a[72:75], v[112:115]
ds_read_b128 a[24:27], v9 offset:6144
v_mfma_f32_16x16x32_bf16 v[116:119], a[104:107], a[76:79], v[116:119]
s_add_u32 m0, s54, 49152
s_nop 0
buffer_load_dwordx4 v4, s[8:11], s49 offen lds
v_mfma_f32_16x16x32_bf16 v[176:179], a[104:107], a[80:83], v[176:179]
ds_read_b128 a[28:31], v9 offset:6400
v_mfma_f32_16x16x32_bf16 v[180:183], a[104:107], a[84:87], v[180:183]
v_mfma_f32_16x16x32_bf16 a[128:131], a[104:107], a[88:91], a[128:131]
ds_read_b64_tr_b16 a[36:37], v13 offset:0
v_mfma_f32_16x16x32_bf16 a[132:135], a[104:107], a[92:95], a[132:135]
buffer_load_dwordx4 v5, s[8:11], s49 offen offset:1024 lds
v_mfma_f32_16x16x32_bf16 v[56:59], a[108:111], a[64:67], v[56:59]
ds_read_b64_tr_b16 a[38:39], v13 offset:2048
v_mfma_f32_16x16x32_bf16 v[60:63], a[108:111], a[68:71], v[60:63]
v_mfma_f32_16x16x32_bf16 v[120:123], a[108:111], a[72:75], v[120:123]
ds_read_b64_tr_b16 a[40:41], v15 offset:0
v_mfma_f32_16x16x32_bf16 v[124:127], a[108:111], a[76:79], v[124:127]
buffer_load_dwordx4 v6, s[8:11], s49 offen offset:2048 lds
v_mfma_f32_16x16x32_bf16 v[184:187], a[108:111], a[80:83], v[184:187]
ds_read_b64_tr_b16 a[42:43], v15 offset:2048
v_mfma_f32_16x16x32_bf16 v[188:191], a[108:111], a[84:87], v[188:191]
v_mfma_f32_16x16x32_bf16 a[136:139], a[108:111], a[88:91], a[136:139]
ds_read_b64_tr_b16 a[44:45], v17 offset:0
v_mfma_f32_16x16x32_bf16 a[140:143], a[108:111], a[92:95], a[140:143]
buffer_load_dwordx4 v7, s[8:11], s49 offen offset:3072 lds
s_add_u32 s49, s49, s50
v_mfma_f32_16x16x32_bf16 v[64:67], a[112:115], a[64:67], v[64:67]
ds_read_b64_tr_b16 a[46:47], v17 offset:2048
v_mfma_f32_16x16x32_bf16 v[68:71], a[112:115], a[68:71], v[68:71]
v_mfma_f32_16x16x32_bf16 v[128:131], a[112:115], a[72:75], v[128:131]
ds_read_b64_tr_b16 a[48:49], v11 offset:8192
v_mfma_f32_16x16x32_bf16 v[132:135], a[112:115], a[76:79], v[132:135]
v_mfma_f32_16x16x32_bf16 v[192:195], a[112:115], a[80:83], v[192:195]
ds_read_b64_tr_b16 a[50:51], v11 offset:10240
v_mfma_f32_16x16x32_bf16 v[196:199], a[112:115], a[84:87], v[196:199]
v_mfma_f32_16x16x32_bf16 a[144:147], a[112:115], a[88:91], a[144:147]
ds_read_b64_tr_b16 a[52:53], v13 offset:8192
v_mfma_f32_16x16x32_bf16 a[148:151], a[112:115], a[92:95], a[148:151]
v_mfma_f32_16x16x32_bf16 v[72:75], a[116:119], a[64:67], v[72:75]
ds_read_b64_tr_b16 a[54:55], v13 offset:10240
v_mfma_f32_16x16x32_bf16 v[76:79], a[116:119], a[68:71], v[76:79]
v_mfma_f32_16x16x32_bf16 v[136:139], a[116:119], a[72:75], v[136:139]
ds_read_b64_tr_b16 a[56:57], v15 offset:8192
v_mfma_f32_16x16x32_bf16 v[140:143], a[116:119], a[76:79], v[140:143]
v_mfma_f32_16x16x32_bf16 v[200:203], a[116:119], a[80:83], v[200:203]
ds_read_b64_tr_b16 a[58:59], v15 offset:10240
v_mfma_f32_16x16x32_bf16 v[204:207], a[116:119], a[84:87], v[204:207]
v_mfma_f32_16x16x32_bf16 a[152:155], a[116:119], a[88:91], a[152:155]
ds_read_b64_tr_b16 a[60:61], v17 offset:8192
v_mfma_f32_16x16x32_bf16 a[156:159], a[116:119], a[92:95], a[156:159]
v_mfma_f32_16x16x32_bf16 v[80:83], a[120:123], a[64:67], v[80:83]
ds_read_b64_tr_b16 a[62:63], v17 offset:10240
v_mfma_f32_16x16x32_bf16 v[84:87], a[120:123], a[68:71], v[84:87]
v_mfma_f32_16x16x32_bf16 v[144:147], a[120:123], a[72:75], v[144:147]
v_mfma_f32_16x16x32_bf16 v[148:151], a[120:123], a[76:79], v[148:151]
v_mfma_f32_16x16x32_bf16 v[208:211], a[120:123], a[80:83], v[208:211]
v_mfma_f32_16x16x32_bf16 v[212:215], a[120:123], a[84:87], v[212:215]
v_mfma_f32_16x16x32_bf16 a[160:163], a[120:123], a[88:91], a[160:163]
v_mfma_f32_16x16x32_bf16 a[164:167], a[120:123], a[92:95], a[164:167]
v_mfma_f32_16x16x32_bf16 v[88:91], a[124:127], a[64:67], v[88:91]
v_mfma_f32_16x16x32_bf16 v[92:95], a[124:127], a[68:71], v[92:95]
v_mfma_f32_16x16x32_bf16 v[152:155], a[124:127], a[72:75], v[152:155]
v_mfma_f32_16x16x32_bf16 v[156:159], a[124:127], a[76:79], v[156:159]
v_mfma_f32_16x16x32_bf16 v[216:219], a[124:127], a[80:83], v[216:219]
v_mfma_f32_16x16x32_bf16 v[220:223], a[124:127], a[84:87], v[220:223]
v_mfma_f32_16x16x32_bf16 a[168:171], a[124:127], a[88:91], a[168:171]
v_mfma_f32_16x16x32_bf16 a[172:175], a[124:127], a[92:95], a[172:175]
s_waitcnt lgkmcnt(0)
v_mfma_f32_16x16x32_bf16 v[32:35], a[32:35], a[0:3], v[32:35]
s_waitcnt vmcnt(16)
s_barrier
v_mfma_f32_16x16x32_bf16 v[36:39], a[32:35], a[4:7], v[36:39]
v_mfma_f32_16x16x32_bf16 v[96:99], a[32:35], a[8:11], v[96:99]
ds_read_b64_tr_b16 a[96:97], v11 offset:32768
v_mfma_f32_16x16x32_bf16 v[100:103], a[32:35], a[12:15], v[100:103]
s_add_u32 m0, s55, 65536
s_nop 0
buffer_load_dwordx4 v2, s[4:7], s48 offen sc1 lds
v_mfma_f32_16x16x32_bf16 v[160:163], a[32:35], a[16:19], v[160:163]
ds_read_b64_tr_b16 a[98:99], v11 offset:34816
v_mfma_f32_16x16x32_bf16 v[164:167], a[32:35], a[20:23], v[164:167]
v_mfma_f32_16x16x32_bf16 v[224:227], a[32:35], a[24:27], v[224:227]
ds_read_b128 a[64:67], v9 offset:32768
v_mfma_f32_16x16x32_bf16 v[228:231], a[32:35], a[28:31], v[228:231]
buffer_load_dwordx4 v2, s[4:7], s48 offen offset:1024 sc1 lds
v_mfma_f32_16x16x32_bf16 v[40:43], a[36:39], a[0:3], v[40:43]
ds_read_b128 a[68:71], v9 offset:33024
v_mfma_f32_16x16x32_bf16 v[44:47], a[36:39], a[4:7], v[44:47]
v_mfma_f32_16x16x32_bf16 v[104:107], a[36:39], a[8:11], v[104:107]
ds_read_b128 a[72:75], v9 offset:34816
v_mfma_f32_16x16x32_bf16 v[108:111], a[36:39], a[12:15], v[108:111]
buffer_load_dwordx4 v3, s[4:7], s48 offen offset:2048 sc1 lds
v_mfma_f32_16x16x32_bf16 v[168:171], a[36:39], a[16:19], v[168:171]
ds_read_b128 a[76:79], v9 offset:35072
v_mfma_f32_16x16x32_bf16 v[172:175], a[36:39], a[20:23], v[172:175]
v_mfma_f32_16x16x32_bf16 v[232:235], a[36:39], a[24:27], v[232:235]
ds_read_b128 a[80:83], v9 offset:36864
v_mfma_f32_16x16x32_bf16 v[236:239], a[36:39], a[28:31], v[236:239]
buffer_load_dwordx4 v3, s[4:7], s48 offen offset:3072 sc1 lds
s_add_u32 s48, s48, 2048
v_mfma_f32_16x16x32_bf16 v[48:51], a[40:43], a[0:3], v[48:51]
ds_read_b128 a[84:87], v9 offset:37120
v_mfma_f32_16x16x32_bf16 v[52:55], a[40:43], a[4:7], v[52:55]
v_mfma_f32_16x16x32_bf16 v[112:115], a[40:43], a[8:11], v[112:115]
ds_read_b128 a[88:91], v9 offset:38912
v_mfma_f32_16x16x32_bf16 v[116:119], a[40:43], a[12:15], v[116:119]
s_add_u32 m0, s54, 81920
s_nop 0
buffer_load_dwordx4 v4, s[8:11], s49 offen lds
v_mfma_f32_16x16x32_bf16 v[176:179], a[40:43], a[16:19], v[176:179]
ds_read_b128 a[92:95], v9 offset:39168
v_mfma_f32_16x16x32_bf16 v[180:183], a[40:43], a[20:23], v[180:183]
v_mfma_f32_16x16x32_bf16 a[128:131], a[40:43], a[24:27], a[128:131]
ds_read_b64_tr_b16 a[100:101], v13 offset:32768
v_mfma_f32_16x16x32_bf16 a[132:135], a[40:43], a[28:31], a[132:135]
buffer_load_dwordx4 v5, s[8:11], s49 offen offset:1024 lds
v_mfma_f32_16x16x32_bf16 v[56:59], a[44:47], a[0:3], v[56:59]
ds_read_b64_tr_b16 a[102:103], v13 offset:34816
v_mfma_f32_16x16x32_bf16 v[60:63], a[44:47], a[4:7], v[60:63]
v_mfma_f32_16x16x32_bf16 v[120:123], a[44:47], a[8:11], v[120:123]
ds_read_b64_tr_b16 a[104:105], v15 offset:32768
v_mfma_f32_16x16x32_bf16 v[124:127], a[44:47], a[12:15], v[124:127]
buffer_load_dwordx4 v6, s[8:11], s49 offen offset:2048 lds
v_mfma_f32_16x16x32_bf16 v[184:187], a[44:47], a[16:19], v[184:187]
ds_read_b64_tr_b16 a[106:107], v15 offset:34816
v_mfma_f32_16x16x32_bf16 v[188:191], a[44:47], a[20:23], v[188:191]
v_mfma_f32_16x16x32_bf16 a[136:139], a[44:47], a[24:27], a[136:139]
ds_read_b64_tr_b16 a[108:109], v17 offset:32768
v_mfma_f32_16x16x32_bf16 a[140:143], a[44:47], a[28:31], a[140:143]
buffer_load_dwordx4 v7, s[8:11], s49 offen offset:3072 lds
s_add_u32 s49, s49, s50
v_mfma_f32_16x16x32_bf16 v[64:67], a[48:51], a[0:3], v[64:67]
ds_read_b64_tr_b16 a[110:111], v17 offset:34816
v_mfma_f32_16x16x32_bf16 v[68:71], a[48:51], a[4:7], v[68:71]
v_mfma_f32_16x16x32_bf16 v[128:131], a[48:51], a[8:11], v[128:131]
ds_read_b64_tr_b16 a[112:113], v11 offset:40960
v_mfma_f32_16x16x32_bf16 v[132:135], a[48:51], a[12:15], v[132:135]
v_mfma_f32_16x16x32_bf16 v[192:195], a[48:51], a[16:19], v[192:195]
ds_read_b64_tr_b16 a[114:115], v11 offset:43008
v_mfma_f32_16x16x32_bf16 v[196:199], a[48:51], a[20:23], v[196:199]
v_mfma_f32_16x16x32_bf16 a[144:147], a[48:51], a[24:27], a[144:147]
ds_read_b64_tr_b16 a[116:117], v13 offset:40960
v_mfma_f32_16x16x32_bf16 a[148:151], a[48:51], a[28:31], a[148:151]
v_mfma_f32_16x16x32_bf16 v[72:75], a[52:55], a[0:3], v[72:75]
ds_read_b64_tr_b16 a[118:119], v13 offset:43008
v_mfma_f32_16x16x32_bf16 v[76:79], a[52:55], a[4:7], v[76:79]
v_mfma_f32_16x16x32_bf16 v[136:139], a[52:55], a[8:11], v[136:139]
ds_read_b64_tr_b16 a[120:121], v15 offset:40960
v_mfma_f32_16x16x32_bf16 v[140:143], a[52:55], a[12:15], v[140:143]
v_mfma_f32_16x16x32_bf16 v[200:203], a[52:55], a[16:19], v[200:203]
ds_read_b64_tr_b16 a[122:123], v15 offset:43008
v_mfma_f32_16x16x32_bf16 v[204:207], a[52:55], a[20:23], v[204:207]
v_mfma_f32_16x16x32_bf16 a[152:155], a[52:55], a[24:27], a[152:155]
ds_read_b64_tr_b16 a[124:125], v17 offset:40960
v_mfma_f32_16x16x32_bf16 a[156:159], a[52:55], a[28:31], a[156:159]
v_mfma_f32_16x16x32_bf16 v[80:83], a[56:59], a[0:3], v[80:83]
ds_read_b64_tr_b16 a[126:127], v17 offset:43008
v_mfma_f32_16x16x32_bf16 v[84:87], a[56:59], a[4:7], v[84:87]
v_mfma_f32_16x16x32_bf16 v[144:147], a[56:59], a[8:11], v[144:147]
v_mfma_f32_16x16x32_bf16 v[148:151], a[56:59], a[12:15], v[148:151]
v_mfma_f32_16x16x32_bf16 v[208:211], a[56:59], a[16:19], v[208:211]
v_mfma_f32_16x16x32_bf16 v[212:215], a[56:59], a[20:23], v[212:215]
v_mfma_f32_16x16x32_bf16 a[160:163], a[56:59], a[24:27], a[160:163]
v_mfma_f32_16x16x32_bf16 a[164:167], a[56:59], a[28:31], a[164:167]
v_mfma_f32_16x16x32_bf16 v[88:91], a[60:63], a[0:3], v[88:91]
v_mfma_f32_16x16x32_bf16 v[92:95], a[60:63], a[4:7], v[92:95]
v_mfma_f32_16x16x32_bf16 v[152:155], a[60:63], a[8:11], v[152:155]
v_mfma_f32_16x16x32_bf16 v[156:159], a[60:63], a[12:15], v[156:159]
v_mfma_f32_16x16x32_bf16 v[216:219], a[60:63], a[16:19], v[216:219]
v_mfma_f32_16x16x32_bf16 v[220:223], a[60:63], a[20:23], v[220:223]
v_mfma_f32_16x16x32_bf16 a[168:171], a[60:63], a[24:27], a[168:171]
v_mfma_f32_16x16x32_bf16 a[172:175], a[60:63], a[28:31], a[172:175]
s_waitcnt lgkmcnt(0)
v_mfma_f32_16x16x32_bf16 v[32:35], a[96:99], a[64:67], v[32:35]
s_waitcnt vmcnt(16)
s_barrier
v_mfma_f32_16x16x32_bf16 v[36:39], a[96:99], a[68:71], v[36:39]
v_mfma_f32_16x16x32_bf16 v[96:99], a[96:99], a[72:75], v[96:99]
ds_read_b64_tr_b16 a[32:33], v10 offset:0
v_mfma_f32_16x16x32_bf16 v[100:103], a[96:99], a[76:79], v[100:103]
s_add_u32 m0, s55, 98304
s_nop 0
buffer_load_dwordx4 v2, s[4:7], s48 offen sc1 lds
v_mfma_f32_16x16x32_bf16 v[160:163], a[96:99], a[80:83], v[160:163]
ds_read_b64_tr_b16 a[34:35], v10 offset:2048
v_mfma_f32_16x16x32_bf16 v[164:167], a[96:99], a[84:87], v[164:167]
v_mfma_f32_16x16x32_bf16 v[224:227], a[96:99], a[88:91], v[224:227]
ds_read_b128 a[0:3], v8 offset:0
v_mfma_f32_16x16x32_bf16 v[228:231], a[96:99], a[92:95], v[228:231]
buffer_load_dwordx4 v2, s[4:7], s48 offen offset:1024 sc1 lds
v_mfma_f32_16x16x32_bf16 v[40:43], a[100:103], a[64:67], v[40:43]
ds_read_b128 a[4:7], v8 offset:256
v_mfma_f32_16x16x32_bf16 v[44:47], a[100:103], a[68:71], v[44:47]
v_mfma_f32_16x16x32_bf16 v[104:107], a[100:103], a[72:75], v[104:107]
ds_read_b128 a[8:11], v8 offset:2048
v_mfma_f32_16x16x32_bf16 v[108:111], a[100:103], a[76:79], v[108:111]
buffer_load_dwordx4 v3, s[4:7], s48 offen offset:2048 sc1 lds
v_mfma_f32_16x16x32_bf16 v[168:171], a[100:103], a[80:83], v[168:171]
ds_read_b128 a[12:15], v8 offset:2304
v_mfma_f32_16x16x32_bf16 v[172:175], a[100:103], a[84:87], v[172:175]
v_mfma_f32_16x16x32_bf16 v[232:235], a[100:103], a[88:91], v[232:235]
ds_read_b128 a[16:19], v8 offset:4096
v_mfma_f32_16x16x32_bf16 v[236:239], a[100:103], a[92:95], v[236:239]
buffer_load_dwordx4 v3, s[4:7], s48 offen offset:3072 sc1 lds
s_add_u32 s48, s48, 2048
v_mfma_f32_16x16x32_bf16 v[48:51], a[104:107], a[64:67], v[48:51]
ds_read_b128 a[20:23], v8 offset:4352
v_mfma_f32_16x16x32_bf16 v[52:55], a[104:107], a[68:71], v[52:55]
v_mfma_f32_16x16x32_bf16 v[112:115], a[104:107], a[72:75], v[112:115]
ds_read_b128 a[24:27], v8 offset:6144
v_mfma_f32_16x16x32_bf16 v[116:119], a[104:107], a[76:79], v[116:119]
s_add_u32 m0, s54, 114688
s_nop 0
buffer_load_dwordx4 v4, s[8:11], s49 offen lds
v_mfma_f32_16x16x32_bf16 v[176:179], a[104:107], a[80:83], v[176:179]
ds_read_b128 a[28:31], v8 offset:6400
v_mfma_f32_16x16x32_bf16 v[180:183], a[104:107], a[84:87], v[180:183]
v_mfma_f32_16x16x32_bf16 a[128:131], a[104:107], a[88:91], a[128:131]
ds_read_b64_tr_b16 a[36:37], v12 offset:0
v_mfma_f32_16x16x32_bf16 a[132:135], a[104:107], a[92:95], a[132:135]
buffer_load_dwordx4 v5, s[8:11], s49 offen offset:1024 lds
v_mfma_f32_16x16x32_bf16 v[56:59], a[108:111], a[64:67], v[56:59]
ds_read_b64_tr_b16 a[38:39], v12 offset:2048
v_mfma_f32_16x16x32_bf16 v[60:63], a[108:111], a[68:71], v[60:63]
v_mfma_f32_16x16x32_bf16 v[120:123], a[108:111], a[72:75], v[120:123]
ds_read_b64_tr_b16 a[40:41], v14 offset:0
v_mfma_f32_16x16x32_bf16 v[124:127], a[108:111], a[76:79], v[124:127]
buffer_load_dwordx4 v6, s[8:11], s49 offen offset:2048 lds
v_mfma_f32_16x16x32_bf16 v[184:187], a[108:111], a[80:83], v[184:187]
ds_read_b64_tr_b16 a[42:43], v14 offset:2048
v_mfma_f32_16x16x32_bf16 v[188:191], a[108:111], a[84:87], v[188:191]
v_mfma_f32_16x16x32_bf16 a[136:139], a[108:111], a[88:91], a[136:139]
ds_read_b64_tr_b16 a[44:45], v16 offset:0
v_mfma_f32_16x16x32_bf16 a[140:143], a[108:111], a[92:95], a[140:143]
buffer_load_dwordx4 v7, s[8:11], s49 offen offset:3072 lds
s_add_u32 s49, s49, s50
v_mfma_f32_16x16x32_bf16 v[64:67], a[112:115], a[64:67], v[64:67]
ds_read_b64_tr_b16 a[46:47], v16 offset:2048
v_mfma_f32_16x16x32_bf16 v[68:71], a[112:115], a[68:71], v[68:71]
v_mfma_f32_16x16x32_bf16 v[128:131], a[112:115], a[72:75], v[128:131]
ds_read_b64_tr_b16 a[48:49], v10 offset:8192
v_mfma_f32_16x16x32_bf16 v[132:135], a[112:115], a[76:79], v[132:135]
v_mfma_f32_16x16x32_bf16 v[192:195], a[112:115], a[80:83], v[192:195]
ds_read_b64_tr_b16 a[50:51], v10 offset:10240
v_mfma_f32_16x16x32_bf16 v[196:199], a[112:115], a[84:87], v[196:199]
v_mfma_f32_16x16x32_bf16 a[144:147], a[112:115], a[88:91], a[144:147]
ds_read_b64_tr_b16 a[52:53], v12 offset:8192
v_mfma_f32_16x16x32_bf16 a[148:151], a[112:115], a[92:95], a[148:151]
v_mfma_f32_16x16x32_bf16 v[72:75], a[116:119], a[64:67], v[72:75]
ds_read_b64_tr_b16 a[54:55], v12 offset:10240
v_mfma_f32_16x16x32_bf16 v[76:79], a[116:119], a[68:71], v[76:79]
v_mfma_f32_16x16x32_bf16 v[136:139], a[116:119], a[72:75], v[136:139]
ds_read_b64_tr_b16 a[56:57], v14 offset:8192
v_mfma_f32_16x16x32_bf16 v[140:143], a[116:119], a[76:79], v[140:143]
v_mfma_f32_16x16x32_bf16 v[200:203], a[116:119], a[80:83], v[200:203]
ds_read_b64_tr_b16 a[58:59], v14 offset:10240
v_mfma_f32_16x16x32_bf16 v[204:207], a[116:119], a[84:87], v[204:207]
v_mfma_f32_16x16x32_bf16 a[152:155], a[116:119], a[88:91], a[152:155]
ds_read_b64_tr_b16 a[60:61], v16 offset:8192
v_mfma_f32_16x16x32_bf16 a[156:159], a[116:119], a[92:95], a[156:159]
v_mfma_f32_16x16x32_bf16 v[80:83], a[120:123], a[64:67], v[80:83]
ds_read_b64_tr_b16 a[62:63], v16 offset:10240
v_mfma_f32_16x16x32_bf16 v[84:87], a[120:123], a[68:71], v[84:87]
v_mfma_f32_16x16x32_bf16 v[144:147], a[120:123], a[72:75], v[144:147]
v_mfma_f32_16x16x32_bf16 v[148:151], a[120:123], a[76:79], v[148:151]
v_mfma_f32_16x16x32_bf16 v[208:211], a[120:123], a[80:83], v[208:211]
v_mfma_f32_16x16x32_bf16 v[212:215], a[120:123], a[84:87], v[212:215]
v_mfma_f32_16x16x32_bf16 a[160:163], a[120:123], a[88:91], a[160:163]
v_mfma_f32_16x16x32_bf16 a[164:167], a[120:123], a[92:95], a[164:167]
v_mfma_f32_16x16x32_bf16 v[88:91], a[124:127], a[64:67], v[88:91]
v_mfma_f32_16x16x32_bf16 v[92:95], a[124:127], a[68:71], v[92:95]
v_mfma_f32_16x16x32_bf16 v[152:155], a[124:127], a[72:75], v[152:155]
v_mfma_f32_16x16x32_bf16 v[156:159], a[124:127], a[76:79], v[156:159]
v_mfma_f32_16x16x32_bf16 v[216:219], a[124:127], a[80:83], v[216:219]
v_mfma_f32_16x16x32_bf16 v[220:223], a[124:127], a[84:87], v[220:223]
v_mfma_f32_16x16x32_bf16 a[168:171], a[124:127], a[88:91], a[168:171]
v_mfma_f32_16x16x32_bf16 a[172:175], a[124:127], a[92:95], a[172:175]
s_sub_u32 s51, s51, 1
s_cmp_lg_u32 s51, 0
s_cbranch_scc1 L_gl_3252
L_gl_end_3251:
s_waitcnt lgkmcnt(0)
v_mfma_f32_16x16x32_bf16 v[32:35], a[32:35], a[0:3], v[32:35]
s_waitcnt vmcnt(16)
s_barrier
s_cmp_lg_u32 s91, 2
s_cbranch_scc1 L_nll_3253
s_cmp_lg_u32 s3, 0
s_cbranch_scc1 L_nll_3253
s_and_b32 s94, s73, 255
s_lshl_b32 s94, s94, 8
s_add_u32 s94, s94, 98566144
v_mov_b32 v29, 0
buffer_load_dword v31, v29, s[4:7], s94 offen sc1
L_nll_3253:
v_mfma_f32_16x16x32_bf16 v[36:39], a[32:35], a[4:7], v[36:39]
v_mfma_f32_16x16x32_bf16 v[96:99], a[32:35], a[8:11], v[96:99]
ds_read_b64_tr_b16 a[96:97], v10 offset:32768
v_mfma_f32_16x16x32_bf16 v[100:103], a[32:35], a[12:15], v[100:103]
v_mfma_f32_16x16x32_bf16 v[160:163], a[32:35], a[16:19], v[160:163]
ds_read_b64_tr_b16 a[98:99], v10 offset:34816
v_mfma_f32_16x16x32_bf16 v[164:167], a[32:35], a[20:23], v[164:167]
v_mfma_f32_16x16x32_bf16 v[224:227], a[32:35], a[24:27], v[224:227]
ds_read_b128 a[64:67], v8 offset:32768
v_mfma_f32_16x16x32_bf16 v[228:231], a[32:35], a[28:31], v[228:231]
v_mfma_f32_16x16x32_bf16 v[40:43], a[36:39], a[0:3], v[40:43]
ds_read_b128 a[68:71], v8 offset:33024
v_mfma_f32_16x16x32_bf16 v[44:47], a[36:39], a[4:7], v[44:47]
v_mfma_f32_16x16x32_bf16 v[104:107], a[36:39], a[8:11], v[104:107]
ds_read_b128 a[72:75], v8 offset:34816
v_mfma_f32_16x16x32_bf16 v[108:111], a[36:39], a[12:15], v[108:111]
v_mfma_f32_16x16x32_bf16 v[168:171], a[36:39], a[16:19], v[168:171]
ds_read_b128 a[76:79], v8 offset:35072
v_mfma_f32_16x16x32_bf16 v[172:175], a[36:39], a[20:23], v[172:175]
v_mfma_f32_16x16x32_bf16 v[232:235], a[36:39], a[24:27], v[232:235]
ds_read_b128 a[80:83], v8 offset:36864
v_mfma_f32_16x16x32_bf16 v[236:239], a[36:39], a[28:31], v[236:239]
v_mfma_f32_16x16x32_bf16 v[48:51], a[40:43], a[0:3], v[48:51]
ds_read_b128 a[84:87], v8 offset:37120
v_mfma_f32_16x16x32_bf16 v[52:55], a[40:43], a[4:7], v[52:55]
v_mfma_f32_16x16x32_bf16 v[112:115], a[40:43], a[8:11], v[112:115]
ds_read_b128 a[88:91], v8 offset:38912
v_mfma_f32_16x16x32_bf16 v[116:119], a[40:43], a[12:15], v[116:119]
v_mfma_f32_16x16x32_bf16 v[176:179], a[40:43], a[16:19], v[176:179]
ds_read_b128 a[92:95], v8 offset:39168
v_mfma_f32_16x16x32_bf16 v[180:183], a[40:43], a[20:23], v[180:183]
v_mfma_f32_16x16x32_bf16 a[128:131], a[40:43], a[24:27], a[128:131]
ds_read_b64_tr_b16 a[100:101], v12 offset:32768
v_mfma_f32_16x16x32_bf16 a[132:135], a[40:43], a[28:31], a[132:135]
v_mfma_f32_16x16x32_bf16 v[56:59], a[44:47], a[0:3], v[56:59]
ds_read_b64_tr_b16 a[102:103], v12 offset:34816
v_mfma_f32_16x16x32_bf16 v[60:63], a[44:47], a[4:7], v[60:63]
v_mfma_f32_16x16x32_bf16 v[120:123], a[44:47], a[8:11], v[120:123]
ds_read_b64_tr_b16 a[104:105], v14 offset:32768
v_mfma_f32_16x16x32_bf16 v[124:127], a[44:47], a[12:15], v[124:127]
v_mfma_f32_16x16x32_bf16 v[184:187], a[44:47], a[16:19], v[184:187]
ds_read_b64_tr_b16 a[106:107], v14 offset:34816
v_mfma_f32_16x16x32_bf16 v[188:191], a[44:47], a[20:23], v[188:191]
v_mfma_f32_16x16x32_bf16 a[136:139], a[44:47], a[24:27], a[136:139]
ds_read_b64_tr_b16 a[108:109], v16 offset:32768
v_mfma_f32_16x16x32_bf16 a[140:143], a[44:47], a[28:31], a[140:143]
v_mfma_f32_16x16x32_bf16 v[64:67], a[48:51], a[0:3], v[64:67]
ds_read_b64_tr_b16 a[110:111], v16 offset:34816
s_cmp_lg_u32 s91, 1
s_cbranch_scc1 L_npf_3254
s_cmp_ge_u32 s90, 4
s_cbranch_scc1 L_pfh_3255
s_add_u32 m0, s87, 0
s_nop 0
buffer_load_dwordx4 v20, s[4:7], s84 offen sc1 lds
buffer_load_dwordx4 v20, s[4:7], s84 offen offset:1024 sc1 lds
buffer_load_dwordx4 v21, s[4:7], s84 offen offset:2048 sc1 lds
buffer_load_dwordx4 v21, s[4:7], s84 offen offset:3072 sc1 lds
s_add_u32 s84, s84, 2048
s_add_u32 m0, s54, 16384
s_nop 0
buffer_load_dwordx4 v22, s[80:83], s85 offen lds
buffer_load_dwordx4 v23, s[80:83], s85 offen offset:1024 lds
buffer_load_dwordx4 v24, s[80:83], s85 offen offset:2048 lds
buffer_load_dwordx4 v25, s[80:83], s85 offen offset:3072 lds
s_add_u32 s85, s85, s86
s_branch L_npf_3254
L_pfh_3255:
s_add_u32 m0, s87, 0
s_nop 0
buffer_load_dwordx4 v20, s[4:7], s84 offen sc1 lds
buffer_load_dwordx4 v20, s[4:7], s84 offen offset:1024 sc1 lds
s_add_u32 s84, s84, 2048
s_add_u32 m0, s54, 16384
s_nop 0
buffer_load_dwordx4 v22, s[80:83], s85 offen lds
buffer_load_dwordx4 v23, s[80:83], s85 offen offset:1024 lds
buffer_load_dwordx4 v24, s[80:83], s85 offen offset:2048 lds
buffer_load_dwordx4 v25, s[80:83], s85 offen offset:3072 lds
s_add_u32 s85, s85, s86
L_npf_3254:
v_mfma_f32_16x16x32_bf16 v[68:71], a[48:51], a[4:7], v[68:71]
v_mfma_f32_16x16x32_bf16 v[128:131], a[48:51], a[8:11], v[128:131]
ds_read_b64_tr_b16 a[112:113], v10 offset:40960
v_mfma_f32_16x16x32_bf16 v[132:135], a[48:51], a[12:15], v[132:135]
v_mfma_f32_16x16x32_bf16 v[192:195], a[48:51], a[16:19], v[192:195]
ds_read_b64_tr_b16 a[114:115], v10 offset:43008
v_mfma_f32_16x16x32_bf16 v[196:199], a[48:51], a[20:23], v[196:199]
v_mfma_f32_16x16x32_bf16 a[144:147], a[48:51], a[24:27], a[144:147]
ds_read_b64_tr_b16 a[116:117], v12 offset:40960
v_mfma_f32_16x16x32_bf16 a[148:151], a[48:51], a[28:31], a[148:151]
v_mfma_f32_16x16x32_bf16 v[72:75], a[52:55], a[0:3], v[72:75]
ds_read_b64_tr_b16 a[118:119], v12 offset:43008
v_mfma_f32_16x16x32_bf16 v[76:79], a[52:55], a[4:7], v[76:79]
v_mfma_f32_16x16x32_bf16 v[136:139], a[52:55], a[8:11], v[136:139]
ds_read_b64_tr_b16 a[120:121], v14 offset:40960
v_mfma_f32_16x16x32_bf16 v[140:143], a[52:55], a[12:15], v[140:143]
v_mfma_f32_16x16x32_bf16 v[200:203], a[52:55], a[16:19], v[200:203]
ds_read_b64_tr_b16 a[122:123], v14 offset:43008
v_mfma_f32_16x16x32_bf16 v[204:207], a[52:55], a[20:23], v[204:207]
v_mfma_f32_16x16x32_bf16 a[152:155], a[52:55], a[24:27], a[152:155]
ds_read_b64_tr_b16 a[124:125], v16 offset:40960
v_mfma_f32_16x16x32_bf16 a[156:159], a[52:55], a[28:31], a[156:159]
v_mfma_f32_16x16x32_bf16 v[80:83], a[56:59], a[0:3], v[80:83]
ds_read_b64_tr_b16 a[126:127], v16 offset:43008
v_mfma_f32_16x16x32_bf16 v[84:87], a[56:59], a[4:7], v[84:87]
v_mfma_f32_16x16x32_bf16 v[144:147], a[56:59], a[8:11], v[144:147]
v_mfma_f32_16x16x32_bf16 v[148:151], a[56:59], a[12:15], v[148:151]
v_mfma_f32_16x16x32_bf16 v[208:211], a[56:59], a[16:19], v[208:211]
v_mfma_f32_16x16x32_bf16 v[212:215], a[56:59], a[20:23], v[212:215]
v_mfma_f32_16x16x32_bf16 a[160:163], a[56:59], a[24:27], a[160:163]
v_mfma_f32_16x16x32_bf16 a[164:167], a[56:59], a[28:31], a[164:167]
v_mfma_f32_16x16x32_bf16 v[88:91], a[60:63], a[0:3], v[88:91]
v_mfma_f32_16x16x32_bf16 v[92:95], a[60:63], a[4:7], v[92:95]
v_mfma_f32_16x16x32_bf16 v[152:155], a[60:63], a[8:11], v[152:155]
v_mfma_f32_16x16x32_bf16 v[156:159], a[60:63], a[12:15], v[156:159]
v_mfma_f32_16x16x32_bf16 v[216:219], a[60:63], a[16:19], v[216:219]
v_mfma_f32_16x16x32_bf16 v[220:223], a[60:63], a[20:23], v[220:223]
v_mfma_f32_16x16x32_bf16 a[168:171], a[60:63], a[24:27], a[168:171]
v_mfma_f32_16x16x32_bf16 a[172:175], a[60:63], a[28:31], a[172:175]
s_waitcnt lgkmcnt(0)
v_mfma_f32_16x16x32_bf16 v[32:35], a[96:99], a[64:67], v[32:35]
s_cmp_lg_u32 s91, 1
s_cbranch_scc1 L_tw_3256
s_waitcnt vmcnt(14)
s_branch L_tw_3257
L_tw_3256:
s_waitcnt vmcnt(8)
L_tw_3257:
s_barrier
v_mfma_f32_16x16x32_bf16 v[36:39], a[96:99], a[68:71], v[36:39]
v_mfma_f32_16x16x32_bf16 v[96:99], a[96:99], a[72:75], v[96:99]
ds_read_b64_tr_b16 a[32:33], v11 offset:0
v_mfma_f32_16x16x32_bf16 v[100:103], a[96:99], a[76:79], v[100:103]
v_mfma_f32_16x16x32_bf16 v[160:163], a[96:99], a[80:83], v[160:163]
ds_read_b64_tr_b16 a[34:35], v11 offset:2048
v_mfma_f32_16x16x32_bf16 v[164:167], a[96:99], a[84:87], v[164:167]
v_mfma_f32_16x16x32_bf16 v[224:227], a[96:99], a[88:91], v[224:227]
ds_read_b128 a[0:3], v9 offset:0
v_mfma_f32_16x16x32_bf16 v[228:231], a[96:99], a[92:95], v[228:231]
v_mfma_f32_16x16x32_bf16 v[40:43], a[100:103], a[64:67], v[40:43]
ds_read_b128 a[4:7], v9 offset:256
v_mfma_f32_16x16x32_bf16 v[44:47], a[100:103], a[68:71], v[44:47]
v_mfma_f32_16x16x32_bf16 v[104:107], a[100:103], a[72:75], v[104:107]
ds_read_b128 a[8:11], v9 offset:2048
v_mfma_f32_16x16x32_bf16 v[108:111], a[100:103], a[76:79], v[108:111]
v_mfma_f32_16x16x32_bf16 v[168:171], a[100:103], a[80:83], v[168:171]
ds_read_b128 a[12:15], v9 offset:2304
v_mfma_f32_16x16x32_bf16 v[172:175], a[100:103], a[84:87], v[172:175]
v_mfma_f32_16x16x32_bf16 v[232:235], a[100:103], a[88:91], v[232:235]
ds_read_b128 a[16:19], v9 offset:4096
v_mfma_f32_16x16x32_bf16 v[236:239], a[100:103], a[92:95], v[236:239]
v_mfma_f32_16x16x32_bf16 v[48:51], a[104:107], a[64:67], v[48:51]
ds_read_b128 a[20:23], v9 offset:4352
v_mfma_f32_16x16x32_bf16 v[52:55], a[104:107], a[68:71], v[52:55]
v_mfma_f32_16x16x32_bf16 v[112:115], a[104:107], a[72:75], v[112:115]
ds_read_b128 a[24:27], v9 offset:6144
v_mfma_f32_16x16x32_bf16 v[116:119], a[104:107], a[76:79], v[116:119]
v_mfma_f32_16x16x32_bf16 v[176:179], a[104:107], a[80:83], v[176:179]
ds_read_b128 a[28:31], v9 offset:6400
v_mfma_f32_16x16x32_bf16 v[180:183], a[104:107], a[84:87], v[180:183]
v_mfma_f32_16x16x32_bf16 a[128:131], a[104:107], a[88:91], a[128:131]
ds_read_b64_tr_b16 a[36:37], v13 offset:0
v_mfma_f32_16x16x32_bf16 a[132:135], a[104:107], a[92:95], a[132:135]
v_mfma_f32_16x16x32_bf16 v[56:59], a[108:111], a[64:67], v[56:59]
ds_read_b64_tr_b16 a[38:39], v13 offset:2048
v_mfma_f32_16x16x32_bf16 v[60:63], a[108:111], a[68:71], v[60:63]
v_mfma_f32_16x16x32_bf16 v[120:123], a[108:111], a[72:75], v[120:123]
ds_read_b64_tr_b16 a[40:41], v15 offset:0
v_mfma_f32_16x16x32_bf16 v[124:127], a[108:111], a[76:79], v[124:127]
v_mfma_f32_16x16x32_bf16 v[184:187], a[108:111], a[80:83], v[184:187]
ds_read_b64_tr_b16 a[42:43], v15 offset:2048
v_mfma_f32_16x16x32_bf16 v[188:191], a[108:111], a[84:87], v[188:191]
v_mfma_f32_16x16x32_bf16 a[136:139], a[108:111], a[88:91], a[136:139]
ds_read_b64_tr_b16 a[44:45], v17 offset:0
v_mfma_f32_16x16x32_bf16 a[140:143], a[108:111], a[92:95], a[140:143]
v_mfma_f32_16x16x32_bf16 v[64:67], a[112:115], a[64:67], v[64:67]
ds_read_b64_tr_b16 a[46:47], v17 offset:2048
s_cmp_lg_u32 s91, 1
s_cbranch_scc1 L_npf_4258
s_cmp_ge_u32 s90, 4
s_cbranch_scc1 L_pfh_4259
s_add_u32 m0, s87, 32768
s_nop 0
buffer_load_dwordx4 v20, s[4:7], s84 offen sc1 lds
buffer_load_dwordx4 v20, s[4:7], s84 offen offset:1024 sc1 lds
buffer_load_dwordx4 v21, s[4:7], s84 offen offset:2048 sc1 lds
buffer_load_dwordx4 v21, s[4:7], s84 offen offset:3072 sc1 lds
s_add_u32 s84, s84, 2048
s_add_u32 m0, s54, 49152
s_nop 0
buffer_load_dwordx4 v22, s[80:83], s85 offen lds
buffer_load_dwordx4 v23, s[80:83], s85 offen offset:1024 lds
buffer_load_dwordx4 v24, s[80:83], s85 offen offset:2048 lds
buffer_load_dwordx4 v25, s[80:83], s85 offen offset:3072 lds
s_add_u32 s85, s85, s86
s_branch L_npf_4258
L_pfh_4259:
s_add_u32 m0, s87, 32768
s_nop 0
buffer_load_dwordx4 v20, s[4:7], s84 offen sc1 lds
buffer_load_dwordx4 v20, s[4:7], s84 offen offset:1024 sc1 lds
s_add_u32 s84, s84, 2048
s_add_u32 m0, s54, 49152
s_nop 0
buffer_load_dwordx4 v22, s[80:83], s85 offen lds
buffer_load_dwordx4 v23, s[80:83], s85 offen offset:1024 lds
buffer_load_dwordx4 v24, s[80:83], s85 offen offset:2048 lds
buffer_load_dwordx4 v25, s[80:83], s85 offen offset:3072 lds
s_add_u32 s85, s85, s86
L_npf_4258:
v_mfma_f32_16x16x32_bf16 v[68:71], a[112:115], a[68:71], v[68:71]
v_mfma_f32_16x16x32_bf16 v[128:131], a[112:115], a[72:75], v[128:131]
ds_read_b64_tr_b16 a[48:49], v11 offset:8192
v_mfma_f32_16x16x32_bf16 v[132:135], a[112:115], a[76:79], v[132:135]
v_mfma_f32_16x16x32_bf16 v[192:195], a[112:115], a[80:83], v[192:195]
ds_read_b64_tr_b16 a[50:51], v11 offset:10240
v_mfma_f32_16x16x32_bf16 v[196:199], a[112:115], a[84:87], v[196:199]
v_mfma_f32_16x16x32_bf16 a[144:147], a[112:115], a[88:91], a[144:147]
ds_read_b64_tr_b16 a[52:53], v13 offset:8192
v_mfma_f32_16x16x32_bf16 a[148:151], a[112:115], a[92:95], a[148:151]
v_mfma_f32_16x16x32_bf16 v[72:75], a[116:119], a[64:67], v[72:75]
ds_read_b64_tr_b16 a[54:55], v13 offset:10240
v_mfma_f32_16x16x32_bf16 v[76:79], a[116:119], a[68:71], v[76:79]
v_mfma_f32_16x16x32_bf16 v[136:139], a[116:119], a[72:75], v[136:139]
ds_read_b64_tr_b16 a[56:57], v15 offset:8192
v_mfma_f32_16x16x32_bf16 v[140:143], a[116:119], a[76:79], v[140:143]
v_mfma_f32_16x16x32_bf16 v[200:203], a[116:119], a[80:83], v[200:203]
ds_read_b64_tr_b16 a[58:59], v15 offset:10240
v_mfma_f32_16x16x32_bf16 v[204:207], a[116:119], a[84:87], v[204:207]
v_mfma_f32_16x16x32_bf16 a[152:155], a[116:119], a[88:91], a[152:155]
ds_read_b64_tr_b16 a[60:61], v17 offset:8192
v_mfma_f32_16x16x32_bf16 a[156:159], a[116:119], a[92:95], a[156:159]
v_mfma_f32_16x16x32_bf16 v[80:83], a[120:123], a[64:67], v[80:83]
ds_read_b64_tr_b16 a[62:63], v17 offset:10240
v_mfma_f32_16x16x32_bf16 v[84:87], a[120:123], a[68:71], v[84:87]
v_mfma_f32_16x16x32_bf16 v[144:147], a[120:123], a[72:75], v[144:147]
v_mfma_f32_16x16x32_bf16 v[148:151], a[120:123], a[76:79], v[148:151]
v_mfma_f32_16x16x32_bf16 v[208:211], a[120:123], a[80:83], v[208:211]
v_mfma_f32_16x16x32_bf16 v[212:215], a[120:123], a[84:87], v[212:215]
v_mfma_f32_16x16x32_bf16 a[160:163], a[120:123], a[88:91], a[160:163]
v_mfma_f32_16x16x32_bf16 a[164:167], a[120:123], a[92:95], a[164:167]
v_mfma_f32_16x16x32_bf16 v[88:91], a[124:127], a[64:67], v[88:91]
v_mfma_f32_16x16x32_bf16 v[92:95], a[124:127], a[68:71], v[92:95]
v_mfma_f32_16x16x32_bf16 v[152:155], a[124:127], a[72:75], v[152:155]
v_mfma_f32_16x16x32_bf16 v[156:159], a[124:127], a[76:79], v[156:159]
v_mfma_f32_16x16x32_bf16 v[216:219], a[124:127], a[80:83], v[216:219]
v_mfma_f32_16x16x32_bf16 v[220:223], a[124:127], a[84:87], v[220:223]
v_mfma_f32_16x16x32_bf16 a[168:171], a[124:127], a[88:91], a[168:171]
v_mfma_f32_16x16x32_bf16 a[172:175], a[124:127], a[92:95], a[172:175]
s_waitcnt lgkmcnt(0)
v_mfma_f32_16x16x32_bf16 v[32:35], a[32:35], a[0:3], v[32:35]
s_cmp_lg_u32 s91, 1
s_cbranch_scc1 L_tw_4260
s_waitcnt vmcnt(12)
s_branch L_tw_4261
L_tw_4260:
s_waitcnt vmcnt(0)
L_tw_4261:
s_barrier
s_cmp_lg_u32 s91, 2
s_cbranch_scc1 L_nld_6262
s_cmp_lg_u32 s3, 0
s_cbranch_scc1 L_nld_6262
s_bfe_u32 s94, s73, 0x80008
v_cmp_le_u32 vcc, s94, v31
v_mov_b32 v29, 131072
s_nop 0
v_cndmask_b32 v30, 0, 3, vcc
ds_write_b32 v29, v30
L_nld_6262:
v_mfma_f32_16x16x32_bf16 v[36:39], a[32:35], a[4:7], v[36:39]
v_mfma_f32_16x16x32_bf16 v[96:99], a[32:35], a[8:11], v[96:99]
ds_read_b64_tr_b16 a[96:97], v11 offset:32768
v_mfma_f32_16x16x32_bf16 v[100:103], a[32:35], a[12:15], v[100:103]
v_mfma_f32_16x16x32_bf16 v[160:163], a[32:35], a[16:19], v[160:163]
ds_read_b64_tr_b16 a[98:99], v11 offset:34816
v_mfma_f32_16x16x32_bf16 v[164:167], a[32:35], a[20:23], v[164:167]
v_mfma_f32_16x16x32_bf16 v[224:227], a[32:35], a[24:27], v[224:227]
ds_read_b128 a[64:67], v9 offset:32768
v_mfma_f32_16x16x32_bf16 v[228:231], a[32:35], a[28:31], v[228:231]
v_mfma_f32_16x16x32_bf16 v[40:43], a[36:39], a[0:3], v[40:43]
ds_read_b128 a[68:71], v9 offset:33024
v_mfma_f32_16x16x32_bf16 v[44:47], a[36:39], a[4:7], v[44:47]
v_mfma_f32_16x16x32_bf16 v[104:107], a[36:39], a[8:11], v[104:107]
ds_read_b128 a[72:75], v9 offset:34816
v_mfma_f32_16x16x32_bf16 v[108:111], a[36:39], a[12:15], v[108:111]
v_mfma_f32_16x16x32_bf16 v[168:171], a[36:39], a[16:19], v[168:171]
ds_read_b128 a[76:79], v9 offset:35072
v_mfma_f32_16x16x32_bf16 v[172:175], a[36:39], a[20:23], v[172:175]
v_mfma_f32_16x16x32_bf16 v[232:235], a[36:39], a[24:27], v[232:235]
ds_read_b128 a[80:83], v9 offset:36864
v_mfma_f32_16x16x32_bf16 v[236:239], a[36:39], a[28:31], v[236:239]
v_mfma_f32_16x16x32_bf16 v[48:51], a[40:43], a[0:3], v[48:51]
ds_read_b128 a[84:87], v9 offset:37120
v_mfma_f32_16x16x32_bf16 v[52:55], a[40:43], a[4:7], v[52:55]
v_mfma_f32_16x16x32_bf16 v[112:115], a[40:43], a[8:11], v[112:115]
ds_read_b128 a[88:91], v9 offset:38912
v_mfma_f32_16x16x32_bf16 v[116:119], a[40:43], a[12:15], v[116:119]
v_mfma_f32_16x16x32_bf16 v[176:179], a[40:43], a[16:19], v[176:179]
ds_read_b128 a[92:95], v9 offset:39168
v_mfma_f32_16x16x32_bf16 v[180:183], a[40:43], a[20:23], v[180:183]
v_mfma_f32_16x16x32_bf16 a[128:131], a[40:43], a[24:27], a[128:131]
ds_read_b64_tr_b16 a[100:101], v13 offset:32768
v_mfma_f32_16x16x32_bf16 a[132:135], a[40:43], a[28:31], a[132:135]
v_mfma_f32_16x16x32_bf16 v[56:59], a[44:47], a[0:3], v[56:59]
ds_read_b64_tr_b16 a[102:103], v13 offset:34816
v_mfma_f32_16x16x32_bf16 v[60:63], a[44:47], a[4:7], v[60:63]
v_mfma_f32_16x16x32_bf16 v[120:123], a[44:47], a[8:11], v[120:123]
ds_read_b64_tr_b16 a[104:105], v15 offset:32768
v_mfma_f32_16x16x32_bf16 v[124:127], a[44:47], a[12:15], v[124:127]
v_mfma_f32_16x16x32_bf16 v[184:187], a[44:47], a[16:19], v[184:187]
ds_read_b64_tr_b16 a[106:107], v15 offset:34816
v_mfma_f32_16x16x32_bf16 v[188:191], a[44:47], a[20:23], v[188:191]
v_mfma_f32_16x16x32_bf16 a[136:139], a[44:47], a[24:27], a[136:139]
ds_read_b64_tr_b16 a[108:109], v17 offset:32768
v_mfma_f32_16x16x32_bf16 a[140:143], a[44:47], a[28:31], a[140:143]
v_mfma_f32_16x16x32_bf16 v[64:67], a[48:51], a[0:3], v[64:67]
ds_read_b64_tr_b16 a[110:111], v17 offset:34816
s_cmp_lg_u32 s91, 1
s_cbranch_scc1 L_npf_6263
s_cmp_ge_u32 s90, 4
s_cbranch_scc1 L_pfh_6264
s_add_u32 m0, s87, 65536
s_nop 0
buffer_load_dwordx4 v20, s[4:7], s84 offen sc1 lds
buffer_load_dwordx4 v20, s[4:7], s84 offen offset:1024 sc1 lds
buffer_load_dwordx4 v21, s[4:7], s84 offen offset:2048 sc1 lds
buffer_load_dwordx4 v21, s[4:7], s84 offen offset:3072 sc1 lds
s_add_u32 s84, s84, 2048
s_add_u32 m0, s54, 81920
s_nop 0
buffer_load_dwordx4 v22, s[80:83], s85 offen lds
buffer_load_dwordx4 v23, s[80:83], s85 offen offset:1024 lds
buffer_load_dwordx4 v24, s[80:83], s85 offen offset:2048 lds
buffer_load_dwordx4 v25, s[80:83], s85 offen offset:3072 lds
s_add_u32 s85, s85, s86
s_branch L_npf_6263
L_pfh_6264:
s_add_u32 m0, s87, 65536
s_nop 0
buffer_load_dwordx4 v20, s[4:7], s84 offen sc1 lds
buffer_load_dwordx4 v20, s[4:7], s84 offen offset:1024 sc1 lds
s_add_u32 s84, s84, 2048
s_add_u32 m0, s54, 81920
s_nop 0
buffer_load_dwordx4 v22, s[80:83], s85 offen lds
buffer_load_dwordx4 v23, s[80:83], s85 offen offset:1024 lds
buffer_load_dwordx4 v24, s[80:83], s85 offen offset:2048 lds
buffer_load_dwordx4 v25, s[80:83], s85 offen offset:3072 lds
s_add_u32 s85, s85, s86
L_npf_6263:
v_mfma_f32_16x16x32_bf16 v[68:71], a[48:51], a[4:7], v[68:71]
v_mfma_f32_16x16x32_bf16 v[128:131], a[48:51], a[8:11], v[128:131]
ds_read_b64_tr_b16 a[112:113], v11 offset:40960
v_mfma_f32_16x16x32_bf16 v[132:135], a[48:51], a[12:15], v[132:135]
v_mfma_f32_16x16x32_bf16 v[192:195], a[48:51], a[16:19], v[192:195]
ds_read_b64_tr_b16 a[114:115], v11 offset:43008
v_mfma_f32_16x16x32_bf16 v[196:199], a[48:51], a[20:23], v[196:199]
v_mfma_f32_16x16x32_bf16 a[144:147], a[48:51], a[24:27], a[144:147]
ds_read_b64_tr_b16 a[116:117], v13 offset:40960
v_mfma_f32_16x16x32_bf16 a[148:151], a[48:51], a[28:31], a[148:151]
v_mfma_f32_16x16x32_bf16 v[72:75], a[52:55], a[0:3], v[72:75]
ds_read_b64_tr_b16 a[118:119], v13 offset:43008
v_mfma_f32_16x16x32_bf16 v[76:79], a[52:55], a[4:7], v[76:79]
v_mfma_f32_16x16x32_bf16 v[136:139], a[52:55], a[8:11], v[136:139]
ds_read_b64_tr_b16 a[120:121], v15 offset:40960
v_mfma_f32_16x16x32_bf16 v[140:143], a[52:55], a[12:15], v[140:143]
v_mfma_f32_16x16x32_bf16 v[200:203], a[52:55], a[16:19], v[200:203]
ds_read_b64_tr_b16 a[122:123], v15 offset:43008
v_mfma_f32_16x16x32_bf16 v[204:207], a[52:55], a[20:23], v[204:207]
v_mfma_f32_16x16x32_bf16 a[152:155], a[52:55], a[24:27], a[152:155]
ds_read_b64_tr_b16 a[124:125], v17 offset:40960
v_mfma_f32_16x16x32_bf16 a[156:159], a[52:55], a[28:31], a[156:159]
v_mfma_f32_16x16x32_bf16 v[80:83], a[56:59], a[0:3], v[80:83]
ds_read_b64_tr_b16 a[126:127], v17 offset:43008
v_mfma_f32_16x16x32_bf16 v[84:87], a[56:59], a[4:7], v[84:87]
v_mfma_f32_16x16x32_bf16 v[144:147], a[56:59], a[8:11], v[144:147]
v_mfma_f32_16x16x32_bf16 v[148:151], a[56:59], a[12:15], v[148:151]
v_mfma_f32_16x16x32_bf16 v[208:211], a[56:59], a[16:19], v[208:211]
v_mfma_f32_16x16x32_bf16 v[212:215], a[56:59], a[20:23], v[212:215]
v_mfma_f32_16x16x32_bf16 a[160:163], a[56:59], a[24:27], a[160:163]
v_mfma_f32_16x16x32_bf16 a[164:167], a[56:59], a[28:31], a[164:167]
v_mfma_f32_16x16x32_bf16 v[88:91], a[60:63], a[0:3], v[88:91]
v_mfma_f32_16x16x32_bf16 v[92:95], a[60:63], a[4:7], v[92:95]
v_mfma_f32_16x16x32_bf16 v[152:155], a[60:63], a[8:11], v[152:155]
v_mfma_f32_16x16x32_bf16 v[156:159], a[60:63], a[12:15], v[156:159]
v_mfma_f32_16x16x32_bf16 v[216:219], a[60:63], a[16:19], v[216:219]
v_mfma_f32_16x16x32_bf16 v[220:223], a[60:63], a[20:23], v[220:223]
v_mfma_f32_16x16x32_bf16 a[168:171], a[60:63], a[24:27], a[168:171]
v_mfma_f32_16x16x32_bf16 a[172:175], a[60:63], a[28:31], a[172:175]
s_waitcnt lgkmcnt(0)
v_mfma_f32_16x16x32_bf16 v[32:35], a[96:99], a[64:67], v[32:35]
s_barrier
s_cmp_lg_u32 s91, 2
s_cbranch_scc1 L_nlp_6265
v_mov_b32 v29, 131072
ds_read_b32 v30, v29
s_waitcnt lgkmcnt(0)
v_readfirstlane_b32 s91, v30
s_cmp_eq_u32 s91, 0
s_cbranch_scc1 L_nlp_6265
s_cmp_ge_u32 s90, 4
s_cbranch_scc1 L_lph_6266
s_add_u32 m0, s87, 0
s_nop 0
buffer_load_dwordx4 v20, s[4:7], s84 offen sc1 lds
buffer_load_dwordx4 v20, s[4:7], s84 offen offset:1024 sc1 lds
buffer_load_dwordx4 v21, s[4:7], s84 offen offset:2048 sc1 lds
buffer_load_dwordx4 v21, s[4:7], s84 offen offset:3072 sc1 lds
s_add_u32 s84, s84, 2048
s_add_u32 m0, s54, 16384
s_nop 0
buffer_load_dwordx4 v22, s[80:83], s85 offen lds
buffer_load_dwordx4 v23, s[80:83], s85 offen offset:1024 lds
buffer_load_dwordx4 v24, s[80:83], s85 offen offset:2048 lds
buffer_load_dwordx4 v25, s[80:83], s85 offen offset:3072 lds
s_add_u32 s85, s85, s86
s_add_u32 m0, s87, 32768
s_nop 0
buffer_load_dwordx4 v20, s[4:7], s84 offen sc1 lds
buffer_load_dwordx4 v20, s[4:7], s84 offen offset:1024 sc1 lds
buffer_load_dwordx4 v21, s[4:7], s84 offen offset:2048 sc1 lds
buffer_load_dwordx4 v21, s[4:7], s84 offen offset:3072 sc1 lds
s_add_u32 s84, s84, 2048
s_add_u32 m0, s54, 49152
s_nop 0
buffer_load_dwordx4 v22, s[80:83], s85 offen lds
buffer_load_dwordx4 v23, s[80:83], s85 offen offset:1024 lds
buffer_load_dwordx4 v24, s[80:83], s85 offen offset:2048 lds
buffer_load_dwordx4 v25, s[80:83], s85 offen offset:3072 lds
s_add_u32 s85, s85, s86
s_add_u32 m0, s87, 65536
s_nop 0
buffer_load_dwordx4 v20, s[4:7], s84 offen sc1 lds
buffer_load_dwordx4 v20, s[4:7], s84 offen offset:1024 sc1 lds
buffer_load_dwordx4 v21, s[4:7], s84 offen offset:2048 sc1 lds
buffer_load_dwordx4 v21, s[4:7], s84 offen offset:3072 sc1 lds
s_add_u32 s84, s84, 2048
s_add_u32 m0, s54, 81920
s_nop 0
buffer_load_dwordx4 v22, s[80:83], s85 offen lds
buffer_load_dwordx4 v23, s[80:83], s85 offen offset:1024 lds
buffer_load_dwordx4 v24, s[80:83], s85 offen offset:2048 lds
buffer_load_dwordx4 v25, s[80:83], s85 offen offset:3072 lds
s_add_u32 s85, s85, s86
s_add_u32 m0, s87, 98304
s_nop 0
buffer_load_dwordx4 v20, s[4:7], s84 offen sc1 lds
buffer_load_dwordx4 v20, s[4:7], s84 offen offset:1024 sc1 lds
buffer_load_dwordx4 v21, s[4:7], s84 offen offset:2048 sc1 lds
buffer_load_dwordx4 v21, s[4:7], s84 offen offset:3072 sc1 lds
s_add_u32 s84, s84, 2048
s_add_u32 m0, s54, 114688
s_nop 0
buffer_load_dwordx4 v22, s[80:83], s85 offen lds
buffer_load_dwordx4 v23, s[80:83], s85 offen offset:1024 lds
buffer_load_dwordx4 v24, s[80:83], s85 offen offset:2048 lds
buffer_load_dwordx4 v25, s[80:83], s85 offen offset:3072 lds
s_add_u32 s85, s85, s86
s_branch L_nlp_6265
L_lph_6266:
s_add_u32 m0, s87, 0
s_nop 0
buffer_load_dwordx4 v20, s[4:7], s84 offen sc1 lds
buffer_load_dwordx4 v20, s[4:7], s84 offen offset:1024 sc1 lds
s_add_u32 s84, s84, 2048
s_add_u32 m0, s54, 16384
s_nop 0
buffer_load_dwordx4 v22, s[80:83], s85 offen lds
buffer_load_dwordx4 v23, s[80:83], s85 offen offset:1024 lds
buffer_load_dwordx4 v24, s[80:83], s85 offen offset:2048 lds
buffer_load_dwordx4 v25, s[80:83], s85 offen offset:3072 lds
s_add_u32 s85, s85, s86
s_add_u32 m0, s87, 32768
s_nop 0
buffer_load_dwordx4 v20, s[4:7], s84 offen sc1 lds
buffer_load_dwordx4 v20, s[4:7], s84 offen offset:1024 sc1 lds
s_add_u32 s84, s84, 2048
s_add_u32 m0, s54, 49152
s_nop 0
buffer_load_dwordx4 v22, s[80:83], s85 offen lds
buffer_load_dwordx4 v23, s[80:83], s85 offen offset:1024 lds
buffer_load_dwordx4 v24, s[80:83], s85 offen offset:2048 lds
buffer_load_dwordx4 v25, s[80:83], s85 offen offset:3072 lds
s_add_u32 s85, s85, s86
s_add_u32 m0, s87, 65536
s_nop 0
buffer_load_dwordx4 v20, s[4:7], s84 offen sc1 lds
buffer_load_dwordx4 v20, s[4:7], s84 offen offset:1024 sc1 lds
s_add_u32 s84, s84, 2048
s_add_u32 m0, s54, 81920
s_nop 0
buffer_load_dwordx4 v22, s[80:83], s85 offen lds
buffer_load_dwordx4 v23, s[80:83], s85 offen offset:1024 lds
buffer_load_dwordx4 v24, s[80:83], s85 offen offset:2048 lds
buffer_load_dwordx4 v25, s[80:83], s85 offen offset:3072 lds
s_add_u32 s85, s85, s86
s_add_u32 m0, s87, 98304
s_nop 0
buffer_load_dwordx4 v20, s[4:7], s84 offen sc1 lds
buffer_load_dwordx4 v20, s[4:7], s84 offen offset:1024 sc1 lds
s_add_u32 s84, s84, 2048
s_add_u32 m0, s54, 114688
s_nop 0
buffer_load_dwordx4 v22, s[80:83], s85 offen lds
buffer_load_dwordx4 v23, s[80:83], s85 offen offset:1024 lds
buffer_load_dwordx4 v24, s[80:83], s85 offen offset:2048 lds
buffer_load_dwordx4 v25, s[80:83], s85 offen offset:3072 lds
s_add_u32 s85, s85, s86
L_nlp_6265:
v_mfma_f32_16x16x32_bf16 v[36:39], a[96:99], a[68:71], v[36:39]
v_mfma_f32_16x16x32_bf16 v[96:99], a[96:99], a[72:75], v[96:99]
v_mfma_f32_16x16x32_bf16 v[100:103], a[96:99], a[76:79], v[100:103]
v_mfma_f32_16x16x32_bf16 v[160:163], a[96:99], a[80:83], v[160:163]
v_mfma_f32_16x16x32_bf16 v[164:167], a[96:99], a[84:87], v[164:167]
v_mfma_f32_16x16x32_bf16 v[224:227], a[96:99], a[88:91], v[224:227]
v_mfma_f32_16x16x32_bf16 v[228:231], a[96:99], a[92:95], v[228:231]
v_mfma_f32_16x16x32_bf16 v[40:43], a[100:103], a[64:67], v[40:43]
v_mfma_f32_16x16x32_bf16 v[44:47], a[100:103], a[68:71], v[44:47]
v_mfma_f32_16x16x32_bf16 v[104:107], a[100:103], a[72:75], v[104:107]
v_mfma_f32_16x16x32_bf16 v[108:111], a[100:103], a[76:79], v[108:111]
v_mfma_f32_16x16x32_bf16 v[168:171], a[100:103], a[80:83], v[168:171]
v_mfma_f32_16x16x32_bf16 v[172:175], a[100:103], a[84:87], v[172:175]
v_mfma_f32_16x16x32_bf16 v[232:235], a[100:103], a[88:91], v[232:235]
v_mfma_f32_16x16x32_bf16 v[236:239], a[100:103], a[92:95], v[236:239]
v_mfma_f32_16x16x32_bf16 v[48:51], a[104:107], a[64:67], v[48:51]
v_mfma_f32_16x16x32_bf16 v[52:55], a[104:107], a[68:71], v[52:55]
v_mfma_f32_16x16x32_bf16 v[112:115], a[104:107], a[72:75], v[112:115]
v_mfma_f32_16x16x32_bf16 v[116:119], a[104:107], a[76:79], v[116:119]
v_mfma_f32_16x16x32_bf16 v[176:179], a[104:107], a[80:83], v[176:179]
v_mfma_f32_16x16x32_bf16 v[180:183], a[104:107], a[84:87], v[180:183]
v_mfma_f32_16x16x32_bf16 a[128:131], a[104:107], a[88:91], a[128:131]
v_mfma_f32_16x16x32_bf16 a[132:135], a[104:107], a[92:95], a[132:135]
v_mfma_f32_16x16x32_bf16 v[56:59], a[108:111], a[64:67], v[56:59]
v_mfma_f32_16x16x32_bf16 v[60:63], a[108:111], a[68:71], v[60:63]
v_mfma_f32_16x16x32_bf16 v[120:123], a[108:111], a[72:75], v[120:123]
v_mfma_f32_16x16x32_bf16 v[124:127], a[108:111], a[76:79], v[124:127]
v_mfma_f32_16x16x32_bf16 v[184:187], a[108:111], a[80:83], v[184:187]
v_mfma_f32_16x16x32_bf16 v[188:191], a[108:111], a[84:87], v[188:191]
v_mfma_f32_16x16x32_bf16 a[136:139], a[108:111], a[88:91], a[136:139]
v_mfma_f32_16x16x32_bf16 a[140:143], a[108:111], a[92:95], a[140:143]
v_mfma_f32_16x16x32_bf16 v[64:67], a[112:115], a[64:67], v[64:67]
s_cmp_lg_u32 s91, 1
s_cbranch_scc1 L_npf_6267
s_cmp_ge_u32 s90, 4
s_cbranch_scc1 L_pfh_6268
s_add_u32 m0, s87, 98304
s_nop 0
buffer_load_dwordx4 v20, s[4:7], s84 offen sc1 lds
buffer_load_dwordx4 v20, s[4:7], s84 offen offset:1024 sc1 lds
buffer_load_dwordx4 v21, s[4:7], s84 offen offset:2048 sc1 lds
buffer_load_dwordx4 v21, s[4:7], s84 offen offset:3072 sc1 lds
s_add_u32 s84, s84, 2048
s_add_u32 m0, s54, 114688
s_nop 0
buffer_load_dwordx4 v22, s[80:83], s85 offen lds
buffer_load_dwordx4 v23, s[80:83], s85 offen offset:1024 lds
buffer_load_dwordx4 v24, s[80:83], s85 offen offset:2048 lds
buffer_load_dwordx4 v25, s[80:83], s85 offen offset:3072 lds
s_add_u32 s85, s85, s86
s_branch L_npf_6267
L_pfh_6268:
s_add_u32 m0, s87, 98304
s_nop 0
buffer_load_dwordx4 v20, s[4:7], s84 offen sc1 lds
buffer_load_dwordx4 v20, s[4:7], s84 offen offset:1024 sc1 lds
s_add_u32 s84, s84, 2048
s_add_u32 m0, s54, 114688
s_nop 0
buffer_load_dwordx4 v22, s[80:83], s85 offen lds
buffer_load_dwordx4 v23, s[80:83], s85 offen offset:1024 lds
buffer_load_dwordx4 v24, s[80:83], s85 offen offset:2048 lds
buffer_load_dwordx4 v25, s[80:83], s85 offen offset:3072 lds
s_add_u32 s85, s85, s86
L_npf_6267:
v_mfma_f32_16x16x32_bf16 v[68:71], a[112:115], a[68:71], v[68:71]
v_mfma_f32_16x16x32_bf16 v[128:131], a[112:115], a[72:75], v[128:131]
v_mfma_f32_16x16x32_bf16 v[132:135], a[112:115], a[76:79], v[132:135]
v_mfma_f32_16x16x32_bf16 v[192:195], a[112:115], a[80:83], v[192:195]
v_mfma_f32_16x16x32_bf16 v[196:199], a[112:115], a[84:87], v[196:199]
v_mfma_f32_16x16x32_bf16 a[144:147], a[112:115], a[88:91], a[144:147]
v_mfma_f32_16x16x32_bf16 a[148:151], a[112:115], a[92:95], a[148:151]
v_mfma_f32_16x16x32_bf16 v[72:75], a[116:119], a[64:67], v[72:75]
v_mfma_f32_16x16x32_bf16 v[76:79], a[116:119], a[68:71], v[76:79]
v_mfma_f32_16x16x32_bf16 v[136:139], a[116:119], a[72:75], v[136:139]
v_mfma_f32_16x16x32_bf16 v[140:143], a[116:119], a[76:79], v[140:143]
v_mfma_f32_16x16x32_bf16 v[200:203], a[116:119], a[80:83], v[200:203]
v_mfma_f32_16x16x32_bf16 v[204:207], a[116:119], a[84:87], v[204:207]
v_mfma_f32_16x16x32_bf16 a[152:155], a[116:119], a[88:91], a[152:155]
v_mfma_f32_16x16x32_bf16 a[156:159], a[116:119], a[92:95], a[156:159]
v_mfma_f32_16x16x32_bf16 v[80:83], a[120:123], a[64:67], v[80:83]
v_mfma_f32_16x16x32_bf16 v[84:87], a[120:123], a[68:71], v[84:87]
v_mfma_f32_16x16x32_bf16 v[144:147], a[120:123], a[72:75], v[144:147]
v_mfma_f32_16x16x32_bf16 v[148:151], a[120:123], a[76:79], v[148:151]
v_mfma_f32_16x16x32_bf16 v[208:211], a[120:123], a[80:83], v[208:211]
v_mfma_f32_16x16x32_bf16 v[212:215], a[120:123], a[84:87], v[212:215]
v_mfma_f32_16x16x32_bf16 a[160:163], a[120:123], a[88:91], a[160:163]
v_mfma_f32_16x16x32_bf16 a[164:167], a[120:123], a[92:95], a[164:167]
v_mfma_f32_16x16x32_bf16 v[88:91], a[124:127], a[64:67], v[88:91]
v_mfma_f32_16x16x32_bf16 v[92:95], a[124:127], a[68:71], v[92:95]
v_mfma_f32_16x16x32_bf16 v[152:155], a[124:127], a[72:75], v[152:155]
v_mfma_f32_16x16x32_bf16 v[156:159], a[124:127], a[76:79], v[156:159]
v_mfma_f32_16x16x32_bf16 v[216:219], a[124:127], a[80:83], v[216:219]
v_mfma_f32_16x16x32_bf16 v[220:223], a[124:127], a[84:87], v[220:223]
v_mfma_f32_16x16x32_bf16 a[168:171], a[124:127], a[88:91], a[168:171]
v_mfma_f32_16x16x32_bf16 a[172:175], a[124:127], a[92:95], a[172:175]
s_nop 7
s_cmp_eq_u32 s93, 2
s_cbranch_scc1 L_egu_240
s_lshr_b32 s56, s3, 1
s_lshl_b32 s56, s56, 2
s_mul_i32 s56, s56, s53
s_add_u32 s52, s52, s56
s_and_b32 s56, s3, 1
s_lshl_b32 s56, s56, 12
s_add_u32 s52, s52, s56
s_add_u32 s57, s52, 0
v_cvt_pk_bf16_f32 v32, v32, v33
v_cvt_pk_bf16_f32 v33, v34, v35
v_cvt_pk_bf16_f32 v34, v40, v41
v_cvt_pk_bf16_f32 v35, v42, v43
v_cvt_pk_bf16_f32 v36, v36, v37
v_cvt_pk_bf16_f32 v37, v38, v39
v_cvt_pk_bf16_f32 v38, v44, v45
v_cvt_pk_bf16_f32 v39, v46, v47
buffer_store_dwordx4 v[32:35], v18, s[4:7], s57 offen offset:0 sc1
buffer_store_dwordx4 v[36:39], v18, s[4:7], s57 offen offset:256 sc1
v_cvt_pk_bf16_f32 v48, v48, v49
v_cvt_pk_bf16_f32 v49, v50, v51
v_cvt_pk_bf16_f32 v50, v56, v57
v_cvt_pk_bf16_f32 v51, v58, v59
v_cvt_pk_bf16_f32 v52, v52, v53
v_cvt_pk_bf16_f32 v53, v54, v55
v_cvt_pk_bf16_f32 v54, v60, v61
v_cvt_pk_bf16_f32 v55, v62, v63
buffer_store_dwordx4 v[48:51], v18, s[4:7], s57 offen offset:2048 sc1
buffer_store_dwordx4 v[52:55], v18, s[4:7], s57 offen offset:2304 sc1
s_add_u32 s57, s52, 8192
v_cvt_pk_bf16_f32 v64, v64, v65
v_cvt_pk_bf16_f32 v65, v66, v67
v_cvt_pk_bf16_f32 v66, v72, v73
v_cvt_pk_bf16_f32 v67, v74, v75
v_cvt_pk_bf16_f32 v68, v68, v69
v_cvt_pk_bf16_f32 v69, v70, v71
v_cvt_pk_bf16_f32 v70, v76, v77
v_cvt_pk_bf16_f32 v71, v78, v79
buffer_store_dwordx4 v[64:67], v18, s[4:7], s57 offen offset:0 sc1
buffer_store_dwordx4 v[68:71], v18, s[4:7], s57 offen offset:256 sc1
v_cvt_pk_bf16_f32 v80, v80, v81
v_cvt_pk_bf16_f32 v81, v82, v83
v_cvt_pk_bf16_f32 v82, v88, v89
v_cvt_pk_bf16_f32 v83, v90, v91
v_cvt_pk_bf16_f32 v84, v84, v85
v_cvt_pk_bf16_f32 v85, v86, v87
v_cvt_pk_bf16_f32 v86, v92, v93
v_cvt_pk_bf16_f32 v87, v94, v95
buffer_store_dwordx4 v[80:83], v18, s[4:7], s57 offen offset:2048 sc1
buffer_store_dwordx4 v[84:87], v18, s[4:7], s57 offen offset:2304 sc1
s_add_u32 s52, s52, s53
s_add_u32 s57, s52, 0
v_cvt_pk_bf16_f32 v96, v96, v97
v_cvt_pk_bf16_f32 v97, v98, v99
v_cvt_pk_bf16_f32 v98, v104, v105
v_cvt_pk_bf16_f32 v99, v106, v107
v_cvt_pk_bf16_f32 v100, v100, v101
v_cvt_pk_bf16_f32 v101, v102, v103
v_cvt_pk_bf16_f32 v102, v108, v109
v_cvt_pk_bf16_f32 v103, v110, v111
buffer_store_dwordx4 v[96:99], v18, s[4:7], s57 offen offset:0 sc1
buffer_store_dwordx4 v[100:103], v18, s[4:7], s57 offen offset:256 sc1
v_cvt_pk_bf16_f32 v112, v112, v113
v_cvt_pk_bf16_f32 v113, v114, v115
v_cvt_pk_bf16_f32 v114, v120, v121
v_cvt_pk_bf16_f32 v115, v122, v123
v_cvt_pk_bf16_f32 v116, v116, v117
v_cvt_pk_bf16_f32 v117, v118, v119
v_cvt_pk_bf16_f32 v118, v124, v125
v_cvt_pk_bf16_f32 v119, v126, v127
buffer_store_dwordx4 v[112:115], v18, s[4:7], s57 offen offset:2048 sc1
buffer_store_dwordx4 v[116:119], v18, s[4:7], s57 offen offset:2304 sc1
s_add_u32 s57, s52, 8192
v_cvt_pk_bf16_f32 v128, v128, v129
v_cvt_pk_bf16_f32 v129, v130, v131
v_cvt_pk_bf16_f32 v130, v136, v137
v_cvt_pk_bf16_f32 v131, v138, v139
v_cvt_pk_bf16_f32 v132, v132, v133
v_cvt_pk_bf16_f32 v133, v134, v135
v_cvt_pk_bf16_f32 v134, v140, v141
v_cvt_pk_bf16_f32 v135, v142, v143
buffer_store_dwordx4 v[128:131], v18, s[4:7], s57 offen offset:0 sc1
buffer_store_dwordx4 v[132:135], v18, s[4:7], s57 offen offset:256 sc1
v_cvt_pk_bf16_f32 v144, v144, v145
v_cvt_pk_bf16_f32 v145, v146, v147
v_cvt_pk_bf16_f32 v146, v152, v153
v_cvt_pk_bf16_f32 v147, v154, v155
v_cvt_pk_bf16_f32 v148, v148, v149
v_cvt_pk_bf16_f32 v149, v150, v151
v_cvt_pk_bf16_f32 v150, v156, v157
v_cvt_pk_bf16_f32 v151, v158, v159
buffer_store_dwordx4 v[144:147], v18, s[4:7], s57 offen offset:2048 sc1
buffer_store_dwordx4 v[148:151], v18, s[4:7], s57 offen offset:2304 sc1
s_add_u32 s52, s52, s53
s_add_u32 s57, s52, 0
v_cvt_pk_bf16_f32 v160, v160, v161
v_cvt_pk_bf16_f32 v161, v162, v163
v_cvt_pk_bf16_f32 v162, v168, v169
v_cvt_pk_bf16_f32 v163, v170, v171
v_cvt_pk_bf16_f32 v164, v164, v165
v_cvt_pk_bf16_f32 v165, v166, v167
v_cvt_pk_bf16_f32 v166, v172, v173
v_cvt_pk_bf16_f32 v167, v174, v175
buffer_store_dwordx4 v[160:163], v18, s[4:7], s57 offen offset:0 sc1
buffer_store_dwordx4 v[164:167], v18, s[4:7], s57 offen offset:256 sc1
v_cvt_pk_bf16_f32 v176, v176, v177
v_cvt_pk_bf16_f32 v177, v178, v179
v_cvt_pk_bf16_f32 v178, v184, v185
v_cvt_pk_bf16_f32 v179, v186, v187
v_cvt_pk_bf16_f32 v180, v180, v181
v_cvt_pk_bf16_f32 v181, v182, v183
v_cvt_pk_bf16_f32 v182, v188, v189
v_cvt_pk_bf16_f32 v183, v190, v191
buffer_store_dwordx4 v[176:179], v18, s[4:7], s57 offen offset:2048 sc1
buffer_store_dwordx4 v[180:183], v18, s[4:7], s57 offen offset:2304 sc1
s_add_u32 s57, s52, 8192
v_cvt_pk_bf16_f32 v192, v192, v193
v_cvt_pk_bf16_f32 v193, v194, v195
v_cvt_pk_bf16_f32 v194, v200, v201
v_cvt_pk_bf16_f32 v195, v202, v203
v_cvt_pk_bf16_f32 v196, v196, v197
v_cvt_pk_bf16_f32 v197, v198, v199
v_cvt_pk_bf16_f32 v198, v204, v205
v_cvt_pk_bf16_f32 v199, v206, v207
buffer_store_dwordx4 v[192:195], v18, s[4:7], s57 offen offset:0 sc1
buffer_store_dwordx4 v[196:199], v18, s[4:7], s57 offen offset:256 sc1
v_cvt_pk_bf16_f32 v208, v208, v209
v_cvt_pk_bf16_f32 v209, v210, v211
v_cvt_pk_bf16_f32 v210, v216, v217
v_cvt_pk_bf16_f32 v211, v218, v219
v_cvt_pk_bf16_f32 v212, v212, v213
v_cvt_pk_bf16_f32 v213, v214, v215
v_cvt_pk_bf16_f32 v214, v220, v221
v_cvt_pk_bf16_f32 v215, v222, v223
buffer_store_dwordx4 v[208:211], v18, s[4:7], s57 offen offset:2048 sc1
buffer_store_dwordx4 v[212:215], v18, s[4:7], s57 offen offset:2304 sc1
s_add_u32 s52, s52, s53
s_add_u32 s57, s52, 0
v_cvt_pk_bf16_f32 v224, v224, v225
v_cvt_pk_bf16_f32 v225, v226, v227
v_cvt_pk_bf16_f32 v226, v232, v233
v_cvt_pk_bf16_f32 v227, v234, v235
v_cvt_pk_bf16_f32 v228, v228, v229
v_cvt_pk_bf16_f32 v229, v230, v231
v_cvt_pk_bf16_f32 v230, v236, v237
v_cvt_pk_bf16_f32 v231, v238, v239
buffer_store_dwordx4 v[224:227], v18, s[4:7], s57 offen offset:0 sc1
buffer_store_dwordx4 v[228:231], v18, s[4:7], s57 offen offset:256 sc1
v_accvgpr_read_b32 v32, a128
v_accvgpr_read_b32 v33, a129
v_accvgpr_read_b32 v34, a130
v_accvgpr_read_b32 v35, a131
v_accvgpr_read_b32 v36, a136
v_accvgpr_read_b32 v37, a137
v_accvgpr_read_b32 v38, a138
v_accvgpr_read_b32 v39, a139
v_cvt_pk_bf16_f32 v32, v32, v33
v_cvt_pk_bf16_f32 v33, v34, v35
v_cvt_pk_bf16_f32 v34, v36, v37
v_cvt_pk_bf16_f32 v35, v38, v39
v_accvgpr_read_b32 v40, a132
v_accvgpr_read_b32 v41, a133
v_accvgpr_read_b32 v42, a134
v_accvgpr_read_b32 v43, a135
v_accvgpr_read_b32 v44, a140
v_accvgpr_read_b32 v45, a141
v_accvgpr_read_b32 v46, a142
v_accvgpr_read_b32 v47, a143
v_cvt_pk_bf16_f32 v40, v40, v41
v_cvt_pk_bf16_f32 v41, v42, v43
v_cvt_pk_bf16_f32 v42, v44, v45
v_cvt_pk_bf16_f32 v43, v46, v47
buffer_store_dwordx4 v[32:35], v18, s[4:7], s57 offen offset:2048 sc1
buffer_store_dwordx4 v[40:43], v18, s[4:7], s57 offen offset:2304 sc1
s_add_u32 s57, s52, 8192
v_accvgpr_read_b32 v48, a144
v_accvgpr_read_b32 v49, a145
v_accvgpr_read_b32 v50, a146
v_accvgpr_read_b32 v51, a147
v_accvgpr_read_b32 v52, a152
v_accvgpr_read_b32 v53, a153
v_accvgpr_read_b32 v54, a154
v_accvgpr_read_b32 v55, a155
v_cvt_pk_bf16_f32 v48, v48, v49
v_cvt_pk_bf16_f32 v49, v50, v51
v_cvt_pk_bf16_f32 v50, v52, v53
v_cvt_pk_bf16_f32 v51, v54, v55
v_accvgpr_read_b32 v56, a148
v_accvgpr_read_b32 v57, a149
v_accvgpr_read_b32 v58, a150
v_accvgpr_read_b32 v59, a151
v_accvgpr_read_b32 v60, a156
v_accvgpr_read_b32 v61, a157
v_accvgpr_read_b32 v62, a158
v_accvgpr_read_b32 v63, a159
v_cvt_pk_bf16_f32 v56, v56, v57
v_cvt_pk_bf16_f32 v57, v58, v59
v_cvt_pk_bf16_f32 v58, v60, v61
v_cvt_pk_bf16_f32 v59, v62, v63
buffer_store_dwordx4 v[48:51], v18, s[4:7], s57 offen offset:0 sc1
buffer_store_dwordx4 v[56:59], v18, s[4:7], s57 offen offset:256 sc1
v_accvgpr_read_b32 v64, a160
v_accvgpr_read_b32 v65, a161
v_accvgpr_read_b32 v66, a162
v_accvgpr_read_b32 v67, a163
v_accvgpr_read_b32 v68, a168
v_accvgpr_read_b32 v69, a169
v_accvgpr_read_b32 v70, a170
v_accvgpr_read_b32 v71, a171
v_cvt_pk_bf16_f32 v64, v64, v65
v_cvt_pk_bf16_f32 v65, v66, v67
v_cvt_pk_bf16_f32 v66, v68, v69
v_cvt_pk_bf16_f32 v67, v70, v71
v_accvgpr_read_b32 v72, a164
v_accvgpr_read_b32 v73, a165
v_accvgpr_read_b32 v74, a166
v_accvgpr_read_b32 v75, a167
v_accvgpr_read_b32 v76, a172
v_accvgpr_read_b32 v77, a173
v_accvgpr_read_b32 v78, a174
v_accvgpr_read_b32 v79, a175
v_cvt_pk_bf16_f32 v72, v72, v73
v_cvt_pk_bf16_f32 v73, v74, v75
v_cvt_pk_bf16_f32 v74, v76, v77
v_cvt_pk_bf16_f32 v75, v78, v79
buffer_store_dwordx4 v[64:67], v18, s[4:7], s57 offen offset:2048 sc1
buffer_store_dwordx4 v[72:75], v18, s[4:7], s57 offen offset:2304 sc1
s_add_u32 s52, s52, s53
s_branch L_gdone
L_egu_240:
s_lshr_b32 s56, s3, 1
s_lshl_b32 s56, s56, 2
s_mul_i32 s56, s56, s53
s_add_u32 s52, s52, s56
s_and_b32 s56, s3, 1
s_lshl_b32 s56, s56, 12
s_add_u32 s52, s52, s56
s_mov_b32 s58, 0xbdd2d3e8
s_mov_b32 s59, s58
v_mov_b32 v30, 0xc0135761
v_mov_b32 v31, v30
v_pk_mul_f32 v[240:241], v[32:33], v[32:33]
v_pk_mul_f32 v[242:243], v[34:35], v[34:35]
v_pk_mul_f32 v[244:245], v[40:41], v[40:41]
v_pk_mul_f32 v[246:247], v[42:43], v[42:43]
v_pk_fma_f32 v[240:241], v[240:241], s[58:59], v[30:31]
v_pk_fma_f32 v[242:243], v[242:243], s[58:59], v[30:31]
v_pk_fma_f32 v[244:245], v[244:245], s[58:59], v[30:31]
v_pk_fma_f32 v[246:247], v[246:247], s[58:59], v[30:31]
v_pk_mul_f32 v[240:241], v[240:241], v[32:33]
v_pk_mul_f32 v[242:243], v[242:243], v[34:35]
v_pk_mul_f32 v[244:245], v[244:245], v[40:41]
v_pk_mul_f32 v[246:247], v[246:247], v[42:43]
v_exp_f32 v240, v240
v_exp_f32 v241, v241
v_pk_mul_f32 v[32:33], v[32:33], v[64:65]
v_exp_f32 v242, v242
v_exp_f32 v243, v243
v_pk_mul_f32 v[34:35], v[34:35], v[66:67]
v_exp_f32 v244, v244
v_exp_f32 v245, v245
v_pk_mul_f32 v[40:41], v[40:41], v[72:73]
v_exp_f32 v246, v246
v_exp_f32 v247, v247
v_pk_mul_f32 v[42:43], v[42:43], v[74:75]
v_pk_add_f32 v[240:241], v[240:241], 1.0 op_sel_hi:[1,0]
v_pk_add_f32 v[242:243], v[242:243], 1.0 op_sel_hi:[1,0]
v_pk_add_f32 v[244:245], v[244:245], 1.0 op_sel_hi:[1,0]
v_pk_add_f32 v[246:247], v[246:247], 1.0 op_sel_hi:[1,0]
v_rcp_f32 v240, v240
v_rcp_f32 v241, v241
v_rcp_f32 v242, v242
v_rcp_f32 v243, v243
v_rcp_f32 v244, v244
v_rcp_f32 v245, v245
v_rcp_f32 v246, v246
v_rcp_f32 v247, v247
v_pk_mul_f32 v[32:33], v[32:33], v[240:241]
v_pk_mul_f32 v[34:35], v[34:35], v[242:243]
v_pk_mul_f32 v[40:41], v[40:41], v[244:245]
v_pk_mul_f32 v[42:43], v[42:43], v[246:247]
v_cvt_pk_bf16_f32 v64, v32, v33
v_cvt_pk_bf16_f32 v65, v34, v35
v_cvt_pk_bf16_f32 v66, v40, v41
v_cvt_pk_bf16_f32 v67, v42, v43
buffer_store_dwordx4 v[64:67], v18, s[4:7], s52 offen offset:0 sc1
v_pk_mul_f32 v[240:241], v[36:37], v[36:37]
v_pk_mul_f32 v[242:243], v[38:39], v[38:39]
v_pk_mul_f32 v[244:245], v[44:45], v[44:45]
v_pk_mul_f32 v[246:247], v[46:47], v[46:47]
v_pk_fma_f32 v[240:241], v[240:241], s[58:59], v[30:31]
v_pk_fma_f32 v[242:243], v[242:243], s[58:59], v[30:31]
v_pk_fma_f32 v[244:245], v[244:245], s[58:59], v[30:31]
v_pk_fma_f32 v[246:247], v[246:247], s[58:59], v[30:31]
v_pk_mul_f32 v[240:241], v[240:241], v[36:37]
v_pk_mul_f32 v[242:243], v[242:243], v[38:39]
v_pk_mul_f32 v[244:245], v[244:245], v[44:45]
v_pk_mul_f32 v[246:247], v[246:247], v[46:47]
v_exp_f32 v240, v240
v_exp_f32 v241, v241
v_pk_mul_f32 v[36:37], v[36:37], v[68:69]
v_exp_f32 v242, v242
v_exp_f32 v243, v243
v_pk_mul_f32 v[38:39], v[38:39], v[70:71]
v_exp_f32 v244, v244
v_exp_f32 v245, v245
v_pk_mul_f32 v[44:45], v[44:45], v[76:77]
v_exp_f32 v246, v246
v_exp_f32 v247, v247
v_pk_mul_f32 v[46:47], v[46:47], v[78:79]
v_pk_add_f32 v[240:241], v[240:241], 1.0 op_sel_hi:[1,0]
v_pk_add_f32 v[242:243], v[242:243], 1.0 op_sel_hi:[1,0]
v_pk_add_f32 v[244:245], v[244:245], 1.0 op_sel_hi:[1,0]
v_pk_add_f32 v[246:247], v[246:247], 1.0 op_sel_hi:[1,0]
v_rcp_f32 v240, v240
v_rcp_f32 v241, v241
v_rcp_f32 v242, v242
v_rcp_f32 v243, v243
v_rcp_f32 v244, v244
v_rcp_f32 v245, v245
v_rcp_f32 v246, v246
v_rcp_f32 v247, v247
v_pk_mul_f32 v[36:37], v[36:37], v[240:241]
v_pk_mul_f32 v[38:39], v[38:39], v[242:243]
v_pk_mul_f32 v[44:45], v[44:45], v[244:245]
v_pk_mul_f32 v[46:47], v[46:47], v[246:247]
v_cvt_pk_bf16_f32 v68, v36, v37
v_cvt_pk_bf16_f32 v69, v38, v39
v_cvt_pk_bf16_f32 v70, v44, v45
v_cvt_pk_bf16_f32 v71, v46, v47
buffer_store_dwordx4 v[68:71], v18, s[4:7], s52 offen offset:256 sc1
v_pk_mul_f32 v[240:241], v[48:49], v[48:49]
v_pk_mul_f32 v[242:243], v[50:51], v[50:51]
v_pk_mul_f32 v[244:245], v[56:57], v[56:57]
v_pk_mul_f32 v[246:247], v[58:59], v[58:59]
v_pk_fma_f32 v[240:241], v[240:241], s[58:59], v[30:31]
v_pk_fma_f32 v[242:243], v[242:243], s[58:59], v[30:31]
v_pk_fma_f32 v[244:245], v[244:245], s[58:59], v[30:31]
v_pk_fma_f32 v[246:247], v[246:247], s[58:59], v[30:31]
v_pk_mul_f32 v[240:241], v[240:241], v[48:49]
v_pk_mul_f32 v[242:243], v[242:243], v[50:51]
v_pk_mul_f32 v[244:245], v[244:245], v[56:57]
v_pk_mul_f32 v[246:247], v[246:247], v[58:59]
v_exp_f32 v240, v240
v_exp_f32 v241, v241
v_pk_mul_f32 v[48:49], v[48:49], v[80:81]
v_exp_f32 v242, v242
v_exp_f32 v243, v243
v_pk_mul_f32 v[50:51], v[50:51], v[82:83]
v_exp_f32 v244, v244
v_exp_f32 v245, v245
v_pk_mul_f32 v[56:57], v[56:57], v[88:89]
v_exp_f32 v246, v246
v_exp_f32 v247, v247
v_pk_mul_f32 v[58:59], v[58:59], v[90:91]
v_pk_add_f32 v[240:241], v[240:241], 1.0 op_sel_hi:[1,0]
v_pk_add_f32 v[242:243], v[242:243], 1.0 op_sel_hi:[1,0]
v_pk_add_f32 v[244:245], v[244:245], 1.0 op_sel_hi:[1,0]
v_pk_add_f32 v[246:247], v[246:247], 1.0 op_sel_hi:[1,0]
v_rcp_f32 v240, v240
v_rcp_f32 v241, v241
v_rcp_f32 v242, v242
v_rcp_f32 v243, v243
v_rcp_f32 v244, v244
v_rcp_f32 v245, v245
v_rcp_f32 v246, v246
v_rcp_f32 v247, v247
v_pk_mul_f32 v[48:49], v[48:49], v[240:241]
v_pk_mul_f32 v[50:51], v[50:51], v[242:243]
v_pk_mul_f32 v[56:57], v[56:57], v[244:245]
v_pk_mul_f32 v[58:59], v[58:59], v[246:247]
v_cvt_pk_bf16_f32 v80, v48, v49
v_cvt_pk_bf16_f32 v81, v50, v51
v_cvt_pk_bf16_f32 v82, v56, v57
v_cvt_pk_bf16_f32 v83, v58, v59
buffer_store_dwordx4 v[80:83], v18, s[4:7], s52 offen offset:2048 sc1
v_pk_mul_f32 v[240:241], v[52:53], v[52:53]
v_pk_mul_f32 v[242:243], v[54:55], v[54:55]
v_pk_mul_f32 v[244:245], v[60:61], v[60:61]
v_pk_mul_f32 v[246:247], v[62:63], v[62:63]
v_pk_fma_f32 v[240:241], v[240:241], s[58:59], v[30:31]
v_pk_fma_f32 v[242:243], v[242:243], s[58:59], v[30:31]
v_pk_fma_f32 v[244:245], v[244:245], s[58:59], v[30:31]
v_pk_fma_f32 v[246:247], v[246:247], s[58:59], v[30:31]
v_pk_mul_f32 v[240:241], v[240:241], v[52:53]
v_pk_mul_f32 v[242:243], v[242:243], v[54:55]
v_pk_mul_f32 v[244:245], v[244:245], v[60:61]
v_pk_mul_f32 v[246:247], v[246:247], v[62:63]
v_exp_f32 v240, v240
v_exp_f32 v241, v241
v_pk_mul_f32 v[52:53], v[52:53], v[84:85]
v_exp_f32 v242, v242
v_exp_f32 v243, v243
v_pk_mul_f32 v[54:55], v[54:55], v[86:87]
v_exp_f32 v244, v244
v_exp_f32 v245, v245
v_pk_mul_f32 v[60:61], v[60:61], v[92:93]
v_exp_f32 v246, v246
v_exp_f32 v247, v247
v_pk_mul_f32 v[62:63], v[62:63], v[94:95]
v_pk_add_f32 v[240:241], v[240:241], 1.0 op_sel_hi:[1,0]
v_pk_add_f32 v[242:243], v[242:243], 1.0 op_sel_hi:[1,0]
v_pk_add_f32 v[244:245], v[244:245], 1.0 op_sel_hi:[1,0]
v_pk_add_f32 v[246:247], v[246:247], 1.0 op_sel_hi:[1,0]
v_rcp_f32 v240, v240
v_rcp_f32 v241, v241
v_rcp_f32 v242, v242
v_rcp_f32 v243, v243
v_rcp_f32 v244, v244
v_rcp_f32 v245, v245
v_rcp_f32 v246, v246
v_rcp_f32 v247, v247
v_pk_mul_f32 v[52:53], v[52:53], v[240:241]
v_pk_mul_f32 v[54:55], v[54:55], v[242:243]
v_pk_mul_f32 v[60:61], v[60:61], v[244:245]
v_pk_mul_f32 v[62:63], v[62:63], v[246:247]
v_cvt_pk_bf16_f32 v84, v52, v53
v_cvt_pk_bf16_f32 v85, v54, v55
v_cvt_pk_bf16_f32 v86, v60, v61
v_cvt_pk_bf16_f32 v87, v62, v63
buffer_store_dwordx4 v[84:87], v18, s[4:7], s52 offen offset:2304 sc1
s_add_u32 s52, s52, s53
v_pk_mul_f32 v[240:241], v[96:97], v[96:97]
v_pk_mul_f32 v[242:243], v[98:99], v[98:99]
v_pk_mul_f32 v[244:245], v[104:105], v[104:105]
v_pk_mul_f32 v[246:247], v[106:107], v[106:107]
v_pk_fma_f32 v[240:241], v[240:241], s[58:59], v[30:31]
v_pk_fma_f32 v[242:243], v[242:243], s[58:59], v[30:31]
v_pk_fma_f32 v[244:245], v[244:245], s[58:59], v[30:31]
v_pk_fma_f32 v[246:247], v[246:247], s[58:59], v[30:31]
v_pk_mul_f32 v[240:241], v[240:241], v[96:97]
v_pk_mul_f32 v[242:243], v[242:243], v[98:99]
v_pk_mul_f32 v[244:245], v[244:245], v[104:105]
v_pk_mul_f32 v[246:247], v[246:247], v[106:107]
v_exp_f32 v240, v240
v_exp_f32 v241, v241
v_pk_mul_f32 v[96:97], v[96:97], v[128:129]
v_exp_f32 v242, v242
v_exp_f32 v243, v243
v_pk_mul_f32 v[98:99], v[98:99], v[130:131]
v_exp_f32 v244, v244
v_exp_f32 v245, v245
v_pk_mul_f32 v[104:105], v[104:105], v[136:137]
v_exp_f32 v246, v246
v_exp_f32 v247, v247
v_pk_mul_f32 v[106:107], v[106:107], v[138:139]
v_pk_add_f32 v[240:241], v[240:241], 1.0 op_sel_hi:[1,0]
v_pk_add_f32 v[242:243], v[242:243], 1.0 op_sel_hi:[1,0]
v_pk_add_f32 v[244:245], v[244:245], 1.0 op_sel_hi:[1,0]
v_pk_add_f32 v[246:247], v[246:247], 1.0 op_sel_hi:[1,0]
v_rcp_f32 v240, v240
v_rcp_f32 v241, v241
v_rcp_f32 v242, v242
v_rcp_f32 v243, v243
v_rcp_f32 v244, v244
v_rcp_f32 v245, v245
v_rcp_f32 v246, v246
v_rcp_f32 v247, v247
v_pk_mul_f32 v[96:97], v[96:97], v[240:241]
v_pk_mul_f32 v[98:99], v[98:99], v[242:243]
v_pk_mul_f32 v[104:105], v[104:105], v[244:245]
v_pk_mul_f32 v[106:107], v[106:107], v[246:247]
v_cvt_pk_bf16_f32 v128, v96, v97
v_cvt_pk_bf16_f32 v129, v98, v99
v_cvt_pk_bf16_f32 v130, v104, v105
v_cvt_pk_bf16_f32 v131, v106, v107
buffer_store_dwordx4 v[128:131], v18, s[4:7], s52 offen offset:0 sc1
v_pk_mul_f32 v[240:241], v[100:101], v[100:101]
v_pk_mul_f32 v[242:243], v[102:103], v[102:103]
v_pk_mul_f32 v[244:245], v[108:109], v[108:109]
v_pk_mul_f32 v[246:247], v[110:111], v[110:111]
v_pk_fma_f32 v[240:241], v[240:241], s[58:59], v[30:31]
v_pk_fma_f32 v[242:243], v[242:243], s[58:59], v[30:31]
v_pk_fma_f32 v[244:245], v[244:245], s[58:59], v[30:31]
v_pk_fma_f32 v[246:247], v[246:247], s[58:59], v[30:31]
v_pk_mul_f32 v[240:241], v[240:241], v[100:101]
v_pk_mul_f32 v[242:243], v[242:243], v[102:103]
v_pk_mul_f32 v[244:245], v[244:245], v[108:109]
v_pk_mul_f32 v[246:247], v[246:247], v[110:111]
v_exp_f32 v240, v240
v_exp_f32 v241, v241
v_pk_mul_f32 v[100:101], v[100:101], v[132:133]
v_exp_f32 v242, v242
v_exp_f32 v243, v243
v_pk_mul_f32 v[102:103], v[102:103], v[134:135]
v_exp_f32 v244, v244
v_exp_f32 v245, v245
v_pk_mul_f32 v[108:109], v[108:109], v[140:141]
v_exp_f32 v246, v246
v_exp_f32 v247, v247
v_pk_mul_f32 v[110:111], v[110:111], v[142:143]
v_pk_add_f32 v[240:241], v[240:241], 1.0 op_sel_hi:[1,0]
v_pk_add_f32 v[242:243], v[242:243], 1.0 op_sel_hi:[1,0]
v_pk_add_f32 v[244:245], v[244:245], 1.0 op_sel_hi:[1,0]
v_pk_add_f32 v[246:247], v[246:247], 1.0 op_sel_hi:[1,0]
v_rcp_f32 v240, v240
v_rcp_f32 v241, v241
v_rcp_f32 v242, v242
v_rcp_f32 v243, v243
v_rcp_f32 v244, v244
v_rcp_f32 v245, v245
v_rcp_f32 v246, v246
v_rcp_f32 v247, v247
v_pk_mul_f32 v[100:101], v[100:101], v[240:241]
v_pk_mul_f32 v[102:103], v[102:103], v[242:243]
v_pk_mul_f32 v[108:109], v[108:109], v[244:245]
v_pk_mul_f32 v[110:111], v[110:111], v[246:247]
v_cvt_pk_bf16_f32 v132, v100, v101
v_cvt_pk_bf16_f32 v133, v102, v103
v_cvt_pk_bf16_f32 v134, v108, v109
v_cvt_pk_bf16_f32 v135, v110, v111
buffer_store_dwordx4 v[132:135], v18, s[4:7], s52 offen offset:256 sc1
v_pk_mul_f32 v[240:241], v[112:113], v[112:113]
v_pk_mul_f32 v[242:243], v[114:115], v[114:115]
v_pk_mul_f32 v[244:245], v[120:121], v[120:121]
v_pk_mul_f32 v[246:247], v[122:123], v[122:123]
v_pk_fma_f32 v[240:241], v[240:241], s[58:59], v[30:31]
v_pk_fma_f32 v[242:243], v[242:243], s[58:59], v[30:31]
v_pk_fma_f32 v[244:245], v[244:245], s[58:59], v[30:31]
v_pk_fma_f32 v[246:247], v[246:247], s[58:59], v[30:31]
v_pk_mul_f32 v[240:241], v[240:241], v[112:113]
v_pk_mul_f32 v[242:243], v[242:243], v[114:115]
v_pk_mul_f32 v[244:245], v[244:245], v[120:121]
v_pk_mul_f32 v[246:247], v[246:247], v[122:123]
v_exp_f32 v240, v240
v_exp_f32 v241, v241
v_pk_mul_f32 v[112:113], v[112:113], v[144:145]
v_exp_f32 v242, v242
v_exp_f32 v243, v243
v_pk_mul_f32 v[114:115], v[114:115], v[146:147]
v_exp_f32 v244, v244
v_exp_f32 v245, v245
v_pk_mul_f32 v[120:121], v[120:121], v[152:153]
v_exp_f32 v246, v246
v_exp_f32 v247, v247
v_pk_mul_f32 v[122:123], v[122:123], v[154:155]
v_pk_add_f32 v[240:241], v[240:241], 1.0 op_sel_hi:[1,0]
v_pk_add_f32 v[242:243], v[242:243], 1.0 op_sel_hi:[1,0]
v_pk_add_f32 v[244:245], v[244:245], 1.0 op_sel_hi:[1,0]
v_pk_add_f32 v[246:247], v[246:247], 1.0 op_sel_hi:[1,0]
v_rcp_f32 v240, v240
v_rcp_f32 v241, v241
v_rcp_f32 v242, v242
v_rcp_f32 v243, v243
v_rcp_f32 v244, v244
v_rcp_f32 v245, v245
v_rcp_f32 v246, v246
v_rcp_f32 v247, v247
v_pk_mul_f32 v[112:113], v[112:113], v[240:241]
v_pk_mul_f32 v[114:115], v[114:115], v[242:243]
v_pk_mul_f32 v[120:121], v[120:121], v[244:245]
v_pk_mul_f32 v[122:123], v[122:123], v[246:247]
v_cvt_pk_bf16_f32 v144, v112, v113
v_cvt_pk_bf16_f32 v145, v114, v115
v_cvt_pk_bf16_f32 v146, v120, v121
v_cvt_pk_bf16_f32 v147, v122, v123
buffer_store_dwordx4 v[144:147], v18, s[4:7], s52 offen offset:2048 sc1
v_pk_mul_f32 v[240:241], v[116:117], v[116:117]
v_pk_mul_f32 v[242:243], v[118:119], v[118:119]
v_pk_mul_f32 v[244:245], v[124:125], v[124:125]
v_pk_mul_f32 v[246:247], v[126:127], v[126:127]
v_pk_fma_f32 v[240:241], v[240:241], s[58:59], v[30:31]
v_pk_fma_f32 v[242:243], v[242:243], s[58:59], v[30:31]
v_pk_fma_f32 v[244:245], v[244:245], s[58:59], v[30:31]
v_pk_fma_f32 v[246:247], v[246:247], s[58:59], v[30:31]
v_pk_mul_f32 v[240:241], v[240:241], v[116:117]
v_pk_mul_f32 v[242:243], v[242:243], v[118:119]
v_pk_mul_f32 v[244:245], v[244:245], v[124:125]
v_pk_mul_f32 v[246:247], v[246:247], v[126:127]
v_exp_f32 v240, v240
v_exp_f32 v241, v241
v_pk_mul_f32 v[116:117], v[116:117], v[148:149]
v_exp_f32 v242, v242
v_exp_f32 v243, v243
v_pk_mul_f32 v[118:119], v[118:119], v[150:151]
v_exp_f32 v244, v244
v_exp_f32 v245, v245
v_pk_mul_f32 v[124:125], v[124:125], v[156:157]
v_exp_f32 v246, v246
v_exp_f32 v247, v247
v_pk_mul_f32 v[126:127], v[126:127], v[158:159]
v_pk_add_f32 v[240:241], v[240:241], 1.0 op_sel_hi:[1,0]
v_pk_add_f32 v[242:243], v[242:243], 1.0 op_sel_hi:[1,0]
v_pk_add_f32 v[244:245], v[244:245], 1.0 op_sel_hi:[1,0]
v_pk_add_f32 v[246:247], v[246:247], 1.0 op_sel_hi:[1,0]
v_rcp_f32 v240, v240
v_rcp_f32 v241, v241
v_rcp_f32 v242, v242
v_rcp_f32 v243, v243
v_rcp_f32 v244, v244
v_rcp_f32 v245, v245
v_rcp_f32 v246, v246
v_rcp_f32 v247, v247
v_pk_mul_f32 v[116:117], v[116:117], v[240:241]
v_pk_mul_f32 v[118:119], v[118:119], v[242:243]
v_pk_mul_f32 v[124:125], v[124:125], v[244:245]
v_pk_mul_f32 v[126:127], v[126:127], v[246:247]
v_cvt_pk_bf16_f32 v148, v116, v117
v_cvt_pk_bf16_f32 v149, v118, v119
v_cvt_pk_bf16_f32 v150, v124, v125
v_cvt_pk_bf16_f32 v151, v126, v127
buffer_store_dwordx4 v[148:151], v18, s[4:7], s52 offen offset:2304 sc1
s_add_u32 s52, s52, s53
v_pk_mul_f32 v[240:241], v[160:161], v[160:161]
v_pk_mul_f32 v[242:243], v[162:163], v[162:163]
v_pk_mul_f32 v[244:245], v[168:169], v[168:169]
v_pk_mul_f32 v[246:247], v[170:171], v[170:171]
v_pk_fma_f32 v[240:241], v[240:241], s[58:59], v[30:31]
v_pk_fma_f32 v[242:243], v[242:243], s[58:59], v[30:31]
v_pk_fma_f32 v[244:245], v[244:245], s[58:59], v[30:31]
v_pk_fma_f32 v[246:247], v[246:247], s[58:59], v[30:31]
v_pk_mul_f32 v[240:241], v[240:241], v[160:161]
v_pk_mul_f32 v[242:243], v[242:243], v[162:163]
v_pk_mul_f32 v[244:245], v[244:245], v[168:169]
v_pk_mul_f32 v[246:247], v[246:247], v[170:171]
v_exp_f32 v240, v240
v_exp_f32 v241, v241
v_pk_mul_f32 v[160:161], v[160:161], v[192:193]
v_exp_f32 v242, v242
v_exp_f32 v243, v243
v_pk_mul_f32 v[162:163], v[162:163], v[194:195]
v_exp_f32 v244, v244
v_exp_f32 v245, v245
v_pk_mul_f32 v[168:169], v[168:169], v[200:201]
v_exp_f32 v246, v246
v_exp_f32 v247, v247
v_pk_mul_f32 v[170:171], v[170:171], v[202:203]
v_pk_add_f32 v[240:241], v[240:241], 1.0 op_sel_hi:[1,0]
v_pk_add_f32 v[242:243], v[242:243], 1.0 op_sel_hi:[1,0]
v_pk_add_f32 v[244:245], v[244:245], 1.0 op_sel_hi:[1,0]
v_pk_add_f32 v[246:247], v[246:247], 1.0 op_sel_hi:[1,0]
v_rcp_f32 v240, v240
v_rcp_f32 v241, v241
v_rcp_f32 v242, v242
v_rcp_f32 v243, v243
v_rcp_f32 v244, v244
v_rcp_f32 v245, v245
v_rcp_f32 v246, v246
v_rcp_f32 v247, v247
v_pk_mul_f32 v[160:161], v[160:161], v[240:241]
v_pk_mul_f32 v[162:163], v[162:163], v[242:243]
v_pk_mul_f32 v[168:169], v[168:169], v[244:245]
v_pk_mul_f32 v[170:171], v[170:171], v[246:247]
v_cvt_pk_bf16_f32 v192, v160, v161
v_cvt_pk_bf16_f32 v193, v162, v163
v_cvt_pk_bf16_f32 v194, v168, v169
v_cvt_pk_bf16_f32 v195, v170, v171
buffer_store_dwordx4 v[192:195], v18, s[4:7], s52 offen offset:0 sc1
v_pk_mul_f32 v[240:241], v[164:165], v[164:165]
v_pk_mul_f32 v[242:243], v[166:167], v[166:167]
v_pk_mul_f32 v[244:245], v[172:173], v[172:173]
v_pk_mul_f32 v[246:247], v[174:175], v[174:175]
v_pk_fma_f32 v[240:241], v[240:241], s[58:59], v[30:31]
v_pk_fma_f32 v[242:243], v[242:243], s[58:59], v[30:31]
v_pk_fma_f32 v[244:245], v[244:245], s[58:59], v[30:31]
v_pk_fma_f32 v[246:247], v[246:247], s[58:59], v[30:31]
v_pk_mul_f32 v[240:241], v[240:241], v[164:165]
v_pk_mul_f32 v[242:243], v[242:243], v[166:167]
v_pk_mul_f32 v[244:245], v[244:245], v[172:173]
v_pk_mul_f32 v[246:247], v[246:247], v[174:175]
v_exp_f32 v240, v240
v_exp_f32 v241, v241
v_pk_mul_f32 v[164:165], v[164:165], v[196:197]
v_exp_f32 v242, v242
v_exp_f32 v243, v243
v_pk_mul_f32 v[166:167], v[166:167], v[198:199]
v_exp_f32 v244, v244
v_exp_f32 v245, v245
v_pk_mul_f32 v[172:173], v[172:173], v[204:205]
v_exp_f32 v246, v246
v_exp_f32 v247, v247
v_pk_mul_f32 v[174:175], v[174:175], v[206:207]
v_pk_add_f32 v[240:241], v[240:241], 1.0 op_sel_hi:[1,0]
v_pk_add_f32 v[242:243], v[242:243], 1.0 op_sel_hi:[1,0]
v_pk_add_f32 v[244:245], v[244:245], 1.0 op_sel_hi:[1,0]
v_pk_add_f32 v[246:247], v[246:247], 1.0 op_sel_hi:[1,0]
v_rcp_f32 v240, v240
v_rcp_f32 v241, v241
v_rcp_f32 v242, v242
v_rcp_f32 v243, v243
v_rcp_f32 v244, v244
v_rcp_f32 v245, v245
v_rcp_f32 v246, v246
v_rcp_f32 v247, v247
v_pk_mul_f32 v[164:165], v[164:165], v[240:241]
v_pk_mul_f32 v[166:167], v[166:167], v[242:243]
v_pk_mul_f32 v[172:173], v[172:173], v[244:245]
v_pk_mul_f32 v[174:175], v[174:175], v[246:247]
v_cvt_pk_bf16_f32 v196, v164, v165
v_cvt_pk_bf16_f32 v197, v166, v167
v_cvt_pk_bf16_f32 v198, v172, v173
v_cvt_pk_bf16_f32 v199, v174, v175
buffer_store_dwordx4 v[196:199], v18, s[4:7], s52 offen offset:256 sc1
v_pk_mul_f32 v[240:241], v[176:177], v[176:177]
v_pk_mul_f32 v[242:243], v[178:179], v[178:179]
v_pk_mul_f32 v[244:245], v[184:185], v[184:185]
v_pk_mul_f32 v[246:247], v[186:187], v[186:187]
v_pk_fma_f32 v[240:241], v[240:241], s[58:59], v[30:31]
v_pk_fma_f32 v[242:243], v[242:243], s[58:59], v[30:31]
v_pk_fma_f32 v[244:245], v[244:245], s[58:59], v[30:31]
v_pk_fma_f32 v[246:247], v[246:247], s[58:59], v[30:31]
v_pk_mul_f32 v[240:241], v[240:241], v[176:177]
v_pk_mul_f32 v[242:243], v[242:243], v[178:179]
v_pk_mul_f32 v[244:245], v[244:245], v[184:185]
v_pk_mul_f32 v[246:247], v[246:247], v[186:187]
v_exp_f32 v240, v240
v_exp_f32 v241, v241
v_pk_mul_f32 v[176:177], v[176:177], v[208:209]
v_exp_f32 v242, v242
v_exp_f32 v243, v243
v_pk_mul_f32 v[178:179], v[178:179], v[210:211]
v_exp_f32 v244, v244
v_exp_f32 v245, v245
v_pk_mul_f32 v[184:185], v[184:185], v[216:217]
v_exp_f32 v246, v246
v_exp_f32 v247, v247
v_pk_mul_f32 v[186:187], v[186:187], v[218:219]
v_pk_add_f32 v[240:241], v[240:241], 1.0 op_sel_hi:[1,0]
v_pk_add_f32 v[242:243], v[242:243], 1.0 op_sel_hi:[1,0]
v_pk_add_f32 v[244:245], v[244:245], 1.0 op_sel_hi:[1,0]
v_pk_add_f32 v[246:247], v[246:247], 1.0 op_sel_hi:[1,0]
v_rcp_f32 v240, v240
v_rcp_f32 v241, v241
v_rcp_f32 v242, v242
v_rcp_f32 v243, v243
v_rcp_f32 v244, v244
v_rcp_f32 v245, v245
v_rcp_f32 v246, v246
v_rcp_f32 v247, v247
v_pk_mul_f32 v[176:177], v[176:177], v[240:241]
v_pk_mul_f32 v[178:179], v[178:179], v[242:243]
v_pk_mul_f32 v[184:185], v[184:185], v[244:245]
v_pk_mul_f32 v[186:187], v[186:187], v[246:247]
v_cvt_pk_bf16_f32 v208, v176, v177
v_cvt_pk_bf16_f32 v209, v178, v179
v_cvt_pk_bf16_f32 v210, v184, v185
v_cvt_pk_bf16_f32 v211, v186, v187
buffer_store_dwordx4 v[208:211], v18, s[4:7], s52 offen offset:2048 sc1
v_pk_mul_f32 v[240:241], v[180:181], v[180:181]
v_pk_mul_f32 v[242:243], v[182:183], v[182:183]
v_pk_mul_f32 v[244:245], v[188:189], v[188:189]
v_pk_mul_f32 v[246:247], v[190:191], v[190:191]
v_pk_fma_f32 v[240:241], v[240:241], s[58:59], v[30:31]
v_pk_fma_f32 v[242:243], v[242:243], s[58:59], v[30:31]
v_pk_fma_f32 v[244:245], v[244:245], s[58:59], v[30:31]
v_pk_fma_f32 v[246:247], v[246:247], s[58:59], v[30:31]
v_pk_mul_f32 v[240:241], v[240:241], v[180:181]
v_pk_mul_f32 v[242:243], v[242:243], v[182:183]
v_pk_mul_f32 v[244:245], v[244:245], v[188:189]
v_pk_mul_f32 v[246:247], v[246:247], v[190:191]
v_exp_f32 v240, v240
v_exp_f32 v241, v241
v_pk_mul_f32 v[180:181], v[180:181], v[212:213]
v_exp_f32 v242, v242
v_exp_f32 v243, v243
v_pk_mul_f32 v[182:183], v[182:183], v[214:215]
v_exp_f32 v244, v244
v_exp_f32 v245, v245
v_pk_mul_f32 v[188:189], v[188:189], v[220:221]
v_exp_f32 v246, v246
v_exp_f32 v247, v247
v_pk_mul_f32 v[190:191], v[190:191], v[222:223]
v_pk_add_f32 v[240:241], v[240:241], 1.0 op_sel_hi:[1,0]
v_pk_add_f32 v[242:243], v[242:243], 1.0 op_sel_hi:[1,0]
v_pk_add_f32 v[244:245], v[244:245], 1.0 op_sel_hi:[1,0]
v_pk_add_f32 v[246:247], v[246:247], 1.0 op_sel_hi:[1,0]
v_rcp_f32 v240, v240
v_rcp_f32 v241, v241
v_rcp_f32 v242, v242
v_rcp_f32 v243, v243
v_rcp_f32 v244, v244
v_rcp_f32 v245, v245
v_rcp_f32 v246, v246
v_rcp_f32 v247, v247
v_pk_mul_f32 v[180:181], v[180:181], v[240:241]
v_pk_mul_f32 v[182:183], v[182:183], v[242:243]
v_pk_mul_f32 v[188:189], v[188:189], v[244:245]
v_pk_mul_f32 v[190:191], v[190:191], v[246:247]
v_cvt_pk_bf16_f32 v212, v180, v181
v_cvt_pk_bf16_f32 v213, v182, v183
v_cvt_pk_bf16_f32 v214, v188, v189
v_cvt_pk_bf16_f32 v215, v190, v191
buffer_store_dwordx4 v[212:215], v18, s[4:7], s52 offen offset:2304 sc1
s_add_u32 s52, s52, s53
v_accvgpr_read_b32 v32, a144
v_accvgpr_read_b32 v33, a145
v_accvgpr_read_b32 v34, a146
v_accvgpr_read_b32 v35, a147
v_accvgpr_read_b32 v36, a152
v_accvgpr_read_b32 v37, a153
v_accvgpr_read_b32 v38, a154
v_accvgpr_read_b32 v39, a155
v_pk_mul_f32 v[240:241], v[224:225], v[224:225]
v_pk_mul_f32 v[242:243], v[226:227], v[226:227]
v_pk_mul_f32 v[244:245], v[232:233], v[232:233]
v_pk_mul_f32 v[246:247], v[234:235], v[234:235]
v_pk_fma_f32 v[240:241], v[240:241], s[58:59], v[30:31]
v_pk_fma_f32 v[242:243], v[242:243], s[58:59], v[30:31]
v_pk_fma_f32 v[244:245], v[244:245], s[58:59], v[30:31]
v_pk_fma_f32 v[246:247], v[246:247], s[58:59], v[30:31]
v_pk_mul_f32 v[240:241], v[240:241], v[224:225]
v_pk_mul_f32 v[242:243], v[242:243], v[226:227]
v_pk_mul_f32 v[244:245], v[244:245], v[232:233]
v_pk_mul_f32 v[246:247], v[246:247], v[234:235]
v_exp_f32 v240, v240
v_exp_f32 v241, v241
v_pk_mul_f32 v[224:225], v[224:225], v[32:33]
v_exp_f32 v242, v242
v_exp_f32 v243, v243
v_pk_mul_f32 v[226:227], v[226:227], v[34:35]
v_exp_f32 v244, v244
v_exp_f32 v245, v245
v_pk_mul_f32 v[232:233], v[232:233], v[36:37]
v_exp_f32 v246, v246
v_exp_f32 v247, v247
v_pk_mul_f32 v[234:235], v[234:235], v[38:39]
v_pk_add_f32 v[240:241], v[240:241], 1.0 op_sel_hi:[1,0]
v_pk_add_f32 v[242:243], v[242:243], 1.0 op_sel_hi:[1,0]
v_pk_add_f32 v[244:245], v[244:245], 1.0 op_sel_hi:[1,0]
v_pk_add_f32 v[246:247], v[246:247], 1.0 op_sel_hi:[1,0]
v_rcp_f32 v240, v240
v_rcp_f32 v241, v241
v_rcp_f32 v242, v242
v_rcp_f32 v243, v243
v_rcp_f32 v244, v244
v_rcp_f32 v245, v245
v_rcp_f32 v246, v246
v_rcp_f32 v247, v247
v_pk_mul_f32 v[224:225], v[224:225], v[240:241]
v_pk_mul_f32 v[226:227], v[226:227], v[242:243]
v_pk_mul_f32 v[232:233], v[232:233], v[244:245]
v_pk_mul_f32 v[234:235], v[234:235], v[246:247]
v_cvt_pk_bf16_f32 v32, v224, v225
v_cvt_pk_bf16_f32 v33, v226, v227
v_cvt_pk_bf16_f32 v34, v232, v233
v_cvt_pk_bf16_f32 v35, v234, v235
buffer_store_dwordx4 v[32:35], v18, s[4:7], s52 offen offset:0 sc1
v_accvgpr_read_b32 v40, a148
v_accvgpr_read_b32 v41, a149
v_accvgpr_read_b32 v42, a150
v_accvgpr_read_b32 v43, a151
v_accvgpr_read_b32 v44, a156
v_accvgpr_read_b32 v45, a157
v_accvgpr_read_b32 v46, a158
v_accvgpr_read_b32 v47, a159
v_pk_mul_f32 v[240:241], v[228:229], v[228:229]
v_pk_mul_f32 v[242:243], v[230:231], v[230:231]
v_pk_mul_f32 v[244:245], v[236:237], v[236:237]
v_pk_mul_f32 v[246:247], v[238:239], v[238:239]
v_pk_fma_f32 v[240:241], v[240:241], s[58:59], v[30:31]
v_pk_fma_f32 v[242:243], v[242:243], s[58:59], v[30:31]
v_pk_fma_f32 v[244:245], v[244:245], s[58:59], v[30:31]
v_pk_fma_f32 v[246:247], v[246:247], s[58:59], v[30:31]
v_pk_mul_f32 v[240:241], v[240:241], v[228:229]
v_pk_mul_f32 v[242:243], v[242:243], v[230:231]
v_pk_mul_f32 v[244:245], v[244:245], v[236:237]
v_pk_mul_f32 v[246:247], v[246:247], v[238:239]
v_exp_f32 v240, v240
v_exp_f32 v241, v241
v_pk_mul_f32 v[228:229], v[228:229], v[40:41]
v_exp_f32 v242, v242
v_exp_f32 v243, v243
v_pk_mul_f32 v[230:231], v[230:231], v[42:43]
v_exp_f32 v244, v244
v_exp_f32 v245, v245
v_pk_mul_f32 v[236:237], v[236:237], v[44:45]
v_exp_f32 v246, v246
v_exp_f32 v247, v247
v_pk_mul_f32 v[238:239], v[238:239], v[46:47]
v_pk_add_f32 v[240:241], v[240:241], 1.0 op_sel_hi:[1,0]
v_pk_add_f32 v[242:243], v[242:243], 1.0 op_sel_hi:[1,0]
v_pk_add_f32 v[244:245], v[244:245], 1.0 op_sel_hi:[1,0]
v_pk_add_f32 v[246:247], v[246:247], 1.0 op_sel_hi:[1,0]
v_rcp_f32 v240, v240
v_rcp_f32 v241, v241
v_rcp_f32 v242, v242
v_rcp_f32 v243, v243
v_rcp_f32 v244, v244
v_rcp_f32 v245, v245
v_rcp_f32 v246, v246
v_rcp_f32 v247, v247
v_pk_mul_f32 v[228:229], v[228:229], v[240:241]
v_pk_mul_f32 v[230:231], v[230:231], v[242:243]
v_pk_mul_f32 v[236:237], v[236:237], v[244:245]
v_pk_mul_f32 v[238:239], v[238:239], v[246:247]
v_cvt_pk_bf16_f32 v40, v228, v229
v_cvt_pk_bf16_f32 v41, v230, v231
v_cvt_pk_bf16_f32 v42, v236, v237
v_cvt_pk_bf16_f32 v43, v238, v239
buffer_store_dwordx4 v[40:43], v18, s[4:7], s52 offen offset:256 sc1
v_accvgpr_read_b32 v48, a128
v_accvgpr_read_b32 v49, a129
v_accvgpr_read_b32 v50, a130
v_accvgpr_read_b32 v51, a131
v_accvgpr_read_b32 v52, a136
v_accvgpr_read_b32 v53, a137
v_accvgpr_read_b32 v54, a138
v_accvgpr_read_b32 v55, a139
v_accvgpr_read_b32 v56, a160
v_accvgpr_read_b32 v57, a161
v_accvgpr_read_b32 v58, a162
v_accvgpr_read_b32 v59, a163
v_accvgpr_read_b32 v60, a168
v_accvgpr_read_b32 v61, a169
v_accvgpr_read_b32 v62, a170
v_accvgpr_read_b32 v63, a171
v_pk_mul_f32 v[240:241], v[48:49], v[48:49]
v_pk_mul_f32 v[242:243], v[50:51], v[50:51]
v_pk_mul_f32 v[244:245], v[52:53], v[52:53]
v_pk_mul_f32 v[246:247], v[54:55], v[54:55]
v_pk_fma_f32 v[240:241], v[240:241], s[58:59], v[30:31]
v_pk_fma_f32 v[242:243], v[242:243], s[58:59], v[30:31]
v_pk_fma_f32 v[244:245], v[244:245], s[58:59], v[30:31]
v_pk_fma_f32 v[246:247], v[246:247], s[58:59], v[30:31]
v_pk_mul_f32 v[240:241], v[240:241], v[48:49]
v_pk_mul_f32 v[242:243], v[242:243], v[50:51]
v_pk_mul_f32 v[244:245], v[244:245], v[52:53]
v_pk_mul_f32 v[246:247], v[246:247], v[54:55]
v_exp_f32 v240, v240
v_exp_f32 v241, v241
v_pk_mul_f32 v[48:49], v[48:49], v[56:57]
v_exp_f32 v242, v242
v_exp_f32 v243, v243
v_pk_mul_f32 v[50:51], v[50:51], v[58:59]
v_exp_f32 v244, v244
v_exp_f32 v245, v245
v_pk_mul_f32 v[52:53], v[52:53], v[60:61]
v_exp_f32 v246, v246
v_exp_f32 v247, v247
v_pk_mul_f32 v[54:55], v[54:55], v[62:63]
v_pk_add_f32 v[240:241], v[240:241], 1.0 op_sel_hi:[1,0]
v_pk_add_f32 v[242:243], v[242:243], 1.0 op_sel_hi:[1,0]
v_pk_add_f32 v[244:245], v[244:245], 1.0 op_sel_hi:[1,0]
v_pk_add_f32 v[246:247], v[246:247], 1.0 op_sel_hi:[1,0]
v_rcp_f32 v240, v240
v_rcp_f32 v241, v241
v_rcp_f32 v242, v242
v_rcp_f32 v243, v243
v_rcp_f32 v244, v244
v_rcp_f32 v245, v245
v_rcp_f32 v246, v246
v_rcp_f32 v247, v247
v_pk_mul_f32 v[48:49], v[48:49], v[240:241]
v_pk_mul_f32 v[50:51], v[50:51], v[242:243]
v_pk_mul_f32 v[52:53], v[52:53], v[244:245]
v_pk_mul_f32 v[54:55], v[54:55], v[246:247]
v_cvt_pk_bf16_f32 v56, v48, v49
v_cvt_pk_bf16_f32 v57, v50, v51
v_cvt_pk_bf16_f32 v58, v52, v53
v_cvt_pk_bf16_f32 v59, v54, v55
buffer_store_dwordx4 v[56:59], v18, s[4:7], s52 offen offset:2048 sc1
v_accvgpr_read_b32 v64, a132
v_accvgpr_read_b32 v65, a133
v_accvgpr_read_b32 v66, a134
v_accvgpr_read_b32 v67, a135
v_accvgpr_read_b32 v68, a140
v_accvgpr_read_b32 v69, a141
v_accvgpr_read_b32 v70, a142
v_accvgpr_read_b32 v71, a143
v_accvgpr_read_b32 v72, a164
v_accvgpr_read_b32 v73, a165
v_accvgpr_read_b32 v74, a166
v_accvgpr_read_b32 v75, a167
v_accvgpr_read_b32 v76, a172
v_accvgpr_read_b32 v77, a173
v_accvgpr_read_b32 v78, a174
v_accvgpr_read_b32 v79, a175
v_pk_mul_f32 v[240:241], v[64:65], v[64:65]
v_pk_mul_f32 v[242:243], v[66:67], v[66:67]
v_pk_mul_f32 v[244:245], v[68:69], v[68:69]
v_pk_mul_f32 v[246:247], v[70:71], v[70:71]
v_pk_fma_f32 v[240:241], v[240:241], s[58:59], v[30:31]
v_pk_fma_f32 v[242:243], v[242:243], s[58:59], v[30:31]
v_pk_fma_f32 v[244:245], v[244:245], s[58:59], v[30:31]
v_pk_fma_f32 v[246:247], v[246:247], s[58:59], v[30:31]
v_pk_mul_f32 v[240:241], v[240:241], v[64:65]
v_pk_mul_f32 v[242:243], v[242:243], v[66:67]
v_pk_mul_f32 v[244:245], v[244:245], v[68:69]
v_pk_mul_f32 v[246:247], v[246:247], v[70:71]
v_exp_f32 v240, v240
v_exp_f32 v241, v241
v_pk_mul_f32 v[64:65], v[64:65], v[72:73]
v_exp_f32 v242, v242
v_exp_f32 v243, v243
v_pk_mul_f32 v[66:67], v[66:67], v[74:75]
v_exp_f32 v244, v244
v_exp_f32 v245, v245
v_pk_mul_f32 v[68:69], v[68:69], v[76:77]
v_exp_f32 v246, v246
v_exp_f32 v247, v247
v_pk_mul_f32 v[70:71], v[70:71], v[78:79]
v_pk_add_f32 v[240:241], v[240:241], 1.0 op_sel_hi:[1,0]
v_pk_add_f32 v[242:243], v[242:243], 1.0 op_sel_hi:[1,0]
v_pk_add_f32 v[244:245], v[244:245], 1.0 op_sel_hi:[1,0]
v_pk_add_f32 v[246:247], v[246:247], 1.0 op_sel_hi:[1,0]
v_rcp_f32 v240, v240
v_rcp_f32 v241, v241
v_rcp_f32 v242, v242
v_rcp_f32 v243, v243
v_rcp_f32 v244, v244
v_rcp_f32 v245, v245
v_rcp_f32 v246, v246
v_rcp_f32 v247, v247
v_pk_mul_f32 v[64:65], v[64:65], v[240:241]
v_pk_mul_f32 v[66:67], v[66:67], v[242:243]
v_pk_mul_f32 v[68:69], v[68:69], v[244:245]
v_pk_mul_f32 v[70:71], v[70:71], v[246:247]
v_cvt_pk_bf16_f32 v72, v64, v65
v_cvt_pk_bf16_f32 v73, v66, v67
v_cvt_pk_bf16_f32 v74, v68, v69
v_cvt_pk_bf16_f32 v75, v70, v71
buffer_store_dwordx4 v[72:75], v18, s[4:7], s52 offen offset:2304 sc1
s_add_u32 s52, s52, s53
s_branch L_gdone
L_mv_237:
s_cmp_eq_u32 s96, 1
s_cbranch_scc1 L_w1_6269
s_cmp_eq_u32 s96, 2
s_cbranch_scc1 L_w2_6270
s_cmp_eq_u32 s96, 3
s_cbranch_scc1 L_w3_6271
s_waitcnt vmcnt(12)
s_branch L_wg_6272
L_w1_6269:
s_waitcnt vmcnt(16)
s_branch L_wg_6272
L_w2_6270:
s_waitcnt vmcnt(32)
s_branch L_wg_6272
L_w3_6271:
s_waitcnt vmcnt(63)
L_wg_6272:
s_barrier
ds_read_b64_tr_b16 a[32:33], v10 offset:0
ds_read_b64_tr_b16 a[34:35], v10 offset:2048
ds_read_b128 a[0:3], v8 offset:0
ds_read_b128 a[4:7], v8 offset:256
ds_read_b128 a[8:11], v8 offset:2048
ds_read_b128 a[12:15], v8 offset:2304
ds_read_b128 a[16:19], v8 offset:4096
ds_read_b128 a[20:23], v8 offset:4352
ds_read_b128 a[24:27], v8 offset:6144
ds_read_b128 a[28:31], v8 offset:6400
ds_read_b64_tr_b16 a[36:37], v12 offset:0
ds_read_b64_tr_b16 a[38:39], v12 offset:2048
ds_read_b64_tr_b16 a[40:41], v14 offset:0
ds_read_b64_tr_b16 a[42:43], v14 offset:2048
ds_read_b64_tr_b16 a[44:45], v16 offset:0
ds_read_b64_tr_b16 a[46:47], v16 offset:2048
ds_read_b64_tr_b16 a[48:49], v10 offset:8192
ds_read_b64_tr_b16 a[50:51], v10 offset:10240
ds_read_b64_tr_b16 a[52:53], v12 offset:8192
ds_read_b64_tr_b16 a[54:55], v12 offset:10240
ds_read_b64_tr_b16 a[56:57], v14 offset:8192
ds_read_b64_tr_b16 a[58:59], v14 offset:10240
ds_read_b64_tr_b16 a[60:61], v16 offset:8192
ds_read_b64_tr_b16 a[62:63], v16 offset:10240
s_waitcnt lgkmcnt(0)
v_mfma_f32_16x16x32_bf16 v[32:35], a[0:3], a[32:35], 0
s_cmp_lg_u32 s96, 0
s_cbranch_scc1 L_cw_7273
s_waitcnt vmcnt(8)
L_cw_7273:
s_barrier
v_mfma_f32_16x16x32_bf16 v[36:39], a[4:7], a[32:35], 0
v_mfma_f32_16x16x32_bf16 v[96:99], a[8:11], a[32:35], 0
ds_read_b64_tr_b16 a[96:97], v10 offset:32768
v_mfma_f32_16x16x32_bf16 v[100:103], a[12:15], a[32:35], 0
s_add_u32 m0, s55, 0
s_nop 0
buffer_load_dwordx4 v2, s[4:7], s48 offen sc1 lds
v_mfma_f32_16x16x32_bf16 v[160:163], a[16:19], a[32:35], 0
ds_read_b64_tr_b16 a[98:99], v10 offset:34816
v_mfma_f32_16x16x32_bf16 v[164:167], a[20:23], a[32:35], 0
v_mfma_f32_16x16x32_bf16 v[224:227], a[24:27], a[32:35], 0
ds_read_b128 a[64:67], v8 offset:32768
v_mfma_f32_16x16x32_bf16 v[228:231], a[28:31], a[32:35], 0
buffer_load_dwordx4 v2, s[4:7], s48 offen offset:1024 sc1 lds
v_mfma_f32_16x16x32_bf16 v[40:43], a[0:3], a[36:39], 0
ds_read_b128 a[68:71], v8 offset:33024
v_mfma_f32_16x16x32_bf16 v[44:47], a[4:7], a[36:39], 0
v_mfma_f32_16x16x32_bf16 v[104:107], a[8:11], a[36:39], 0
ds_read_b128 a[72:75], v8 offset:34816
v_mfma_f32_16x16x32_bf16 v[108:111], a[12:15], a[36:39], 0
buffer_load_dwordx4 v3, s[4:7], s48 offen offset:2048 sc1 lds
v_mfma_f32_16x16x32_bf16 v[168:171], a[16:19], a[36:39], 0
ds_read_b128 a[76:79], v8 offset:35072
v_mfma_f32_16x16x32_bf16 v[172:175], a[20:23], a[36:39], 0
v_mfma_f32_16x16x32_bf16 v[232:235], a[24:27], a[36:39], 0
ds_read_b128 a[80:83], v8 offset:36864
v_mfma_f32_16x16x32_bf16 v[236:239], a[28:31], a[36:39], 0
buffer_load_dwordx4 v3, s[4:7], s48 offen offset:3072 sc1 lds
s_add_u32 s48, s48, 2048
v_mfma_f32_16x16x32_bf16 v[48:51], a[0:3], a[40:43], 0
ds_read_b128 a[84:87], v8 offset:37120
v_mfma_f32_16x16x32_bf16 v[52:55], a[4:7], a[40:43], 0
v_mfma_f32_16x16x32_bf16 v[112:115], a[8:11], a[40:43], 0
ds_read_b128 a[88:91], v8 offset:38912
v_mfma_f32_16x16x32_bf16 v[116:119], a[12:15], a[40:43], 0
s_add_u32 m0, s54, 16384
s_nop 0
buffer_load_dwordx4 v4, s[8:11], s49 offen lds
v_mfma_f32_16x16x32_bf16 v[176:179], a[16:19], a[40:43], 0
ds_read_b128 a[92:95], v8 offset:39168
v_mfma_f32_16x16x32_bf16 v[180:183], a[20:23], a[40:43], 0
v_mfma_f32_16x16x32_bf16 a[128:131], a[24:27], a[40:43], 0
ds_read_b64_tr_b16 a[100:101], v12 offset:32768
v_mfma_f32_16x16x32_bf16 a[132:135], a[28:31], a[40:43], 0
buffer_load_dwordx4 v5, s[8:11], s49 offen offset:1024 lds
v_mfma_f32_16x16x32_bf16 v[56:59], a[0:3], a[44:47], 0
ds_read_b64_tr_b16 a[102:103], v12 offset:34816
v_mfma_f32_16x16x32_bf16 v[60:63], a[4:7], a[44:47], 0
v_mfma_f32_16x16x32_bf16 v[120:123], a[8:11], a[44:47], 0
ds_read_b64_tr_b16 a[104:105], v14 offset:32768
v_mfma_f32_16x16x32_bf16 v[124:127], a[12:15], a[44:47], 0
buffer_load_dwordx4 v6, s[8:11], s49 offen offset:2048 lds
v_mfma_f32_16x16x32_bf16 v[184:187], a[16:19], a[44:47], 0
ds_read_b64_tr_b16 a[106:107], v14 offset:34816
v_mfma_f32_16x16x32_bf16 v[188:191], a[20:23], a[44:47], 0
v_mfma_f32_16x16x32_bf16 a[136:139], a[24:27], a[44:47], 0
ds_read_b64_tr_b16 a[108:109], v16 offset:32768
v_mfma_f32_16x16x32_bf16 a[140:143], a[28:31], a[44:47], 0
buffer_load_dwordx4 v7, s[8:11], s49 offen offset:3072 lds
s_add_u32 s49, s49, s50
v_mfma_f32_16x16x32_bf16 v[64:67], a[0:3], a[48:51], 0
ds_read_b64_tr_b16 a[110:111], v16 offset:34816
v_mfma_f32_16x16x32_bf16 v[68:71], a[4:7], a[48:51], 0
v_mfma_f32_16x16x32_bf16 v[128:131], a[8:11], a[48:51], 0
ds_read_b64_tr_b16 a[112:113], v10 offset:40960
v_mfma_f32_16x16x32_bf16 v[132:135], a[12:15], a[48:51], 0
v_mfma_f32_16x16x32_bf16 v[192:195], a[16:19], a[48:51], 0
ds_read_b64_tr_b16 a[114:115], v10 offset:43008
v_mfma_f32_16x16x32_bf16 v[196:199], a[20:23], a[48:51], 0
v_mfma_f32_16x16x32_bf16 a[144:147], a[24:27], a[48:51], 0
ds_read_b64_tr_b16 a[116:117], v12 offset:40960
v_mfma_f32_16x16x32_bf16 a[148:151], a[28:31], a[48:51], 0
v_mfma_f32_16x16x32_bf16 v[72:75], a[0:3], a[52:55], 0
ds_read_b64_tr_b16 a[118:119], v12 offset:43008
v_mfma_f32_16x16x32_bf16 v[76:79], a[4:7], a[52:55], 0
v_mfma_f32_16x16x32_bf16 v[136:139], a[8:11], a[52:55], 0
ds_read_b64_tr_b16 a[120:121], v14 offset:40960
v_mfma_f32_16x16x32_bf16 v[140:143], a[12:15], a[52:55], 0
v_mfma_f32_16x16x32_bf16 v[200:203], a[16:19], a[52:55], 0
ds_read_b64_tr_b16 a[122:123], v14 offset:43008
v_mfma_f32_16x16x32_bf16 v[204:207], a[20:23], a[52:55], 0
v_mfma_f32_16x16x32_bf16 a[152:155], a[24:27], a[52:55], 0
ds_read_b64_tr_b16 a[124:125], v16 offset:40960
v_mfma_f32_16x16x32_bf16 a[156:159], a[28:31], a[52:55], 0
v_mfma_f32_16x16x32_bf16 v[80:83], a[0:3], a[56:59], 0
ds_read_b64_tr_b16 a[126:127], v16 offset:43008
v_mfma_f32_16x16x32_bf16 v[84:87], a[4:7], a[56:59], 0
v_mfma_f32_16x16x32_bf16 v[144:147], a[8:11], a[56:59], 0
v_mfma_f32_16x16x32_bf16 v[148:151], a[12:15], a[56:59], 0
v_mfma_f32_16x16x32_bf16 v[208:211], a[16:19], a[56:59], 0
v_mfma_f32_16x16x32_bf16 v[212:215], a[20:23], a[56:59], 0
v_mfma_f32_16x16x32_bf16 a[160:163], a[24:27], a[56:59], 0
v_mfma_f32_16x16x32_bf16 a[164:167], a[28:31], a[56:59], 0
v_mfma_f32_16x16x32_bf16 v[88:91], a[0:3], a[60:63], 0
v_mfma_f32_16x16x32_bf16 v[92:95], a[4:7], a[60:63], 0
v_mfma_f32_16x16x32_bf16 v[152:155], a[8:11], a[60:63], 0
v_mfma_f32_16x16x32_bf16 v[156:159], a[12:15], a[60:63], 0
v_mfma_f32_16x16x32_bf16 v[216:219], a[16:19], a[60:63], 0
v_mfma_f32_16x16x32_bf16 v[220:223], a[20:23], a[60:63], 0
v_mfma_f32_16x16x32_bf16 a[168:171], a[24:27], a[60:63], 0
v_mfma_f32_16x16x32_bf16 a[172:175], a[28:31], a[60:63], 0
s_waitcnt lgkmcnt(0)
v_mfma_f32_16x16x32_bf16 v[32:35], a[64:67], a[96:99], v[32:35]
s_cmp_lg_u32 s96, 0
s_cbranch_scc1 L_cw_8274
s_waitcnt vmcnt(12)
L_cw_8274:
s_barrier
v_mfma_f32_16x16x32_bf16 v[36:39], a[68:71], a[96:99], v[36:39]
v_mfma_f32_16x16x32_bf16 v[96:99], a[72:75], a[96:99], v[96:99]
ds_read_b64_tr_b16 a[32:33], v11 offset:0
v_mfma_f32_16x16x32_bf16 v[100:103], a[76:79], a[96:99], v[100:103]
s_add_u32 m0, s55, 32768
s_nop 0
buffer_load_dwordx4 v2, s[4:7], s48 offen sc1 lds
v_mfma_f32_16x16x32_bf16 v[160:163], a[80:83], a[96:99], v[160:163]
ds_read_b64_tr_b16 a[34:35], v11 offset:2048
v_mfma_f32_16x16x32_bf16 v[164:167], a[84:87], a[96:99], v[164:167]
v_mfma_f32_16x16x32_bf16 v[224:227], a[88:91], a[96:99], v[224:227]
ds_read_b128 a[0:3], v9 offset:0
v_mfma_f32_16x16x32_bf16 v[228:231], a[92:95], a[96:99], v[228:231]
buffer_load_dwordx4 v2, s[4:7], s48 offen offset:1024 sc1 lds
v_mfma_f32_16x16x32_bf16 v[40:43], a[64:67], a[100:103], v[40:43]
ds_read_b128 a[4:7], v9 offset:256
v_mfma_f32_16x16x32_bf16 v[44:47], a[68:71], a[100:103], v[44:47]
v_mfma_f32_16x16x32_bf16 v[104:107], a[72:75], a[100:103], v[104:107]
ds_read_b128 a[8:11], v9 offset:2048
v_mfma_f32_16x16x32_bf16 v[108:111], a[76:79], a[100:103], v[108:111]
buffer_load_dwordx4 v3, s[4:7], s48 offen offset:2048 sc1 lds
v_mfma_f32_16x16x32_bf16 v[168:171], a[80:83], a[100:103], v[168:171]
ds_read_b128 a[12:15], v9 offset:2304
v_mfma_f32_16x16x32_bf16 v[172:175], a[84:87], a[100:103], v[172:175]
v_mfma_f32_16x16x32_bf16 v[232:235], a[88:91], a[100:103], v[232:235]
ds_read_b128 a[16:19], v9 offset:4096
v_mfma_f32_16x16x32_bf16 v[236:239], a[92:95], a[100:103], v[236:239]
buffer_load_dwordx4 v3, s[4:7], s48 offen offset:3072 sc1 lds
s_add_u32 s48, s48, 2048
v_mfma_f32_16x16x32_bf16 v[48:51], a[64:67], a[104:107], v[48:51]
ds_read_b128 a[20:23], v9 offset:4352
v_mfma_f32_16x16x32_bf16 v[52:55], a[68:71], a[104:107], v[52:55]
v_mfma_f32_16x16x32_bf16 v[112:115], a[72:75], a[104:107], v[112:115]
ds_read_b128 a[24:27], v9 offset:6144
v_mfma_f32_16x16x32_bf16 v[116:119], a[76:79], a[104:107], v[116:119]
s_add_u32 m0, s54, 49152
s_nop 0
buffer_load_dwordx4 v4, s[8:11], s49 offen lds
v_mfma_f32_16x16x32_bf16 v[176:179], a[80:83], a[104:107], v[176:179]
ds_read_b128 a[28:31], v9 offset:6400
v_mfma_f32_16x16x32_bf16 v[180:183], a[84:87], a[104:107], v[180:183]
v_mfma_f32_16x16x32_bf16 a[128:131], a[88:91], a[104:107], a[128:131]
ds_read_b64_tr_b16 a[36:37], v13 offset:0
v_mfma_f32_16x16x32_bf16 a[132:135], a[92:95], a[104:107], a[132:135]
buffer_load_dwordx4 v5, s[8:11], s49 offen offset:1024 lds
v_mfma_f32_16x16x32_bf16 v[56:59], a[64:67], a[108:111], v[56:59]
ds_read_b64_tr_b16 a[38:39], v13 offset:2048
v_mfma_f32_16x16x32_bf16 v[60:63], a[68:71], a[108:111], v[60:63]
v_mfma_f32_16x16x32_bf16 v[120:123], a[72:75], a[108:111], v[120:123]
ds_read_b64_tr_b16 a[40:41], v15 offset:0
v_mfma_f32_16x16x32_bf16 v[124:127], a[76:79], a[108:111], v[124:127]
buffer_load_dwordx4 v6, s[8:11], s49 offen offset:2048 lds
v_mfma_f32_16x16x32_bf16 v[184:187], a[80:83], a[108:111], v[184:187]
ds_read_b64_tr_b16 a[42:43], v15 offset:2048
v_mfma_f32_16x16x32_bf16 v[188:191], a[84:87], a[108:111], v[188:191]
v_mfma_f32_16x16x32_bf16 a[136:139], a[88:91], a[108:111], a[136:139]
ds_read_b64_tr_b16 a[44:45], v17 offset:0
v_mfma_f32_16x16x32_bf16 a[140:143], a[92:95], a[108:111], a[140:143]
buffer_load_dwordx4 v7, s[8:11], s49 offen offset:3072 lds
s_add_u32 s49, s49, s50
v_mfma_f32_16x16x32_bf16 v[64:67], a[64:67], a[112:115], v[64:67]
ds_read_b64_tr_b16 a[46:47], v17 offset:2048
v_mfma_f32_16x16x32_bf16 v[68:71], a[68:71], a[112:115], v[68:71]
v_mfma_f32_16x16x32_bf16 v[128:131], a[72:75], a[112:115], v[128:131]
ds_read_b64_tr_b16 a[48:49], v11 offset:8192
v_mfma_f32_16x16x32_bf16 v[132:135], a[76:79], a[112:115], v[132:135]
v_mfma_f32_16x16x32_bf16 v[192:195], a[80:83], a[112:115], v[192:195]
ds_read_b64_tr_b16 a[50:51], v11 offset:10240
v_mfma_f32_16x16x32_bf16 v[196:199], a[84:87], a[112:115], v[196:199]
v_mfma_f32_16x16x32_bf16 a[144:147], a[88:91], a[112:115], a[144:147]
ds_read_b64_tr_b16 a[52:53], v13 offset:8192
v_mfma_f32_16x16x32_bf16 a[148:151], a[92:95], a[112:115], a[148:151]
v_mfma_f32_16x16x32_bf16 v[72:75], a[64:67], a[116:119], v[72:75]
ds_read_b64_tr_b16 a[54:55], v13 offset:10240
v_mfma_f32_16x16x32_bf16 v[76:79], a[68:71], a[116:119], v[76:79]
v_mfma_f32_16x16x32_bf16 v[136:139], a[72:75], a[116:119], v[136:139]
ds_read_b64_tr_b16 a[56:57], v15 offset:8192
v_mfma_f32_16x16x32_bf16 v[140:143], a[76:79], a[116:119], v[140:143]
v_mfma_f32_16x16x32_bf16 v[200:203], a[80:83], a[116:119], v[200:203]
ds_read_b64_tr_b16 a[58:59], v15 offset:10240
v_mfma_f32_16x16x32_bf16 v[204:207], a[84:87], a[116:119], v[204:207]
v_mfma_f32_16x16x32_bf16 a[152:155], a[88:91], a[116:119], a[152:155]
ds_read_b64_tr_b16 a[60:61], v17 offset:8192
v_mfma_f32_16x16x32_bf16 a[156:159], a[92:95], a[116:119], a[156:159]
v_mfma_f32_16x16x32_bf16 v[80:83], a[64:67], a[120:123], v[80:83]
ds_read_b64_tr_b16 a[62:63], v17 offset:10240
v_mfma_f32_16x16x32_bf16 v[84:87], a[68:71], a[120:123], v[84:87]
v_mfma_f32_16x16x32_bf16 v[144:147], a[72:75], a[120:123], v[144:147]
v_mfma_f32_16x16x32_bf16 v[148:151], a[76:79], a[120:123], v[148:151]
v_mfma_f32_16x16x32_bf16 v[208:211], a[80:83], a[120:123], v[208:211]
v_mfma_f32_16x16x32_bf16 v[212:215], a[84:87], a[120:123], v[212:215]
v_mfma_f32_16x16x32_bf16 a[160:163], a[88:91], a[120:123], a[160:163]
v_mfma_f32_16x16x32_bf16 a[164:167], a[92:95], a[120:123], a[164:167]
v_mfma_f32_16x16x32_bf16 v[88:91], a[64:67], a[124:127], v[88:91]
v_mfma_f32_16x16x32_bf16 v[92:95], a[68:71], a[124:127], v[92:95]
v_mfma_f32_16x16x32_bf16 v[152:155], a[72:75], a[124:127], v[152:155]
v_mfma_f32_16x16x32_bf16 v[156:159], a[76:79], a[124:127], v[156:159]
v_mfma_f32_16x16x32_bf16 v[216:219], a[80:83], a[124:127], v[216:219]
v_mfma_f32_16x16x32_bf16 v[220:223], a[84:87], a[124:127], v[220:223]
v_mfma_f32_16x16x32_bf16 a[168:171], a[88:91], a[124:127], a[168:171]
v_mfma_f32_16x16x32_bf16 a[172:175], a[92:95], a[124:127], a[172:175]
s_waitcnt lgkmcnt(0)
v_mfma_f32_16x16x32_bf16 v[32:35], a[0:3], a[32:35], v[32:35]
s_cmp_lg_u32 s96, 0
s_cbranch_scc1 L_cw_9275
s_waitcnt vmcnt(16)
L_cw_9275:
s_barrier
v_mfma_f32_16x16x32_bf16 v[36:39], a[4:7], a[32:35], v[36:39]
v_mfma_f32_16x16x32_bf16 v[96:99], a[8:11], a[32:35], v[96:99]
ds_read_b64_tr_b16 a[96:97], v11 offset:32768
v_mfma_f32_16x16x32_bf16 v[100:103], a[12:15], a[32:35], v[100:103]
s_add_u32 m0, s55, 65536
s_nop 0
buffer_load_dwordx4 v2, s[4:7], s48 offen sc1 lds
v_mfma_f32_16x16x32_bf16 v[160:163], a[16:19], a[32:35], v[160:163]
ds_read_b64_tr_b16 a[98:99], v11 offset:34816
v_mfma_f32_16x16x32_bf16 v[164:167], a[20:23], a[32:35], v[164:167]
v_mfma_f32_16x16x32_bf16 v[224:227], a[24:27], a[32:35], v[224:227]
ds_read_b128 a[64:67], v9 offset:32768
v_mfma_f32_16x16x32_bf16 v[228:231], a[28:31], a[32:35], v[228:231]
buffer_load_dwordx4 v2, s[4:7], s48 offen offset:1024 sc1 lds
v_mfma_f32_16x16x32_bf16 v[40:43], a[0:3], a[36:39], v[40:43]
ds_read_b128 a[68:71], v9 offset:33024
v_mfma_f32_16x16x32_bf16 v[44:47], a[4:7], a[36:39], v[44:47]
v_mfma_f32_16x16x32_bf16 v[104:107], a[8:11], a[36:39], v[104:107]
ds_read_b128 a[72:75], v9 offset:34816
v_mfma_f32_16x16x32_bf16 v[108:111], a[12:15], a[36:39], v[108:111]
buffer_load_dwordx4 v3, s[4:7], s48 offen offset:2048 sc1 lds
v_mfma_f32_16x16x32_bf16 v[168:171], a[16:19], a[36:39], v[168:171]
ds_read_b128 a[76:79], v9 offset:35072
v_mfma_f32_16x16x32_bf16 v[172:175], a[20:23], a[36:39], v[172:175]
v_mfma_f32_16x16x32_bf16 v[232:235], a[24:27], a[36:39], v[232:235]
ds_read_b128 a[80:83], v9 offset:36864
v_mfma_f32_16x16x32_bf16 v[236:239], a[28:31], a[36:39], v[236:239]
buffer_load_dwordx4 v3, s[4:7], s48 offen offset:3072 sc1 lds
s_add_u32 s48, s48, 2048
v_mfma_f32_16x16x32_bf16 v[48:51], a[0:3], a[40:43], v[48:51]
ds_read_b128 a[84:87], v9 offset:37120
v_mfma_f32_16x16x32_bf16 v[52:55], a[4:7], a[40:43], v[52:55]
v_mfma_f32_16x16x32_bf16 v[112:115], a[8:11], a[40:43], v[112:115]
ds_read_b128 a[88:91], v9 offset:38912
v_mfma_f32_16x16x32_bf16 v[116:119], a[12:15], a[40:43], v[116:119]
s_add_u32 m0, s54, 81920
s_nop 0
buffer_load_dwordx4 v4, s[8:11], s49 offen lds
v_mfma_f32_16x16x32_bf16 v[176:179], a[16:19], a[40:43], v[176:179]
ds_read_b128 a[92:95], v9 offset:39168
v_mfma_f32_16x16x32_bf16 v[180:183], a[20:23], a[40:43], v[180:183]
v_mfma_f32_16x16x32_bf16 a[128:131], a[24:27], a[40:43], a[128:131]
ds_read_b64_tr_b16 a[100:101], v13 offset:32768
v_mfma_f32_16x16x32_bf16 a[132:135], a[28:31], a[40:43], a[132:135]
buffer_load_dwordx4 v5, s[8:11], s49 offen offset:1024 lds
v_mfma_f32_16x16x32_bf16 v[56:59], a[0:3], a[44:47], v[56:59]
ds_read_b64_tr_b16 a[102:103], v13 offset:34816
v_mfma_f32_16x16x32_bf16 v[60:63], a[4:7], a[44:47], v[60:63]
v_mfma_f32_16x16x32_bf16 v[120:123], a[8:11], a[44:47], v[120:123]
ds_read_b64_tr_b16 a[104:105], v15 offset:32768
v_mfma_f32_16x16x32_bf16 v[124:127], a[12:15], a[44:47], v[124:127]
buffer_load_dwordx4 v6, s[8:11], s49 offen offset:2048 lds
v_mfma_f32_16x16x32_bf16 v[184:187], a[16:19], a[44:47], v[184:187]
ds_read_b64_tr_b16 a[106:107], v15 offset:34816
v_mfma_f32_16x16x32_bf16 v[188:191], a[20:23], a[44:47], v[188:191]
v_mfma_f32_16x16x32_bf16 a[136:139], a[24:27], a[44:47], a[136:139]
ds_read_b64_tr_b16 a[108:109], v17 offset:32768
v_mfma_f32_16x16x32_bf16 a[140:143], a[28:31], a[44:47], a[140:143]
buffer_load_dwordx4 v7, s[8:11], s49 offen offset:3072 lds
s_add_u32 s49, s49, s50
v_mfma_f32_16x16x32_bf16 v[64:67], a[0:3], a[48:51], v[64:67]
ds_read_b64_tr_b16 a[110:111], v17 offset:34816
v_mfma_f32_16x16x32_bf16 v[68:71], a[4:7], a[48:51], v[68:71]
v_mfma_f32_16x16x32_bf16 v[128:131], a[8:11], a[48:51], v[128:131]
ds_read_b64_tr_b16 a[112:113], v11 offset:40960
v_mfma_f32_16x16x32_bf16 v[132:135], a[12:15], a[48:51], v[132:135]
v_mfma_f32_16x16x32_bf16 v[192:195], a[16:19], a[48:51], v[192:195]
ds_read_b64_tr_b16 a[114:115], v11 offset:43008
v_mfma_f32_16x16x32_bf16 v[196:199], a[20:23], a[48:51], v[196:199]
v_mfma_f32_16x16x32_bf16 a[144:147], a[24:27], a[48:51], a[144:147]
ds_read_b64_tr_b16 a[116:117], v13 offset:40960
v_mfma_f32_16x16x32_bf16 a[148:151], a[28:31], a[48:51], a[148:151]
v_mfma_f32_16x16x32_bf16 v[72:75], a[0:3], a[52:55], v[72:75]
ds_read_b64_tr_b16 a[118:119], v13 offset:43008
v_mfma_f32_16x16x32_bf16 v[76:79], a[4:7], a[52:55], v[76:79]
v_mfma_f32_16x16x32_bf16 v[136:139], a[8:11], a[52:55], v[136:139]
ds_read_b64_tr_b16 a[120:121], v15 offset:40960
v_mfma_f32_16x16x32_bf16 v[140:143], a[12:15], a[52:55], v[140:143]
v_mfma_f32_16x16x32_bf16 v[200:203], a[16:19], a[52:55], v[200:203]
ds_read_b64_tr_b16 a[122:123], v15 offset:43008
v_mfma_f32_16x16x32_bf16 v[204:207], a[20:23], a[52:55], v[204:207]
v_mfma_f32_16x16x32_bf16 a[152:155], a[24:27], a[52:55], a[152:155]
ds_read_b64_tr_b16 a[124:125], v17 offset:40960
v_mfma_f32_16x16x32_bf16 a[156:159], a[28:31], a[52:55], a[156:159]
v_mfma_f32_16x16x32_bf16 v[80:83], a[0:3], a[56:59], v[80:83]
ds_read_b64_tr_b16 a[126:127], v17 offset:43008
v_mfma_f32_16x16x32_bf16 v[84:87], a[4:7], a[56:59], v[84:87]
v_mfma_f32_16x16x32_bf16 v[144:147], a[8:11], a[56:59], v[144:147]
v_mfma_f32_16x16x32_bf16 v[148:151], a[12:15], a[56:59], v[148:151]
v_mfma_f32_16x16x32_bf16 v[208:211], a[16:19], a[56:59], v[208:211]
v_mfma_f32_16x16x32_bf16 v[212:215], a[20:23], a[56:59], v[212:215]
v_mfma_f32_16x16x32_bf16 a[160:163], a[24:27], a[56:59], a[160:163]
v_mfma_f32_16x16x32_bf16 a[164:167], a[28:31], a[56:59], a[164:167]
v_mfma_f32_16x16x32_bf16 v[88:91], a[0:3], a[60:63], v[88:91]
v_mfma_f32_16x16x32_bf16 v[92:95], a[4:7], a[60:63], v[92:95]
v_mfma_f32_16x16x32_bf16 v[152:155], a[8:11], a[60:63], v[152:155]
v_mfma_f32_16x16x32_bf16 v[156:159], a[12:15], a[60:63], v[156:159]
v_mfma_f32_16x16x32_bf16 v[216:219], a[16:19], a[60:63], v[216:219]
v_mfma_f32_16x16x32_bf16 v[220:223], a[20:23], a[60:63], v[220:223]
v_mfma_f32_16x16x32_bf16 a[168:171], a[24:27], a[60:63], a[168:171]
v_mfma_f32_16x16x32_bf16 a[172:175], a[28:31], a[60:63], a[172:175]
s_waitcnt lgkmcnt(0)
v_mfma_f32_16x16x32_bf16 v[32:35], a[64:67], a[96:99], v[32:35]
s_waitcnt vmcnt(16)
s_barrier
s_cmp_eq_u32 s92, 255
s_cbranch_scc1 L_nsig_9276
s_cmp_lg_u32 s3, 0
s_cbranch_scc1 L_nsig_9276
s_lshl_b32 s94, s92, 8
s_add_u32 s94, s94, 98566144
v_mov_b32 v29, 0
v_mov_b32 v30, 1
s_mov_b64 exec, 1
buffer_atomic_add v30, v29, s[4:7], s94 offen sc1
s_mov_b64 exec, -1
L_nsig_9276:
v_mfma_f32_16x16x32_bf16 v[36:39], a[68:71], a[96:99], v[36:39]
v_mfma_f32_16x16x32_bf16 v[96:99], a[72:75], a[96:99], v[96:99]
ds_read_b64_tr_b16 a[32:33], v10 offset:0
v_mfma_f32_16x16x32_bf16 v[100:103], a[76:79], a[96:99], v[100:103]
s_add_u32 m0, s55, 98304
s_nop 0
buffer_load_dwordx4 v2, s[4:7], s48 offen sc1 lds
v_mfma_f32_16x16x32_bf16 v[160:163], a[80:83], a[96:99], v[160:163]
ds_read_b64_tr_b16 a[34:35], v10 offset:2048
v_mfma_f32_16x16x32_bf16 v[164:167], a[84:87], a[96:99], v[164:167]
v_mfma_f32_16x16x32_bf16 v[224:227], a[88:91], a[96:99], v[224:227]
ds_read_b128 a[0:3], v8 offset:0
v_mfma_f32_16x16x32_bf16 v[228:231], a[92:95], a[96:99], v[228:231]
buffer_load_dwordx4 v2, s[4:7], s48 offen offset:1024 sc1 lds
v_mfma_f32_16x16x32_bf16 v[40:43], a[64:67], a[100:103], v[40:43]
ds_read_b128 a[4:7], v8 offset:256
v_mfma_f32_16x16x32_bf16 v[44:47], a[68:71], a[100:103], v[44:47]
v_mfma_f32_16x16x32_bf16 v[104:107], a[72:75], a[100:103], v[104:107]
ds_read_b128 a[8:11], v8 offset:2048
v_mfma_f32_16x16x32_bf16 v[108:111], a[76:79], a[100:103], v[108:111]
buffer_load_dwordx4 v3, s[4:7], s48 offen offset:2048 sc1 lds
v_mfma_f32_16x16x32_bf16 v[168:171], a[80:83], a[100:103], v[168:171]
ds_read_b128 a[12:15], v8 offset:2304
v_mfma_f32_16x16x32_bf16 v[172:175], a[84:87], a[100:103], v[172:175]
v_mfma_f32_16x16x32_bf16 v[232:235], a[88:91], a[100:103], v[232:235]
ds_read_b128 a[16:19], v8 offset:4096
v_mfma_f32_16x16x32_bf16 v[236:239], a[92:95], a[100:103], v[236:239]
buffer_load_dwordx4 v3, s[4:7], s48 offen offset:3072 sc1 lds
s_add_u32 s48, s48, 2048
v_mfma_f32_16x16x32_bf16 v[48:51], a[64:67], a[104:107], v[48:51]
ds_read_b128 a[20:23], v8 offset:4352
v_mfma_f32_16x16x32_bf16 v[52:55], a[68:71], a[104:107], v[52:55]
v_mfma_f32_16x16x32_bf16 v[112:115], a[72:75], a[104:107], v[112:115]
ds_read_b128 a[24:27], v8 offset:6144
v_mfma_f32_16x16x32_bf16 v[116:119], a[76:79], a[104:107], v[116:119]
s_add_u32 m0, s54, 114688
s_nop 0
buffer_load_dwordx4 v4, s[8:11], s49 offen lds
v_mfma_f32_16x16x32_bf16 v[176:179], a[80:83], a[104:107], v[176:179]
ds_read_b128 a[28:31], v8 offset:6400
v_mfma_f32_16x16x32_bf16 v[180:183], a[84:87], a[104:107], v[180:183]
v_mfma_f32_16x16x32_bf16 a[128:131], a[88:91], a[104:107], a[128:131]
ds_read_b64_tr_b16 a[36:37], v12 offset:0
v_mfma_f32_16x16x32_bf16 a[132:135], a[92:95], a[104:107], a[132:135]
buffer_load_dwordx4 v5, s[8:11], s49 offen offset:1024 lds
v_mfma_f32_16x16x32_bf16 v[56:59], a[64:67], a[108:111], v[56:59]
ds_read_b64_tr_b16 a[38:39], v12 offset:2048
v_mfma_f32_16x16x32_bf16 v[60:63], a[68:71], a[108:111], v[60:63]
v_mfma_f32_16x16x32_bf16 v[120:123], a[72:75], a[108:111], v[120:123]
ds_read_b64_tr_b16 a[40:41], v14 offset:0
v_mfma_f32_16x16x32_bf16 v[124:127], a[76:79], a[108:111], v[124:127]
buffer_load_dwordx4 v6, s[8:11], s49 offen offset:2048 lds
v_mfma_f32_16x16x32_bf16 v[184:187], a[80:83], a[108:111], v[184:187]
ds_read_b64_tr_b16 a[42:43], v14 offset:2048
v_mfma_f32_16x16x32_bf16 v[188:191], a[84:87], a[108:111], v[188:191]
v_mfma_f32_16x16x32_bf16 a[136:139], a[88:91], a[108:111], a[136:139]
ds_read_b64_tr_b16 a[44:45], v16 offset:0
v_mfma_f32_16x16x32_bf16 a[140:143], a[92:95], a[108:111], a[140:143]
buffer_load_dwordx4 v7, s[8:11], s49 offen offset:3072 lds
s_add_u32 s49, s49, s50
v_mfma_f32_16x16x32_bf16 v[64:67], a[64:67], a[112:115], v[64:67]
ds_read_b64_tr_b16 a[46:47], v16 offset:2048
v_mfma_f32_16x16x32_bf16 v[68:71], a[68:71], a[112:115], v[68:71]
v_mfma_f32_16x16x32_bf16 v[128:131], a[72:75], a[112:115], v[128:131]
ds_read_b64_tr_b16 a[48:49], v10 offset:8192
v_mfma_f32_16x16x32_bf16 v[132:135], a[76:79], a[112:115], v[132:135]
v_mfma_f32_16x16x32_bf16 v[192:195], a[80:83], a[112:115], v[192:195]
ds_read_b64_tr_b16 a[50:51], v10 offset:10240
v_mfma_f32_16x16x32_bf16 v[196:199], a[84:87], a[112:115], v[196:199]
v_mfma_f32_16x16x32_bf16 a[144:147], a[88:91], a[112:115], a[144:147]
ds_read_b64_tr_b16 a[52:53], v12 offset:8192
v_mfma_f32_16x16x32_bf16 a[148:151], a[92:95], a[112:115], a[148:151]
v_mfma_f32_16x16x32_bf16 v[72:75], a[64:67], a[116:119], v[72:75]
ds_read_b64_tr_b16 a[54:55], v12 offset:10240
v_mfma_f32_16x16x32_bf16 v[76:79], a[68:71], a[116:119], v[76:79]
v_mfma_f32_16x16x32_bf16 v[136:139], a[72:75], a[116:119], v[136:139]
ds_read_b64_tr_b16 a[56:57], v14 offset:8192
v_mfma_f32_16x16x32_bf16 v[140:143], a[76:79], a[116:119], v[140:143]
v_mfma_f32_16x16x32_bf16 v[200:203], a[80:83], a[116:119], v[200:203]
ds_read_b64_tr_b16 a[58:59], v14 offset:10240
v_mfma_f32_16x16x32_bf16 v[204:207], a[84:87], a[116:119], v[204:207]
v_mfma_f32_16x16x32_bf16 a[152:155], a[88:91], a[116:119], a[152:155]
ds_read_b64_tr_b16 a[60:61], v16 offset:8192
v_mfma_f32_16x16x32_bf16 a[156:159], a[92:95], a[116:119], a[156:159]
v_mfma_f32_16x16x32_bf16 v[80:83], a[64:67], a[120:123], v[80:83]
ds_read_b64_tr_b16 a[62:63], v16 offset:10240
v_mfma_f32_16x16x32_bf16 v[84:87], a[68:71], a[120:123], v[84:87]
v_mfma_f32_16x16x32_bf16 v[144:147], a[72:75], a[120:123], v[144:147]
v_mfma_f32_16x16x32_bf16 v[148:151], a[76:79], a[120:123], v[148:151]
v_mfma_f32_16x16x32_bf16 v[208:211], a[80:83], a[120:123], v[208:211]
v_mfma_f32_16x16x32_bf16 v[212:215], a[84:87], a[120:123], v[212:215]
v_mfma_f32_16x16x32_bf16 a[160:163], a[88:91], a[120:123], a[160:163]
v_mfma_f32_16x16x32_bf16 a[164:167], a[92:95], a[120:123], a[164:167]
v_mfma_f32_16x16x32_bf16 v[88:91], a[64:67], a[124:127], v[88:91]
v_mfma_f32_16x16x32_bf16 v[92:95], a[68:71], a[124:127], v[92:95]
v_mfma_f32_16x16x32_bf16 v[152:155], a[72:75], a[124:127], v[152:155]
v_mfma_f32_16x16x32_bf16 v[156:159], a[76:79], a[124:127], v[156:159]
v_mfma_f32_16x16x32_bf16 v[216:219], a[80:83], a[124:127], v[216:219]
v_mfma_f32_16x16x32_bf16 v[220:223], a[84:87], a[124:127], v[220:223]
v_mfma_f32_16x16x32_bf16 a[168:171], a[88:91], a[124:127], a[168:171]
v_mfma_f32_16x16x32_bf16 a[172:175], a[92:95], a[124:127], a[172:175]
s_sub_u32 s51, s51, 2
s_cmp_eq_u32 s51, 0
s_cbranch_scc1 L_gl_end_9277
L_gl_9278:
s_waitcnt lgkmcnt(0)
v_mfma_f32_16x16x32_bf16 v[32:35], a[0:3], a[32:35], v[32:35]
s_waitcnt vmcnt(16)
s_barrier
v_mfma_f32_16x16x32_bf16 v[36:39], a[4:7], a[32:35], v[36:39]
v_mfma_f32_16x16x32_bf16 v[96:99], a[8:11], a[32:35], v[96:99]
ds_read_b64_tr_b16 a[96:97], v10 offset:32768
v_mfma_f32_16x16x32_bf16 v[100:103], a[12:15], a[32:35], v[100:103]
s_add_u32 m0, s55, 0
s_nop 0
buffer_load_dwordx4 v2, s[4:7], s48 offen sc1 lds
v_mfma_f32_16x16x32_bf16 v[160:163], a[16:19], a[32:35], v[160:163]
ds_read_b64_tr_b16 a[98:99], v10 offset:34816
v_mfma_f32_16x16x32_bf16 v[164:167], a[20:23], a[32:35], v[164:167]
v_mfma_f32_16x16x32_bf16 v[224:227], a[24:27], a[32:35], v[224:227]
ds_read_b128 a[64:67], v8 offset:32768
v_mfma_f32_16x16x32_bf16 v[228:231], a[28:31], a[32:35], v[228:231]
buffer_load_dwordx4 v2, s[4:7], s48 offen offset:1024 sc1 lds
v_mfma_f32_16x16x32_bf16 v[40:43], a[0:3], a[36:39], v[40:43]
ds_read_b128 a[68:71], v8 offset:33024
v_mfma_f32_16x16x32_bf16 v[44:47], a[4:7], a[36:39], v[44:47]
v_mfma_f32_16x16x32_bf16 v[104:107], a[8:11], a[36:39], v[104:107]
ds_read_b128 a[72:75], v8 offset:34816
v_mfma_f32_16x16x32_bf16 v[108:111], a[12:15], a[36:39], v[108:111]
buffer_load_dwordx4 v3, s[4:7], s48 offen offset:2048 sc1 lds
v_mfma_f32_16x16x32_bf16 v[168:171], a[16:19], a[36:39], v[168:171]
ds_read_b128 a[76:79], v8 offset:35072
v_mfma_f32_16x16x32_bf16 v[172:175], a[20:23], a[36:39], v[172:175]
v_mfma_f32_16x16x32_bf16 v[232:235], a[24:27], a[36:39], v[232:235]
ds_read_b128 a[80:83], v8 offset:36864
v_mfma_f32_16x16x32_bf16 v[236:239], a[28:31], a[36:39], v[236:239]
buffer_load_dwordx4 v3, s[4:7], s48 offen offset:3072 sc1 lds
s_add_u32 s48, s48, 2048
v_mfma_f32_16x16x32_bf16 v[48:51], a[0:3], a[40:43], v[48:51]
ds_read_b128 a[84:87], v8 offset:37120
v_mfma_f32_16x16x32_bf16 v[52:55], a[4:7], a[40:43], v[52:55]
v_mfma_f32_16x16x32_bf16 v[112:115], a[8:11], a[40:43], v[112:115]
ds_read_b128 a[88:91], v8 offset:38912
v_mfma_f32_16x16x32_bf16 v[116:119], a[12:15], a[40:43], v[116:119]
s_add_u32 m0, s54, 16384
s_nop 0
buffer_load_dwordx4 v4, s[8:11], s49 offen lds
v_mfma_f32_16x16x32_bf16 v[176:179], a[16:19], a[40:43], v[176:179]
ds_read_b128 a[92:95], v8 offset:39168
v_mfma_f32_16x16x32_bf16 v[180:183], a[20:23], a[40:43], v[180:183]
v_mfma_f32_16x16x32_bf16 a[128:131], a[24:27], a[40:43], a[128:131]
ds_read_b64_tr_b16 a[100:101], v12 offset:32768
v_mfma_f32_16x16x32_bf16 a[132:135], a[28:31], a[40:43], a[132:135]
buffer_load_dwordx4 v5, s[8:11], s49 offen offset:1024 lds
v_mfma_f32_16x16x32_bf16 v[56:59], a[0:3], a[44:47], v[56:59]
ds_read_b64_tr_b16 a[102:103], v12 offset:34816
v_mfma_f32_16x16x32_bf16 v[60:63], a[4:7], a[44:47], v[60:63]
v_mfma_f32_16x16x32_bf16 v[120:123], a[8:11], a[44:47], v[120:123]
ds_read_b64_tr_b16 a[104:105], v14 offset:32768
v_mfma_f32_16x16x32_bf16 v[124:127], a[12:15], a[44:47], v[124:127]
buffer_load_dwordx4 v6, s[8:11], s49 offen offset:2048 lds
v_mfma_f32_16x16x32_bf16 v[184:187], a[16:19], a[44:47], v[184:187]
ds_read_b64_tr_b16 a[106:107], v14 offset:34816
v_mfma_f32_16x16x32_bf16 v[188:191], a[20:23], a[44:47], v[188:191]
v_mfma_f32_16x16x32_bf16 a[136:139], a[24:27], a[44:47], a[136:139]
ds_read_b64_tr_b16 a[108:109], v16 offset:32768
v_mfma_f32_16x16x32_bf16 a[140:143], a[28:31], a[44:47], a[140:143]
buffer_load_dwordx4 v7, s[8:11], s49 offen offset:3072 lds
s_add_u32 s49, s49, s50
v_mfma_f32_16x16x32_bf16 v[64:67], a[0:3], a[48:51], v[64:67]
ds_read_b64_tr_b16 a[110:111], v16 offset:34816
v_mfma_f32_16x16x32_bf16 v[68:71], a[4:7], a[48:51], v[68:71]
v_mfma_f32_16x16x32_bf16 v[128:131], a[8:11], a[48:51], v[128:131]
ds_read_b64_tr_b16 a[112:113], v10 offset:40960
v_mfma_f32_16x16x32_bf16 v[132:135], a[12:15], a[48:51], v[132:135]
v_mfma_f32_16x16x32_bf16 v[192:195], a[16:19], a[48:51], v[192:195]
ds_read_b64_tr_b16 a[114:115], v10 offset:43008
v_mfma_f32_16x16x32_bf16 v[196:199], a[20:23], a[48:51], v[196:199]
v_mfma_f32_16x16x32_bf16 a[144:147], a[24:27], a[48:51], a[144:147]
ds_read_b64_tr_b16 a[116:117], v12 offset:40960
v_mfma_f32_16x16x32_bf16 a[148:151], a[28:31], a[48:51], a[148:151]
v_mfma_f32_16x16x32_bf16 v[72:75], a[0:3], a[52:55], v[72:75]
ds_read_b64_tr_b16 a[118:119], v12 offset:43008
v_mfma_f32_16x16x32_bf16 v[76:79], a[4:7], a[52:55], v[76:79]
v_mfma_f32_16x16x32_bf16 v[136:139], a[8:11], a[52:55], v[136:139]
ds_read_b64_tr_b16 a[120:121], v14 offset:40960
v_mfma_f32_16x16x32_bf16 v[140:143], a[12:15], a[52:55], v[140:143]
v_mfma_f32_16x16x32_bf16 v[200:203], a[16:19], a[52:55], v[200:203]
ds_read_b64_tr_b16 a[122:123], v14 offset:43008
v_mfma_f32_16x16x32_bf16 v[204:207], a[20:23], a[52:55], v[204:207]
v_mfma_f32_16x16x32_bf16 a[152:155], a[24:27], a[52:55], a[152:155]
ds_read_b64_tr_b16 a[124:125], v16 offset:40960
v_mfma_f32_16x16x32_bf16 a[156:159], a[28:31], a[52:55], a[156:159]
v_mfma_f32_16x16x32_bf16 v[80:83], a[0:3], a[56:59], v[80:83]
ds_read_b64_tr_b16 a[126:127], v16 offset:43008
v_mfma_f32_16x16x32_bf16 v[84:87], a[4:7], a[56:59], v[84:87]
v_mfma_f32_16x16x32_bf16 v[144:147], a[8:11], a[56:59], v[144:147]
v_mfma_f32_16x16x32_bf16 v[148:151], a[12:15], a[56:59], v[148:151]
v_mfma_f32_16x16x32_bf16 v[208:211], a[16:19], a[56:59], v[208:211]
v_mfma_f32_16x16x32_bf16 v[212:215], a[20:23], a[56:59], v[212:215]
v_mfma_f32_16x16x32_bf16 a[160:163], a[24:27], a[56:59], a[160:163]
v_mfma_f32_16x16x32_bf16 a[164:167], a[28:31], a[56:59], a[164:167]
v_mfma_f32_16x16x32_bf16 v[88:91], a[0:3], a[60:63], v[88:91]
v_mfma_f32_16x16x32_bf16 v[92:95], a[4:7], a[60:63], v[92:95]
v_mfma_f32_16x16x32_bf16 v[152:155], a[8:11], a[60:63], v[152:155]
v_mfma_f32_16x16x32_bf16 v[156:159], a[12:15], a[60:63], v[156:159]
v_mfma_f32_16x16x32_bf16 v[216:219], a[16:19], a[60:63], v[216:219]
v_mfma_f32_16x16x32_bf16 v[220:223], a[20:23], a[60:63], v[220:223]
v_mfma_f32_16x16x32_bf16 a[168:171], a[24:27], a[60:63], a[168:171]
v_mfma_f32_16x16x32_bf16 a[172:175], a[28:31], a[60:63], a[172:175]
s_waitcnt lgkmcnt(0)
v_mfma_f32_16x16x32_bf16 v[32:35], a[64:67], a[96:99], v[32:35]
s_waitcnt vmcnt(16)
s_barrier
v_mfma_f32_16x16x32_bf16 v[36:39], a[68:71], a[96:99], v[36:39]
v_mfma_f32_16x16x32_bf16 v[96:99], a[72:75], a[96:99], v[96:99]
ds_read_b64_tr_b16 a[32:33], v11 offset:0
v_mfma_f32_16x16x32_bf16 v[100:103], a[76:79], a[96:99], v[100:103]
s_add_u32 m0, s55, 32768
s_nop 0
buffer_load_dwordx4 v2, s[4:7], s48 offen sc1 lds
v_mfma_f32_16x16x32_bf16 v[160:163], a[80:83], a[96:99], v[160:163]
ds_read_b64_tr_b16 a[34:35], v11 offset:2048
v_mfma_f32_16x16x32_bf16 v[164:167], a[84:87], a[96:99], v[164:167]
v_mfma_f32_16x16x32_bf16 v[224:227], a[88:91], a[96:99], v[224:227]
ds_read_b128 a[0:3], v9 offset:0
v_mfma_f32_16x16x32_bf16 v[228:231], a[92:95], a[96:99], v[228:231]
buffer_load_dwordx4 v2, s[4:7], s48 offen offset:1024 sc1 lds
v_mfma_f32_16x16x32_bf16 v[40:43], a[64:67], a[100:103], v[40:43]
ds_read_b128 a[4:7], v9 offset:256
v_mfma_f32_16x16x32_bf16 v[44:47], a[68:71], a[100:103], v[44:47]
v_mfma_f32_16x16x32_bf16 v[104:107], a[72:75], a[100:103], v[104:107]
ds_read_b128 a[8:11], v9 offset:2048
v_mfma_f32_16x16x32_bf16 v[108:111], a[76:79], a[100:103], v[108:111]
buffer_load_dwordx4 v3, s[4:7], s48 offen offset:2048 sc1 lds
v_mfma_f32_16x16x32_bf16 v[168:171], a[80:83], a[100:103], v[168:171]
ds_read_b128 a[12:15], v9 offset:2304
v_mfma_f32_16x16x32_bf16 v[172:175], a[84:87], a[100:103], v[172:175]
v_mfma_f32_16x16x32_bf16 v[232:235], a[88:91], a[100:103], v[232:235]
ds_read_b128 a[16:19], v9 offset:4096
v_mfma_f32_16x16x32_bf16 v[236:239], a[92:95], a[100:103], v[236:239]
buffer_load_dwordx4 v3, s[4:7], s48 offen offset:3072 sc1 lds
s_add_u32 s48, s48, 2048
v_mfma_f32_16x16x32_bf16 v[48:51], a[64:67], a[104:107], v[48:51]
ds_read_b128 a[20:23], v9 offset:4352
v_mfma_f32_16x16x32_bf16 v[52:55], a[68:71], a[104:107], v[52:55]
v_mfma_f32_16x16x32_bf16 v[112:115], a[72:75], a[104:107], v[112:115]
ds_read_b128 a[24:27], v9 offset:6144
v_mfma_f32_16x16x32_bf16 v[116:119], a[76:79], a[104:107], v[116:119]
s_add_u32 m0, s54, 49152
s_nop 0
buffer_load_dwordx4 v4, s[8:11], s49 offen lds
v_mfma_f32_16x16x32_bf16 v[176:179], a[80:83], a[104:107], v[176:179]
ds_read_b128 a[28:31], v9 offset:6400
v_mfma_f32_16x16x32_bf16 v[180:183], a[84:87], a[104:107], v[180:183]
v_mfma_f32_16x16x32_bf16 a[128:131], a[88:91], a[104:107], a[128:131]
ds_read_b64_tr_b16 a[36:37], v13 offset:0
v_mfma_f32_16x16x32_bf16 a[132:135], a[92:95], a[104:107], a[132:135]
buffer_load_dwordx4 v5, s[8:11], s49 offen offset:1024 lds
v_mfma_f32_16x16x32_bf16 v[56:59], a[64:67], a[108:111], v[56:59]
ds_read_b64_tr_b16 a[38:39], v13 offset:2048
v_mfma_f32_16x16x32_bf16 v[60:63], a[68:71], a[108:111], v[60:63]
v_mfma_f32_16x16x32_bf16 v[120:123], a[72:75], a[108:111], v[120:123]
ds_read_b64_tr_b16 a[40:41], v15 offset:0
v_mfma_f32_16x16x32_bf16 v[124:127], a[76:79], a[108:111], v[124:127]
buffer_load_dwordx4 v6, s[8:11], s49 offen offset:2048 lds
v_mfma_f32_16x16x32_bf16 v[184:187], a[80:83], a[108:111], v[184:187]
ds_read_b64_tr_b16 a[42:43], v15 offset:2048
v_mfma_f32_16x16x32_bf16 v[188:191], a[84:87], a[108:111], v[188:191]
v_mfma_f32_16x16x32_bf16 a[136:139], a[88:91], a[108:111], a[136:139]
ds_read_b64_tr_b16 a[44:45], v17 offset:0
v_mfma_f32_16x16x32_bf16 a[140:143], a[92:95], a[108:111], a[140:143]
buffer_load_dwordx4 v7, s[8:11], s49 offen offset:3072 lds
s_add_u32 s49, s49, s50
v_mfma_f32_16x16x32_bf16 v[64:67], a[64:67], a[112:115], v[64:67]
ds_read_b64_tr_b16 a[46:47], v17 offset:2048
v_mfma_f32_16x16x32_bf16 v[68:71], a[68:71], a[112:115], v[68:71]
v_mfma_f32_16x16x32_bf16 v[128:131], a[72:75], a[112:115], v[128:131]
ds_read_b64_tr_b16 a[48:49], v11 offset:8192
v_mfma_f32_16x16x32_bf16 v[132:135], a[76:79], a[112:115], v[132:135]
v_mfma_f32_16x16x32_bf16 v[192:195], a[80:83], a[112:115], v[192:195]
ds_read_b64_tr_b16 a[50:51], v11 offset:10240
v_mfma_f32_16x16x32_bf16 v[196:199], a[84:87], a[112:115], v[196:199]
v_mfma_f32_16x16x32_bf16 a[144:147], a[88:91], a[112:115], a[144:147]
ds_read_b64_tr_b16 a[52:53], v13 offset:8192
v_mfma_f32_16x16x32_bf16 a[148:151], a[92:95], a[112:115], a[148:151]
v_mfma_f32_16x16x32_bf16 v[72:75], a[64:67], a[116:119], v[72:75]
ds_read_b64_tr_b16 a[54:55], v13 offset:10240
v_mfma_f32_16x16x32_bf16 v[76:79], a[68:71], a[116:119], v[76:79]
v_mfma_f32_16x16x32_bf16 v[136:139], a[72:75], a[116:119], v[136:139]
ds_read_b64_tr_b16 a[56:57], v15 offset:8192
v_mfma_f32_16x16x32_bf16 v[140:143], a[76:79], a[116:119], v[140:143]
v_mfma_f32_16x16x32_bf16 v[200:203], a[80:83], a[116:119], v[200:203]
ds_read_b64_tr_b16 a[58:59], v15 offset:10240
v_mfma_f32_16x16x32_bf16 v[204:207], a[84:87], a[116:119], v[204:207]
v_mfma_f32_16x16x32_bf16 a[152:155], a[88:91], a[116:119], a[152:155]
ds_read_b64_tr_b16 a[60:61], v17 offset:8192
v_mfma_f32_16x16x32_bf16 a[156:159], a[92:95], a[116:119], a[156:159]
v_mfma_f32_16x16x32_bf16 v[80:83], a[64:67], a[120:123], v[80:83]
ds_read_b64_tr_b16 a[62:63], v17 offset:10240
v_mfma_f32_16x16x32_bf16 v[84:87], a[68:71], a[120:123], v[84:87]
v_mfma_f32_16x16x32_bf16 v[144:147], a[72:75], a[120:123], v[144:147]
v_mfma_f32_16x16x32_bf16 v[148:151], a[76:79], a[120:123], v[148:151]
v_mfma_f32_16x16x32_bf16 v[208:211], a[80:83], a[120:123], v[208:211]
v_mfma_f32_16x16x32_bf16 v[212:215], a[84:87], a[120:123], v[212:215]
v_mfma_f32_16x16x32_bf16 a[160:163], a[88:91], a[120:123], a[160:163]
v_mfma_f32_16x16x32_bf16 a[164:167], a[92:95], a[120:123], a[164:167]
v_mfma_f32_16x16x32_bf16 v[88:91], a[64:67], a[124:127], v[88:91]
v_mfma_f32_16x16x32_bf16 v[92:95], a[68:71], a[124:127], v[92:95]
v_mfma_f32_16x16x32_bf16 v[152:155], a[72:75], a[124:127], v[152:155]
v_mfma_f32_16x16x32_bf16 v[156:159], a[76:79], a[124:127], v[156:159]
v_mfma_f32_16x16x32_bf16 v[216:219], a[80:83], a[124:127], v[216:219]
v_mfma_f32_16x16x32_bf16 v[220:223], a[84:87], a[124:127], v[220:223]
v_mfma_f32_16x16x32_bf16 a[168:171], a[88:91], a[124:127], a[168:171]
v_mfma_f32_16x16x32_bf16 a[172:175], a[92:95], a[124:127], a[172:175]
s_waitcnt lgkmcnt(0)
v_mfma_f32_16x16x32_bf16 v[32:35], a[0:3], a[32:35], v[32:35]
s_waitcnt vmcnt(16)
s_barrier
v_mfma_f32_16x16x32_bf16 v[36:39], a[4:7], a[32:35], v[36:39]
v_mfma_f32_16x16x32_bf16 v[96:99], a[8:11], a[32:35], v[96:99]
ds_read_b64_tr_b16 a[96:97], v11 offset:32768
v_mfma_f32_16x16x32_bf16 v[100:103], a[12:15], a[32:35], v[100:103]
s_add_u32 m0, s55, 65536
s_nop 0
buffer_load_dwordx4 v2, s[4:7], s48 offen sc1 lds
v_mfma_f32_16x16x32_bf16 v[160:163], a[16:19], a[32:35], v[160:163]
ds_read_b64_tr_b16 a[98:99], v11 offset:34816
v_mfma_f32_16x16x32_bf16 v[164:167], a[20:23], a[32:35], v[164:167]
v_mfma_f32_16x16x32_bf16 v[224:227], a[24:27], a[32:35], v[224:227]
ds_read_b128 a[64:67], v9 offset:32768
v_mfma_f32_16x16x32_bf16 v[228:231], a[28:31], a[32:35], v[228:231]
buffer_load_dwordx4 v2, s[4:7], s48 offen offset:1024 sc1 lds
v_mfma_f32_16x16x32_bf16 v[40:43], a[0:3], a[36:39], v[40:43]
ds_read_b128 a[68:71], v9 offset:33024
v_mfma_f32_16x16x32_bf16 v[44:47], a[4:7], a[36:39], v[44:47]
v_mfma_f32_16x16x32_bf16 v[104:107], a[8:11], a[36:39], v[104:107]
ds_read_b128 a[72:75], v9 offset:34816
v_mfma_f32_16x16x32_bf16 v[108:111], a[12:15], a[36:39], v[108:111]
buffer_load_dwordx4 v3, s[4:7], s48 offen offset:2048 sc1 lds
v_mfma_f32_16x16x32_bf16 v[168:171], a[16:19], a[36:39], v[168:171]
ds_read_b128 a[76:79], v9 offset:35072
v_mfma_f32_16x16x32_bf16 v[172:175], a[20:23], a[36:39], v[172:175]
v_mfma_f32_16x16x32_bf16 v[232:235], a[24:27], a[36:39], v[232:235]
ds_read_b128 a[80:83], v9 offset:36864
v_mfma_f32_16x16x32_bf16 v[236:239], a[28:31], a[36:39], v[236:239]
buffer_load_dwordx4 v3, s[4:7], s48 offen offset:3072 sc1 lds
s_add_u32 s48, s48, 2048
v_mfma_f32_16x16x32_bf16 v[48:51], a[0:3], a[40:43], v[48:51]
ds_read_b128 a[84:87], v9 offset:37120
v_mfma_f32_16x16x32_bf16 v[52:55], a[4:7], a[40:43], v[52:55]
v_mfma_f32_16x16x32_bf16 v[112:115], a[8:11], a[40:43], v[112:115]
ds_read_b128 a[88:91], v9 offset:38912
v_mfma_f32_16x16x32_bf16 v[116:119], a[12:15], a[40:43], v[116:119]
s_add_u32 m0, s54, 81920
s_nop 0
buffer_load_dwordx4 v4, s[8:11], s49 offen lds
v_mfma_f32_16x16x32_bf16 v[176:179], a[16:19], a[40:43], v[176:179]
ds_read_b128 a[92:95], v9 offset:39168
v_mfma_f32_16x16x32_bf16 v[180:183], a[20:23], a[40:43], v[180:183]
v_mfma_f32_16x16x32_bf16 a[128:131], a[24:27], a[40:43], a[128:131]
ds_read_b64_tr_b16 a[100:101], v13 offset:32768
v_mfma_f32_16x16x32_bf16 a[132:135], a[28:31], a[40:43], a[132:135]
buffer_load_dwordx4 v5, s[8:11], s49 offen offset:1024 lds
v_mfma_f32_16x16x32_bf16 v[56:59], a[0:3], a[44:47], v[56:59]
ds_read_b64_tr_b16 a[102:103], v13 offset:34816
v_mfma_f32_16x16x32_bf16 v[60:63], a[4:7], a[44:47], v[60:63]
v_mfma_f32_16x16x32_bf16 v[120:123], a[8:11], a[44:47], v[120:123]
ds_read_b64_tr_b16 a[104:105], v15 offset:32768
v_mfma_f32_16x16x32_bf16 v[124:127], a[12:15], a[44:47], v[124:127]
buffer_load_dwordx4 v6, s[8:11], s49 offen offset:2048 lds
v_mfma_f32_16x16x32_bf16 v[184:187], a[16:19], a[44:47], v[184:187]
ds_read_b64_tr_b16 a[106:107], v15 offset:34816
v_mfma_f32_16x16x32_bf16 v[188:191], a[20:23], a[44:47], v[188:191]
v_mfma_f32_16x16x32_bf16 a[136:139], a[24:27], a[44:47], a[136:139]
ds_read_b64_tr_b16 a[108:109], v17 offset:32768
v_mfma_f32_16x16x32_bf16 a[140:143], a[28:31], a[44:47], a[140:143]
buffer_load_dwordx4 v7, s[8:11], s49 offen offset:3072 lds
s_add_u32 s49, s49, s50
v_mfma_f32_16x16x32_bf16 v[64:67], a[0:3], a[48:51], v[64:67]
ds_read_b64_tr_b16 a[110:111], v17 offset:34816
v_mfma_f32_16x16x32_bf16 v[68:71], a[4:7], a[48:51], v[68:71]
v_mfma_f32_16x16x32_bf16 v[128:131], a[8:11], a[48:51], v[128:131]
ds_read_b64_tr_b16 a[112:113], v11 offset:40960
v_mfma_f32_16x16x32_bf16 v[132:135], a[12:15], a[48:51], v[132:135]
v_mfma_f32_16x16x32_bf16 v[192:195], a[16:19], a[48:51], v[192:195]
ds_read_b64_tr_b16 a[114:115], v11 offset:43008
v_mfma_f32_16x16x32_bf16 v[196:199], a[20:23], a[48:51], v[196:199]
v_mfma_f32_16x16x32_bf16 a[144:147], a[24:27], a[48:51], a[144:147]
ds_read_b64_tr_b16 a[116:117], v13 offset:40960
v_mfma_f32_16x16x32_bf16 a[148:151], a[28:31], a[48:51], a[148:151]
v_mfma_f32_16x16x32_bf16 v[72:75], a[0:3], a[52:55], v[72:75]
ds_read_b64_tr_b16 a[118:119], v13 offset:43008
v_mfma_f32_16x16x32_bf16 v[76:79], a[4:7], a[52:55], v[76:79]
v_mfma_f32_16x16x32_bf16 v[136:139], a[8:11], a[52:55], v[136:139]
ds_read_b64_tr_b16 a[120:121], v15 offset:40960
v_mfma_f32_16x16x32_bf16 v[140:143], a[12:15], a[52:55], v[140:143]
v_mfma_f32_16x16x32_bf16 v[200:203], a[16:19], a[52:55], v[200:203]
ds_read_b64_tr_b16 a[122:123], v15 offset:43008
v_mfma_f32_16x16x32_bf16 v[204:207], a[20:23], a[52:55], v[204:207]
v_mfma_f32_16x16x32_bf16 a[152:155], a[24:27], a[52:55], a[152:155]
ds_read_b64_tr_b16 a[124:125], v17 offset:40960
v_mfma_f32_16x16x32_bf16 a[156:159], a[28:31], a[52:55], a[156:159]
v_mfma_f32_16x16x32_bf16 v[80:83], a[0:3], a[56:59], v[80:83]
ds_read_b64_tr_b16 a[126:127], v17 offset:43008
v_mfma_f32_16x16x32_bf16 v[84:87], a[4:7], a[56:59], v[84:87]
v_mfma_f32_16x16x32_bf16 v[144:147], a[8:11], a[56:59], v[144:147]
v_mfma_f32_16x16x32_bf16 v[148:151], a[12:15], a[56:59], v[148:151]
v_mfma_f32_16x16x32_bf16 v[208:211], a[16:19], a[56:59], v[208:211]
v_mfma_f32_16x16x32_bf16 v[212:215], a[20:23], a[56:59], v[212:215]
v_mfma_f32_16x16x32_bf16 a[160:163], a[24:27], a[56:59], a[160:163]
v_mfma_f32_16x16x32_bf16 a[164:167], a[28:31], a[56:59], a[164:167]
v_mfma_f32_16x16x32_bf16 v[88:91], a[0:3], a[60:63], v[88:91]
v_mfma_f32_16x16x32_bf16 v[92:95], a[4:7], a[60:63], v[92:95]
v_mfma_f32_16x16x32_bf16 v[152:155], a[8:11], a[60:63], v[152:155]
v_mfma_f32_16x16x32_bf16 v[156:159], a[12:15], a[60:63], v[156:159]
v_mfma_f32_16x16x32_bf16 v[216:219], a[16:19], a[60:63], v[216:219]
v_mfma_f32_16x16x32_bf16 v[220:223], a[20:23], a[60:63], v[220:223]
v_mfma_f32_16x16x32_bf16 a[168:171], a[24:27], a[60:63], a[168:171]
v_mfma_f32_16x16x32_bf16 a[172:175], a[28:31], a[60:63], a[172:175]
s_waitcnt lgkmcnt(0)
v_mfma_f32_16x16x32_bf16 v[32:35], a[64:67], a[96:99], v[32:35]
s_waitcnt vmcnt(16)
s_barrier
v_mfma_f32_16x16x32_bf16 v[36:39], a[68:71], a[96:99], v[36:39]
v_mfma_f32_16x16x32_bf16 v[96:99], a[72:75], a[96:99], v[96:99]
ds_read_b64_tr_b16 a[32:33], v10 offset:0
v_mfma_f32_16x16x32_bf16 v[100:103], a[76:79], a[96:99], v[100:103]
s_add_u32 m0, s55, 98304
s_nop 0
buffer_load_dwordx4 v2, s[4:7], s48 offen sc1 lds
v_mfma_f32_16x16x32_bf16 v[160:163], a[80:83], a[96:99], v[160:163]
ds_read_b64_tr_b16 a[34:35], v10 offset:2048
v_mfma_f32_16x16x32_bf16 v[164:167], a[84:87], a[96:99], v[164:167]
v_mfma_f32_16x16x32_bf16 v[224:227], a[88:91], a[96:99], v[224:227]
ds_read_b128 a[0:3], v8 offset:0
v_mfma_f32_16x16x32_bf16 v[228:231], a[92:95], a[96:99], v[228:231]
buffer_load_dwordx4 v2, s[4:7], s48 offen offset:1024 sc1 lds
v_mfma_f32_16x16x32_bf16 v[40:43], a[64:67], a[100:103], v[40:43]
ds_read_b128 a[4:7], v8 offset:256
v_mfma_f32_16x16x32_bf16 v[44:47], a[68:71], a[100:103], v[44:47]
v_mfma_f32_16x16x32_bf16 v[104:107], a[72:75], a[100:103], v[104:107]
ds_read_b128 a[8:11], v8 offset:2048
v_mfma_f32_16x16x32_bf16 v[108:111], a[76:79], a[100:103], v[108:111]
buffer_load_dwordx4 v3, s[4:7], s48 offen offset:2048 sc1 lds
v_mfma_f32_16x16x32_bf16 v[168:171], a[80:83], a[100:103], v[168:171]
ds_read_b128 a[12:15], v8 offset:2304
v_mfma_f32_16x16x32_bf16 v[172:175], a[84:87], a[100:103], v[172:175]
v_mfma_f32_16x16x32_bf16 v[232:235], a[88:91], a[100:103], v[232:235]
ds_read_b128 a[16:19], v8 offset:4096
v_mfma_f32_16x16x32_bf16 v[236:239], a[92:95], a[100:103], v[236:239]
buffer_load_dwordx4 v3, s[4:7], s48 offen offset:3072 sc1 lds
s_add_u32 s48, s48, 2048
v_mfma_f32_16x16x32_bf16 v[48:51], a[64:67], a[104:107], v[48:51]
ds_read_b128 a[20:23], v8 offset:4352
v_mfma_f32_16x16x32_bf16 v[52:55], a[68:71], a[104:107], v[52:55]
v_mfma_f32_16x16x32_bf16 v[112:115], a[72:75], a[104:107], v[112:115]
ds_read_b128 a[24:27], v8 offset:6144
v_mfma_f32_16x16x32_bf16 v[116:119], a[76:79], a[104:107], v[116:119]
s_add_u32 m0, s54, 114688
s_nop 0
buffer_load_dwordx4 v4, s[8:11], s49 offen lds
v_mfma_f32_16x16x32_bf16 v[176:179], a[80:83], a[104:107], v[176:179]
ds_read_b128 a[28:31], v8 offset:6400
v_mfma_f32_16x16x32_bf16 v[180:183], a[84:87], a[104:107], v[180:183]
v_mfma_f32_16x16x32_bf16 a[128:131], a[88:91], a[104:107], a[128:131]
ds_read_b64_tr_b16 a[36:37], v12 offset:0
v_mfma_f32_16x16x32_bf16 a[132:135], a[92:95], a[104:107], a[132:135]
buffer_load_dwordx4 v5, s[8:11], s49 offen offset:1024 lds
v_mfma_f32_16x16x32_bf16 v[56:59], a[64:67], a[108:111], v[56:59]
ds_read_b64_tr_b16 a[38:39], v12 offset:2048
v_mfma_f32_16x16x32_bf16 v[60:63], a[68:71], a[108:111], v[60:63]
v_mfma_f32_16x16x32_bf16 v[120:123], a[72:75], a[108:111], v[120:123]
ds_read_b64_tr_b16 a[40:41], v14 offset:0
v_mfma_f32_16x16x32_bf16 v[124:127], a[76:79], a[108:111], v[124:127]
buffer_load_dwordx4 v6, s[8:11], s49 offen offset:2048 lds
v_mfma_f32_16x16x32_bf16 v[184:187], a[80:83], a[108:111], v[184:187]
ds_read_b64_tr_b16 a[42:43], v14 offset:2048
v_mfma_f32_16x16x32_bf16 v[188:191], a[84:87], a[108:111], v[188:191]
v_mfma_f32_16x16x32_bf16 a[136:139], a[88:91], a[108:111], a[136:139]
ds_read_b64_tr_b16 a[44:45], v16 offset:0
v_mfma_f32_16x16x32_bf16 a[140:143], a[92:95], a[108:111], a[140:143]
buffer_load_dwordx4 v7, s[8:11], s49 offen offset:3072 lds
s_add_u32 s49, s49, s50
v_mfma_f32_16x16x32_bf16 v[64:67], a[64:67], a[112:115], v[64:67]
ds_read_b64_tr_b16 a[46:47], v16 offset:2048
v_mfma_f32_16x16x32_bf16 v[68:71], a[68:71], a[112:115], v[68:71]
v_mfma_f32_16x16x32_bf16 v[128:131], a[72:75], a[112:115], v[128:131]
ds_read_b64_tr_b16 a[48:49], v10 offset:8192
v_mfma_f32_16x16x32_bf16 v[132:135], a[76:79], a[112:115], v[132:135]
v_mfma_f32_16x16x32_bf16 v[192:195], a[80:83], a[112:115], v[192:195]
ds_read_b64_tr_b16 a[50:51], v10 offset:10240
v_mfma_f32_16x16x32_bf16 v[196:199], a[84:87], a[112:115], v[196:199]
v_mfma_f32_16x16x32_bf16 a[144:147], a[88:91], a[112:115], a[144:147]
ds_read_b64_tr_b16 a[52:53], v12 offset:8192
v_mfma_f32_16x16x32_bf16 a[148:151], a[92:95], a[112:115], a[148:151]
v_mfma_f32_16x16x32_bf16 v[72:75], a[64:67], a[116:119], v[72:75]
ds_read_b64_tr_b16 a[54:55], v12 offset:10240
v_mfma_f32_16x16x32_bf16 v[76:79], a[68:71], a[116:119], v[76:79]
v_mfma_f32_16x16x32_bf16 v[136:139], a[72:75], a[116:119], v[136:139]
ds_read_b64_tr_b16 a[56:57], v14 offset:8192
v_mfma_f32_16x16x32_bf16 v[140:143], a[76:79], a[116:119], v[140:143]
v_mfma_f32_16x16x32_bf16 v[200:203], a[80:83], a[116:119], v[200:203]
ds_read_b64_tr_b16 a[58:59], v14 offset:10240
v_mfma_f32_16x16x32_bf16 v[204:207], a[84:87], a[116:119], v[204:207]
v_mfma_f32_16x16x32_bf16 a[152:155], a[88:91], a[116:119], a[152:155]
ds_read_b64_tr_b16 a[60:61], v16 offset:8192
v_mfma_f32_16x16x32_bf16 a[156:159], a[92:95], a[116:119], a[156:159]
v_mfma_f32_16x16x32_bf16 v[80:83], a[64:67], a[120:123], v[80:83]
ds_read_b64_tr_b16 a[62:63], v16 offset:10240
v_mfma_f32_16x16x32_bf16 v[84:87], a[68:71], a[120:123], v[84:87]
v_mfma_f32_16x16x32_bf16 v[144:147], a[72:75], a[120:123], v[144:147]
v_mfma_f32_16x16x32_bf16 v[148:151], a[76:79], a[120:123], v[148:151]
v_mfma_f32_16x16x32_bf16 v[208:211], a[80:83], a[120:123], v[208:211]
v_mfma_f32_16x16x32_bf16 v[212:215], a[84:87], a[120:123], v[212:215]
v_mfma_f32_16x16x32_bf16 a[160:163], a[88:91], a[120:123], a[160:163]
v_mfma_f32_16x16x32_bf16 a[164:167], a[92:95], a[120:123], a[164:167]
v_mfma_f32_16x16x32_bf16 v[88:91], a[64:67], a[124:127], v[88:91]
v_mfma_f32_16x16x32_bf16 v[92:95], a[68:71], a[124:127], v[92:95]
v_mfma_f32_16x16x32_bf16 v[152:155], a[72:75], a[124:127], v[152:155]
v_mfma_f32_16x16x32_bf16 v[156:159], a[76:79], a[124:127], v[156:159]
v_mfma_f32_16x16x32_bf16 v[216:219], a[80:83], a[124:127], v[216:219]
v_mfma_f32_16x16x32_bf16 v[220:223], a[84:87], a[124:127], v[220:223]
v_mfma_f32_16x16x32_bf16 a[168:171], a[88:91], a[124:127], a[168:171]
v_mfma_f32_16x16x32_bf16 a[172:175], a[92:95], a[124:127], a[172:175]
s_sub_u32 s51, s51, 1
s_cmp_lg_u32 s51, 0
s_cbranch_scc1 L_gl_9278
L_gl_end_9277:
s_waitcnt lgkmcnt(0)
v_mfma_f32_16x16x32_bf16 v[32:35], a[0:3], a[32:35], v[32:35]
s_waitcnt vmcnt(16)
s_barrier
s_cmp_lg_u32 s91, 2
s_cbranch_scc1 L_nll_9279
s_cmp_lg_u32 s3, 0
s_cbranch_scc1 L_nll_9279
s_and_b32 s94, s73, 255
s_lshl_b32 s94, s94, 8
s_add_u32 s94, s94, 98566144
v_mov_b32 v29, 0
buffer_load_dword v31, v29, s[4:7], s94 offen sc1
L_nll_9279:
v_mfma_f32_16x16x32_bf16 v[36:39], a[4:7], a[32:35], v[36:39]
v_mfma_f32_16x16x32_bf16 v[96:99], a[8:11], a[32:35], v[96:99]
ds_read_b64_tr_b16 a[96:97], v10 offset:32768
v_mfma_f32_16x16x32_bf16 v[100:103], a[12:15], a[32:35], v[100:103]
v_mfma_f32_16x16x32_bf16 v[160:163], a[16:19], a[32:35], v[160:163]
ds_read_b64_tr_b16 a[98:99], v10 offset:34816
v_mfma_f32_16x16x32_bf16 v[164:167], a[20:23], a[32:35], v[164:167]
v_mfma_f32_16x16x32_bf16 v[224:227], a[24:27], a[32:35], v[224:227]
ds_read_b128 a[64:67], v8 offset:32768
v_mfma_f32_16x16x32_bf16 v[228:231], a[28:31], a[32:35], v[228:231]
v_mfma_f32_16x16x32_bf16 v[40:43], a[0:3], a[36:39], v[40:43]
ds_read_b128 a[68:71], v8 offset:33024
v_mfma_f32_16x16x32_bf16 v[44:47], a[4:7], a[36:39], v[44:47]
v_mfma_f32_16x16x32_bf16 v[104:107], a[8:11], a[36:39], v[104:107]
ds_read_b128 a[72:75], v8 offset:34816
v_mfma_f32_16x16x32_bf16 v[108:111], a[12:15], a[36:39], v[108:111]
v_mfma_f32_16x16x32_bf16 v[168:171], a[16:19], a[36:39], v[168:171]
ds_read_b128 a[76:79], v8 offset:35072
v_mfma_f32_16x16x32_bf16 v[172:175], a[20:23], a[36:39], v[172:175]
v_mfma_f32_16x16x32_bf16 v[232:235], a[24:27], a[36:39], v[232:235]
ds_read_b128 a[80:83], v8 offset:36864
v_mfma_f32_16x16x32_bf16 v[236:239], a[28:31], a[36:39], v[236:239]
v_mfma_f32_16x16x32_bf16 v[48:51], a[0:3], a[40:43], v[48:51]
ds_read_b128 a[84:87], v8 offset:37120
v_mfma_f32_16x16x32_bf16 v[52:55], a[4:7], a[40:43], v[52:55]
v_mfma_f32_16x16x32_bf16 v[112:115], a[8:11], a[40:43], v[112:115]
ds_read_b128 a[88:91], v8 offset:38912
v_mfma_f32_16x16x32_bf16 v[116:119], a[12:15], a[40:43], v[116:119]
v_mfma_f32_16x16x32_bf16 v[176:179], a[16:19], a[40:43], v[176:179]
ds_read_b128 a[92:95], v8 offset:39168
v_mfma_f32_16x16x32_bf16 v[180:183], a[20:23], a[40:43], v[180:183]
v_mfma_f32_16x16x32_bf16 a[128:131], a[24:27], a[40:43], a[128:131]
ds_read_b64_tr_b16 a[100:101], v12 offset:32768
v_mfma_f32_16x16x32_bf16 a[132:135], a[28:31], a[40:43], a[132:135]
v_mfma_f32_16x16x32_bf16 v[56:59], a[0:3], a[44:47], v[56:59]
ds_read_b64_tr_b16 a[102:103], v12 offset:34816
v_mfma_f32_16x16x32_bf16 v[60:63], a[4:7], a[44:47], v[60:63]
v_mfma_f32_16x16x32_bf16 v[120:123], a[8:11], a[44:47], v[120:123]
ds_read_b64_tr_b16 a[104:105], v14 offset:32768
v_mfma_f32_16x16x32_bf16 v[124:127], a[12:15], a[44:47], v[124:127]
v_mfma_f32_16x16x32_bf16 v[184:187], a[16:19], a[44:47], v[184:187]
ds_read_b64_tr_b16 a[106:107], v14 offset:34816
v_mfma_f32_16x16x32_bf16 v[188:191], a[20:23], a[44:47], v[188:191]
v_mfma_f32_16x16x32_bf16 a[136:139], a[24:27], a[44:47], a[136:139]
ds_read_b64_tr_b16 a[108:109], v16 offset:32768
v_mfma_f32_16x16x32_bf16 a[140:143], a[28:31], a[44:47], a[140:143]
v_mfma_f32_16x16x32_bf16 v[64:67], a[0:3], a[48:51], v[64:67]
ds_read_b64_tr_b16 a[110:111], v16 offset:34816
s_cmp_lg_u32 s91, 1
s_cbranch_scc1 L_npf_9280
s_cmp_ge_u32 s90, 4
s_cbranch_scc1 L_pfh_9281
s_add_u32 m0, s87, 0
s_nop 0
buffer_load_dwordx4 v20, s[4:7], s84 offen sc1 lds
buffer_load_dwordx4 v20, s[4:7], s84 offen offset:1024 sc1 lds
buffer_load_dwordx4 v21, s[4:7], s84 offen offset:2048 sc1 lds
buffer_load_dwordx4 v21, s[4:7], s84 offen offset:3072 sc1 lds
s_add_u32 s84, s84, 2048
s_add_u32 m0, s54, 16384
s_nop 0
buffer_load_dwordx4 v22, s[80:83], s85 offen lds
buffer_load_dwordx4 v23, s[80:83], s85 offen offset:1024 lds
buffer_load_dwordx4 v24, s[80:83], s85 offen offset:2048 lds
buffer_load_dwordx4 v25, s[80:83], s85 offen offset:3072 lds
s_add_u32 s85, s85, s86
s_branch L_npf_9280
L_pfh_9281:
s_add_u32 m0, s87, 0
s_nop 0
buffer_load_dwordx4 v20, s[4:7], s84 offen sc1 lds
buffer_load_dwordx4 v20, s[4:7], s84 offen offset:1024 sc1 lds
s_add_u32 s84, s84, 2048
s_add_u32 m0, s54, 16384
s_nop 0
buffer_load_dwordx4 v22, s[80:83], s85 offen lds
buffer_load_dwordx4 v23, s[80:83], s85 offen offset:1024 lds
buffer_load_dwordx4 v24, s[80:83], s85 offen offset:2048 lds
buffer_load_dwordx4 v25, s[80:83], s85 offen offset:3072 lds
s_add_u32 s85, s85, s86
L_npf_9280:
v_mfma_f32_16x16x32_bf16 v[68:71], a[4:7], a[48:51], v[68:71]
v_mfma_f32_16x16x32_bf16 v[128:131], a[8:11], a[48:51], v[128:131]
ds_read_b64_tr_b16 a[112:113], v10 offset:40960
v_mfma_f32_16x16x32_bf16 v[132:135], a[12:15], a[48:51], v[132:135]
v_mfma_f32_16x16x32_bf16 v[192:195], a[16:19], a[48:51], v[192:195]
ds_read_b64_tr_b16 a[114:115], v10 offset:43008
v_mfma_f32_16x16x32_bf16 v[196:199], a[20:23], a[48:51], v[196:199]
v_mfma_f32_16x16x32_bf16 a[144:147], a[24:27], a[48:51], a[144:147]
ds_read_b64_tr_b16 a[116:117], v12 offset:40960
v_mfma_f32_16x16x32_bf16 a[148:151], a[28:31], a[48:51], a[148:151]
v_mfma_f32_16x16x32_bf16 v[72:75], a[0:3], a[52:55], v[72:75]
ds_read_b64_tr_b16 a[118:119], v12 offset:43008
v_mfma_f32_16x16x32_bf16 v[76:79], a[4:7], a[52:55], v[76:79]
v_mfma_f32_16x16x32_bf16 v[136:139], a[8:11], a[52:55], v[136:139]
ds_read_b64_tr_b16 a[120:121], v14 offset:40960
v_mfma_f32_16x16x32_bf16 v[140:143], a[12:15], a[52:55], v[140:143]
v_mfma_f32_16x16x32_bf16 v[200:203], a[16:19], a[52:55], v[200:203]
ds_read_b64_tr_b16 a[122:123], v14 offset:43008
v_mfma_f32_16x16x32_bf16 v[204:207], a[20:23], a[52:55], v[204:207]
v_mfma_f32_16x16x32_bf16 a[152:155], a[24:27], a[52:55], a[152:155]
ds_read_b64_tr_b16 a[124:125], v16 offset:40960
v_mfma_f32_16x16x32_bf16 a[156:159], a[28:31], a[52:55], a[156:159]
v_mfma_f32_16x16x32_bf16 v[80:83], a[0:3], a[56:59], v[80:83]
ds_read_b64_tr_b16 a[126:127], v16 offset:43008
v_mfma_f32_16x16x32_bf16 v[84:87], a[4:7], a[56:59], v[84:87]
v_mfma_f32_16x16x32_bf16 v[144:147], a[8:11], a[56:59], v[144:147]
v_mfma_f32_16x16x32_bf16 v[148:151], a[12:15], a[56:59], v[148:151]
v_mfma_f32_16x16x32_bf16 v[208:211], a[16:19], a[56:59], v[208:211]
v_mfma_f32_16x16x32_bf16 v[212:215], a[20:23], a[56:59], v[212:215]
v_mfma_f32_16x16x32_bf16 a[160:163], a[24:27], a[56:59], a[160:163]
v_mfma_f32_16x16x32_bf16 a[164:167], a[28:31], a[56:59], a[164:167]
v_mfma_f32_16x16x32_bf16 v[88:91], a[0:3], a[60:63], v[88:91]
v_mfma_f32_16x16x32_bf16 v[92:95], a[4:7], a[60:63], v[92:95]
v_mfma_f32_16x16x32_bf16 v[152:155], a[8:11], a[60:63], v[152:155]
v_mfma_f32_16x16x32_bf16 v[156:159], a[12:15], a[60:63], v[156:159]
v_mfma_f32_16x16x32_bf16 v[216:219], a[16:19], a[60:63], v[216:219]
v_mfma_f32_16x16x32_bf16 v[220:223], a[20:23], a[60:63], v[220:223]
v_mfma_f32_16x16x32_bf16 a[168:171], a[24:27], a[60:63], a[168:171]
v_mfma_f32_16x16x32_bf16 a[172:175], a[28:31], a[60:63], a[172:175]
s_waitcnt lgkmcnt(0)
v_mfma_f32_16x16x32_bf16 v[32:35], a[64:67], a[96:99], v[32:35]
s_cmp_lg_u32 s91, 1
s_cbranch_scc1 L_tw_9282
s_waitcnt vmcnt(14)
s_branch L_tw_9283
L_tw_9282:
s_waitcnt vmcnt(8)
L_tw_9283:
s_barrier
v_mfma_f32_16x16x32_bf16 v[36:39], a[68:71], a[96:99], v[36:39]
v_mfma_f32_16x16x32_bf16 v[96:99], a[72:75], a[96:99], v[96:99]
ds_read_b64_tr_b16 a[32:33], v11 offset:0
v_mfma_f32_16x16x32_bf16 v[100:103], a[76:79], a[96:99], v[100:103]
v_mfma_f32_16x16x32_bf16 v[160:163], a[80:83], a[96:99], v[160:163]
ds_read_b64_tr_b16 a[34:35], v11 offset:2048
v_mfma_f32_16x16x32_bf16 v[164:167], a[84:87], a[96:99], v[164:167]
v_mfma_f32_16x16x32_bf16 v[224:227], a[88:91], a[96:99], v[224:227]
ds_read_b128 a[0:3], v9 offset:0
v_mfma_f32_16x16x32_bf16 v[228:231], a[92:95], a[96:99], v[228:231]
v_mfma_f32_16x16x32_bf16 v[40:43], a[64:67], a[100:103], v[40:43]
ds_read_b128 a[4:7], v9 offset:256
v_mfma_f32_16x16x32_bf16 v[44:47], a[68:71], a[100:103], v[44:47]
v_mfma_f32_16x16x32_bf16 v[104:107], a[72:75], a[100:103], v[104:107]
ds_read_b128 a[8:11], v9 offset:2048
v_mfma_f32_16x16x32_bf16 v[108:111], a[76:79], a[100:103], v[108:111]
v_mfma_f32_16x16x32_bf16 v[168:171], a[80:83], a[100:103], v[168:171]
ds_read_b128 a[12:15], v9 offset:2304
v_mfma_f32_16x16x32_bf16 v[172:175], a[84:87], a[100:103], v[172:175]
v_mfma_f32_16x16x32_bf16 v[232:235], a[88:91], a[100:103], v[232:235]
ds_read_b128 a[16:19], v9 offset:4096
v_mfma_f32_16x16x32_bf16 v[236:239], a[92:95], a[100:103], v[236:239]
v_mfma_f32_16x16x32_bf16 v[48:51], a[64:67], a[104:107], v[48:51]
ds_read_b128 a[20:23], v9 offset:4352
v_mfma_f32_16x16x32_bf16 v[52:55], a[68:71], a[104:107], v[52:55]
v_mfma_f32_16x16x32_bf16 v[112:115], a[72:75], a[104:107], v[112:115]
ds_read_b128 a[24:27], v9 offset:6144
v_mfma_f32_16x16x32_bf16 v[116:119], a[76:79], a[104:107], v[116:119]
v_mfma_f32_16x16x32_bf16 v[176:179], a[80:83], a[104:107], v[176:179]
ds_read_b128 a[28:31], v9 offset:6400
v_mfma_f32_16x16x32_bf16 v[180:183], a[84:87], a[104:107], v[180:183]
v_mfma_f32_16x16x32_bf16 a[128:131], a[88:91], a[104:107], a[128:131]
ds_read_b64_tr_b16 a[36:37], v13 offset:0
v_mfma_f32_16x16x32_bf16 a[132:135], a[92:95], a[104:107], a[132:135]
v_mfma_f32_16x16x32_bf16 v[56:59], a[64:67], a[108:111], v[56:59]
ds_read_b64_tr_b16 a[38:39], v13 offset:2048
v_mfma_f32_16x16x32_bf16 v[60:63], a[68:71], a[108:111], v[60:63]
v_mfma_f32_16x16x32_bf16 v[120:123], a[72:75], a[108:111], v[120:123]
ds_read_b64_tr_b16 a[40:41], v15 offset:0
v_mfma_f32_16x16x32_bf16 v[124:127], a[76:79], a[108:111], v[124:127]
v_mfma_f32_16x16x32_bf16 v[184:187], a[80:83], a[108:111], v[184:187]
ds_read_b64_tr_b16 a[42:43], v15 offset:2048
v_mfma_f32_16x16x32_bf16 v[188:191], a[84:87], a[108:111], v[188:191]
v_mfma_f32_16x16x32_bf16 a[136:139], a[88:91], a[108:111], a[136:139]
ds_read_b64_tr_b16 a[44:45], v17 offset:0
v_mfma_f32_16x16x32_bf16 a[140:143], a[92:95], a[108:111], a[140:143]
v_mfma_f32_16x16x32_bf16 v[64:67], a[64:67], a[112:115], v[64:67]
ds_read_b64_tr_b16 a[46:47], v17 offset:2048
s_cmp_lg_u32 s91, 1
s_cbranch_scc1 L_npf_10284
s_cmp_ge_u32 s90, 4
s_cbranch_scc1 L_pfh_10285
s_add_u32 m0, s87, 32768
s_nop 0
buffer_load_dwordx4 v20, s[4:7], s84 offen sc1 lds
buffer_load_dwordx4 v20, s[4:7], s84 offen offset:1024 sc1 lds
buffer_load_dwordx4 v21, s[4:7], s84 offen offset:2048 sc1 lds
buffer_load_dwordx4 v21, s[4:7], s84 offen offset:3072 sc1 lds
s_add_u32 s84, s84, 2048
s_add_u32 m0, s54, 49152
s_nop 0
buffer_load_dwordx4 v22, s[80:83], s85 offen lds
buffer_load_dwordx4 v23, s[80:83], s85 offen offset:1024 lds
buffer_load_dwordx4 v24, s[80:83], s85 offen offset:2048 lds
buffer_load_dwordx4 v25, s[80:83], s85 offen offset:3072 lds
s_add_u32 s85, s85, s86
s_branch L_npf_10284
L_pfh_10285:
s_add_u32 m0, s87, 32768
s_nop 0
buffer_load_dwordx4 v20, s[4:7], s84 offen sc1 lds
buffer_load_dwordx4 v20, s[4:7], s84 offen offset:1024 sc1 lds
s_add_u32 s84, s84, 2048
s_add_u32 m0, s54, 49152
s_nop 0
buffer_load_dwordx4 v22, s[80:83], s85 offen lds
buffer_load_dwordx4 v23, s[80:83], s85 offen offset:1024 lds
buffer_load_dwordx4 v24, s[80:83], s85 offen offset:2048 lds
buffer_load_dwordx4 v25, s[80:83], s85 offen offset:3072 lds
s_add_u32 s85, s85, s86
L_npf_10284:
v_mfma_f32_16x16x32_bf16 v[68:71], a[68:71], a[112:115], v[68:71]
v_mfma_f32_16x16x32_bf16 v[128:131], a[72:75], a[112:115], v[128:131]
ds_read_b64_tr_b16 a[48:49], v11 offset:8192
v_mfma_f32_16x16x32_bf16 v[132:135], a[76:79], a[112:115], v[132:135]
v_mfma_f32_16x16x32_bf16 v[192:195], a[80:83], a[112:115], v[192:195]
ds_read_b64_tr_b16 a[50:51], v11 offset:10240
v_mfma_f32_16x16x32_bf16 v[196:199], a[84:87], a[112:115], v[196:199]
v_mfma_f32_16x16x32_bf16 a[144:147], a[88:91], a[112:115], a[144:147]
ds_read_b64_tr_b16 a[52:53], v13 offset:8192
v_mfma_f32_16x16x32_bf16 a[148:151], a[92:95], a[112:115], a[148:151]
v_mfma_f32_16x16x32_bf16 v[72:75], a[64:67], a[116:119], v[72:75]
ds_read_b64_tr_b16 a[54:55], v13 offset:10240
v_mfma_f32_16x16x32_bf16 v[76:79], a[68:71], a[116:119], v[76:79]
v_mfma_f32_16x16x32_bf16 v[136:139], a[72:75], a[116:119], v[136:139]
ds_read_b64_tr_b16 a[56:57], v15 offset:8192
v_mfma_f32_16x16x32_bf16 v[140:143], a[76:79], a[116:119], v[140:143]
v_mfma_f32_16x16x32_bf16 v[200:203], a[80:83], a[116:119], v[200:203]
ds_read_b64_tr_b16 a[58:59], v15 offset:10240
v_mfma_f32_16x16x32_bf16 v[204:207], a[84:87], a[116:119], v[204:207]
v_mfma_f32_16x16x32_bf16 a[152:155], a[88:91], a[116:119], a[152:155]
ds_read_b64_tr_b16 a[60:61], v17 offset:8192
v_mfma_f32_16x16x32_bf16 a[156:159], a[92:95], a[116:119], a[156:159]
v_mfma_f32_16x16x32_bf16 v[80:83], a[64:67], a[120:123], v[80:83]
ds_read_b64_tr_b16 a[62:63], v17 offset:10240
v_mfma_f32_16x16x32_bf16 v[84:87], a[68:71], a[120:123], v[84:87]
v_mfma_f32_16x16x32_bf16 v[144:147], a[72:75], a[120:123], v[144:147]
v_mfma_f32_16x16x32_bf16 v[148:151], a[76:79], a[120:123], v[148:151]
v_mfma_f32_16x16x32_bf16 v[208:211], a[80:83], a[120:123], v[208:211]
v_mfma_f32_16x16x32_bf16 v[212:215], a[84:87], a[120:123], v[212:215]
v_mfma_f32_16x16x32_bf16 a[160:163], a[88:91], a[120:123], a[160:163]
v_mfma_f32_16x16x32_bf16 a[164:167], a[92:95], a[120:123], a[164:167]
v_mfma_f32_16x16x32_bf16 v[88:91], a[64:67], a[124:127], v[88:91]
v_mfma_f32_16x16x32_bf16 v[92:95], a[68:71], a[124:127], v[92:95]
v_mfma_f32_16x16x32_bf16 v[152:155], a[72:75], a[124:127], v[152:155]
v_mfma_f32_16x16x32_bf16 v[156:159], a[76:79], a[124:127], v[156:159]
v_mfma_f32_16x16x32_bf16 v[216:219], a[80:83], a[124:127], v[216:219]
v_mfma_f32_16x16x32_bf16 v[220:223], a[84:87], a[124:127], v[220:223]
v_mfma_f32_16x16x32_bf16 a[168:171], a[88:91], a[124:127], a[168:171]
v_mfma_f32_16x16x32_bf16 a[172:175], a[92:95], a[124:127], a[172:175]
s_waitcnt lgkmcnt(0)
v_mfma_f32_16x16x32_bf16 v[32:35], a[0:3], a[32:35], v[32:35]
s_cmp_lg_u32 s91, 1
s_cbranch_scc1 L_tw_10286
s_waitcnt vmcnt(12)
s_branch L_tw_10287
L_tw_10286:
s_waitcnt vmcnt(0)
L_tw_10287:
s_barrier
s_cmp_lg_u32 s91, 2
s_cbranch_scc1 L_nld_12288
s_cmp_lg_u32 s3, 0
s_cbranch_scc1 L_nld_12288
s_bfe_u32 s94, s73, 0x80008
v_cmp_le_u32 vcc, s94, v31
v_mov_b32 v29, 131072
s_nop 0
v_cndmask_b32 v30, 0, 3, vcc
ds_write_b32 v29, v30
L_nld_12288:
v_mfma_f32_16x16x32_bf16 v[36:39], a[4:7], a[32:35], v[36:39]
v_mfma_f32_16x16x32_bf16 v[96:99], a[8:11], a[32:35], v[96:99]
ds_read_b64_tr_b16 a[96:97], v11 offset:32768
v_mfma_f32_16x16x32_bf16 v[100:103], a[12:15], a[32:35], v[100:103]
v_mfma_f32_16x16x32_bf16 v[160:163], a[16:19], a[32:35], v[160:163]
ds_read_b64_tr_b16 a[98:99], v11 offset:34816
v_mfma_f32_16x16x32_bf16 v[164:167], a[20:23], a[32:35], v[164:167]
v_mfma_f32_16x16x32_bf16 v[224:227], a[24:27], a[32:35], v[224:227]
ds_read_b128 a[64:67], v9 offset:32768
v_mfma_f32_16x16x32_bf16 v[228:231], a[28:31], a[32:35], v[228:231]
v_mfma_f32_16x16x32_bf16 v[40:43], a[0:3], a[36:39], v[40:43]
ds_read_b128 a[68:71], v9 offset:33024
v_mfma_f32_16x16x32_bf16 v[44:47], a[4:7], a[36:39], v[44:47]
v_mfma_f32_16x16x32_bf16 v[104:107], a[8:11], a[36:39], v[104:107]
ds_read_b128 a[72:75], v9 offset:34816
v_mfma_f32_16x16x32_bf16 v[108:111], a[12:15], a[36:39], v[108:111]
v_mfma_f32_16x16x32_bf16 v[168:171], a[16:19], a[36:39], v[168:171]
ds_read_b128 a[76:79], v9 offset:35072
v_mfma_f32_16x16x32_bf16 v[172:175], a[20:23], a[36:39], v[172:175]
v_mfma_f32_16x16x32_bf16 v[232:235], a[24:27], a[36:39], v[232:235]
ds_read_b128 a[80:83], v9 offset:36864
v_mfma_f32_16x16x32_bf16 v[236:239], a[28:31], a[36:39], v[236:239]
v_mfma_f32_16x16x32_bf16 v[48:51], a[0:3], a[40:43], v[48:51]
ds_read_b128 a[84:87], v9 offset:37120
v_mfma_f32_16x16x32_bf16 v[52:55], a[4:7], a[40:43], v[52:55]
v_mfma_f32_16x16x32_bf16 v[112:115], a[8:11], a[40:43], v[112:115]
ds_read_b128 a[88:91], v9 offset:38912
v_mfma_f32_16x16x32_bf16 v[116:119], a[12:15], a[40:43], v[116:119]
v_mfma_f32_16x16x32_bf16 v[176:179], a[16:19], a[40:43], v[176:179]
ds_read_b128 a[92:95], v9 offset:39168
v_mfma_f32_16x16x32_bf16 v[180:183], a[20:23], a[40:43], v[180:183]
v_mfma_f32_16x16x32_bf16 a[128:131], a[24:27], a[40:43], a[128:131]
ds_read_b64_tr_b16 a[100:101], v13 offset:32768
v_mfma_f32_16x16x32_bf16 a[132:135], a[28:31], a[40:43], a[132:135]
v_mfma_f32_16x16x32_bf16 v[56:59], a[0:3], a[44:47], v[56:59]
ds_read_b64_tr_b16 a[102:103], v13 offset:34816
v_mfma_f32_16x16x32_bf16 v[60:63], a[4:7], a[44:47], v[60:63]
v_mfma_f32_16x16x32_bf16 v[120:123], a[8:11], a[44:47], v[120:123]
ds_read_b64_tr_b16 a[104:105], v15 offset:32768
v_mfma_f32_16x16x32_bf16 v[124:127], a[12:15], a[44:47], v[124:127]
v_mfma_f32_16x16x32_bf16 v[184:187], a[16:19], a[44:47], v[184:187]
ds_read_b64_tr_b16 a[106:107], v15 offset:34816
v_mfma_f32_16x16x32_bf16 v[188:191], a[20:23], a[44:47], v[188:191]
v_mfma_f32_16x16x32_bf16 a[136:139], a[24:27], a[44:47], a[136:139]
ds_read_b64_tr_b16 a[108:109], v17 offset:32768
v_mfma_f32_16x16x32_bf16 a[140:143], a[28:31], a[44:47], a[140:143]
v_mfma_f32_16x16x32_bf16 v[64:67], a[0:3], a[48:51], v[64:67]
ds_read_b64_tr_b16 a[110:111], v17 offset:34816
s_cmp_lg_u32 s91, 1
s_cbranch_scc1 L_npf_12289
s_cmp_ge_u32 s90, 4
s_cbranch_scc1 L_pfh_12290
s_add_u32 m0, s87, 65536
s_nop 0
buffer_load_dwordx4 v20, s[4:7], s84 offen sc1 lds
buffer_load_dwordx4 v20, s[4:7], s84 offen offset:1024 sc1 lds
buffer_load_dwordx4 v21, s[4:7], s84 offen offset:2048 sc1 lds
buffer_load_dwordx4 v21, s[4:7], s84 offen offset:3072 sc1 lds
s_add_u32 s84, s84, 2048
s_add_u32 m0, s54, 81920
s_nop 0
buffer_load_dwordx4 v22, s[80:83], s85 offen lds
buffer_load_dwordx4 v23, s[80:83], s85 offen offset:1024 lds
buffer_load_dwordx4 v24, s[80:83], s85 offen offset:2048 lds
buffer_load_dwordx4 v25, s[80:83], s85 offen offset:3072 lds
s_add_u32 s85, s85, s86
s_branch L_npf_12289
L_pfh_12290:
s_add_u32 m0, s87, 65536
s_nop 0
buffer_load_dwordx4 v20, s[4:7], s84 offen sc1 lds
buffer_load_dwordx4 v20, s[4:7], s84 offen offset:1024 sc1 lds
s_add_u32 s84, s84, 2048
s_add_u32 m0, s54, 81920
s_nop 0
buffer_load_dwordx4 v22, s[80:83], s85 offen lds
buffer_load_dwordx4 v23, s[80:83], s85 offen offset:1024 lds
buffer_load_dwordx4 v24, s[80:83], s85 offen offset:2048 lds
buffer_load_dwordx4 v25, s[80:83], s85 offen offset:3072 lds
s_add_u32 s85, s85, s86
L_npf_12289:
v_mfma_f32_16x16x32_bf16 v[68:71], a[4:7], a[48:51], v[68:71]
v_mfma_f32_16x16x32_bf16 v[128:131], a[8:11], a[48:51], v[128:131]
ds_read_b64_tr_b16 a[112:113], v11 offset:40960
v_mfma_f32_16x16x32_bf16 v[132:135], a[12:15], a[48:51], v[132:135]
v_mfma_f32_16x16x32_bf16 v[192:195], a[16:19], a[48:51], v[192:195]
ds_read_b64_tr_b16 a[114:115], v11 offset:43008
v_mfma_f32_16x16x32_bf16 v[196:199], a[20:23], a[48:51], v[196:199]
v_mfma_f32_16x16x32_bf16 a[144:147], a[24:27], a[48:51], a[144:147]
ds_read_b64_tr_b16 a[116:117], v13 offset:40960
v_mfma_f32_16x16x32_bf16 a[148:151], a[28:31], a[48:51], a[148:151]
v_mfma_f32_16x16x32_bf16 v[72:75], a[0:3], a[52:55], v[72:75]
ds_read_b64_tr_b16 a[118:119], v13 offset:43008
v_mfma_f32_16x16x32_bf16 v[76:79], a[4:7], a[52:55], v[76:79]
v_mfma_f32_16x16x32_bf16 v[136:139], a[8:11], a[52:55], v[136:139]
ds_read_b64_tr_b16 a[120:121], v15 offset:40960
v_mfma_f32_16x16x32_bf16 v[140:143], a[12:15], a[52:55], v[140:143]
v_mfma_f32_16x16x32_bf16 v[200:203], a[16:19], a[52:55], v[200:203]
ds_read_b64_tr_b16 a[122:123], v15 offset:43008
v_mfma_f32_16x16x32_bf16 v[204:207], a[20:23], a[52:55], v[204:207]
v_mfma_f32_16x16x32_bf16 a[152:155], a[24:27], a[52:55], a[152:155]
ds_read_b64_tr_b16 a[124:125], v17 offset:40960
v_mfma_f32_16x16x32_bf16 a[156:159], a[28:31], a[52:55], a[156:159]
v_mfma_f32_16x16x32_bf16 v[80:83], a[0:3], a[56:59], v[80:83]
ds_read_b64_tr_b16 a[126:127], v17 offset:43008
v_mfma_f32_16x16x32_bf16 v[84:87], a[4:7], a[56:59], v[84:87]
v_mfma_f32_16x16x32_bf16 v[144:147], a[8:11], a[56:59], v[144:147]
v_mfma_f32_16x16x32_bf16 v[148:151], a[12:15], a[56:59], v[148:151]
v_mfma_f32_16x16x32_bf16 v[208:211], a[16:19], a[56:59], v[208:211]
v_mfma_f32_16x16x32_bf16 v[212:215], a[20:23], a[56:59], v[212:215]
v_mfma_f32_16x16x32_bf16 a[160:163], a[24:27], a[56:59], a[160:163]
v_mfma_f32_16x16x32_bf16 a[164:167], a[28:31], a[56:59], a[164:167]
v_mfma_f32_16x16x32_bf16 v[88:91], a[0:3], a[60:63], v[88:91]
v_mfma_f32_16x16x32_bf16 v[92:95], a[4:7], a[60:63], v[92:95]
v_mfma_f32_16x16x32_bf16 v[152:155], a[8:11], a[60:63], v[152:155]
v_mfma_f32_16x16x32_bf16 v[156:159], a[12:15], a[60:63], v[156:159]
v_mfma_f32_16x16x32_bf16 v[216:219], a[16:19], a[60:63], v[216:219]
v_mfma_f32_16x16x32_bf16 v[220:223], a[20:23], a[60:63], v[220:223]
v_mfma_f32_16x16x32_bf16 a[168:171], a[24:27], a[60:63], a[168:171]
v_mfma_f32_16x16x32_bf16 a[172:175], a[28:31], a[60:63], a[172:175]
s_waitcnt lgkmcnt(0)
v_mfma_f32_16x16x32_bf16 v[32:35], a[64:67], a[96:99], v[32:35]
s_barrier
s_cmp_lg_u32 s91, 2
s_cbranch_scc1 L_nlp_12291
v_mov_b32 v29, 131072
ds_read_b32 v30, v29
s_waitcnt lgkmcnt(0)
v_readfirstlane_b32 s91, v30
s_cmp_eq_u32 s91, 0
s_cbranch_scc1 L_nlp_12291
s_cmp_ge_u32 s90, 4
s_cbranch_scc1 L_lph_12292
s_add_u32 m0, s87, 0
s_nop 0
buffer_load_dwordx4 v20, s[4:7], s84 offen sc1 lds
buffer_load_dwordx4 v20, s[4:7], s84 offen offset:1024 sc1 lds
buffer_load_dwordx4 v21, s[4:7], s84 offen offset:2048 sc1 lds
buffer_load_dwordx4 v21, s[4:7], s84 offen offset:3072 sc1 lds
s_add_u32 s84, s84, 2048
s_add_u32 m0, s54, 16384
s_nop 0
buffer_load_dwordx4 v22, s[80:83], s85 offen lds
buffer_load_dwordx4 v23, s[80:83], s85 offen offset:1024 lds
buffer_load_dwordx4 v24, s[80:83], s85 offen offset:2048 lds
buffer_load_dwordx4 v25, s[80:83], s85 offen offset:3072 lds
s_add_u32 s85, s85, s86
s_add_u32 m0, s87, 32768
s_nop 0
buffer_load_dwordx4 v20, s[4:7], s84 offen sc1 lds
buffer_load_dwordx4 v20, s[4:7], s84 offen offset:1024 sc1 lds
buffer_load_dwordx4 v21, s[4:7], s84 offen offset:2048 sc1 lds
buffer_load_dwordx4 v21, s[4:7], s84 offen offset:3072 sc1 lds
s_add_u32 s84, s84, 2048
s_add_u32 m0, s54, 49152
s_nop 0
buffer_load_dwordx4 v22, s[80:83], s85 offen lds
buffer_load_dwordx4 v23, s[80:83], s85 offen offset:1024 lds
buffer_load_dwordx4 v24, s[80:83], s85 offen offset:2048 lds
buffer_load_dwordx4 v25, s[80:83], s85 offen offset:3072 lds
s_add_u32 s85, s85, s86
s_add_u32 m0, s87, 65536
s_nop 0
buffer_load_dwordx4 v20, s[4:7], s84 offen sc1 lds
buffer_load_dwordx4 v20, s[4:7], s84 offen offset:1024 sc1 lds
buffer_load_dwordx4 v21, s[4:7], s84 offen offset:2048 sc1 lds
buffer_load_dwordx4 v21, s[4:7], s84 offen offset:3072 sc1 lds
s_add_u32 s84, s84, 2048
s_add_u32 m0, s54, 81920
s_nop 0
buffer_load_dwordx4 v22, s[80:83], s85 offen lds
buffer_load_dwordx4 v23, s[80:83], s85 offen offset:1024 lds
buffer_load_dwordx4 v24, s[80:83], s85 offen offset:2048 lds
buffer_load_dwordx4 v25, s[80:83], s85 offen offset:3072 lds
s_add_u32 s85, s85, s86
s_add_u32 m0, s87, 98304
s_nop 0
buffer_load_dwordx4 v20, s[4:7], s84 offen sc1 lds
buffer_load_dwordx4 v20, s[4:7], s84 offen offset:1024 sc1 lds
buffer_load_dwordx4 v21, s[4:7], s84 offen offset:2048 sc1 lds
buffer_load_dwordx4 v21, s[4:7], s84 offen offset:3072 sc1 lds
s_add_u32 s84, s84, 2048
s_add_u32 m0, s54, 114688
s_nop 0
buffer_load_dwordx4 v22, s[80:83], s85 offen lds
buffer_load_dwordx4 v23, s[80:83], s85 offen offset:1024 lds
buffer_load_dwordx4 v24, s[80:83], s85 offen offset:2048 lds
buffer_load_dwordx4 v25, s[80:83], s85 offen offset:3072 lds
s_add_u32 s85, s85, s86
s_branch L_nlp_12291
L_lph_12292:
s_add_u32 m0, s87, 0
s_nop 0
buffer_load_dwordx4 v20, s[4:7], s84 offen sc1 lds
buffer_load_dwordx4 v20, s[4:7], s84 offen offset:1024 sc1 lds
s_add_u32 s84, s84, 2048
s_add_u32 m0, s54, 16384
s_nop 0
buffer_load_dwordx4 v22, s[80:83], s85 offen lds
buffer_load_dwordx4 v23, s[80:83], s85 offen offset:1024 lds
buffer_load_dwordx4 v24, s[80:83], s85 offen offset:2048 lds
buffer_load_dwordx4 v25, s[80:83], s85 offen offset:3072 lds
s_add_u32 s85, s85, s86
s_add_u32 m0, s87, 32768
s_nop 0
buffer_load_dwordx4 v20, s[4:7], s84 offen sc1 lds
buffer_load_dwordx4 v20, s[4:7], s84 offen offset:1024 sc1 lds
s_add_u32 s84, s84, 2048
s_add_u32 m0, s54, 49152
s_nop 0
buffer_load_dwordx4 v22, s[80:83], s85 offen lds
buffer_load_dwordx4 v23, s[80:83], s85 offen offset:1024 lds
buffer_load_dwordx4 v24, s[80:83], s85 offen offset:2048 lds
buffer_load_dwordx4 v25, s[80:83], s85 offen offset:3072 lds
s_add_u32 s85, s85, s86
s_add_u32 m0, s87, 65536
s_nop 0
buffer_load_dwordx4 v20, s[4:7], s84 offen sc1 lds
buffer_load_dwordx4 v20, s[4:7], s84 offen offset:1024 sc1 lds
s_add_u32 s84, s84, 2048
s_add_u32 m0, s54, 81920
s_nop 0
buffer_load_dwordx4 v22, s[80:83], s85 offen lds
buffer_load_dwordx4 v23, s[80:83], s85 offen offset:1024 lds
buffer_load_dwordx4 v24, s[80:83], s85 offen offset:2048 lds
buffer_load_dwordx4 v25, s[80:83], s85 offen offset:3072 lds
s_add_u32 s85, s85, s86
s_add_u32 m0, s87, 98304
s_nop 0
buffer_load_dwordx4 v20, s[4:7], s84 offen sc1 lds
buffer_load_dwordx4 v20, s[4:7], s84 offen offset:1024 sc1 lds
s_add_u32 s84, s84, 2048
s_add_u32 m0, s54, 114688
s_nop 0
buffer_load_dwordx4 v22, s[80:83], s85 offen lds
buffer_load_dwordx4 v23, s[80:83], s85 offen offset:1024 lds
buffer_load_dwordx4 v24, s[80:83], s85 offen offset:2048 lds
buffer_load_dwordx4 v25, s[80:83], s85 offen offset:3072 lds
s_add_u32 s85, s85, s86
L_nlp_12291:
v_mfma_f32_16x16x32_bf16 v[36:39], a[68:71], a[96:99], v[36:39]
v_mfma_f32_16x16x32_bf16 v[96:99], a[72:75], a[96:99], v[96:99]
v_mfma_f32_16x16x32_bf16 v[100:103], a[76:79], a[96:99], v[100:103]
v_mfma_f32_16x16x32_bf16 v[160:163], a[80:83], a[96:99], v[160:163]
v_mfma_f32_16x16x32_bf16 v[164:167], a[84:87], a[96:99], v[164:167]
v_mfma_f32_16x16x32_bf16 v[224:227], a[88:91], a[96:99], v[224:227]
v_mfma_f32_16x16x32_bf16 v[228:231], a[92:95], a[96:99], v[228:231]
v_mfma_f32_16x16x32_bf16 v[40:43], a[64:67], a[100:103], v[40:43]
v_mfma_f32_16x16x32_bf16 v[44:47], a[68:71], a[100:103], v[44:47]
v_mfma_f32_16x16x32_bf16 v[104:107], a[72:75], a[100:103], v[104:107]
v_mfma_f32_16x16x32_bf16 v[108:111], a[76:79], a[100:103], v[108:111]
v_mfma_f32_16x16x32_bf16 v[168:171], a[80:83], a[100:103], v[168:171]
v_mfma_f32_16x16x32_bf16 v[172:175], a[84:87], a[100:103], v[172:175]
v_mfma_f32_16x16x32_bf16 v[232:235], a[88:91], a[100:103], v[232:235]
v_mfma_f32_16x16x32_bf16 v[236:239], a[92:95], a[100:103], v[236:239]
v_mfma_f32_16x16x32_bf16 v[48:51], a[64:67], a[104:107], v[48:51]
v_mfma_f32_16x16x32_bf16 v[52:55], a[68:71], a[104:107], v[52:55]
v_mfma_f32_16x16x32_bf16 v[112:115], a[72:75], a[104:107], v[112:115]
v_mfma_f32_16x16x32_bf16 v[116:119], a[76:79], a[104:107], v[116:119]
v_mfma_f32_16x16x32_bf16 v[176:179], a[80:83], a[104:107], v[176:179]
v_mfma_f32_16x16x32_bf16 v[180:183], a[84:87], a[104:107], v[180:183]
v_mfma_f32_16x16x32_bf16 a[128:131], a[88:91], a[104:107], a[128:131]
v_mfma_f32_16x16x32_bf16 a[132:135], a[92:95], a[104:107], a[132:135]
v_mfma_f32_16x16x32_bf16 v[56:59], a[64:67], a[108:111], v[56:59]
v_mfma_f32_16x16x32_bf16 v[60:63], a[68:71], a[108:111], v[60:63]
v_mfma_f32_16x16x32_bf16 v[120:123], a[72:75], a[108:111], v[120:123]
v_mfma_f32_16x16x32_bf16 v[124:127], a[76:79], a[108:111], v[124:127]
v_mfma_f32_16x16x32_bf16 v[184:187], a[80:83], a[108:111], v[184:187]
v_mfma_f32_16x16x32_bf16 v[188:191], a[84:87], a[108:111], v[188:191]
v_mfma_f32_16x16x32_bf16 a[136:139], a[88:91], a[108:111], a[136:139]
v_mfma_f32_16x16x32_bf16 a[140:143], a[92:95], a[108:111], a[140:143]
v_mfma_f32_16x16x32_bf16 v[64:67], a[64:67], a[112:115], v[64:67]
s_cmp_lg_u32 s91, 1
s_cbranch_scc1 L_npf_12293
s_cmp_ge_u32 s90, 4
s_cbranch_scc1 L_pfh_12294
s_add_u32 m0, s87, 98304
s_nop 0
buffer_load_dwordx4 v20, s[4:7], s84 offen sc1 lds
buffer_load_dwordx4 v20, s[4:7], s84 offen offset:1024 sc1 lds
buffer_load_dwordx4 v21, s[4:7], s84 offen offset:2048 sc1 lds
buffer_load_dwordx4 v21, s[4:7], s84 offen offset:3072 sc1 lds
s_add_u32 s84, s84, 2048
s_add_u32 m0, s54, 114688
s_nop 0
buffer_load_dwordx4 v22, s[80:83], s85 offen lds
buffer_load_dwordx4 v23, s[80:83], s85 offen offset:1024 lds
buffer_load_dwordx4 v24, s[80:83], s85 offen offset:2048 lds
buffer_load_dwordx4 v25, s[80:83], s85 offen offset:3072 lds
s_add_u32 s85, s85, s86
s_branch L_npf_12293
L_pfh_12294:
s_add_u32 m0, s87, 98304
s_nop 0
buffer_load_dwordx4 v20, s[4:7], s84 offen sc1 lds
buffer_load_dwordx4 v20, s[4:7], s84 offen offset:1024 sc1 lds
s_add_u32 s84, s84, 2048
s_add_u32 m0, s54, 114688
s_nop 0
buffer_load_dwordx4 v22, s[80:83], s85 offen lds
buffer_load_dwordx4 v23, s[80:83], s85 offen offset:1024 lds
buffer_load_dwordx4 v24, s[80:83], s85 offen offset:2048 lds
buffer_load_dwordx4 v25, s[80:83], s85 offen offset:3072 lds
s_add_u32 s85, s85, s86
L_npf_12293:
v_mfma_f32_16x16x32_bf16 v[68:71], a[68:71], a[112:115], v[68:71]
v_mfma_f32_16x16x32_bf16 v[128:131], a[72:75], a[112:115], v[128:131]
v_mfma_f32_16x16x32_bf16 v[132:135], a[76:79], a[112:115], v[132:135]
v_mfma_f32_16x16x32_bf16 v[192:195], a[80:83], a[112:115], v[192:195]
v_mfma_f32_16x16x32_bf16 v[196:199], a[84:87], a[112:115], v[196:199]
v_mfma_f32_16x16x32_bf16 a[144:147], a[88:91], a[112:115], a[144:147]
v_mfma_f32_16x16x32_bf16 a[148:151], a[92:95], a[112:115], a[148:151]
v_mfma_f32_16x16x32_bf16 v[72:75], a[64:67], a[116:119], v[72:75]
v_mfma_f32_16x16x32_bf16 v[76:79], a[68:71], a[116:119], v[76:79]
v_mfma_f32_16x16x32_bf16 v[136:139], a[72:75], a[116:119], v[136:139]
v_mfma_f32_16x16x32_bf16 v[140:143], a[76:79], a[116:119], v[140:143]
v_mfma_f32_16x16x32_bf16 v[200:203], a[80:83], a[116:119], v[200:203]
v_mfma_f32_16x16x32_bf16 v[204:207], a[84:87], a[116:119], v[204:207]
v_mfma_f32_16x16x32_bf16 a[152:155], a[88:91], a[116:119], a[152:155]
v_mfma_f32_16x16x32_bf16 a[156:159], a[92:95], a[116:119], a[156:159]
v_mfma_f32_16x16x32_bf16 v[80:83], a[64:67], a[120:123], v[80:83]
v_mfma_f32_16x16x32_bf16 v[84:87], a[68:71], a[120:123], v[84:87]
v_mfma_f32_16x16x32_bf16 v[144:147], a[72:75], a[120:123], v[144:147]
v_mfma_f32_16x16x32_bf16 v[148:151], a[76:79], a[120:123], v[148:151]
v_mfma_f32_16x16x32_bf16 v[208:211], a[80:83], a[120:123], v[208:211]
v_mfma_f32_16x16x32_bf16 v[212:215], a[84:87], a[120:123], v[212:215]
v_mfma_f32_16x16x32_bf16 a[160:163], a[88:91], a[120:123], a[160:163]
v_mfma_f32_16x16x32_bf16 a[164:167], a[92:95], a[120:123], a[164:167]
v_mfma_f32_16x16x32_bf16 v[88:91], a[64:67], a[124:127], v[88:91]
v_mfma_f32_16x16x32_bf16 v[92:95], a[68:71], a[124:127], v[92:95]
v_mfma_f32_16x16x32_bf16 v[152:155], a[72:75], a[124:127], v[152:155]
v_mfma_f32_16x16x32_bf16 v[156:159], a[76:79], a[124:127], v[156:159]
v_mfma_f32_16x16x32_bf16 v[216:219], a[80:83], a[124:127], v[216:219]
v_mfma_f32_16x16x32_bf16 v[220:223], a[84:87], a[124:127], v[220:223]
v_mfma_f32_16x16x32_bf16 a[168:171], a[88:91], a[124:127], a[168:171]
v_mfma_f32_16x16x32_bf16 a[172:175], a[92:95], a[124:127], a[172:175]
s_nop 7
s_lshr_b32 s56, s3, 1
s_lshl_b32 s56, s56, 2
s_mul_i32 s56, s56, s53
s_add_u32 s52, s52, s56
s_and_b32 s56, s3, 1
s_lshl_b32 s56, s56, 12
s_add_u32 s52, s52, s56
s_add_u32 s57, s52, 0
v_cvt_pk_bf16_f32 v32, v32, v33
v_cvt_pk_bf16_f32 v33, v34, v35
v_cvt_pk_bf16_f32 v34, v36, v37
v_cvt_pk_bf16_f32 v35, v38, v39
v_cvt_pk_bf16_f32 v40, v40, v41
v_cvt_pk_bf16_f32 v41, v42, v43
v_cvt_pk_bf16_f32 v42, v44, v45
v_cvt_pk_bf16_f32 v43, v46, v47
s_nop 0
v_permlane32_swap_b32 v32, v34
v_permlane32_swap_b32 v33, v35
v_permlane32_swap_b32 v40, v42
v_permlane32_swap_b32 v41, v43
buffer_store_dwordx4 v[32:35], v19, s[4:7], s57 offen offset:0 sc1
buffer_store_dwordx4 v[40:43], v19, s[4:7], s57 offen offset:128 sc1
v_cvt_pk_bf16_f32 v48, v48, v49
v_cvt_pk_bf16_f32 v49, v50, v51
v_cvt_pk_bf16_f32 v50, v52, v53
v_cvt_pk_bf16_f32 v51, v54, v55
v_cvt_pk_bf16_f32 v56, v56, v57
v_cvt_pk_bf16_f32 v57, v58, v59
v_cvt_pk_bf16_f32 v58, v60, v61
v_cvt_pk_bf16_f32 v59, v62, v63
s_nop 0
v_permlane32_swap_b32 v48, v50
v_permlane32_swap_b32 v49, v51
v_permlane32_swap_b32 v56, v58
v_permlane32_swap_b32 v57, v59
buffer_store_dwordx4 v[48:51], v19, s[4:7], s57 offen offset:2048 sc1
buffer_store_dwordx4 v[56:59], v19, s[4:7], s57 offen offset:2176 sc1
s_add_u32 s57, s52, 8192
v_cvt_pk_bf16_f32 v64, v64, v65
v_cvt_pk_bf16_f32 v65, v66, v67
v_cvt_pk_bf16_f32 v66, v68, v69
v_cvt_pk_bf16_f32 v67, v70, v71
v_cvt_pk_bf16_f32 v72, v72, v73
v_cvt_pk_bf16_f32 v73, v74, v75
v_cvt_pk_bf16_f32 v74, v76, v77
v_cvt_pk_bf16_f32 v75, v78, v79
s_nop 0
v_permlane32_swap_b32 v64, v66
v_permlane32_swap_b32 v65, v67
v_permlane32_swap_b32 v72, v74
v_permlane32_swap_b32 v73, v75
buffer_store_dwordx4 v[64:67], v19, s[4:7], s57 offen offset:0 sc1
buffer_store_dwordx4 v[72:75], v19, s[4:7], s57 offen offset:128 sc1
v_cvt_pk_bf16_f32 v80, v80, v81
v_cvt_pk_bf16_f32 v81, v82, v83
v_cvt_pk_bf16_f32 v82, v84, v85
v_cvt_pk_bf16_f32 v83, v86, v87
v_cvt_pk_bf16_f32 v88, v88, v89
v_cvt_pk_bf16_f32 v89, v90, v91
v_cvt_pk_bf16_f32 v90, v92, v93
v_cvt_pk_bf16_f32 v91, v94, v95
s_nop 0
v_permlane32_swap_b32 v80, v82
v_permlane32_swap_b32 v81, v83
v_permlane32_swap_b32 v88, v90
v_permlane32_swap_b32 v89, v91
buffer_store_dwordx4 v[80:83], v19, s[4:7], s57 offen offset:2048 sc1
buffer_store_dwordx4 v[88:91], v19, s[4:7], s57 offen offset:2176 sc1
s_add_u32 s52, s52, s53
s_add_u32 s57, s52, 0
v_cvt_pk_bf16_f32 v96, v96, v97
v_cvt_pk_bf16_f32 v97, v98, v99
v_cvt_pk_bf16_f32 v98, v100, v101
v_cvt_pk_bf16_f32 v99, v102, v103
v_cvt_pk_bf16_f32 v104, v104, v105
v_cvt_pk_bf16_f32 v105, v106, v107
v_cvt_pk_bf16_f32 v106, v108, v109
v_cvt_pk_bf16_f32 v107, v110, v111
s_nop 0
v_permlane32_swap_b32 v96, v98
v_permlane32_swap_b32 v97, v99
v_permlane32_swap_b32 v104, v106
v_permlane32_swap_b32 v105, v107
buffer_store_dwordx4 v[96:99], v19, s[4:7], s57 offen offset:0 sc1
buffer_store_dwordx4 v[104:107], v19, s[4:7], s57 offen offset:128 sc1
v_cvt_pk_bf16_f32 v112, v112, v113
v_cvt_pk_bf16_f32 v113, v114, v115
v_cvt_pk_bf16_f32 v114, v116, v117
v_cvt_pk_bf16_f32 v115, v118, v119
v_cvt_pk_bf16_f32 v120, v120, v121
v_cvt_pk_bf16_f32 v121, v122, v123
v_cvt_pk_bf16_f32 v122, v124, v125
v_cvt_pk_bf16_f32 v123, v126, v127
s_nop 0
v_permlane32_swap_b32 v112, v114
v_permlane32_swap_b32 v113, v115
v_permlane32_swap_b32 v120, v122
v_permlane32_swap_b32 v121, v123
buffer_store_dwordx4 v[112:115], v19, s[4:7], s57 offen offset:2048 sc1
buffer_store_dwordx4 v[120:123], v19, s[4:7], s57 offen offset:2176 sc1
s_add_u32 s57, s52, 8192
v_cvt_pk_bf16_f32 v128, v128, v129
v_cvt_pk_bf16_f32 v129, v130, v131
v_cvt_pk_bf16_f32 v130, v132, v133
v_cvt_pk_bf16_f32 v131, v134, v135
v_cvt_pk_bf16_f32 v136, v136, v137
v_cvt_pk_bf16_f32 v137, v138, v139
v_cvt_pk_bf16_f32 v138, v140, v141
v_cvt_pk_bf16_f32 v139, v142, v143
s_nop 0
v_permlane32_swap_b32 v128, v130
v_permlane32_swap_b32 v129, v131
v_permlane32_swap_b32 v136, v138
v_permlane32_swap_b32 v137, v139
buffer_store_dwordx4 v[128:131], v19, s[4:7], s57 offen offset:0 sc1
buffer_store_dwordx4 v[136:139], v19, s[4:7], s57 offen offset:128 sc1
v_cvt_pk_bf16_f32 v144, v144, v145
v_cvt_pk_bf16_f32 v145, v146, v147
v_cvt_pk_bf16_f32 v146, v148, v149
v_cvt_pk_bf16_f32 v147, v150, v151
v_cvt_pk_bf16_f32 v152, v152, v153
v_cvt_pk_bf16_f32 v153, v154, v155
v_cvt_pk_bf16_f32 v154, v156, v157
v_cvt_pk_bf16_f32 v155, v158, v159
s_nop 0
v_permlane32_swap_b32 v144, v146
v_permlane32_swap_b32 v145, v147
v_permlane32_swap_b32 v152, v154
v_permlane32_swap_b32 v153, v155
buffer_store_dwordx4 v[144:147], v19, s[4:7], s57 offen offset:2048 sc1
buffer_store_dwordx4 v[152:155], v19, s[4:7], s57 offen offset:2176 sc1
s_add_u32 s52, s52, s53
s_add_u32 s57, s52, 0
v_cvt_pk_bf16_f32 v160, v160, v161
v_cvt_pk_bf16_f32 v161, v162, v163
v_cvt_pk_bf16_f32 v162, v164, v165
v_cvt_pk_bf16_f32 v163, v166, v167
v_cvt_pk_bf16_f32 v168, v168, v169
v_cvt_pk_bf16_f32 v169, v170, v171
v_cvt_pk_bf16_f32 v170, v172, v173
v_cvt_pk_bf16_f32 v171, v174, v175
s_nop 0
v_permlane32_swap_b32 v160, v162
v_permlane32_swap_b32 v161, v163
v_permlane32_swap_b32 v168, v170
v_permlane32_swap_b32 v169, v171
buffer_store_dwordx4 v[160:163], v19, s[4:7], s57 offen offset:0 sc1
buffer_store_dwordx4 v[168:171], v19, s[4:7], s57 offen offset:128 sc1
v_cvt_pk_bf16_f32 v176, v176, v177
v_cvt_pk_bf16_f32 v177, v178, v179
v_cvt_pk_bf16_f32 v178, v180, v181
v_cvt_pk_bf16_f32 v179, v182, v183
v_cvt_pk_bf16_f32 v184, v184, v185
v_cvt_pk_bf16_f32 v185, v186, v187
v_cvt_pk_bf16_f32 v186, v188, v189
v_cvt_pk_bf16_f32 v187, v190, v191
s_nop 0
v_permlane32_swap_b32 v176, v178
v_permlane32_swap_b32 v177, v179
v_permlane32_swap_b32 v184, v186
v_permlane32_swap_b32 v185, v187
buffer_store_dwordx4 v[176:179], v19, s[4:7], s57 offen offset:2048 sc1
buffer_store_dwordx4 v[184:187], v19, s[4:7], s57 offen offset:2176 sc1
s_add_u32 s57, s52, 8192
v_cvt_pk_bf16_f32 v192, v192, v193
v_cvt_pk_bf16_f32 v193, v194, v195
v_cvt_pk_bf16_f32 v194, v196, v197
v_cvt_pk_bf16_f32 v195, v198, v199
v_cvt_pk_bf16_f32 v200, v200, v201
v_cvt_pk_bf16_f32 v201, v202, v203
v_cvt_pk_bf16_f32 v202, v204, v205
v_cvt_pk_bf16_f32 v203, v206, v207
s_nop 0
v_permlane32_swap_b32 v192, v194
v_permlane32_swap_b32 v193, v195
v_permlane32_swap_b32 v200, v202
v_permlane32_swap_b32 v201, v203
buffer_store_dwordx4 v[192:195], v19, s[4:7], s57 offen offset:0 sc1
buffer_store_dwordx4 v[200:203], v19, s[4:7], s57 offen offset:128 sc1
v_cvt_pk_bf16_f32 v208, v208, v209
v_cvt_pk_bf16_f32 v209, v210, v211
v_cvt_pk_bf16_f32 v210, v212, v213
v_cvt_pk_bf16_f32 v211, v214, v215
v_cvt_pk_bf16_f32 v216, v216, v217
v_cvt_pk_bf16_f32 v217, v218, v219
v_cvt_pk_bf16_f32 v218, v220, v221
v_cvt_pk_bf16_f32 v219, v222, v223
s_nop 0
v_permlane32_swap_b32 v208, v210
v_permlane32_swap_b32 v209, v211
v_permlane32_swap_b32 v216, v218
v_permlane32_swap_b32 v217, v219
buffer_store_dwordx4 v[208:211], v19, s[4:7], s57 offen offset:2048 sc1
buffer_store_dwordx4 v[216:219], v19, s[4:7], s57 offen offset:2176 sc1
s_add_u32 s52, s52, s53
s_add_u32 s57, s52, 0
v_cvt_pk_bf16_f32 v224, v224, v225
v_cvt_pk_bf16_f32 v225, v226, v227
v_cvt_pk_bf16_f32 v226, v228, v229
v_cvt_pk_bf16_f32 v227, v230, v231
v_cvt_pk_bf16_f32 v232, v232, v233
v_cvt_pk_bf16_f32 v233, v234, v235
v_cvt_pk_bf16_f32 v234, v236, v237
v_cvt_pk_bf16_f32 v235, v238, v239
s_nop 0
v_permlane32_swap_b32 v224, v226
v_permlane32_swap_b32 v225, v227
v_permlane32_swap_b32 v232, v234
v_permlane32_swap_b32 v233, v235
buffer_store_dwordx4 v[224:227], v19, s[4:7], s57 offen offset:0 sc1
buffer_store_dwordx4 v[232:235], v19, s[4:7], s57 offen offset:128 sc1
v_accvgpr_read_b32 v32, a128
v_accvgpr_read_b32 v33, a129
v_accvgpr_read_b32 v34, a130
v_accvgpr_read_b32 v35, a131
v_accvgpr_read_b32 v36, a132
v_accvgpr_read_b32 v37, a133
v_accvgpr_read_b32 v38, a134
v_accvgpr_read_b32 v39, a135
v_cvt_pk_bf16_f32 v32, v32, v33
v_cvt_pk_bf16_f32 v33, v34, v35
v_cvt_pk_bf16_f32 v34, v36, v37
v_cvt_pk_bf16_f32 v35, v38, v39
v_accvgpr_read_b32 v40, a136
v_accvgpr_read_b32 v41, a137
v_accvgpr_read_b32 v42, a138
v_accvgpr_read_b32 v43, a139
v_accvgpr_read_b32 v44, a140
v_accvgpr_read_b32 v45, a141
v_accvgpr_read_b32 v46, a142
v_accvgpr_read_b32 v47, a143
v_cvt_pk_bf16_f32 v40, v40, v41
v_cvt_pk_bf16_f32 v41, v42, v43
v_cvt_pk_bf16_f32 v42, v44, v45
v_cvt_pk_bf16_f32 v43, v46, v47
s_nop 0
v_permlane32_swap_b32 v32, v34
v_permlane32_swap_b32 v33, v35
v_permlane32_swap_b32 v40, v42
v_permlane32_swap_b32 v41, v43
buffer_store_dwordx4 v[32:35], v19, s[4:7], s57 offen offset:2048 sc1
buffer_store_dwordx4 v[40:43], v19, s[4:7], s57 offen offset:2176 sc1
s_add_u32 s57, s52, 8192
v_accvgpr_read_b32 v48, a144
v_accvgpr_read_b32 v49, a145
v_accvgpr_read_b32 v50, a146
v_accvgpr_read_b32 v51, a147
v_accvgpr_read_b32 v52, a148
v_accvgpr_read_b32 v53, a149
v_accvgpr_read_b32 v54, a150
v_accvgpr_read_b32 v55, a151
v_cvt_pk_bf16_f32 v48, v48, v49
v_cvt_pk_bf16_f32 v49, v50, v51
v_cvt_pk_bf16_f32 v50, v52, v53
v_cvt_pk_bf16_f32 v51, v54, v55
v_accvgpr_read_b32 v56, a152
v_accvgpr_read_b32 v57, a153
v_accvgpr_read_b32 v58, a154
v_accvgpr_read_b32 v59, a155
v_accvgpr_read_b32 v60, a156
v_accvgpr_read_b32 v61, a157
v_accvgpr_read_b32 v62, a158
v_accvgpr_read_b32 v63, a159
v_cvt_pk_bf16_f32 v56, v56, v57
v_cvt_pk_bf16_f32 v57, v58, v59
v_cvt_pk_bf16_f32 v58, v60, v61
v_cvt_pk_bf16_f32 v59, v62, v63
s_nop 0
v_permlane32_swap_b32 v48, v50
v_permlane32_swap_b32 v49, v51
v_permlane32_swap_b32 v56, v58
v_permlane32_swap_b32 v57, v59
buffer_store_dwordx4 v[48:51], v19, s[4:7], s57 offen offset:0 sc1
buffer_store_dwordx4 v[56:59], v19, s[4:7], s57 offen offset:128 sc1
v_accvgpr_read_b32 v64, a160
v_accvgpr_read_b32 v65, a161
v_accvgpr_read_b32 v66, a162
v_accvgpr_read_b32 v67, a163
v_accvgpr_read_b32 v68, a164
v_accvgpr_read_b32 v69, a165
v_accvgpr_read_b32 v70, a166
v_accvgpr_read_b32 v71, a167
v_cvt_pk_bf16_f32 v64, v64, v65
v_cvt_pk_bf16_f32 v65, v66, v67
v_cvt_pk_bf16_f32 v66, v68, v69
v_cvt_pk_bf16_f32 v67, v70, v71
v_accvgpr_read_b32 v72, a168
v_accvgpr_read_b32 v73, a169
v_accvgpr_read_b32 v74, a170
v_accvgpr_read_b32 v75, a171
v_accvgpr_read_b32 v76, a172
v_accvgpr_read_b32 v77, a173
v_accvgpr_read_b32 v78, a174
v_accvgpr_read_b32 v79, a175
v_cvt_pk_bf16_f32 v72, v72, v73
v_cvt_pk_bf16_f32 v73, v74, v75
v_cvt_pk_bf16_f32 v74, v76, v77
v_cvt_pk_bf16_f32 v75, v78, v79
s_nop 0
v_permlane32_swap_b32 v64, v66
v_permlane32_swap_b32 v65, v67
v_permlane32_swap_b32 v72, v74
v_permlane32_swap_b32 v73, v75
buffer_store_dwordx4 v[64:67], v19, s[4:7], s57 offen offset:2048 sc1
buffer_store_dwordx4 v[72:75], v19, s[4:7], s57 offen offset:2176 sc1
s_add_u32 s52, s52, s53
s_branch L_gdone
L_mh_238:
s_cmp_eq_u32 s96, 1
s_cbranch_scc1 L_w1_12295
s_cmp_eq_u32 s96, 2
s_cbranch_scc1 L_w2_12296
s_cmp_eq_u32 s96, 3
s_cbranch_scc1 L_w3_12297
s_waitcnt vmcnt(6)
s_branch L_wg_12298
L_w1_12295:
s_waitcnt vmcnt(16)
s_branch L_wg_12298
L_w2_12296:
s_waitcnt vmcnt(32)
s_branch L_wg_12298
L_w3_12297:
s_waitcnt vmcnt(63)
L_wg_12298:
s_barrier
ds_read_b64_tr_b16 a[32:33], v10 offset:0
ds_read_b64_tr_b16 a[34:35], v10 offset:2048
ds_read_b128 a[0:3], v26 offset:0
ds_read_b128 a[4:7], v26 offset:256
ds_read_b128 a[8:11], v26 offset:2048
ds_read_b128 a[12:15], v26 offset:2304
ds_read_b64_tr_b16 a[36:37], v12 offset:0
ds_read_b64_tr_b16 a[38:39], v12 offset:2048
ds_read_b64_tr_b16 a[40:41], v14 offset:0
ds_read_b64_tr_b16 a[42:43], v14 offset:2048
ds_read_b64_tr_b16 a[44:45], v16 offset:0
ds_read_b64_tr_b16 a[46:47], v16 offset:2048
ds_read_b64_tr_b16 a[48:49], v10 offset:8192
ds_read_b64_tr_b16 a[50:51], v10 offset:10240
ds_read_b64_tr_b16 a[52:53], v12 offset:8192
ds_read_b64_tr_b16 a[54:55], v12 offset:10240
ds_read_b64_tr_b16 a[56:57], v14 offset:8192
ds_read_b64_tr_b16 a[58:59], v14 offset:10240
ds_read_b64_tr_b16 a[60:61], v16 offset:8192
ds_read_b64_tr_b16 a[62:63], v16 offset:10240
s_waitcnt lgkmcnt(0)
v_mfma_f32_16x16x32_bf16 v[32:35], a[32:35], a[0:3], 0
s_cmp_lg_u32 s96, 0
s_cbranch_scc1 L_cw_13299
s_waitcnt vmcnt(4)
L_cw_13299:
s_barrier
v_mfma_f32_16x16x32_bf16 v[36:39], a[32:35], a[4:7], 0
v_mfma_f32_16x16x32_bf16 v[96:99], a[32:35], a[8:11], 0
ds_read_b64_tr_b16 a[96:97], v10 offset:32768
v_mfma_f32_16x16x32_bf16 v[100:103], a[32:35], a[12:15], 0
ds_read_b64_tr_b16 a[98:99], v10 offset:34816
s_add_u32 m0, s55, 0
s_nop 0
buffer_load_dwordx4 v2, s[4:7], s48 offen sc1 lds
v_mfma_f32_16x16x32_bf16 v[40:43], a[36:39], a[0:3], 0
ds_read_b128 a[64:67], v26 offset:32768
v_mfma_f32_16x16x32_bf16 v[44:47], a[36:39], a[4:7], 0
ds_read_b128 a[68:71], v26 offset:33024
v_mfma_f32_16x16x32_bf16 v[104:107], a[36:39], a[8:11], 0
ds_read_b128 a[72:75], v26 offset:34816
v_mfma_f32_16x16x32_bf16 v[108:111], a[36:39], a[12:15], 0
ds_read_b128 a[76:79], v26 offset:35072
buffer_load_dwordx4 v2, s[4:7], s48 offen offset:1024 sc1 lds
s_add_u32 s48, s48, 2048
v_mfma_f32_16x16x32_bf16 v[48:51], a[40:43], a[0:3], 0
ds_read_b64_tr_b16 a[100:101], v12 offset:32768
v_mfma_f32_16x16x32_bf16 v[52:55], a[40:43], a[4:7], 0
ds_read_b64_tr_b16 a[102:103], v12 offset:34816
v_mfma_f32_16x16x32_bf16 v[112:115], a[40:43], a[8:11], 0
ds_read_b64_tr_b16 a[104:105], v14 offset:32768
v_mfma_f32_16x16x32_bf16 v[116:119], a[40:43], a[12:15], 0
ds_read_b64_tr_b16 a[106:107], v14 offset:34816
s_add_u32 m0, s54, 16384
s_nop 0
buffer_load_dwordx4 v4, s[8:11], s49 offen lds
v_mfma_f32_16x16x32_bf16 v[56:59], a[44:47], a[0:3], 0
ds_read_b64_tr_b16 a[108:109], v16 offset:32768
v_mfma_f32_16x16x32_bf16 v[60:63], a[44:47], a[4:7], 0
ds_read_b64_tr_b16 a[110:111], v16 offset:34816
v_mfma_f32_16x16x32_bf16 v[120:123], a[44:47], a[8:11], 0
ds_read_b64_tr_b16 a[112:113], v10 offset:40960
v_mfma_f32_16x16x32_bf16 v[124:127], a[44:47], a[12:15], 0
ds_read_b64_tr_b16 a[114:115], v10 offset:43008
buffer_load_dwordx4 v5, s[8:11], s49 offen offset:1024 lds
v_mfma_f32_16x16x32_bf16 v[64:67], a[48:51], a[0:3], 0
ds_read_b64_tr_b16 a[116:117], v12 offset:40960
v_mfma_f32_16x16x32_bf16 v[68:71], a[48:51], a[4:7], 0
ds_read_b64_tr_b16 a[118:119], v12 offset:43008
v_mfma_f32_16x16x32_bf16 v[128:131], a[48:51], a[8:11], 0
ds_read_b64_tr_b16 a[120:121], v14 offset:40960
v_mfma_f32_16x16x32_bf16 v[132:135], a[48:51], a[12:15], 0
ds_read_b64_tr_b16 a[122:123], v14 offset:43008
buffer_load_dwordx4 v6, s[8:11], s49 offen offset:2048 lds
v_mfma_f32_16x16x32_bf16 v[72:75], a[52:55], a[0:3], 0
ds_read_b64_tr_b16 a[124:125], v16 offset:40960
v_mfma_f32_16x16x32_bf16 v[76:79], a[52:55], a[4:7], 0
ds_read_b64_tr_b16 a[126:127], v16 offset:43008
v_mfma_f32_16x16x32_bf16 v[136:139], a[52:55], a[8:11], 0
v_mfma_f32_16x16x32_bf16 v[140:143], a[52:55], a[12:15], 0
buffer_load_dwordx4 v7, s[8:11], s49 offen offset:3072 lds
s_add_u32 s49, s49, s50
v_mfma_f32_16x16x32_bf16 v[80:83], a[56:59], a[0:3], 0
v_mfma_f32_16x16x32_bf16 v[84:87], a[56:59], a[4:7], 0
v_mfma_f32_16x16x32_bf16 v[144:147], a[56:59], a[8:11], 0
v_mfma_f32_16x16x32_bf16 v[148:151], a[56:59], a[12:15], 0
v_mfma_f32_16x16x32_bf16 v[88:91], a[60:63], a[0:3], 0
v_mfma_f32_16x16x32_bf16 v[92:95], a[60:63], a[4:7], 0
v_mfma_f32_16x16x32_bf16 v[152:155], a[60:63], a[8:11], 0
v_mfma_f32_16x16x32_bf16 v[156:159], a[60:63], a[12:15], 0
s_waitcnt lgkmcnt(0)
v_mfma_f32_16x16x32_bf16 v[32:35], a[96:99], a[64:67], v[32:35]
s_cmp_lg_u32 s96, 0
s_cbranch_scc1 L_cw_14300
s_waitcnt vmcnt(8)
L_cw_14300:
s_barrier
v_mfma_f32_16x16x32_bf16 v[36:39], a[96:99], a[68:71], v[36:39]
v_mfma_f32_16x16x32_bf16 v[96:99], a[96:99], a[72:75], v[96:99]
ds_read_b64_tr_b16 a[32:33], v11 offset:0
v_mfma_f32_16x16x32_bf16 v[100:103], a[96:99], a[76:79], v[100:103]
ds_read_b64_tr_b16 a[34:35], v11 offset:2048
s_add_u32 m0, s55, 32768
s_nop 0
buffer_load_dwordx4 v2, s[4:7], s48 offen sc1 lds
v_mfma_f32_16x16x32_bf16 v[40:43], a[100:103], a[64:67], v[40:43]
ds_read_b128 a[0:3], v27 offset:0
v_mfma_f32_16x16x32_bf16 v[44:47], a[100:103], a[68:71], v[44:47]
ds_read_b128 a[4:7], v27 offset:256
v_mfma_f32_16x16x32_bf16 v[104:107], a[100:103], a[72:75], v[104:107]
ds_read_b128 a[8:11], v27 offset:2048
v_mfma_f32_16x16x32_bf16 v[108:111], a[100:103], a[76:79], v[108:111]
ds_read_b128 a[12:15], v27 offset:2304
buffer_load_dwordx4 v2, s[4:7], s48 offen offset:1024 sc1 lds
s_add_u32 s48, s48, 2048
v_mfma_f32_16x16x32_bf16 v[48:51], a[104:107], a[64:67], v[48:51]
ds_read_b64_tr_b16 a[36:37], v13 offset:0
v_mfma_f32_16x16x32_bf16 v[52:55], a[104:107], a[68:71], v[52:55]
ds_read_b64_tr_b16 a[38:39], v13 offset:2048
v_mfma_f32_16x16x32_bf16 v[112:115], a[104:107], a[72:75], v[112:115]
ds_read_b64_tr_b16 a[40:41], v15 offset:0
v_mfma_f32_16x16x32_bf16 v[116:119], a[104:107], a[76:79], v[116:119]
ds_read_b64_tr_b16 a[42:43], v15 offset:2048
s_add_u32 m0, s54, 49152
s_nop 0
buffer_load_dwordx4 v4, s[8:11], s49 offen lds
v_mfma_f32_16x16x32_bf16 v[56:59], a[108:111], a[64:67], v[56:59]
ds_read_b64_tr_b16 a[44:45], v17 offset:0
v_mfma_f32_16x16x32_bf16 v[60:63], a[108:111], a[68:71], v[60:63]
ds_read_b64_tr_b16 a[46:47], v17 offset:2048
v_mfma_f32_16x16x32_bf16 v[120:123], a[108:111], a[72:75], v[120:123]
ds_read_b64_tr_b16 a[48:49], v11 offset:8192
v_mfma_f32_16x16x32_bf16 v[124:127], a[108:111], a[76:79], v[124:127]
ds_read_b64_tr_b16 a[50:51], v11 offset:10240
buffer_load_dwordx4 v5, s[8:11], s49 offen offset:1024 lds
v_mfma_f32_16x16x32_bf16 v[64:67], a[112:115], a[64:67], v[64:67]
ds_read_b64_tr_b16 a[52:53], v13 offset:8192
v_mfma_f32_16x16x32_bf16 v[68:71], a[112:115], a[68:71], v[68:71]
ds_read_b64_tr_b16 a[54:55], v13 offset:10240
v_mfma_f32_16x16x32_bf16 v[128:131], a[112:115], a[72:75], v[128:131]
ds_read_b64_tr_b16 a[56:57], v15 offset:8192
v_mfma_f32_16x16x32_bf16 v[132:135], a[112:115], a[76:79], v[132:135]
ds_read_b64_tr_b16 a[58:59], v15 offset:10240
buffer_load_dwordx4 v6, s[8:11], s49 offen offset:2048 lds
v_mfma_f32_16x16x32_bf16 v[72:75], a[116:119], a[64:67], v[72:75]
ds_read_b64_tr_b16 a[60:61], v17 offset:8192
v_mfma_f32_16x16x32_bf16 v[76:79], a[116:119], a[68:71], v[76:79]
ds_read_b64_tr_b16 a[62:63], v17 offset:10240
v_mfma_f32_16x16x32_bf16 v[136:139], a[116:119], a[72:75], v[136:139]
v_mfma_f32_16x16x32_bf16 v[140:143], a[116:119], a[76:79], v[140:143]
buffer_load_dwordx4 v7, s[8:11], s49 offen offset:3072 lds
s_add_u32 s49, s49, s50
v_mfma_f32_16x16x32_bf16 v[80:83], a[120:123], a[64:67], v[80:83]
v_mfma_f32_16x16x32_bf16 v[84:87], a[120:123], a[68:71], v[84:87]
v_mfma_f32_16x16x32_bf16 v[144:147], a[120:123], a[72:75], v[144:147]
v_mfma_f32_16x16x32_bf16 v[148:151], a[120:123], a[76:79], v[148:151]
v_mfma_f32_16x16x32_bf16 v[88:91], a[124:127], a[64:67], v[88:91]
v_mfma_f32_16x16x32_bf16 v[92:95], a[124:127], a[68:71], v[92:95]
v_mfma_f32_16x16x32_bf16 v[152:155], a[124:127], a[72:75], v[152:155]
v_mfma_f32_16x16x32_bf16 v[156:159], a[124:127], a[76:79], v[156:159]
s_waitcnt lgkmcnt(0)
v_mfma_f32_16x16x32_bf16 v[32:35], a[32:35], a[0:3], v[32:35]
s_cmp_lg_u32 s96, 0
s_cbranch_scc1 L_cw_15301
s_waitcnt vmcnt(12)
L_cw_15301:
s_barrier
v_mfma_f32_16x16x32_bf16 v[36:39], a[32:35], a[4:7], v[36:39]
v_mfma_f32_16x16x32_bf16 v[96:99], a[32:35], a[8:11], v[96:99]
ds_read_b64_tr_b16 a[96:97], v11 offset:32768
v_mfma_f32_16x16x32_bf16 v[100:103], a[32:35], a[12:15], v[100:103]
ds_read_b64_tr_b16 a[98:99], v11 offset:34816
s_add_u32 m0, s55, 65536
s_nop 0
buffer_load_dwordx4 v2, s[4:7], s48 offen sc1 lds
v_mfma_f32_16x16x32_bf16 v[40:43], a[36:39], a[0:3], v[40:43]
ds_read_b128 a[64:67], v27 offset:32768
v_mfma_f32_16x16x32_bf16 v[44:47], a[36:39], a[4:7], v[44:47]
ds_read_b128 a[68:71], v27 offset:33024
v_mfma_f32_16x16x32_bf16 v[104:107], a[36:39], a[8:11], v[104:107]
ds_read_b128 a[72:75], v27 offset:34816
v_mfma_f32_16x16x32_bf16 v[108:111], a[36:39], a[12:15], v[108:111]
ds_read_b128 a[76:79], v27 offset:35072
buffer_load_dwordx4 v2, s[4:7], s48 offen offset:1024 sc1 lds
s_add_u32 s48, s48, 2048
v_mfma_f32_16x16x32_bf16 v[48:51], a[40:43], a[0:3], v[48:51]
ds_read_b64_tr_b16 a[100:101], v13 offset:32768
v_mfma_f32_16x16x32_bf16 v[52:55], a[40:43], a[4:7], v[52:55]
ds_read_b64_tr_b16 a[102:103], v13 offset:34816
v_mfma_f32_16x16x32_bf16 v[112:115], a[40:43], a[8:11], v[112:115]
ds_read_b64_tr_b16 a[104:105], v15 offset:32768
v_mfma_f32_16x16x32_bf16 v[116:119], a[40:43], a[12:15], v[116:119]
ds_read_b64_tr_b16 a[106:107], v15 offset:34816
s_add_u32 m0, s54, 81920
s_nop 0
buffer_load_dwordx4 v4, s[8:11], s49 offen lds
v_mfma_f32_16x16x32_bf16 v[56:59], a[44:47], a[0:3], v[56:59]
ds_read_b64_tr_b16 a[108:109], v17 offset:32768
v_mfma_f32_16x16x32_bf16 v[60:63], a[44:47], a[4:7], v[60:63]
ds_read_b64_tr_b16 a[110:111], v17 offset:34816
v_mfma_f32_16x16x32_bf16 v[120:123], a[44:47], a[8:11], v[120:123]
ds_read_b64_tr_b16 a[112:113], v11 offset:40960
v_mfma_f32_16x16x32_bf16 v[124:127], a[44:47], a[12:15], v[124:127]
ds_read_b64_tr_b16 a[114:115], v11 offset:43008
buffer_load_dwordx4 v5, s[8:11], s49 offen offset:1024 lds
v_mfma_f32_16x16x32_bf16 v[64:67], a[48:51], a[0:3], v[64:67]
ds_read_b64_tr_b16 a[116:117], v13 offset:40960
v_mfma_f32_16x16x32_bf16 v[68:71], a[48:51], a[4:7], v[68:71]
ds_read_b64_tr_b16 a[118:119], v13 offset:43008
v_mfma_f32_16x16x32_bf16 v[128:131], a[48:51], a[8:11], v[128:131]
ds_read_b64_tr_b16 a[120:121], v15 offset:40960
v_mfma_f32_16x16x32_bf16 v[132:135], a[48:51], a[12:15], v[132:135]
ds_read_b64_tr_b16 a[122:123], v15 offset:43008
buffer_load_dwordx4 v6, s[8:11], s49 offen offset:2048 lds
v_mfma_f32_16x16x32_bf16 v[72:75], a[52:55], a[0:3], v[72:75]
ds_read_b64_tr_b16 a[124:125], v17 offset:40960
v_mfma_f32_16x16x32_bf16 v[76:79], a[52:55], a[4:7], v[76:79]
ds_read_b64_tr_b16 a[126:127], v17 offset:43008
v_mfma_f32_16x16x32_bf16 v[136:139], a[52:55], a[8:11], v[136:139]
v_mfma_f32_16x16x32_bf16 v[140:143], a[52:55], a[12:15], v[140:143]
buffer_load_dwordx4 v7, s[8:11], s49 offen offset:3072 lds
s_add_u32 s49, s49, s50
v_mfma_f32_16x16x32_bf16 v[80:83], a[56:59], a[0:3], v[80:83]
v_mfma_f32_16x16x32_bf16 v[84:87], a[56:59], a[4:7], v[84:87]
v_mfma_f32_16x16x32_bf16 v[144:147], a[56:59], a[8:11], v[144:147]
v_mfma_f32_16x16x32_bf16 v[148:151], a[56:59], a[12:15], v[148:151]
v_mfma_f32_16x16x32_bf16 v[88:91], a[60:63], a[0:3], v[88:91]
v_mfma_f32_16x16x32_bf16 v[92:95], a[60:63], a[4:7], v[92:95]
v_mfma_f32_16x16x32_bf16 v[152:155], a[60:63], a[8:11], v[152:155]
v_mfma_f32_16x16x32_bf16 v[156:159], a[60:63], a[12:15], v[156:159]
s_waitcnt lgkmcnt(0)
v_mfma_f32_16x16x32_bf16 v[32:35], a[96:99], a[64:67], v[32:35]
s_waitcnt vmcnt(12)
s_barrier
s_cmp_eq_u32 s92, 255
s_cbranch_scc1 L_nsig_15302
s_cmp_lg_u32 s3, 0
s_cbranch_scc1 L_nsig_15302
s_lshl_b32 s94, s92, 8
s_add_u32 s94, s94, 98566144
v_mov_b32 v29, 0
v_mov_b32 v30, 1
s_mov_b64 exec, 1
buffer_atomic_add v30, v29, s[4:7], s94 offen sc1
s_mov_b64 exec, -1
L_nsig_15302:
v_mfma_f32_16x16x32_bf16 v[36:39], a[96:99], a[68:71], v[36:39]
v_mfma_f32_16x16x32_bf16 v[96:99], a[96:99], a[72:75], v[96:99]
ds_read_b64_tr_b16 a[32:33], v10 offset:0
v_mfma_f32_16x16x32_bf16 v[100:103], a[96:99], a[76:79], v[100:103]
ds_read_b64_tr_b16 a[34:35], v10 offset:2048
s_add_u32 m0, s55, 98304
s_nop 0
buffer_load_dwordx4 v2, s[4:7], s48 offen sc1 lds
v_mfma_f32_16x16x32_bf16 v[40:43], a[100:103], a[64:67], v[40:43]
ds_read_b128 a[0:3], v26 offset:0
v_mfma_f32_16x16x32_bf16 v[44:47], a[100:103], a[68:71], v[44:47]
ds_read_b128 a[4:7], v26 offset:256
v_mfma_f32_16x16x32_bf16 v[104:107], a[100:103], a[72:75], v[104:107]
ds_read_b128 a[8:11], v26 offset:2048
v_mfma_f32_16x16x32_bf16 v[108:111], a[100:103], a[76:79], v[108:111]
ds_read_b128 a[12:15], v26 offset:2304
buffer_load_dwordx4 v2, s[4:7], s48 offen offset:1024 sc1 lds
s_add_u32 s48, s48, 2048
v_mfma_f32_16x16x32_bf16 v[48:51], a[104:107], a[64:67], v[48:51]
ds_read_b64_tr_b16 a[36:37], v12 offset:0
v_mfma_f32_16x16x32_bf16 v[52:55], a[104:107], a[68:71], v[52:55]
ds_read_b64_tr_b16 a[38:39], v12 offset:2048
v_mfma_f32_16x16x32_bf16 v[112:115], a[104:107], a[72:75], v[112:115]
ds_read_b64_tr_b16 a[40:41], v14 offset:0
v_mfma_f32_16x16x32_bf16 v[116:119], a[104:107], a[76:79], v[116:119]
ds_read_b64_tr_b16 a[42:43], v14 offset:2048
s_add_u32 m0, s54, 114688
s_nop 0
buffer_load_dwordx4 v4, s[8:11], s49 offen lds
v_mfma_f32_16x16x32_bf16 v[56:59], a[108:111], a[64:67], v[56:59]
ds_read_b64_tr_b16 a[44:45], v16 offset:0
v_mfma_f32_16x16x32_bf16 v[60:63], a[108:111], a[68:71], v[60:63]
ds_read_b64_tr_b16 a[46:47], v16 offset:2048
v_mfma_f32_16x16x32_bf16 v[120:123], a[108:111], a[72:75], v[120:123]
ds_read_b64_tr_b16 a[48:49], v10 offset:8192
v_mfma_f32_16x16x32_bf16 v[124:127], a[108:111], a[76:79], v[124:127]
ds_read_b64_tr_b16 a[50:51], v10 offset:10240
buffer_load_dwordx4 v5, s[8:11], s49 offen offset:1024 lds
v_mfma_f32_16x16x32_bf16 v[64:67], a[112:115], a[64:67], v[64:67]
ds_read_b64_tr_b16 a[52:53], v12 offset:8192
v_mfma_f32_16x16x32_bf16 v[68:71], a[112:115], a[68:71], v[68:71]
ds_read_b64_tr_b16 a[54:55], v12 offset:10240
v_mfma_f32_16x16x32_bf16 v[128:131], a[112:115], a[72:75], v[128:131]
ds_read_b64_tr_b16 a[56:57], v14 offset:8192
v_mfma_f32_16x16x32_bf16 v[132:135], a[112:115], a[76:79], v[132:135]
ds_read_b64_tr_b16 a[58:59], v14 offset:10240
buffer_load_dwordx4 v6, s[8:11], s49 offen offset:2048 lds
v_mfma_f32_16x16x32_bf16 v[72:75], a[116:119], a[64:67], v[72:75]
ds_read_b64_tr_b16 a[60:61], v16 offset:8192
v_mfma_f32_16x16x32_bf16 v[76:79], a[116:119], a[68:71], v[76:79]
ds_read_b64_tr_b16 a[62:63], v16 offset:10240
v_mfma_f32_16x16x32_bf16 v[136:139], a[116:119], a[72:75], v[136:139]
v_mfma_f32_16x16x32_bf16 v[140:143], a[116:119], a[76:79], v[140:143]
buffer_load_dwordx4 v7, s[8:11], s49 offen offset:3072 lds
s_add_u32 s49, s49, s50
v_mfma_f32_16x16x32_bf16 v[80:83], a[120:123], a[64:67], v[80:83]
v_mfma_f32_16x16x32_bf16 v[84:87], a[120:123], a[68:71], v[84:87]
v_mfma_f32_16x16x32_bf16 v[144:147], a[120:123], a[72:75], v[144:147]
v_mfma_f32_16x16x32_bf16 v[148:151], a[120:123], a[76:79], v[148:151]
v_mfma_f32_16x16x32_bf16 v[88:91], a[124:127], a[64:67], v[88:91]
v_mfma_f32_16x16x32_bf16 v[92:95], a[124:127], a[68:71], v[92:95]
v_mfma_f32_16x16x32_bf16 v[152:155], a[124:127], a[72:75], v[152:155]
v_mfma_f32_16x16x32_bf16 v[156:159], a[124:127], a[76:79], v[156:159]
s_sub_u32 s51, s51, 2
s_cmp_eq_u32 s51, 0
s_cbranch_scc1 L_gl_end_15303
L_gl_15304:
s_waitcnt lgkmcnt(0)
v_mfma_f32_16x16x32_bf16 v[32:35], a[32:35], a[0:3], v[32:35]
s_waitcnt vmcnt(12)
s_barrier
v_mfma_f32_16x16x32_bf16 v[36:39], a[32:35], a[4:7], v[36:39]
v_mfma_f32_16x16x32_bf16 v[96:99], a[32:35], a[8:11], v[96:99]
ds_read_b64_tr_b16 a[96:97], v10 offset:32768
v_mfma_f32_16x16x32_bf16 v[100:103], a[32:35], a[12:15], v[100:103]
ds_read_b64_tr_b16 a[98:99], v10 offset:34816
s_add_u32 m0, s55, 0
s_nop 0
buffer_load_dwordx4 v2, s[4:7], s48 offen sc1 lds
v_mfma_f32_16x16x32_bf16 v[40:43], a[36:39], a[0:3], v[40:43]
ds_read_b128 a[64:67], v26 offset:32768
v_mfma_f32_16x16x32_bf16 v[44:47], a[36:39], a[4:7], v[44:47]
ds_read_b128 a[68:71], v26 offset:33024
v_mfma_f32_16x16x32_bf16 v[104:107], a[36:39], a[8:11], v[104:107]
ds_read_b128 a[72:75], v26 offset:34816
v_mfma_f32_16x16x32_bf16 v[108:111], a[36:39], a[12:15], v[108:111]
ds_read_b128 a[76:79], v26 offset:35072
buffer_load_dwordx4 v2, s[4:7], s48 offen offset:1024 sc1 lds
s_add_u32 s48, s48, 2048
v_mfma_f32_16x16x32_bf16 v[48:51], a[40:43], a[0:3], v[48:51]
ds_read_b64_tr_b16 a[100:101], v12 offset:32768
v_mfma_f32_16x16x32_bf16 v[52:55], a[40:43], a[4:7], v[52:55]
ds_read_b64_tr_b16 a[102:103], v12 offset:34816
v_mfma_f32_16x16x32_bf16 v[112:115], a[40:43], a[8:11], v[112:115]
ds_read_b64_tr_b16 a[104:105], v14 offset:32768
v_mfma_f32_16x16x32_bf16 v[116:119], a[40:43], a[12:15], v[116:119]
ds_read_b64_tr_b16 a[106:107], v14 offset:34816
s_add_u32 m0, s54, 16384
s_nop 0
buffer_load_dwordx4 v4, s[8:11], s49 offen lds
v_mfma_f32_16x16x32_bf16 v[56:59], a[44:47], a[0:3], v[56:59]
ds_read_b64_tr_b16 a[108:109], v16 offset:32768
v_mfma_f32_16x16x32_bf16 v[60:63], a[44:47], a[4:7], v[60:63]
ds_read_b64_tr_b16 a[110:111], v16 offset:34816
v_mfma_f32_16x16x32_bf16 v[120:123], a[44:47], a[8:11], v[120:123]
ds_read_b64_tr_b16 a[112:113], v10 offset:40960
v_mfma_f32_16x16x32_bf16 v[124:127], a[44:47], a[12:15], v[124:127]
ds_read_b64_tr_b16 a[114:115], v10 offset:43008
buffer_load_dwordx4 v5, s[8:11], s49 offen offset:1024 lds
v_mfma_f32_16x16x32_bf16 v[64:67], a[48:51], a[0:3], v[64:67]
ds_read_b64_tr_b16 a[116:117], v12 offset:40960
v_mfma_f32_16x16x32_bf16 v[68:71], a[48:51], a[4:7], v[68:71]
ds_read_b64_tr_b16 a[118:119], v12 offset:43008
v_mfma_f32_16x16x32_bf16 v[128:131], a[48:51], a[8:11], v[128:131]
ds_read_b64_tr_b16 a[120:121], v14 offset:40960
v_mfma_f32_16x16x32_bf16 v[132:135], a[48:51], a[12:15], v[132:135]
ds_read_b64_tr_b16 a[122:123], v14 offset:43008
buffer_load_dwordx4 v6, s[8:11], s49 offen offset:2048 lds
v_mfma_f32_16x16x32_bf16 v[72:75], a[52:55], a[0:3], v[72:75]
ds_read_b64_tr_b16 a[124:125], v16 offset:40960
v_mfma_f32_16x16x32_bf16 v[76:79], a[52:55], a[4:7], v[76:79]
ds_read_b64_tr_b16 a[126:127], v16 offset:43008
v_mfma_f32_16x16x32_bf16 v[136:139], a[52:55], a[8:11], v[136:139]
v_mfma_f32_16x16x32_bf16 v[140:143], a[52:55], a[12:15], v[140:143]
buffer_load_dwordx4 v7, s[8:11], s49 offen offset:3072 lds
s_add_u32 s49, s49, s50
v_mfma_f32_16x16x32_bf16 v[80:83], a[56:59], a[0:3], v[80:83]
v_mfma_f32_16x16x32_bf16 v[84:87], a[56:59], a[4:7], v[84:87]
v_mfma_f32_16x16x32_bf16 v[144:147], a[56:59], a[8:11], v[144:147]
v_mfma_f32_16x16x32_bf16 v[148:151], a[56:59], a[12:15], v[148:151]
v_mfma_f32_16x16x32_bf16 v[88:91], a[60:63], a[0:3], v[88:91]
v_mfma_f32_16x16x32_bf16 v[92:95], a[60:63], a[4:7], v[92:95]
v_mfma_f32_16x16x32_bf16 v[152:155], a[60:63], a[8:11], v[152:155]
v_mfma_f32_16x16x32_bf16 v[156:159], a[60:63], a[12:15], v[156:159]
s_waitcnt lgkmcnt(0)
v_mfma_f32_16x16x32_bf16 v[32:35], a[96:99], a[64:67], v[32:35]
s_waitcnt vmcnt(12)
s_barrier
v_mfma_f32_16x16x32_bf16 v[36:39], a[96:99], a[68:71], v[36:39]
v_mfma_f32_16x16x32_bf16 v[96:99], a[96:99], a[72:75], v[96:99]
ds_read_b64_tr_b16 a[32:33], v11 offset:0
v_mfma_f32_16x16x32_bf16 v[100:103], a[96:99], a[76:79], v[100:103]
ds_read_b64_tr_b16 a[34:35], v11 offset:2048
s_add_u32 m0, s55, 32768
s_nop 0
buffer_load_dwordx4 v2, s[4:7], s48 offen sc1 lds
v_mfma_f32_16x16x32_bf16 v[40:43], a[100:103], a[64:67], v[40:43]
ds_read_b128 a[0:3], v27 offset:0
v_mfma_f32_16x16x32_bf16 v[44:47], a[100:103], a[68:71], v[44:47]
ds_read_b128 a[4:7], v27 offset:256
v_mfma_f32_16x16x32_bf16 v[104:107], a[100:103], a[72:75], v[104:107]
ds_read_b128 a[8:11], v27 offset:2048
v_mfma_f32_16x16x32_bf16 v[108:111], a[100:103], a[76:79], v[108:111]
ds_read_b128 a[12:15], v27 offset:2304
buffer_load_dwordx4 v2, s[4:7], s48 offen offset:1024 sc1 lds
s_add_u32 s48, s48, 2048
v_mfma_f32_16x16x32_bf16 v[48:51], a[104:107], a[64:67], v[48:51]
ds_read_b64_tr_b16 a[36:37], v13 offset:0
v_mfma_f32_16x16x32_bf16 v[52:55], a[104:107], a[68:71], v[52:55]
ds_read_b64_tr_b16 a[38:39], v13 offset:2048
v_mfma_f32_16x16x32_bf16 v[112:115], a[104:107], a[72:75], v[112:115]
ds_read_b64_tr_b16 a[40:41], v15 offset:0
v_mfma_f32_16x16x32_bf16 v[116:119], a[104:107], a[76:79], v[116:119]
ds_read_b64_tr_b16 a[42:43], v15 offset:2048
s_add_u32 m0, s54, 49152
s_nop 0
buffer_load_dwordx4 v4, s[8:11], s49 offen lds
v_mfma_f32_16x16x32_bf16 v[56:59], a[108:111], a[64:67], v[56:59]
ds_read_b64_tr_b16 a[44:45], v17 offset:0
v_mfma_f32_16x16x32_bf16 v[60:63], a[108:111], a[68:71], v[60:63]
ds_read_b64_tr_b16 a[46:47], v17 offset:2048
v_mfma_f32_16x16x32_bf16 v[120:123], a[108:111], a[72:75], v[120:123]
ds_read_b64_tr_b16 a[48:49], v11 offset:8192
v_mfma_f32_16x16x32_bf16 v[124:127], a[108:111], a[76:79], v[124:127]
ds_read_b64_tr_b16 a[50:51], v11 offset:10240
buffer_load_dwordx4 v5, s[8:11], s49 offen offset:1024 lds
v_mfma_f32_16x16x32_bf16 v[64:67], a[112:115], a[64:67], v[64:67]
ds_read_b64_tr_b16 a[52:53], v13 offset:8192
v_mfma_f32_16x16x32_bf16 v[68:71], a[112:115], a[68:71], v[68:71]
ds_read_b64_tr_b16 a[54:55], v13 offset:10240
v_mfma_f32_16x16x32_bf16 v[128:131], a[112:115], a[72:75], v[128:131]
ds_read_b64_tr_b16 a[56:57], v15 offset:8192
v_mfma_f32_16x16x32_bf16 v[132:135], a[112:115], a[76:79], v[132:135]
ds_read_b64_tr_b16 a[58:59], v15 offset:10240
buffer_load_dwordx4 v6, s[8:11], s49 offen offset:2048 lds
v_mfma_f32_16x16x32_bf16 v[72:75], a[116:119], a[64:67], v[72:75]
ds_read_b64_tr_b16 a[60:61], v17 offset:8192
v_mfma_f32_16x16x32_bf16 v[76:79], a[116:119], a[68:71], v[76:79]
ds_read_b64_tr_b16 a[62:63], v17 offset:10240
v_mfma_f32_16x16x32_bf16 v[136:139], a[116:119], a[72:75], v[136:139]
v_mfma_f32_16x16x32_bf16 v[140:143], a[116:119], a[76:79], v[140:143]
buffer_load_dwordx4 v7, s[8:11], s49 offen offset:3072 lds
s_add_u32 s49, s49, s50
v_mfma_f32_16x16x32_bf16 v[80:83], a[120:123], a[64:67], v[80:83]
v_mfma_f32_16x16x32_bf16 v[84:87], a[120:123], a[68:71], v[84:87]
v_mfma_f32_16x16x32_bf16 v[144:147], a[120:123], a[72:75], v[144:147]
v_mfma_f32_16x16x32_bf16 v[148:151], a[120:123], a[76:79], v[148:151]
v_mfma_f32_16x16x32_bf16 v[88:91], a[124:127], a[64:67], v[88:91]
v_mfma_f32_16x16x32_bf16 v[92:95], a[124:127], a[68:71], v[92:95]
v_mfma_f32_16x16x32_bf16 v[152:155], a[124:127], a[72:75], v[152:155]
v_mfma_f32_16x16x32_bf16 v[156:159], a[124:127], a[76:79], v[156:159]
s_waitcnt lgkmcnt(0)
v_mfma_f32_16x16x32_bf16 v[32:35], a[32:35], a[0:3], v[32:35]
s_waitcnt vmcnt(12)
s_barrier
v_mfma_f32_16x16x32_bf16 v[36:39], a[32:35], a[4:7], v[36:39]
v_mfma_f32_16x16x32_bf16 v[96:99], a[32:35], a[8:11], v[96:99]
ds_read_b64_tr_b16 a[96:97], v11 offset:32768
v_mfma_f32_16x16x32_bf16 v[100:103], a[32:35], a[12:15], v[100:103]
ds_read_b64_tr_b16 a[98:99], v11 offset:34816
s_add_u32 m0, s55, 65536
s_nop 0
buffer_load_dwordx4 v2, s[4:7], s48 offen sc1 lds
v_mfma_f32_16x16x32_bf16 v[40:43], a[36:39], a[0:3], v[40:43]
ds_read_b128 a[64:67], v27 offset:32768
v_mfma_f32_16x16x32_bf16 v[44:47], a[36:39], a[4:7], v[44:47]
ds_read_b128 a[68:71], v27 offset:33024
v_mfma_f32_16x16x32_bf16 v[104:107], a[36:39], a[8:11], v[104:107]
ds_read_b128 a[72:75], v27 offset:34816
v_mfma_f32_16x16x32_bf16 v[108:111], a[36:39], a[12:15], v[108:111]
ds_read_b128 a[76:79], v27 offset:35072
buffer_load_dwordx4 v2, s[4:7], s48 offen offset:1024 sc1 lds
s_add_u32 s48, s48, 2048
v_mfma_f32_16x16x32_bf16 v[48:51], a[40:43], a[0:3], v[48:51]
ds_read_b64_tr_b16 a[100:101], v13 offset:32768
v_mfma_f32_16x16x32_bf16 v[52:55], a[40:43], a[4:7], v[52:55]
ds_read_b64_tr_b16 a[102:103], v13 offset:34816
v_mfma_f32_16x16x32_bf16 v[112:115], a[40:43], a[8:11], v[112:115]
ds_read_b64_tr_b16 a[104:105], v15 offset:32768
v_mfma_f32_16x16x32_bf16 v[116:119], a[40:43], a[12:15], v[116:119]
ds_read_b64_tr_b16 a[106:107], v15 offset:34816
s_add_u32 m0, s54, 81920
s_nop 0
buffer_load_dwordx4 v4, s[8:11], s49 offen lds
v_mfma_f32_16x16x32_bf16 v[56:59], a[44:47], a[0:3], v[56:59]
ds_read_b64_tr_b16 a[108:109], v17 offset:32768
v_mfma_f32_16x16x32_bf16 v[60:63], a[44:47], a[4:7], v[60:63]
ds_read_b64_tr_b16 a[110:111], v17 offset:34816
v_mfma_f32_16x16x32_bf16 v[120:123], a[44:47], a[8:11], v[120:123]
ds_read_b64_tr_b16 a[112:113], v11 offset:40960
v_mfma_f32_16x16x32_bf16 v[124:127], a[44:47], a[12:15], v[124:127]
ds_read_b64_tr_b16 a[114:115], v11 offset:43008
buffer_load_dwordx4 v5, s[8:11], s49 offen offset:1024 lds
v_mfma_f32_16x16x32_bf16 v[64:67], a[48:51], a[0:3], v[64:67]
ds_read_b64_tr_b16 a[116:117], v13 offset:40960
v_mfma_f32_16x16x32_bf16 v[68:71], a[48:51], a[4:7], v[68:71]
ds_read_b64_tr_b16 a[118:119], v13 offset:43008
v_mfma_f32_16x16x32_bf16 v[128:131], a[48:51], a[8:11], v[128:131]
ds_read_b64_tr_b16 a[120:121], v15 offset:40960
v_mfma_f32_16x16x32_bf16 v[132:135], a[48:51], a[12:15], v[132:135]
ds_read_b64_tr_b16 a[122:123], v15 offset:43008
buffer_load_dwordx4 v6, s[8:11], s49 offen offset:2048 lds
v_mfma_f32_16x16x32_bf16 v[72:75], a[52:55], a[0:3], v[72:75]
ds_read_b64_tr_b16 a[124:125], v17 offset:40960
v_mfma_f32_16x16x32_bf16 v[76:79], a[52:55], a[4:7], v[76:79]
ds_read_b64_tr_b16 a[126:127], v17 offset:43008
v_mfma_f32_16x16x32_bf16 v[136:139], a[52:55], a[8:11], v[136:139]
v_mfma_f32_16x16x32_bf16 v[140:143], a[52:55], a[12:15], v[140:143]
buffer_load_dwordx4 v7, s[8:11], s49 offen offset:3072 lds
s_add_u32 s49, s49, s50
v_mfma_f32_16x16x32_bf16 v[80:83], a[56:59], a[0:3], v[80:83]
v_mfma_f32_16x16x32_bf16 v[84:87], a[56:59], a[4:7], v[84:87]
v_mfma_f32_16x16x32_bf16 v[144:147], a[56:59], a[8:11], v[144:147]
v_mfma_f32_16x16x32_bf16 v[148:151], a[56:59], a[12:15], v[148:151]
v_mfma_f32_16x16x32_bf16 v[88:91], a[60:63], a[0:3], v[88:91]
v_mfma_f32_16x16x32_bf16 v[92:95], a[60:63], a[4:7], v[92:95]
v_mfma_f32_16x16x32_bf16 v[152:155], a[60:63], a[8:11], v[152:155]
v_mfma_f32_16x16x32_bf16 v[156:159], a[60:63], a[12:15], v[156:159]
s_waitcnt lgkmcnt(0)
v_mfma_f32_16x16x32_bf16 v[32:35], a[96:99], a[64:67], v[32:35]
s_waitcnt vmcnt(12)
s_barrier
v_mfma_f32_16x16x32_bf16 v[36:39], a[96:99], a[68:71], v[36:39]
v_mfma_f32_16x16x32_bf16 v[96:99], a[96:99], a[72:75], v[96:99]
ds_read_b64_tr_b16 a[32:33], v10 offset:0
v_mfma_f32_16x16x32_bf16 v[100:103], a[96:99], a[76:79], v[100:103]
ds_read_b64_tr_b16 a[34:35], v10 offset:2048
s_add_u32 m0, s55, 98304
s_nop 0
buffer_load_dwordx4 v2, s[4:7], s48 offen sc1 lds
v_mfma_f32_16x16x32_bf16 v[40:43], a[100:103], a[64:67], v[40:43]
ds_read_b128 a[0:3], v26 offset:0
v_mfma_f32_16x16x32_bf16 v[44:47], a[100:103], a[68:71], v[44:47]
ds_read_b128 a[4:7], v26 offset:256
v_mfma_f32_16x16x32_bf16 v[104:107], a[100:103], a[72:75], v[104:107]
ds_read_b128 a[8:11], v26 offset:2048
v_mfma_f32_16x16x32_bf16 v[108:111], a[100:103], a[76:79], v[108:111]
ds_read_b128 a[12:15], v26 offset:2304
buffer_load_dwordx4 v2, s[4:7], s48 offen offset:1024 sc1 lds
s_add_u32 s48, s48, 2048
v_mfma_f32_16x16x32_bf16 v[48:51], a[104:107], a[64:67], v[48:51]
ds_read_b64_tr_b16 a[36:37], v12 offset:0
v_mfma_f32_16x16x32_bf16 v[52:55], a[104:107], a[68:71], v[52:55]
ds_read_b64_tr_b16 a[38:39], v12 offset:2048
v_mfma_f32_16x16x32_bf16 v[112:115], a[104:107], a[72:75], v[112:115]
ds_read_b64_tr_b16 a[40:41], v14 offset:0
v_mfma_f32_16x16x32_bf16 v[116:119], a[104:107], a[76:79], v[116:119]
ds_read_b64_tr_b16 a[42:43], v14 offset:2048
s_add_u32 m0, s54, 114688
s_nop 0
buffer_load_dwordx4 v4, s[8:11], s49 offen lds
v_mfma_f32_16x16x32_bf16 v[56:59], a[108:111], a[64:67], v[56:59]
ds_read_b64_tr_b16 a[44:45], v16 offset:0
v_mfma_f32_16x16x32_bf16 v[60:63], a[108:111], a[68:71], v[60:63]
ds_read_b64_tr_b16 a[46:47], v16 offset:2048
v_mfma_f32_16x16x32_bf16 v[120:123], a[108:111], a[72:75], v[120:123]
ds_read_b64_tr_b16 a[48:49], v10 offset:8192
v_mfma_f32_16x16x32_bf16 v[124:127], a[108:111], a[76:79], v[124:127]
ds_read_b64_tr_b16 a[50:51], v10 offset:10240
buffer_load_dwordx4 v5, s[8:11], s49 offen offset:1024 lds
v_mfma_f32_16x16x32_bf16 v[64:67], a[112:115], a[64:67], v[64:67]
ds_read_b64_tr_b16 a[52:53], v12 offset:8192
v_mfma_f32_16x16x32_bf16 v[68:71], a[112:115], a[68:71], v[68:71]
ds_read_b64_tr_b16 a[54:55], v12 offset:10240
v_mfma_f32_16x16x32_bf16 v[128:131], a[112:115], a[72:75], v[128:131]
ds_read_b64_tr_b16 a[56:57], v14 offset:8192
v_mfma_f32_16x16x32_bf16 v[132:135], a[112:115], a[76:79], v[132:135]
ds_read_b64_tr_b16 a[58:59], v14 offset:10240
buffer_load_dwordx4 v6, s[8:11], s49 offen offset:2048 lds
v_mfma_f32_16x16x32_bf16 v[72:75], a[116:119], a[64:67], v[72:75]
ds_read_b64_tr_b16 a[60:61], v16 offset:8192
v_mfma_f32_16x16x32_bf16 v[76:79], a[116:119], a[68:71], v[76:79]
ds_read_b64_tr_b16 a[62:63], v16 offset:10240
v_mfma_f32_16x16x32_bf16 v[136:139], a[116:119], a[72:75], v[136:139]
v_mfma_f32_16x16x32_bf16 v[140:143], a[116:119], a[76:79], v[140:143]
buffer_load_dwordx4 v7, s[8:11], s49 offen offset:3072 lds
s_add_u32 s49, s49, s50
v_mfma_f32_16x16x32_bf16 v[80:83], a[120:123], a[64:67], v[80:83]
v_mfma_f32_16x16x32_bf16 v[84:87], a[120:123], a[68:71], v[84:87]
v_mfma_f32_16x16x32_bf16 v[144:147], a[120:123], a[72:75], v[144:147]
v_mfma_f32_16x16x32_bf16 v[148:151], a[120:123], a[76:79], v[148:151]
v_mfma_f32_16x16x32_bf16 v[88:91], a[124:127], a[64:67], v[88:91]
v_mfma_f32_16x16x32_bf16 v[92:95], a[124:127], a[68:71], v[92:95]
v_mfma_f32_16x16x32_bf16 v[152:155], a[124:127], a[72:75], v[152:155]
v_mfma_f32_16x16x32_bf16 v[156:159], a[124:127], a[76:79], v[156:159]
s_sub_u32 s51, s51, 1
s_cmp_lg_u32 s51, 0
s_cbranch_scc1 L_gl_15304
L_gl_end_15303:
s_waitcnt lgkmcnt(0)
v_mfma_f32_16x16x32_bf16 v[32:35], a[32:35], a[0:3], v[32:35]
s_waitcnt vmcnt(12)
s_barrier
s_cmp_lg_u32 s91, 2
s_cbranch_scc1 L_nll_15305
s_cmp_lg_u32 s3, 0
s_cbranch_scc1 L_nll_15305
s_and_b32 s94, s73, 255
s_lshl_b32 s94, s94, 8
s_add_u32 s94, s94, 98566144
v_mov_b32 v29, 0
buffer_load_dword v31, v29, s[4:7], s94 offen sc1
L_nll_15305:
v_mfma_f32_16x16x32_bf16 v[36:39], a[32:35], a[4:7], v[36:39]
v_mfma_f32_16x16x32_bf16 v[96:99], a[32:35], a[8:11], v[96:99]
ds_read_b64_tr_b16 a[96:97], v10 offset:32768
v_mfma_f32_16x16x32_bf16 v[100:103], a[32:35], a[12:15], v[100:103]
ds_read_b64_tr_b16 a[98:99], v10 offset:34816
v_mfma_f32_16x16x32_bf16 v[40:43], a[36:39], a[0:3], v[40:43]
ds_read_b128 a[64:67], v26 offset:32768
v_mfma_f32_16x16x32_bf16 v[44:47], a[36:39], a[4:7], v[44:47]
ds_read_b128 a[68:71], v26 offset:33024
v_mfma_f32_16x16x32_bf16 v[104:107], a[36:39], a[8:11], v[104:107]
ds_read_b128 a[72:75], v26 offset:34816
v_mfma_f32_16x16x32_bf16 v[108:111], a[36:39], a[12:15], v[108:111]
ds_read_b128 a[76:79], v26 offset:35072
v_mfma_f32_16x16x32_bf16 v[48:51], a[40:43], a[0:3], v[48:51]
ds_read_b64_tr_b16 a[100:101], v12 offset:32768
v_mfma_f32_16x16x32_bf16 v[52:55], a[40:43], a[4:7], v[52:55]
ds_read_b64_tr_b16 a[102:103], v12 offset:34816
v_mfma_f32_16x16x32_bf16 v[112:115], a[40:43], a[8:11], v[112:115]
ds_read_b64_tr_b16 a[104:105], v14 offset:32768
v_mfma_f32_16x16x32_bf16 v[116:119], a[40:43], a[12:15], v[116:119]
ds_read_b64_tr_b16 a[106:107], v14 offset:34816
v_mfma_f32_16x16x32_bf16 v[56:59], a[44:47], a[0:3], v[56:59]
ds_read_b64_tr_b16 a[108:109], v16 offset:32768
v_mfma_f32_16x16x32_bf16 v[60:63], a[44:47], a[4:7], v[60:63]
ds_read_b64_tr_b16 a[110:111], v16 offset:34816
v_mfma_f32_16x16x32_bf16 v[120:123], a[44:47], a[8:11], v[120:123]
ds_read_b64_tr_b16 a[112:113], v10 offset:40960
v_mfma_f32_16x16x32_bf16 v[124:127], a[44:47], a[12:15], v[124:127]
ds_read_b64_tr_b16 a[114:115], v10 offset:43008
v_mfma_f32_16x16x32_bf16 v[64:67], a[48:51], a[0:3], v[64:67]
ds_read_b64_tr_b16 a[116:117], v12 offset:40960
s_cmp_lg_u32 s91, 1
s_cbranch_scc1 L_npf_15306
s_cmp_ge_u32 s90, 4
s_cbranch_scc1 L_pfh_15307
s_add_u32 m0, s87, 0
s_nop 0
buffer_load_dwordx4 v20, s[4:7], s84 offen sc1 lds
buffer_load_dwordx4 v20, s[4:7], s84 offen offset:1024 sc1 lds
buffer_load_dwordx4 v21, s[4:7], s84 offen offset:2048 sc1 lds
buffer_load_dwordx4 v21, s[4:7], s84 offen offset:3072 sc1 lds
s_add_u32 s84, s84, 2048
s_add_u32 m0, s54, 16384
s_nop 0
buffer_load_dwordx4 v22, s[80:83], s85 offen lds
buffer_load_dwordx4 v23, s[80:83], s85 offen offset:1024 lds
buffer_load_dwordx4 v24, s[80:83], s85 offen offset:2048 lds
buffer_load_dwordx4 v25, s[80:83], s85 offen offset:3072 lds
s_add_u32 s85, s85, s86
s_branch L_npf_15306
L_pfh_15307:
s_add_u32 m0, s87, 0
s_nop 0
buffer_load_dwordx4 v20, s[4:7], s84 offen sc1 lds
buffer_load_dwordx4 v20, s[4:7], s84 offen offset:1024 sc1 lds
s_add_u32 s84, s84, 2048
s_add_u32 m0, s54, 16384
s_nop 0
buffer_load_dwordx4 v22, s[80:83], s85 offen lds
buffer_load_dwordx4 v23, s[80:83], s85 offen offset:1024 lds
buffer_load_dwordx4 v24, s[80:83], s85 offen offset:2048 lds
buffer_load_dwordx4 v25, s[80:83], s85 offen offset:3072 lds
s_add_u32 s85, s85, s86
L_npf_15306:
v_mfma_f32_16x16x32_bf16 v[68:71], a[48:51], a[4:7], v[68:71]
ds_read_b64_tr_b16 a[118:119], v12 offset:43008
v_mfma_f32_16x16x32_bf16 v[128:131], a[48:51], a[8:11], v[128:131]
ds_read_b64_tr_b16 a[120:121], v14 offset:40960
v_mfma_f32_16x16x32_bf16 v[132:135], a[48:51], a[12:15], v[132:135]
ds_read_b64_tr_b16 a[122:123], v14 offset:43008
v_mfma_f32_16x16x32_bf16 v[72:75], a[52:55], a[0:3], v[72:75]
ds_read_b64_tr_b16 a[124:125], v16 offset:40960
v_mfma_f32_16x16x32_bf16 v[76:79], a[52:55], a[4:7], v[76:79]
ds_read_b64_tr_b16 a[126:127], v16 offset:43008
v_mfma_f32_16x16x32_bf16 v[136:139], a[52:55], a[8:11], v[136:139]
v_mfma_f32_16x16x32_bf16 v[140:143], a[52:55], a[12:15], v[140:143]
v_mfma_f32_16x16x32_bf16 v[80:83], a[56:59], a[0:3], v[80:83]
v_mfma_f32_16x16x32_bf16 v[84:87], a[56:59], a[4:7], v[84:87]
v_mfma_f32_16x16x32_bf16 v[144:147], a[56:59], a[8:11], v[144:147]
v_mfma_f32_16x16x32_bf16 v[148:151], a[56:59], a[12:15], v[148:151]
v_mfma_f32_16x16x32_bf16 v[88:91], a[60:63], a[0:3], v[88:91]
v_mfma_f32_16x16x32_bf16 v[92:95], a[60:63], a[4:7], v[92:95]
v_mfma_f32_16x16x32_bf16 v[152:155], a[60:63], a[8:11], v[152:155]
v_mfma_f32_16x16x32_bf16 v[156:159], a[60:63], a[12:15], v[156:159]
s_waitcnt lgkmcnt(0)
v_mfma_f32_16x16x32_bf16 v[32:35], a[96:99], a[64:67], v[32:35]
s_cmp_lg_u32 s91, 1
s_cbranch_scc1 L_tw_15308
s_waitcnt vmcnt(12)
s_branch L_tw_15309
L_tw_15308:
s_waitcnt vmcnt(6)
L_tw_15309:
s_barrier
v_mfma_f32_16x16x32_bf16 v[36:39], a[96:99], a[68:71], v[36:39]
v_mfma_f32_16x16x32_bf16 v[96:99], a[96:99], a[72:75], v[96:99]
ds_read_b64_tr_b16 a[32:33], v11 offset:0
v_mfma_f32_16x16x32_bf16 v[100:103], a[96:99], a[76:79], v[100:103]
ds_read_b64_tr_b16 a[34:35], v11 offset:2048
v_mfma_f32_16x16x32_bf16 v[40:43], a[100:103], a[64:67], v[40:43]
ds_read_b128 a[0:3], v27 offset:0
v_mfma_f32_16x16x32_bf16 v[44:47], a[100:103], a[68:71], v[44:47]
ds_read_b128 a[4:7], v27 offset:256
v_mfma_f32_16x16x32_bf16 v[104:107], a[100:103], a[72:75], v[104:107]
ds_read_b128 a[8:11], v27 offset:2048
v_mfma_f32_16x16x32_bf16 v[108:111], a[100:103], a[76:79], v[108:111]
ds_read_b128 a[12:15], v27 offset:2304
v_mfma_f32_16x16x32_bf16 v[48:51], a[104:107], a[64:67], v[48:51]
ds_read_b64_tr_b16 a[36:37], v13 offset:0
v_mfma_f32_16x16x32_bf16 v[52:55], a[104:107], a[68:71], v[52:55]
ds_read_b64_tr_b16 a[38:39], v13 offset:2048
v_mfma_f32_16x16x32_bf16 v[112:115], a[104:107], a[72:75], v[112:115]
ds_read_b64_tr_b16 a[40:41], v15 offset:0
v_mfma_f32_16x16x32_bf16 v[116:119], a[104:107], a[76:79], v[116:119]
ds_read_b64_tr_b16 a[42:43], v15 offset:2048
v_mfma_f32_16x16x32_bf16 v[56:59], a[108:111], a[64:67], v[56:59]
ds_read_b64_tr_b16 a[44:45], v17 offset:0
v_mfma_f32_16x16x32_bf16 v[60:63], a[108:111], a[68:71], v[60:63]
ds_read_b64_tr_b16 a[46:47], v17 offset:2048
v_mfma_f32_16x16x32_bf16 v[120:123], a[108:111], a[72:75], v[120:123]
ds_read_b64_tr_b16 a[48:49], v11 offset:8192
v_mfma_f32_16x16x32_bf16 v[124:127], a[108:111], a[76:79], v[124:127]
ds_read_b64_tr_b16 a[50:51], v11 offset:10240
v_mfma_f32_16x16x32_bf16 v[64:67], a[112:115], a[64:67], v[64:67]
ds_read_b64_tr_b16 a[52:53], v13 offset:8192
s_cmp_lg_u32 s91, 1
s_cbranch_scc1 L_npf_16310
s_cmp_ge_u32 s90, 4
s_cbranch_scc1 L_pfh_16311
s_add_u32 m0, s87, 32768
s_nop 0
buffer_load_dwordx4 v20, s[4:7], s84 offen sc1 lds
buffer_load_dwordx4 v20, s[4:7], s84 offen offset:1024 sc1 lds
buffer_load_dwordx4 v21, s[4:7], s84 offen offset:2048 sc1 lds
buffer_load_dwordx4 v21, s[4:7], s84 offen offset:3072 sc1 lds
s_add_u32 s84, s84, 2048
s_add_u32 m0, s54, 49152
s_nop 0
buffer_load_dwordx4 v22, s[80:83], s85 offen lds
buffer_load_dwordx4 v23, s[80:83], s85 offen offset:1024 lds
buffer_load_dwordx4 v24, s[80:83], s85 offen offset:2048 lds
buffer_load_dwordx4 v25, s[80:83], s85 offen offset:3072 lds
s_add_u32 s85, s85, s86
s_branch L_npf_16310
L_pfh_16311:
s_add_u32 m0, s87, 32768
s_nop 0
buffer_load_dwordx4 v20, s[4:7], s84 offen sc1 lds
buffer_load_dwordx4 v20, s[4:7], s84 offen offset:1024 sc1 lds
s_add_u32 s84, s84, 2048
s_add_u32 m0, s54, 49152
s_nop 0
buffer_load_dwordx4 v22, s[80:83], s85 offen lds
buffer_load_dwordx4 v23, s[80:83], s85 offen offset:1024 lds
buffer_load_dwordx4 v24, s[80:83], s85 offen offset:2048 lds
buffer_load_dwordx4 v25, s[80:83], s85 offen offset:3072 lds
s_add_u32 s85, s85, s86
L_npf_16310:
v_mfma_f32_16x16x32_bf16 v[68:71], a[112:115], a[68:71], v[68:71]
ds_read_b64_tr_b16 a[54:55], v13 offset:10240
v_mfma_f32_16x16x32_bf16 v[128:131], a[112:115], a[72:75], v[128:131]
ds_read_b64_tr_b16 a[56:57], v15 offset:8192
v_mfma_f32_16x16x32_bf16 v[132:135], a[112:115], a[76:79], v[132:135]
ds_read_b64_tr_b16 a[58:59], v15 offset:10240
v_mfma_f32_16x16x32_bf16 v[72:75], a[116:119], a[64:67], v[72:75]
ds_read_b64_tr_b16 a[60:61], v17 offset:8192
v_mfma_f32_16x16x32_bf16 v[76:79], a[116:119], a[68:71], v[76:79]
ds_read_b64_tr_b16 a[62:63], v17 offset:10240
v_mfma_f32_16x16x32_bf16 v[136:139], a[116:119], a[72:75], v[136:139]
v_mfma_f32_16x16x32_bf16 v[140:143], a[116:119], a[76:79], v[140:143]
v_mfma_f32_16x16x32_bf16 v[80:83], a[120:123], a[64:67], v[80:83]
v_mfma_f32_16x16x32_bf16 v[84:87], a[120:123], a[68:71], v[84:87]
v_mfma_f32_16x16x32_bf16 v[144:147], a[120:123], a[72:75], v[144:147]
v_mfma_f32_16x16x32_bf16 v[148:151], a[120:123], a[76:79], v[148:151]
v_mfma_f32_16x16x32_bf16 v[88:91], a[124:127], a[64:67], v[88:91]
v_mfma_f32_16x16x32_bf16 v[92:95], a[124:127], a[68:71], v[92:95]
v_mfma_f32_16x16x32_bf16 v[152:155], a[124:127], a[72:75], v[152:155]
v_mfma_f32_16x16x32_bf16 v[156:159], a[124:127], a[76:79], v[156:159]
s_waitcnt lgkmcnt(0)
v_mfma_f32_16x16x32_bf16 v[32:35], a[32:35], a[0:3], v[32:35]
s_cmp_lg_u32 s91, 1
s_cbranch_scc1 L_tw_16312
s_waitcnt vmcnt(12)
s_branch L_tw_16313
L_tw_16312:
s_waitcnt vmcnt(0)
L_tw_16313:
s_barrier
s_cmp_lg_u32 s91, 2
s_cbranch_scc1 L_nld_18314
s_cmp_lg_u32 s3, 0
s_cbranch_scc1 L_nld_18314
s_bfe_u32 s94, s73, 0x80008
v_cmp_le_u32 vcc, s94, v31
v_mov_b32 v29, 131072
s_nop 0
v_cndmask_b32 v30, 0, 3, vcc
ds_write_b32 v29, v30
L_nld_18314:
v_mfma_f32_16x16x32_bf16 v[36:39], a[32:35], a[4:7], v[36:39]
v_mfma_f32_16x16x32_bf16 v[96:99], a[32:35], a[8:11], v[96:99]
ds_read_b64_tr_b16 a[96:97], v11 offset:32768
v_mfma_f32_16x16x32_bf16 v[100:103], a[32:35], a[12:15], v[100:103]
ds_read_b64_tr_b16 a[98:99], v11 offset:34816
v_mfma_f32_16x16x32_bf16 v[40:43], a[36:39], a[0:3], v[40:43]
ds_read_b128 a[64:67], v27 offset:32768
v_mfma_f32_16x16x32_bf16 v[44:47], a[36:39], a[4:7], v[44:47]
ds_read_b128 a[68:71], v27 offset:33024
v_mfma_f32_16x16x32_bf16 v[104:107], a[36:39], a[8:11], v[104:107]
ds_read_b128 a[72:75], v27 offset:34816
v_mfma_f32_16x16x32_bf16 v[108:111], a[36:39], a[12:15], v[108:111]
ds_read_b128 a[76:79], v27 offset:35072
v_mfma_f32_16x16x32_bf16 v[48:51], a[40:43], a[0:3], v[48:51]
ds_read_b64_tr_b16 a[100:101], v13 offset:32768
v_mfma_f32_16x16x32_bf16 v[52:55], a[40:43], a[4:7], v[52:55]
ds_read_b64_tr_b16 a[102:103], v13 offset:34816
v_mfma_f32_16x16x32_bf16 v[112:115], a[40:43], a[8:11], v[112:115]
ds_read_b64_tr_b16 a[104:105], v15 offset:32768
v_mfma_f32_16x16x32_bf16 v[116:119], a[40:43], a[12:15], v[116:119]
ds_read_b64_tr_b16 a[106:107], v15 offset:34816
v_mfma_f32_16x16x32_bf16 v[56:59], a[44:47], a[0:3], v[56:59]
ds_read_b64_tr_b16 a[108:109], v17 offset:32768
v_mfma_f32_16x16x32_bf16 v[60:63], a[44:47], a[4:7], v[60:63]
ds_read_b64_tr_b16 a[110:111], v17 offset:34816
v_mfma_f32_16x16x32_bf16 v[120:123], a[44:47], a[8:11], v[120:123]
ds_read_b64_tr_b16 a[112:113], v11 offset:40960
v_mfma_f32_16x16x32_bf16 v[124:127], a[44:47], a[12:15], v[124:127]
ds_read_b64_tr_b16 a[114:115], v11 offset:43008
v_mfma_f32_16x16x32_bf16 v[64:67], a[48:51], a[0:3], v[64:67]
ds_read_b64_tr_b16 a[116:117], v13 offset:40960
s_cmp_lg_u32 s91, 1
s_cbranch_scc1 L_npf_18315
s_cmp_ge_u32 s90, 4
s_cbranch_scc1 L_pfh_18316
s_add_u32 m0, s87, 65536
s_nop 0
buffer_load_dwordx4 v20, s[4:7], s84 offen sc1 lds
buffer_load_dwordx4 v20, s[4:7], s84 offen offset:1024 sc1 lds
buffer_load_dwordx4 v21, s[4:7], s84 offen offset:2048 sc1 lds
buffer_load_dwordx4 v21, s[4:7], s84 offen offset:3072 sc1 lds
s_add_u32 s84, s84, 2048
s_add_u32 m0, s54, 81920
s_nop 0
buffer_load_dwordx4 v22, s[80:83], s85 offen lds
buffer_load_dwordx4 v23, s[80:83], s85 offen offset:1024 lds
buffer_load_dwordx4 v24, s[80:83], s85 offen offset:2048 lds
buffer_load_dwordx4 v25, s[80:83], s85 offen offset:3072 lds
s_add_u32 s85, s85, s86
s_branch L_npf_18315
L_pfh_18316:
s_add_u32 m0, s87, 65536
s_nop 0
buffer_load_dwordx4 v20, s[4:7], s84 offen sc1 lds
buffer_load_dwordx4 v20, s[4:7], s84 offen offset:1024 sc1 lds
s_add_u32 s84, s84, 2048
s_add_u32 m0, s54, 81920
s_nop 0
buffer_load_dwordx4 v22, s[80:83], s85 offen lds
buffer_load_dwordx4 v23, s[80:83], s85 offen offset:1024 lds
buffer_load_dwordx4 v24, s[80:83], s85 offen offset:2048 lds
buffer_load_dwordx4 v25, s[80:83], s85 offen offset:3072 lds
s_add_u32 s85, s85, s86
L_npf_18315:
v_mfma_f32_16x16x32_bf16 v[68:71], a[48:51], a[4:7], v[68:71]
ds_read_b64_tr_b16 a[118:119], v13 offset:43008
v_mfma_f32_16x16x32_bf16 v[128:131], a[48:51], a[8:11], v[128:131]
ds_read_b64_tr_b16 a[120:121], v15 offset:40960
v_mfma_f32_16x16x32_bf16 v[132:135], a[48:51], a[12:15], v[132:135]
ds_read_b64_tr_b16 a[122:123], v15 offset:43008
v_mfma_f32_16x16x32_bf16 v[72:75], a[52:55], a[0:3], v[72:75]
ds_read_b64_tr_b16 a[124:125], v17 offset:40960
v_mfma_f32_16x16x32_bf16 v[76:79], a[52:55], a[4:7], v[76:79]
ds_read_b64_tr_b16 a[126:127], v17 offset:43008
v_mfma_f32_16x16x32_bf16 v[136:139], a[52:55], a[8:11], v[136:139]
v_mfma_f32_16x16x32_bf16 v[140:143], a[52:55], a[12:15], v[140:143]
v_mfma_f32_16x16x32_bf16 v[80:83], a[56:59], a[0:3], v[80:83]
v_mfma_f32_16x16x32_bf16 v[84:87], a[56:59], a[4:7], v[84:87]
v_mfma_f32_16x16x32_bf16 v[144:147], a[56:59], a[8:11], v[144:147]
v_mfma_f32_16x16x32_bf16 v[148:151], a[56:59], a[12:15], v[148:151]
v_mfma_f32_16x16x32_bf16 v[88:91], a[60:63], a[0:3], v[88:91]
v_mfma_f32_16x16x32_bf16 v[92:95], a[60:63], a[4:7], v[92:95]
v_mfma_f32_16x16x32_bf16 v[152:155], a[60:63], a[8:11], v[152:155]
v_mfma_f32_16x16x32_bf16 v[156:159], a[60:63], a[12:15], v[156:159]
s_waitcnt lgkmcnt(0)
v_mfma_f32_16x16x32_bf16 v[32:35], a[96:99], a[64:67], v[32:35]
s_barrier
s_cmp_lg_u32 s91, 2
s_cbranch_scc1 L_nlp_18317
v_mov_b32 v29, 131072
ds_read_b32 v30, v29
s_waitcnt lgkmcnt(0)
v_readfirstlane_b32 s91, v30
s_cmp_eq_u32 s91, 0
s_cbranch_scc1 L_nlp_18317
s_cmp_ge_u32 s90, 4
s_cbranch_scc1 L_lph_18318
s_add_u32 m0, s87, 0
s_nop 0
buffer_load_dwordx4 v20, s[4:7], s84 offen sc1 lds
buffer_load_dwordx4 v20, s[4:7], s84 offen offset:1024 sc1 lds
buffer_load_dwordx4 v21, s[4:7], s84 offen offset:2048 sc1 lds
buffer_load_dwordx4 v21, s[4:7], s84 offen offset:3072 sc1 lds
s_add_u32 s84, s84, 2048
s_add_u32 m0, s54, 16384
s_nop 0
buffer_load_dwordx4 v22, s[80:83], s85 offen lds
buffer_load_dwordx4 v23, s[80:83], s85 offen offset:1024 lds
buffer_load_dwordx4 v24, s[80:83], s85 offen offset:2048 lds
buffer_load_dwordx4 v25, s[80:83], s85 offen offset:3072 lds
s_add_u32 s85, s85, s86
s_add_u32 m0, s87, 32768
s_nop 0
buffer_load_dwordx4 v20, s[4:7], s84 offen sc1 lds
buffer_load_dwordx4 v20, s[4:7], s84 offen offset:1024 sc1 lds
buffer_load_dwordx4 v21, s[4:7], s84 offen offset:2048 sc1 lds
buffer_load_dwordx4 v21, s[4:7], s84 offen offset:3072 sc1 lds
s_add_u32 s84, s84, 2048
s_add_u32 m0, s54, 49152
s_nop 0
buffer_load_dwordx4 v22, s[80:83], s85 offen lds
buffer_load_dwordx4 v23, s[80:83], s85 offen offset:1024 lds
buffer_load_dwordx4 v24, s[80:83], s85 offen offset:2048 lds
buffer_load_dwordx4 v25, s[80:83], s85 offen offset:3072 lds
s_add_u32 s85, s85, s86
s_add_u32 m0, s87, 65536
s_nop 0
buffer_load_dwordx4 v20, s[4:7], s84 offen sc1 lds
buffer_load_dwordx4 v20, s[4:7], s84 offen offset:1024 sc1 lds
buffer_load_dwordx4 v21, s[4:7], s84 offen offset:2048 sc1 lds
buffer_load_dwordx4 v21, s[4:7], s84 offen offset:3072 sc1 lds
s_add_u32 s84, s84, 2048
s_add_u32 m0, s54, 81920
s_nop 0
buffer_load_dwordx4 v22, s[80:83], s85 offen lds
buffer_load_dwordx4 v23, s[80:83], s85 offen offset:1024 lds
buffer_load_dwordx4 v24, s[80:83], s85 offen offset:2048 lds
buffer_load_dwordx4 v25, s[80:83], s85 offen offset:3072 lds
s_add_u32 s85, s85, s86
s_add_u32 m0, s87, 98304
s_nop 0
buffer_load_dwordx4 v20, s[4:7], s84 offen sc1 lds
buffer_load_dwordx4 v20, s[4:7], s84 offen offset:1024 sc1 lds
buffer_load_dwordx4 v21, s[4:7], s84 offen offset:2048 sc1 lds
buffer_load_dwordx4 v21, s[4:7], s84 offen offset:3072 sc1 lds
s_add_u32 s84, s84, 2048
s_add_u32 m0, s54, 114688
s_nop 0
buffer_load_dwordx4 v22, s[80:83], s85 offen lds
buffer_load_dwordx4 v23, s[80:83], s85 offen offset:1024 lds
buffer_load_dwordx4 v24, s[80:83], s85 offen offset:2048 lds
buffer_load_dwordx4 v25, s[80:83], s85 offen offset:3072 lds
s_add_u32 s85, s85, s86
s_branch L_nlp_18317
L_lph_18318:
s_add_u32 m0, s87, 0
s_nop 0
buffer_load_dwordx4 v20, s[4:7], s84 offen sc1 lds
buffer_load_dwordx4 v20, s[4:7], s84 offen offset:1024 sc1 lds
s_add_u32 s84, s84, 2048
s_add_u32 m0, s54, 16384
s_nop 0
buffer_load_dwordx4 v22, s[80:83], s85 offen lds
buffer_load_dwordx4 v23, s[80:83], s85 offen offset:1024 lds
buffer_load_dwordx4 v24, s[80:83], s85 offen offset:2048 lds
buffer_load_dwordx4 v25, s[80:83], s85 offen offset:3072 lds
s_add_u32 s85, s85, s86
s_add_u32 m0, s87, 32768
s_nop 0
buffer_load_dwordx4 v20, s[4:7], s84 offen sc1 lds
buffer_load_dwordx4 v20, s[4:7], s84 offen offset:1024 sc1 lds
s_add_u32 s84, s84, 2048
s_add_u32 m0, s54, 49152
s_nop 0
buffer_load_dwordx4 v22, s[80:83], s85 offen lds
buffer_load_dwordx4 v23, s[80:83], s85 offen offset:1024 lds
buffer_load_dwordx4 v24, s[80:83], s85 offen offset:2048 lds
buffer_load_dwordx4 v25, s[80:83], s85 offen offset:3072 lds
s_add_u32 s85, s85, s86
s_add_u32 m0, s87, 65536
s_nop 0
buffer_load_dwordx4 v20, s[4:7], s84 offen sc1 lds
buffer_load_dwordx4 v20, s[4:7], s84 offen offset:1024 sc1 lds
s_add_u32 s84, s84, 2048
s_add_u32 m0, s54, 81920
s_nop 0
buffer_load_dwordx4 v22, s[80:83], s85 offen lds
buffer_load_dwordx4 v23, s[80:83], s85 offen offset:1024 lds
buffer_load_dwordx4 v24, s[80:83], s85 offen offset:2048 lds
buffer_load_dwordx4 v25, s[80:83], s85 offen offset:3072 lds
s_add_u32 s85, s85, s86
s_add_u32 m0, s87, 98304
s_nop 0
buffer_load_dwordx4 v20, s[4:7], s84 offen sc1 lds
buffer_load_dwordx4 v20, s[4:7], s84 offen offset:1024 sc1 lds
s_add_u32 s84, s84, 2048
s_add_u32 m0, s54, 114688
s_nop 0
buffer_load_dwordx4 v22, s[80:83], s85 offen lds
buffer_load_dwordx4 v23, s[80:83], s85 offen offset:1024 lds
buffer_load_dwordx4 v24, s[80:83], s85 offen offset:2048 lds
buffer_load_dwordx4 v25, s[80:83], s85 offen offset:3072 lds
s_add_u32 s85, s85, s86
L_nlp_18317:
v_mfma_f32_16x16x32_bf16 v[36:39], a[96:99], a[68:71], v[36:39]
v_mfma_f32_16x16x32_bf16 v[96:99], a[96:99], a[72:75], v[96:99]
v_mfma_f32_16x16x32_bf16 v[100:103], a[96:99], a[76:79], v[100:103]
v_mfma_f32_16x16x32_bf16 v[40:43], a[100:103], a[64:67], v[40:43]
v_mfma_f32_16x16x32_bf16 v[44:47], a[100:103], a[68:71], v[44:47]
v_mfma_f32_16x16x32_bf16 v[104:107], a[100:103], a[72:75], v[104:107]
v_mfma_f32_16x16x32_bf16 v[108:111], a[100:103], a[76:79], v[108:111]
v_mfma_f32_16x16x32_bf16 v[48:51], a[104:107], a[64:67], v[48:51]
v_mfma_f32_16x16x32_bf16 v[52:55], a[104:107], a[68:71], v[52:55]
v_mfma_f32_16x16x32_bf16 v[112:115], a[104:107], a[72:75], v[112:115]
v_mfma_f32_16x16x32_bf16 v[116:119], a[104:107], a[76:79], v[116:119]
v_mfma_f32_16x16x32_bf16 v[56:59], a[108:111], a[64:67], v[56:59]
v_mfma_f32_16x16x32_bf16 v[60:63], a[108:111], a[68:71], v[60:63]
v_mfma_f32_16x16x32_bf16 v[120:123], a[108:111], a[72:75], v[120:123]
v_mfma_f32_16x16x32_bf16 v[124:127], a[108:111], a[76:79], v[124:127]
v_mfma_f32_16x16x32_bf16 v[64:67], a[112:115], a[64:67], v[64:67]
s_cmp_lg_u32 s91, 1
s_cbranch_scc1 L_npf_18319
s_cmp_ge_u32 s90, 4
s_cbranch_scc1 L_pfh_18320
s_add_u32 m0, s87, 98304
s_nop 0
buffer_load_dwordx4 v20, s[4:7], s84 offen sc1 lds
buffer_load_dwordx4 v20, s[4:7], s84 offen offset:1024 sc1 lds
buffer_load_dwordx4 v21, s[4:7], s84 offen offset:2048 sc1 lds
buffer_load_dwordx4 v21, s[4:7], s84 offen offset:3072 sc1 lds
s_add_u32 s84, s84, 2048
s_add_u32 m0, s54, 114688
s_nop 0
buffer_load_dwordx4 v22, s[80:83], s85 offen lds
buffer_load_dwordx4 v23, s[80:83], s85 offen offset:1024 lds
buffer_load_dwordx4 v24, s[80:83], s85 offen offset:2048 lds
buffer_load_dwordx4 v25, s[80:83], s85 offen offset:3072 lds
s_add_u32 s85, s85, s86
s_branch L_npf_18319
L_pfh_18320:
s_add_u32 m0, s87, 98304
s_nop 0
buffer_load_dwordx4 v20, s[4:7], s84 offen sc1 lds
buffer_load_dwordx4 v20, s[4:7], s84 offen offset:1024 sc1 lds
s_add_u32 s84, s84, 2048
s_add_u32 m0, s54, 114688
s_nop 0
buffer_load_dwordx4 v22, s[80:83], s85 offen lds
buffer_load_dwordx4 v23, s[80:83], s85 offen offset:1024 lds
buffer_load_dwordx4 v24, s[80:83], s85 offen offset:2048 lds
buffer_load_dwordx4 v25, s[80:83], s85 offen offset:3072 lds
s_add_u32 s85, s85, s86
L_npf_18319:
v_mfma_f32_16x16x32_bf16 v[68:71], a[112:115], a[68:71], v[68:71]
v_mfma_f32_16x16x32_bf16 v[128:131], a[112:115], a[72:75], v[128:131]
v_mfma_f32_16x16x32_bf16 v[132:135], a[112:115], a[76:79], v[132:135]
v_mfma_f32_16x16x32_bf16 v[72:75], a[116:119], a[64:67], v[72:75]
v_mfma_f32_16x16x32_bf16 v[76:79], a[116:119], a[68:71], v[76:79]
v_mfma_f32_16x16x32_bf16 v[136:139], a[116:119], a[72:75], v[136:139]
v_mfma_f32_16x16x32_bf16 v[140:143], a[116:119], a[76:79], v[140:143]
v_mfma_f32_16x16x32_bf16 v[80:83], a[120:123], a[64:67], v[80:83]
v_mfma_f32_16x16x32_bf16 v[84:87], a[120:123], a[68:71], v[84:87]
v_mfma_f32_16x16x32_bf16 v[144:147], a[120:123], a[72:75], v[144:147]
v_mfma_f32_16x16x32_bf16 v[148:151], a[120:123], a[76:79], v[148:151]
v_mfma_f32_16x16x32_bf16 v[88:91], a[124:127], a[64:67], v[88:91]
v_mfma_f32_16x16x32_bf16 v[92:95], a[124:127], a[68:71], v[92:95]
v_mfma_f32_16x16x32_bf16 v[152:155], a[124:127], a[72:75], v[152:155]
v_mfma_f32_16x16x32_bf16 v[156:159], a[124:127], a[76:79], v[156:159]
s_nop 7
s_lshr_b32 s56, s3, 1
s_lshl_b32 s56, s56, 1
s_mul_i32 s56, s56, s53
s_add_u32 s52, s52, s56
s_and_b32 s56, s3, 1
s_lshl_b32 s56, s56, 12
s_add_u32 s52, s52, s56
s_add_u32 s57, s52, 0
v_cvt_pk_bf16_f32 v32, v32, v33
v_cvt_pk_bf16_f32 v33, v34, v35
v_cvt_pk_bf16_f32 v34, v40, v41
v_cvt_pk_bf16_f32 v35, v42, v43
v_cvt_pk_bf16_f32 v36, v36, v37
v_cvt_pk_bf16_f32 v37, v38, v39
v_cvt_pk_bf16_f32 v38, v44, v45
v_cvt_pk_bf16_f32 v39, v46, v47
buffer_store_dwordx4 v[32:35], v18, s[4:7], s57 offen offset:0 sc1
buffer_store_dwordx4 v[36:39], v18, s[4:7], s57 offen offset:256 sc1
v_cvt_pk_bf16_f32 v48, v48, v49
v_cvt_pk_bf16_f32 v49, v50, v51
v_cvt_pk_bf16_f32 v50, v56, v57
v_cvt_pk_bf16_f32 v51, v58, v59
v_cvt_pk_bf16_f32 v52, v52, v53
v_cvt_pk_bf16_f32 v53, v54, v55
v_cvt_pk_bf16_f32 v54, v60, v61
v_cvt_pk_bf16_f32 v55, v62, v63
buffer_store_dwordx4 v[48:51], v18, s[4:7], s57 offen offset:2048 sc1
buffer_store_dwordx4 v[52:55], v18, s[4:7], s57 offen offset:2304 sc1
s_add_u32 s57, s52, 8192
v_cvt_pk_bf16_f32 v64, v64, v65
v_cvt_pk_bf16_f32 v65, v66, v67
v_cvt_pk_bf16_f32 v66, v72, v73
v_cvt_pk_bf16_f32 v67, v74, v75
v_cvt_pk_bf16_f32 v68, v68, v69
v_cvt_pk_bf16_f32 v69, v70, v71
v_cvt_pk_bf16_f32 v70, v76, v77
v_cvt_pk_bf16_f32 v71, v78, v79
buffer_store_dwordx4 v[64:67], v18, s[4:7], s57 offen offset:0 sc1
buffer_store_dwordx4 v[68:71], v18, s[4:7], s57 offen offset:256 sc1
v_cvt_pk_bf16_f32 v80, v80, v81
v_cvt_pk_bf16_f32 v81, v82, v83
v_cvt_pk_bf16_f32 v82, v88, v89
v_cvt_pk_bf16_f32 v83, v90, v91
v_cvt_pk_bf16_f32 v84, v84, v85
v_cvt_pk_bf16_f32 v85, v86, v87
v_cvt_pk_bf16_f32 v86, v92, v93
v_cvt_pk_bf16_f32 v87, v94, v95
buffer_store_dwordx4 v[80:83], v18, s[4:7], s57 offen offset:2048 sc1
buffer_store_dwordx4 v[84:87], v18, s[4:7], s57 offen offset:2304 sc1
s_add_u32 s52, s52, s53
s_add_u32 s57, s52, 0
v_cvt_pk_bf16_f32 v96, v96, v97
v_cvt_pk_bf16_f32 v97, v98, v99
v_cvt_pk_bf16_f32 v98, v104, v105
v_cvt_pk_bf16_f32 v99, v106, v107
v_cvt_pk_bf16_f32 v100, v100, v101
v_cvt_pk_bf16_f32 v101, v102, v103
v_cvt_pk_bf16_f32 v102, v108, v109
v_cvt_pk_bf16_f32 v103, v110, v111
buffer_store_dwordx4 v[96:99], v18, s[4:7], s57 offen offset:0 sc1
buffer_store_dwordx4 v[100:103], v18, s[4:7], s57 offen offset:256 sc1
v_cvt_pk_bf16_f32 v112, v112, v113
v_cvt_pk_bf16_f32 v113, v114, v115
v_cvt_pk_bf16_f32 v114, v120, v121
v_cvt_pk_bf16_f32 v115, v122, v123
v_cvt_pk_bf16_f32 v116, v116, v117
v_cvt_pk_bf16_f32 v117, v118, v119
v_cvt_pk_bf16_f32 v118, v124, v125
v_cvt_pk_bf16_f32 v119, v126, v127
buffer_store_dwordx4 v[112:115], v18, s[4:7], s57 offen offset:2048 sc1
buffer_store_dwordx4 v[116:119], v18, s[4:7], s57 offen offset:2304 sc1
s_add_u32 s57, s52, 8192
v_cvt_pk_bf16_f32 v128, v128, v129
v_cvt_pk_bf16_f32 v129, v130, v131
v_cvt_pk_bf16_f32 v130, v136, v137
v_cvt_pk_bf16_f32 v131, v138, v139
v_cvt_pk_bf16_f32 v132, v132, v133
v_cvt_pk_bf16_f32 v133, v134, v135
v_cvt_pk_bf16_f32 v134, v140, v141
v_cvt_pk_bf16_f32 v135, v142, v143
buffer_store_dwordx4 v[128:131], v18, s[4:7], s57 offen offset:0 sc1
buffer_store_dwordx4 v[132:135], v18, s[4:7], s57 offen offset:256 sc1
v_cvt_pk_bf16_f32 v144, v144, v145
v_cvt_pk_bf16_f32 v145, v146, v147
v_cvt_pk_bf16_f32 v146, v152, v153
v_cvt_pk_bf16_f32 v147, v154, v155
v_cvt_pk_bf16_f32 v148, v148, v149
v_cvt_pk_bf16_f32 v149, v150, v151
v_cvt_pk_bf16_f32 v150, v156, v157
v_cvt_pk_bf16_f32 v151, v158, v159
buffer_store_dwordx4 v[144:147], v18, s[4:7], s57 offen offset:2048 sc1
buffer_store_dwordx4 v[148:151], v18, s[4:7], s57 offen offset:2304 sc1
s_add_u32 s52, s52, s53
s_branch L_gdone
L_mhv_239:
s_cmp_eq_u32 s96, 1
s_cbranch_scc1 L_w1_18321
s_cmp_eq_u32 s96, 2
s_cbranch_scc1 L_w2_18322
s_cmp_eq_u32 s96, 3
s_cbranch_scc1 L_w3_18323
s_waitcnt vmcnt(6)
s_branch L_wg_18324
L_w1_18321:
s_waitcnt vmcnt(16)
s_branch L_wg_18324
L_w2_18322:
s_waitcnt vmcnt(32)
s_branch L_wg_18324
L_w3_18323:
s_waitcnt vmcnt(63)
L_wg_18324:
s_barrier
ds_read_b64_tr_b16 a[32:33], v10 offset:0
ds_read_b64_tr_b16 a[34:35], v10 offset:2048
ds_read_b128 a[0:3], v26 offset:0
ds_read_b128 a[4:7], v26 offset:256
ds_read_b128 a[8:11], v26 offset:2048
ds_read_b128 a[12:15], v26 offset:2304
ds_read_b64_tr_b16 a[36:37], v12 offset:0
ds_read_b64_tr_b16 a[38:39], v12 offset:2048
ds_read_b64_tr_b16 a[40:41], v14 offset:0
ds_read_b64_tr_b16 a[42:43], v14 offset:2048
ds_read_b64_tr_b16 a[44:45], v16 offset:0
ds_read_b64_tr_b16 a[46:47], v16 offset:2048
ds_read_b64_tr_b16 a[48:49], v10 offset:8192
ds_read_b64_tr_b16 a[50:51], v10 offset:10240
ds_read_b64_tr_b16 a[52:53], v12 offset:8192
ds_read_b64_tr_b16 a[54:55], v12 offset:10240
ds_read_b64_tr_b16 a[56:57], v14 offset:8192
ds_read_b64_tr_b16 a[58:59], v14 offset:10240
ds_read_b64_tr_b16 a[60:61], v16 offset:8192
ds_read_b64_tr_b16 a[62:63], v16 offset:10240
s_waitcnt lgkmcnt(0)
v_mfma_f32_16x16x32_bf16 v[32:35], a[0:3], a[32:35], 0
s_cmp_lg_u32 s96, 0
s_cbranch_scc1 L_cw_19325
s_waitcnt vmcnt(4)
L_cw_19325:
s_barrier
v_mfma_f32_16x16x32_bf16 v[36:39], a[4:7], a[32:35], 0
v_mfma_f32_16x16x32_bf16 v[96:99], a[8:11], a[32:35], 0
ds_read_b64_tr_b16 a[96:97], v10 offset:32768
v_mfma_f32_16x16x32_bf16 v[100:103], a[12:15], a[32:35], 0
ds_read_b64_tr_b16 a[98:99], v10 offset:34816
s_add_u32 m0, s55, 0
s_nop 0
buffer_load_dwordx4 v2, s[4:7], s48 offen sc1 lds
v_mfma_f32_16x16x32_bf16 v[40:43], a[0:3], a[36:39], 0
ds_read_b128 a[64:67], v26 offset:32768
v_mfma_f32_16x16x32_bf16 v[44:47], a[4:7], a[36:39], 0
ds_read_b128 a[68:71], v26 offset:33024
v_mfma_f32_16x16x32_bf16 v[104:107], a[8:11], a[36:39], 0
ds_read_b128 a[72:75], v26 offset:34816
v_mfma_f32_16x16x32_bf16 v[108:111], a[12:15], a[36:39], 0
ds_read_b128 a[76:79], v26 offset:35072
buffer_load_dwordx4 v2, s[4:7], s48 offen offset:1024 sc1 lds
s_add_u32 s48, s48, 2048
v_mfma_f32_16x16x32_bf16 v[48:51], a[0:3], a[40:43], 0
ds_read_b64_tr_b16 a[100:101], v12 offset:32768
v_mfma_f32_16x16x32_bf16 v[52:55], a[4:7], a[40:43], 0
ds_read_b64_tr_b16 a[102:103], v12 offset:34816
v_mfma_f32_16x16x32_bf16 v[112:115], a[8:11], a[40:43], 0
ds_read_b64_tr_b16 a[104:105], v14 offset:32768
v_mfma_f32_16x16x32_bf16 v[116:119], a[12:15], a[40:43], 0
ds_read_b64_tr_b16 a[106:107], v14 offset:34816
s_add_u32 m0, s54, 16384
s_nop 0
buffer_load_dwordx4 v4, s[8:11], s49 offen lds
v_mfma_f32_16x16x32_bf16 v[56:59], a[0:3], a[44:47], 0
ds_read_b64_tr_b16 a[108:109], v16 offset:32768
v_mfma_f32_16x16x32_bf16 v[60:63], a[4:7], a[44:47], 0
ds_read_b64_tr_b16 a[110:111], v16 offset:34816
v_mfma_f32_16x16x32_bf16 v[120:123], a[8:11], a[44:47], 0
ds_read_b64_tr_b16 a[112:113], v10 offset:40960
v_mfma_f32_16x16x32_bf16 v[124:127], a[12:15], a[44:47], 0
ds_read_b64_tr_b16 a[114:115], v10 offset:43008
buffer_load_dwordx4 v5, s[8:11], s49 offen offset:1024 lds
v_mfma_f32_16x16x32_bf16 v[64:67], a[0:3], a[48:51], 0
ds_read_b64_tr_b16 a[116:117], v12 offset:40960
v_mfma_f32_16x16x32_bf16 v[68:71], a[4:7], a[48:51], 0
ds_read_b64_tr_b16 a[118:119], v12 offset:43008
v_mfma_f32_16x16x32_bf16 v[128:131], a[8:11], a[48:51], 0
ds_read_b64_tr_b16 a[120:121], v14 offset:40960
v_mfma_f32_16x16x32_bf16 v[132:135], a[12:15], a[48:51], 0
ds_read_b64_tr_b16 a[122:123], v14 offset:43008
buffer_load_dwordx4 v6, s[8:11], s49 offen offset:2048 lds
v_mfma_f32_16x16x32_bf16 v[72:75], a[0:3], a[52:55], 0
ds_read_b64_tr_b16 a[124:125], v16 offset:40960
v_mfma_f32_16x16x32_bf16 v[76:79], a[4:7], a[52:55], 0
ds_read_b64_tr_b16 a[126:127], v16 offset:43008
v_mfma_f32_16x16x32_bf16 v[136:139], a[8:11], a[52:55], 0
v_mfma_f32_16x16x32_bf16 v[140:143], a[12:15], a[52:55], 0
buffer_load_dwordx4 v7, s[8:11], s49 offen offset:3072 lds
s_add_u32 s49, s49, s50
v_mfma_f32_16x16x32_bf16 v[80:83], a[0:3], a[56:59], 0
v_mfma_f32_16x16x32_bf16 v[84:87], a[4:7], a[56:59], 0
v_mfma_f32_16x16x32_bf16 v[144:147], a[8:11], a[56:59], 0
v_mfma_f32_16x16x32_bf16 v[148:151], a[12:15], a[56:59], 0
v_mfma_f32_16x16x32_bf16 v[88:91], a[0:3], a[60:63], 0
v_mfma_f32_16x16x32_bf16 v[92:95], a[4:7], a[60:63], 0
v_mfma_f32_16x16x32_bf16 v[152:155], a[8:11], a[60:63], 0
v_mfma_f32_16x16x32_bf16 v[156:159], a[12:15], a[60:63], 0
s_waitcnt lgkmcnt(0)
v_mfma_f32_16x16x32_bf16 v[32:35], a[64:67], a[96:99], v[32:35]
s_cmp_lg_u32 s96, 0
s_cbranch_scc1 L_cw_20326
s_waitcnt vmcnt(8)
L_cw_20326:
s_barrier
v_mfma_f32_16x16x32_bf16 v[36:39], a[68:71], a[96:99], v[36:39]
v_mfma_f32_16x16x32_bf16 v[96:99], a[72:75], a[96:99], v[96:99]
ds_read_b64_tr_b16 a[32:33], v11 offset:0
v_mfma_f32_16x16x32_bf16 v[100:103], a[76:79], a[96:99], v[100:103]
ds_read_b64_tr_b16 a[34:35], v11 offset:2048
s_add_u32 m0, s55, 32768
s_nop 0
buffer_load_dwordx4 v2, s[4:7], s48 offen sc1 lds
v_mfma_f32_16x16x32_bf16 v[40:43], a[64:67], a[100:103], v[40:43]
ds_read_b128 a[0:3], v27 offset:0
v_mfma_f32_16x16x32_bf16 v[44:47], a[68:71], a[100:103], v[44:47]
ds_read_b128 a[4:7], v27 offset:256
v_mfma_f32_16x16x32_bf16 v[104:107], a[72:75], a[100:103], v[104:107]
ds_read_b128 a[8:11], v27 offset:2048
v_mfma_f32_16x16x32_bf16 v[108:111], a[76:79], a[100:103], v[108:111]
ds_read_b128 a[12:15], v27 offset:2304
buffer_load_dwordx4 v2, s[4:7], s48 offen offset:1024 sc1 lds
s_add_u32 s48, s48, 2048
v_mfma_f32_16x16x32_bf16 v[48:51], a[64:67], a[104:107], v[48:51]
ds_read_b64_tr_b16 a[36:37], v13 offset:0
v_mfma_f32_16x16x32_bf16 v[52:55], a[68:71], a[104:107], v[52:55]
ds_read_b64_tr_b16 a[38:39], v13 offset:2048
v_mfma_f32_16x16x32_bf16 v[112:115], a[72:75], a[104:107], v[112:115]
ds_read_b64_tr_b16 a[40:41], v15 offset:0
v_mfma_f32_16x16x32_bf16 v[116:119], a[76:79], a[104:107], v[116:119]
ds_read_b64_tr_b16 a[42:43], v15 offset:2048
s_add_u32 m0, s54, 49152
s_nop 0
buffer_load_dwordx4 v4, s[8:11], s49 offen lds
v_mfma_f32_16x16x32_bf16 v[56:59], a[64:67], a[108:111], v[56:59]
ds_read_b64_tr_b16 a[44:45], v17 offset:0
v_mfma_f32_16x16x32_bf16 v[60:63], a[68:71], a[108:111], v[60:63]
ds_read_b64_tr_b16 a[46:47], v17 offset:2048
v_mfma_f32_16x16x32_bf16 v[120:123], a[72:75], a[108:111], v[120:123]
ds_read_b64_tr_b16 a[48:49], v11 offset:8192
v_mfma_f32_16x16x32_bf16 v[124:127], a[76:79], a[108:111], v[124:127]
ds_read_b64_tr_b16 a[50:51], v11 offset:10240
buffer_load_dwordx4 v5, s[8:11], s49 offen offset:1024 lds
v_mfma_f32_16x16x32_bf16 v[64:67], a[64:67], a[112:115], v[64:67]
ds_read_b64_tr_b16 a[52:53], v13 offset:8192
v_mfma_f32_16x16x32_bf16 v[68:71], a[68:71], a[112:115], v[68:71]
ds_read_b64_tr_b16 a[54:55], v13 offset:10240
v_mfma_f32_16x16x32_bf16 v[128:131], a[72:75], a[112:115], v[128:131]
ds_read_b64_tr_b16 a[56:57], v15 offset:8192
v_mfma_f32_16x16x32_bf16 v[132:135], a[76:79], a[112:115], v[132:135]
ds_read_b64_tr_b16 a[58:59], v15 offset:10240
buffer_load_dwordx4 v6, s[8:11], s49 offen offset:2048 lds
v_mfma_f32_16x16x32_bf16 v[72:75], a[64:67], a[116:119], v[72:75]
ds_read_b64_tr_b16 a[60:61], v17 offset:8192
v_mfma_f32_16x16x32_bf16 v[76:79], a[68:71], a[116:119], v[76:79]
ds_read_b64_tr_b16 a[62:63], v17 offset:10240
v_mfma_f32_16x16x32_bf16 v[136:139], a[72:75], a[116:119], v[136:139]
v_mfma_f32_16x16x32_bf16 v[140:143], a[76:79], a[116:119], v[140:143]
buffer_load_dwordx4 v7, s[8:11], s49 offen offset:3072 lds
s_add_u32 s49, s49, s50
v_mfma_f32_16x16x32_bf16 v[80:83], a[64:67], a[120:123], v[80:83]
v_mfma_f32_16x16x32_bf16 v[84:87], a[68:71], a[120:123], v[84:87]
v_mfma_f32_16x16x32_bf16 v[144:147], a[72:75], a[120:123], v[144:147]
v_mfma_f32_16x16x32_bf16 v[148:151], a[76:79], a[120:123], v[148:151]
v_mfma_f32_16x16x32_bf16 v[88:91], a[64:67], a[124:127], v[88:91]
v_mfma_f32_16x16x32_bf16 v[92:95], a[68:71], a[124:127], v[92:95]
v_mfma_f32_16x16x32_bf16 v[152:155], a[72:75], a[124:127], v[152:155]
v_mfma_f32_16x16x32_bf16 v[156:159], a[76:79], a[124:127], v[156:159]
s_waitcnt lgkmcnt(0)
v_mfma_f32_16x16x32_bf16 v[32:35], a[0:3], a[32:35], v[32:35]
s_cmp_lg_u32 s96, 0
s_cbranch_scc1 L_cw_21327
s_waitcnt vmcnt(12)
L_cw_21327:
s_barrier
v_mfma_f32_16x16x32_bf16 v[36:39], a[4:7], a[32:35], v[36:39]
v_mfma_f32_16x16x32_bf16 v[96:99], a[8:11], a[32:35], v[96:99]
ds_read_b64_tr_b16 a[96:97], v11 offset:32768
v_mfma_f32_16x16x32_bf16 v[100:103], a[12:15], a[32:35], v[100:103]
ds_read_b64_tr_b16 a[98:99], v11 offset:34816
s_add_u32 m0, s55, 65536
s_nop 0
buffer_load_dwordx4 v2, s[4:7], s48 offen sc1 lds
v_mfma_f32_16x16x32_bf16 v[40:43], a[0:3], a[36:39], v[40:43]
ds_read_b128 a[64:67], v27 offset:32768
v_mfma_f32_16x16x32_bf16 v[44:47], a[4:7], a[36:39], v[44:47]
ds_read_b128 a[68:71], v27 offset:33024
v_mfma_f32_16x16x32_bf16 v[104:107], a[8:11], a[36:39], v[104:107]
ds_read_b128 a[72:75], v27 offset:34816
v_mfma_f32_16x16x32_bf16 v[108:111], a[12:15], a[36:39], v[108:111]
ds_read_b128 a[76:79], v27 offset:35072
buffer_load_dwordx4 v2, s[4:7], s48 offen offset:1024 sc1 lds
s_add_u32 s48, s48, 2048
v_mfma_f32_16x16x32_bf16 v[48:51], a[0:3], a[40:43], v[48:51]
ds_read_b64_tr_b16 a[100:101], v13 offset:32768
v_mfma_f32_16x16x32_bf16 v[52:55], a[4:7], a[40:43], v[52:55]
ds_read_b64_tr_b16 a[102:103], v13 offset:34816
v_mfma_f32_16x16x32_bf16 v[112:115], a[8:11], a[40:43], v[112:115]
ds_read_b64_tr_b16 a[104:105], v15 offset:32768
v_mfma_f32_16x16x32_bf16 v[116:119], a[12:15], a[40:43], v[116:119]
ds_read_b64_tr_b16 a[106:107], v15 offset:34816
s_add_u32 m0, s54, 81920
s_nop 0
buffer_load_dwordx4 v4, s[8:11], s49 offen lds
v_mfma_f32_16x16x32_bf16 v[56:59], a[0:3], a[44:47], v[56:59]
ds_read_b64_tr_b16 a[108:109], v17 offset:32768
v_mfma_f32_16x16x32_bf16 v[60:63], a[4:7], a[44:47], v[60:63]
ds_read_b64_tr_b16 a[110:111], v17 offset:34816
v_mfma_f32_16x16x32_bf16 v[120:123], a[8:11], a[44:47], v[120:123]
ds_read_b64_tr_b16 a[112:113], v11 offset:40960
v_mfma_f32_16x16x32_bf16 v[124:127], a[12:15], a[44:47], v[124:127]
ds_read_b64_tr_b16 a[114:115], v11 offset:43008
buffer_load_dwordx4 v5, s[8:11], s49 offen offset:1024 lds
v_mfma_f32_16x16x32_bf16 v[64:67], a[0:3], a[48:51], v[64:67]
ds_read_b64_tr_b16 a[116:117], v13 offset:40960
v_mfma_f32_16x16x32_bf16 v[68:71], a[4:7], a[48:51], v[68:71]
ds_read_b64_tr_b16 a[118:119], v13 offset:43008
v_mfma_f32_16x16x32_bf16 v[128:131], a[8:11], a[48:51], v[128:131]
ds_read_b64_tr_b16 a[120:121], v15 offset:40960
v_mfma_f32_16x16x32_bf16 v[132:135], a[12:15], a[48:51], v[132:135]
ds_read_b64_tr_b16 a[122:123], v15 offset:43008
buffer_load_dwordx4 v6, s[8:11], s49 offen offset:2048 lds
v_mfma_f32_16x16x32_bf16 v[72:75], a[0:3], a[52:55], v[72:75]
ds_read_b64_tr_b16 a[124:125], v17 offset:40960
v_mfma_f32_16x16x32_bf16 v[76:79], a[4:7], a[52:55], v[76:79]
ds_read_b64_tr_b16 a[126:127], v17 offset:43008
v_mfma_f32_16x16x32_bf16 v[136:139], a[8:11], a[52:55], v[136:139]
v_mfma_f32_16x16x32_bf16 v[140:143], a[12:15], a[52:55], v[140:143]
buffer_load_dwordx4 v7, s[8:11], s49 offen offset:3072 lds
s_add_u32 s49, s49, s50
v_mfma_f32_16x16x32_bf16 v[80:83], a[0:3], a[56:59], v[80:83]
v_mfma_f32_16x16x32_bf16 v[84:87], a[4:7], a[56:59], v[84:87]
v_mfma_f32_16x16x32_bf16 v[144:147], a[8:11], a[56:59], v[144:147]
v_mfma_f32_16x16x32_bf16 v[148:151], a[12:15], a[56:59], v[148:151]
v_mfma_f32_16x16x32_bf16 v[88:91], a[0:3], a[60:63], v[88:91]
v_mfma_f32_16x16x32_bf16 v[92:95], a[4:7], a[60:63], v[92:95]
v_mfma_f32_16x16x32_bf16 v[152:155], a[8:11], a[60:63], v[152:155]
v_mfma_f32_16x16x32_bf16 v[156:159], a[12:15], a[60:63], v[156:159]
s_waitcnt lgkmcnt(0)
v_mfma_f32_16x16x32_bf16 v[32:35], a[64:67], a[96:99], v[32:35]
s_waitcnt vmcnt(12)
s_barrier
s_cmp_eq_u32 s92, 255
s_cbranch_scc1 L_nsig_21328
s_cmp_lg_u32 s3, 0
s_cbranch_scc1 L_nsig_21328
s_lshl_b32 s94, s92, 8
s_add_u32 s94, s94, 98566144
v_mov_b32 v29, 0
v_mov_b32 v30, 1
s_mov_b64 exec, 1
buffer_atomic_add v30, v29, s[4:7], s94 offen sc1
s_mov_b64 exec, -1
L_nsig_21328:
v_mfma_f32_16x16x32_bf16 v[36:39], a[68:71], a[96:99], v[36:39]
v_mfma_f32_16x16x32_bf16 v[96:99], a[72:75], a[96:99], v[96:99]
ds_read_b64_tr_b16 a[32:33], v10 offset:0
v_mfma_f32_16x16x32_bf16 v[100:103], a[76:79], a[96:99], v[100:103]
ds_read_b64_tr_b16 a[34:35], v10 offset:2048
s_add_u32 m0, s55, 98304
s_nop 0
buffer_load_dwordx4 v2, s[4:7], s48 offen sc1 lds
v_mfma_f32_16x16x32_bf16 v[40:43], a[64:67], a[100:103], v[40:43]
ds_read_b128 a[0:3], v26 offset:0
v_mfma_f32_16x16x32_bf16 v[44:47], a[68:71], a[100:103], v[44:47]
ds_read_b128 a[4:7], v26 offset:256
v_mfma_f32_16x16x32_bf16 v[104:107], a[72:75], a[100:103], v[104:107]
ds_read_b128 a[8:11], v26 offset:2048
v_mfma_f32_16x16x32_bf16 v[108:111], a[76:79], a[100:103], v[108:111]
ds_read_b128 a[12:15], v26 offset:2304
buffer_load_dwordx4 v2, s[4:7], s48 offen offset:1024 sc1 lds
s_add_u32 s48, s48, 2048
v_mfma_f32_16x16x32_bf16 v[48:51], a[64:67], a[104:107], v[48:51]
ds_read_b64_tr_b16 a[36:37], v12 offset:0
v_mfma_f32_16x16x32_bf16 v[52:55], a[68:71], a[104:107], v[52:55]
ds_read_b64_tr_b16 a[38:39], v12 offset:2048
v_mfma_f32_16x16x32_bf16 v[112:115], a[72:75], a[104:107], v[112:115]
ds_read_b64_tr_b16 a[40:41], v14 offset:0
v_mfma_f32_16x16x32_bf16 v[116:119], a[76:79], a[104:107], v[116:119]
ds_read_b64_tr_b16 a[42:43], v14 offset:2048
s_add_u32 m0, s54, 114688
s_nop 0
buffer_load_dwordx4 v4, s[8:11], s49 offen lds
v_mfma_f32_16x16x32_bf16 v[56:59], a[64:67], a[108:111], v[56:59]
ds_read_b64_tr_b16 a[44:45], v16 offset:0
v_mfma_f32_16x16x32_bf16 v[60:63], a[68:71], a[108:111], v[60:63]
ds_read_b64_tr_b16 a[46:47], v16 offset:2048
v_mfma_f32_16x16x32_bf16 v[120:123], a[72:75], a[108:111], v[120:123]
ds_read_b64_tr_b16 a[48:49], v10 offset:8192
v_mfma_f32_16x16x32_bf16 v[124:127], a[76:79], a[108:111], v[124:127]
ds_read_b64_tr_b16 a[50:51], v10 offset:10240
buffer_load_dwordx4 v5, s[8:11], s49 offen offset:1024 lds
v_mfma_f32_16x16x32_bf16 v[64:67], a[64:67], a[112:115], v[64:67]
ds_read_b64_tr_b16 a[52:53], v12 offset:8192
v_mfma_f32_16x16x32_bf16 v[68:71], a[68:71], a[112:115], v[68:71]
ds_read_b64_tr_b16 a[54:55], v12 offset:10240
v_mfma_f32_16x16x32_bf16 v[128:131], a[72:75], a[112:115], v[128:131]
ds_read_b64_tr_b16 a[56:57], v14 offset:8192
v_mfma_f32_16x16x32_bf16 v[132:135], a[76:79], a[112:115], v[132:135]
ds_read_b64_tr_b16 a[58:59], v14 offset:10240
buffer_load_dwordx4 v6, s[8:11], s49 offen offset:2048 lds
v_mfma_f32_16x16x32_bf16 v[72:75], a[64:67], a[116:119], v[72:75]
ds_read_b64_tr_b16 a[60:61], v16 offset:8192
v_mfma_f32_16x16x32_bf16 v[76:79], a[68:71], a[116:119], v[76:79]
ds_read_b64_tr_b16 a[62:63], v16 offset:10240
v_mfma_f32_16x16x32_bf16 v[136:139], a[72:75], a[116:119], v[136:139]
v_mfma_f32_16x16x32_bf16 v[140:143], a[76:79], a[116:119], v[140:143]
buffer_load_dwordx4 v7, s[8:11], s49 offen offset:3072 lds
s_add_u32 s49, s49, s50
v_mfma_f32_16x16x32_bf16 v[80:83], a[64:67], a[120:123], v[80:83]
v_mfma_f32_16x16x32_bf16 v[84:87], a[68:71], a[120:123], v[84:87]
v_mfma_f32_16x16x32_bf16 v[144:147], a[72:75], a[120:123], v[144:147]
v_mfma_f32_16x16x32_bf16 v[148:151], a[76:79], a[120:123], v[148:151]
v_mfma_f32_16x16x32_bf16 v[88:91], a[64:67], a[124:127], v[88:91]
v_mfma_f32_16x16x32_bf16 v[92:95], a[68:71], a[124:127], v[92:95]
v_mfma_f32_16x16x32_bf16 v[152:155], a[72:75], a[124:127], v[152:155]
v_mfma_f32_16x16x32_bf16 v[156:159], a[76:79], a[124:127], v[156:159]
s_sub_u32 s51, s51, 2
s_cmp_eq_u32 s51, 0
s_cbranch_scc1 L_gl_end_21329
L_gl_21330:
s_waitcnt lgkmcnt(0)
v_mfma_f32_16x16x32_bf16 v[32:35], a[0:3], a[32:35], v[32:35]
s_waitcnt vmcnt(12)
s_barrier
v_mfma_f32_16x16x32_bf16 v[36:39], a[4:7], a[32:35], v[36:39]
v_mfma_f32_16x16x32_bf16 v[96:99], a[8:11], a[32:35], v[96:99]
ds_read_b64_tr_b16 a[96:97], v10 offset:32768
v_mfma_f32_16x16x32_bf16 v[100:103], a[12:15], a[32:35], v[100:103]
ds_read_b64_tr_b16 a[98:99], v10 offset:34816
s_add_u32 m0, s55, 0
s_nop 0
buffer_load_dwordx4 v2, s[4:7], s48 offen sc1 lds
v_mfma_f32_16x16x32_bf16 v[40:43], a[0:3], a[36:39], v[40:43]
ds_read_b128 a[64:67], v26 offset:32768
v_mfma_f32_16x16x32_bf16 v[44:47], a[4:7], a[36:39], v[44:47]
ds_read_b128 a[68:71], v26 offset:33024
v_mfma_f32_16x16x32_bf16 v[104:107], a[8:11], a[36:39], v[104:107]
ds_read_b128 a[72:75], v26 offset:34816
v_mfma_f32_16x16x32_bf16 v[108:111], a[12:15], a[36:39], v[108:111]
ds_read_b128 a[76:79], v26 offset:35072
buffer_load_dwordx4 v2, s[4:7], s48 offen offset:1024 sc1 lds
s_add_u32 s48, s48, 2048
v_mfma_f32_16x16x32_bf16 v[48:51], a[0:3], a[40:43], v[48:51]
ds_read_b64_tr_b16 a[100:101], v12 offset:32768
v_mfma_f32_16x16x32_bf16 v[52:55], a[4:7], a[40:43], v[52:55]
ds_read_b64_tr_b16 a[102:103], v12 offset:34816
v_mfma_f32_16x16x32_bf16 v[112:115], a[8:11], a[40:43], v[112:115]
ds_read_b64_tr_b16 a[104:105], v14 offset:32768
v_mfma_f32_16x16x32_bf16 v[116:119], a[12:15], a[40:43], v[116:119]
ds_read_b64_tr_b16 a[106:107], v14 offset:34816
s_add_u32 m0, s54, 16384
s_nop 0
buffer_load_dwordx4 v4, s[8:11], s49 offen lds
v_mfma_f32_16x16x32_bf16 v[56:59], a[0:3], a[44:47], v[56:59]
ds_read_b64_tr_b16 a[108:109], v16 offset:32768
v_mfma_f32_16x16x32_bf16 v[60:63], a[4:7], a[44:47], v[60:63]
ds_read_b64_tr_b16 a[110:111], v16 offset:34816
v_mfma_f32_16x16x32_bf16 v[120:123], a[8:11], a[44:47], v[120:123]
ds_read_b64_tr_b16 a[112:113], v10 offset:40960
v_mfma_f32_16x16x32_bf16 v[124:127], a[12:15], a[44:47], v[124:127]
ds_read_b64_tr_b16 a[114:115], v10 offset:43008
buffer_load_dwordx4 v5, s[8:11], s49 offen offset:1024 lds
v_mfma_f32_16x16x32_bf16 v[64:67], a[0:3], a[48:51], v[64:67]
ds_read_b64_tr_b16 a[116:117], v12 offset:40960
v_mfma_f32_16x16x32_bf16 v[68:71], a[4:7], a[48:51], v[68:71]
ds_read_b64_tr_b16 a[118:119], v12 offset:43008
v_mfma_f32_16x16x32_bf16 v[128:131], a[8:11], a[48:51], v[128:131]
ds_read_b64_tr_b16 a[120:121], v14 offset:40960
v_mfma_f32_16x16x32_bf16 v[132:135], a[12:15], a[48:51], v[132:135]
ds_read_b64_tr_b16 a[122:123], v14 offset:43008
buffer_load_dwordx4 v6, s[8:11], s49 offen offset:2048 lds
v_mfma_f32_16x16x32_bf16 v[72:75], a[0:3], a[52:55], v[72:75]
ds_read_b64_tr_b16 a[124:125], v16 offset:40960
v_mfma_f32_16x16x32_bf16 v[76:79], a[4:7], a[52:55], v[76:79]
ds_read_b64_tr_b16 a[126:127], v16 offset:43008
v_mfma_f32_16x16x32_bf16 v[136:139], a[8:11], a[52:55], v[136:139]
v_mfma_f32_16x16x32_bf16 v[140:143], a[12:15], a[52:55], v[140:143]
buffer_load_dwordx4 v7, s[8:11], s49 offen offset:3072 lds
s_add_u32 s49, s49, s50
v_mfma_f32_16x16x32_bf16 v[80:83], a[0:3], a[56:59], v[80:83]
v_mfma_f32_16x16x32_bf16 v[84:87], a[4:7], a[56:59], v[84:87]
v_mfma_f32_16x16x32_bf16 v[144:147], a[8:11], a[56:59], v[144:147]
v_mfma_f32_16x16x32_bf16 v[148:151], a[12:15], a[56:59], v[148:151]
v_mfma_f32_16x16x32_bf16 v[88:91], a[0:3], a[60:63], v[88:91]
v_mfma_f32_16x16x32_bf16 v[92:95], a[4:7], a[60:63], v[92:95]
v_mfma_f32_16x16x32_bf16 v[152:155], a[8:11], a[60:63], v[152:155]
v_mfma_f32_16x16x32_bf16 v[156:159], a[12:15], a[60:63], v[156:159]
s_waitcnt lgkmcnt(0)
v_mfma_f32_16x16x32_bf16 v[32:35], a[64:67], a[96:99], v[32:35]
s_waitcnt vmcnt(12)
s_barrier
v_mfma_f32_16x16x32_bf16 v[36:39], a[68:71], a[96:99], v[36:39]
v_mfma_f32_16x16x32_bf16 v[96:99], a[72:75], a[96:99], v[96:99]
ds_read_b64_tr_b16 a[32:33], v11 offset:0
v_mfma_f32_16x16x32_bf16 v[100:103], a[76:79], a[96:99], v[100:103]
ds_read_b64_tr_b16 a[34:35], v11 offset:2048
s_add_u32 m0, s55, 32768
s_nop 0
buffer_load_dwordx4 v2, s[4:7], s48 offen sc1 lds
v_mfma_f32_16x16x32_bf16 v[40:43], a[64:67], a[100:103], v[40:43]
ds_read_b128 a[0:3], v27 offset:0
v_mfma_f32_16x16x32_bf16 v[44:47], a[68:71], a[100:103], v[44:47]
ds_read_b128 a[4:7], v27 offset:256
v_mfma_f32_16x16x32_bf16 v[104:107], a[72:75], a[100:103], v[104:107]
ds_read_b128 a[8:11], v27 offset:2048
v_mfma_f32_16x16x32_bf16 v[108:111], a[76:79], a[100:103], v[108:111]
ds_read_b128 a[12:15], v27 offset:2304
buffer_load_dwordx4 v2, s[4:7], s48 offen offset:1024 sc1 lds
s_add_u32 s48, s48, 2048
v_mfma_f32_16x16x32_bf16 v[48:51], a[64:67], a[104:107], v[48:51]
ds_read_b64_tr_b16 a[36:37], v13 offset:0
v_mfma_f32_16x16x32_bf16 v[52:55], a[68:71], a[104:107], v[52:55]
ds_read_b64_tr_b16 a[38:39], v13 offset:2048
v_mfma_f32_16x16x32_bf16 v[112:115], a[72:75], a[104:107], v[112:115]
ds_read_b64_tr_b16 a[40:41], v15 offset:0
v_mfma_f32_16x16x32_bf16 v[116:119], a[76:79], a[104:107], v[116:119]
ds_read_b64_tr_b16 a[42:43], v15 offset:2048
s_add_u32 m0, s54, 49152
s_nop 0
buffer_load_dwordx4 v4, s[8:11], s49 offen lds
v_mfma_f32_16x16x32_bf16 v[56:59], a[64:67], a[108:111], v[56:59]
ds_read_b64_tr_b16 a[44:45], v17 offset:0
v_mfma_f32_16x16x32_bf16 v[60:63], a[68:71], a[108:111], v[60:63]
ds_read_b64_tr_b16 a[46:47], v17 offset:2048
v_mfma_f32_16x16x32_bf16 v[120:123], a[72:75], a[108:111], v[120:123]
ds_read_b64_tr_b16 a[48:49], v11 offset:8192
v_mfma_f32_16x16x32_bf16 v[124:127], a[76:79], a[108:111], v[124:127]
ds_read_b64_tr_b16 a[50:51], v11 offset:10240
buffer_load_dwordx4 v5, s[8:11], s49 offen offset:1024 lds
v_mfma_f32_16x16x32_bf16 v[64:67], a[64:67], a[112:115], v[64:67]
ds_read_b64_tr_b16 a[52:53], v13 offset:8192
v_mfma_f32_16x16x32_bf16 v[68:71], a[68:71], a[112:115], v[68:71]
ds_read_b64_tr_b16 a[54:55], v13 offset:10240
v_mfma_f32_16x16x32_bf16 v[128:131], a[72:75], a[112:115], v[128:131]
ds_read_b64_tr_b16 a[56:57], v15 offset:8192
v_mfma_f32_16x16x32_bf16 v[132:135], a[76:79], a[112:115], v[132:135]
ds_read_b64_tr_b16 a[58:59], v15 offset:10240
buffer_load_dwordx4 v6, s[8:11], s49 offen offset:2048 lds
v_mfma_f32_16x16x32_bf16 v[72:75], a[64:67], a[116:119], v[72:75]
ds_read_b64_tr_b16 a[60:61], v17 offset:8192
v_mfma_f32_16x16x32_bf16 v[76:79], a[68:71], a[116:119], v[76:79]
ds_read_b64_tr_b16 a[62:63], v17 offset:10240
v_mfma_f32_16x16x32_bf16 v[136:139], a[72:75], a[116:119], v[136:139]
v_mfma_f32_16x16x32_bf16 v[140:143], a[76:79], a[116:119], v[140:143]
buffer_load_dwordx4 v7, s[8:11], s49 offen offset:3072 lds
s_add_u32 s49, s49, s50
v_mfma_f32_16x16x32_bf16 v[80:83], a[64:67], a[120:123], v[80:83]
v_mfma_f32_16x16x32_bf16 v[84:87], a[68:71], a[120:123], v[84:87]
v_mfma_f32_16x16x32_bf16 v[144:147], a[72:75], a[120:123], v[144:147]
v_mfma_f32_16x16x32_bf16 v[148:151], a[76:79], a[120:123], v[148:151]
v_mfma_f32_16x16x32_bf16 v[88:91], a[64:67], a[124:127], v[88:91]
v_mfma_f32_16x16x32_bf16 v[92:95], a[68:71], a[124:127], v[92:95]
v_mfma_f32_16x16x32_bf16 v[152:155], a[72:75], a[124:127], v[152:155]
v_mfma_f32_16x16x32_bf16 v[156:159], a[76:79], a[124:127], v[156:159]
s_waitcnt lgkmcnt(0)
v_mfma_f32_16x16x32_bf16 v[32:35], a[0:3], a[32:35], v[32:35]
s_waitcnt vmcnt(12)
s_barrier
v_mfma_f32_16x16x32_bf16 v[36:39], a[4:7], a[32:35], v[36:39]
v_mfma_f32_16x16x32_bf16 v[96:99], a[8:11], a[32:35], v[96:99]
ds_read_b64_tr_b16 a[96:97], v11 offset:32768
v_mfma_f32_16x16x32_bf16 v[100:103], a[12:15], a[32:35], v[100:103]
ds_read_b64_tr_b16 a[98:99], v11 offset:34816
s_add_u32 m0, s55, 65536
s_nop 0
buffer_load_dwordx4 v2, s[4:7], s48 offen sc1 lds
v_mfma_f32_16x16x32_bf16 v[40:43], a[0:3], a[36:39], v[40:43]
ds_read_b128 a[64:67], v27 offset:32768
v_mfma_f32_16x16x32_bf16 v[44:47], a[4:7], a[36:39], v[44:47]
ds_read_b128 a[68:71], v27 offset:33024
v_mfma_f32_16x16x32_bf16 v[104:107], a[8:11], a[36:39], v[104:107]
ds_read_b128 a[72:75], v27 offset:34816
v_mfma_f32_16x16x32_bf16 v[108:111], a[12:15], a[36:39], v[108:111]
ds_read_b128 a[76:79], v27 offset:35072
buffer_load_dwordx4 v2, s[4:7], s48 offen offset:1024 sc1 lds
s_add_u32 s48, s48, 2048
v_mfma_f32_16x16x32_bf16 v[48:51], a[0:3], a[40:43], v[48:51]
ds_read_b64_tr_b16 a[100:101], v13 offset:32768
v_mfma_f32_16x16x32_bf16 v[52:55], a[4:7], a[40:43], v[52:55]
ds_read_b64_tr_b16 a[102:103], v13 offset:34816
v_mfma_f32_16x16x32_bf16 v[112:115], a[8:11], a[40:43], v[112:115]
ds_read_b64_tr_b16 a[104:105], v15 offset:32768
v_mfma_f32_16x16x32_bf16 v[116:119], a[12:15], a[40:43], v[116:119]
ds_read_b64_tr_b16 a[106:107], v15 offset:34816
s_add_u32 m0, s54, 81920
s_nop 0
buffer_load_dwordx4 v4, s[8:11], s49 offen lds
v_mfma_f32_16x16x32_bf16 v[56:59], a[0:3], a[44:47], v[56:59]
ds_read_b64_tr_b16 a[108:109], v17 offset:32768
v_mfma_f32_16x16x32_bf16 v[60:63], a[4:7], a[44:47], v[60:63]
ds_read_b64_tr_b16 a[110:111], v17 offset:34816
v_mfma_f32_16x16x32_bf16 v[120:123], a[8:11], a[44:47], v[120:123]
ds_read_b64_tr_b16 a[112:113], v11 offset:40960
v_mfma_f32_16x16x32_bf16 v[124:127], a[12:15], a[44:47], v[124:127]
ds_read_b64_tr_b16 a[114:115], v11 offset:43008
buffer_load_dwordx4 v5, s[8:11], s49 offen offset:1024 lds
v_mfma_f32_16x16x32_bf16 v[64:67], a[0:3], a[48:51], v[64:67]
ds_read_b64_tr_b16 a[116:117], v13 offset:40960
v_mfma_f32_16x16x32_bf16 v[68:71], a[4:7], a[48:51], v[68:71]
ds_read_b64_tr_b16 a[118:119], v13 offset:43008
v_mfma_f32_16x16x32_bf16 v[128:131], a[8:11], a[48:51], v[128:131]
ds_read_b64_tr_b16 a[120:121], v15 offset:40960
v_mfma_f32_16x16x32_bf16 v[132:135], a[12:15], a[48:51], v[132:135]
ds_read_b64_tr_b16 a[122:123], v15 offset:43008
buffer_load_dwordx4 v6, s[8:11], s49 offen offset:2048 lds
v_mfma_f32_16x16x32_bf16 v[72:75], a[0:3], a[52:55], v[72:75]
ds_read_b64_tr_b16 a[124:125], v17 offset:40960
v_mfma_f32_16x16x32_bf16 v[76:79], a[4:7], a[52:55], v[76:79]
ds_read_b64_tr_b16 a[126:127], v17 offset:43008
v_mfma_f32_16x16x32_bf16 v[136:139], a[8:11], a[52:55], v[136:139]
v_mfma_f32_16x16x32_bf16 v[140:143], a[12:15], a[52:55], v[140:143]
buffer_load_dwordx4 v7, s[8:11], s49 offen offset:3072 lds
s_add_u32 s49, s49, s50
v_mfma_f32_16x16x32_bf16 v[80:83], a[0:3], a[56:59], v[80:83]
v_mfma_f32_16x16x32_bf16 v[84:87], a[4:7], a[56:59], v[84:87]
v_mfma_f32_16x16x32_bf16 v[144:147], a[8:11], a[56:59], v[144:147]
v_mfma_f32_16x16x32_bf16 v[148:151], a[12:15], a[56:59], v[148:151]
v_mfma_f32_16x16x32_bf16 v[88:91], a[0:3], a[60:63], v[88:91]
v_mfma_f32_16x16x32_bf16 v[92:95], a[4:7], a[60:63], v[92:95]
v_mfma_f32_16x16x32_bf16 v[152:155], a[8:11], a[60:63], v[152:155]
v_mfma_f32_16x16x32_bf16 v[156:159], a[12:15], a[60:63], v[156:159]
s_waitcnt lgkmcnt(0)
v_mfma_f32_16x16x32_bf16 v[32:35], a[64:67], a[96:99], v[32:35]
s_waitcnt vmcnt(12)
s_barrier
v_mfma_f32_16x16x32_bf16 v[36:39], a[68:71], a[96:99], v[36:39]
v_mfma_f32_16x16x32_bf16 v[96:99], a[72:75], a[96:99], v[96:99]
ds_read_b64_tr_b16 a[32:33], v10 offset:0
v_mfma_f32_16x16x32_bf16 v[100:103], a[76:79], a[96:99], v[100:103]
ds_read_b64_tr_b16 a[34:35], v10 offset:2048
s_add_u32 m0, s55, 98304
s_nop 0
buffer_load_dwordx4 v2, s[4:7], s48 offen sc1 lds
v_mfma_f32_16x16x32_bf16 v[40:43], a[64:67], a[100:103], v[40:43]
ds_read_b128 a[0:3], v26 offset:0
v_mfma_f32_16x16x32_bf16 v[44:47], a[68:71], a[100:103], v[44:47]
ds_read_b128 a[4:7], v26 offset:256
v_mfma_f32_16x16x32_bf16 v[104:107], a[72:75], a[100:103], v[104:107]
ds_read_b128 a[8:11], v26 offset:2048
v_mfma_f32_16x16x32_bf16 v[108:111], a[76:79], a[100:103], v[108:111]
ds_read_b128 a[12:15], v26 offset:2304
buffer_load_dwordx4 v2, s[4:7], s48 offen offset:1024 sc1 lds
s_add_u32 s48, s48, 2048
v_mfma_f32_16x16x32_bf16 v[48:51], a[64:67], a[104:107], v[48:51]
ds_read_b64_tr_b16 a[36:37], v12 offset:0
v_mfma_f32_16x16x32_bf16 v[52:55], a[68:71], a[104:107], v[52:55]
ds_read_b64_tr_b16 a[38:39], v12 offset:2048
v_mfma_f32_16x16x32_bf16 v[112:115], a[72:75], a[104:107], v[112:115]
ds_read_b64_tr_b16 a[40:41], v14 offset:0
v_mfma_f32_16x16x32_bf16 v[116:119], a[76:79], a[104:107], v[116:119]
ds_read_b64_tr_b16 a[42:43], v14 offset:2048
s_add_u32 m0, s54, 114688
s_nop 0
buffer_load_dwordx4 v4, s[8:11], s49 offen lds
v_mfma_f32_16x16x32_bf16 v[56:59], a[64:67], a[108:111], v[56:59]
ds_read_b64_tr_b16 a[44:45], v16 offset:0
v_mfma_f32_16x16x32_bf16 v[60:63], a[68:71], a[108:111], v[60:63]
ds_read_b64_tr_b16 a[46:47], v16 offset:2048
v_mfma_f32_16x16x32_bf16 v[120:123], a[72:75], a[108:111], v[120:123]
ds_read_b64_tr_b16 a[48:49], v10 offset:8192
v_mfma_f32_16x16x32_bf16 v[124:127], a[76:79], a[108:111], v[124:127]
ds_read_b64_tr_b16 a[50:51], v10 offset:10240
buffer_load_dwordx4 v5, s[8:11], s49 offen offset:1024 lds
v_mfma_f32_16x16x32_bf16 v[64:67], a[64:67], a[112:115], v[64:67]
ds_read_b64_tr_b16 a[52:53], v12 offset:8192
v_mfma_f32_16x16x32_bf16 v[68:71], a[68:71], a[112:115], v[68:71]
ds_read_b64_tr_b16 a[54:55], v12 offset:10240
v_mfma_f32_16x16x32_bf16 v[128:131], a[72:75], a[112:115], v[128:131]
ds_read_b64_tr_b16 a[56:57], v14 offset:8192
v_mfma_f32_16x16x32_bf16 v[132:135], a[76:79], a[112:115], v[132:135]
ds_read_b64_tr_b16 a[58:59], v14 offset:10240
buffer_load_dwordx4 v6, s[8:11], s49 offen offset:2048 lds
v_mfma_f32_16x16x32_bf16 v[72:75], a[64:67], a[116:119], v[72:75]
ds_read_b64_tr_b16 a[60:61], v16 offset:8192
v_mfma_f32_16x16x32_bf16 v[76:79], a[68:71], a[116:119], v[76:79]
ds_read_b64_tr_b16 a[62:63], v16 offset:10240
v_mfma_f32_16x16x32_bf16 v[136:139], a[72:75], a[116:119], v[136:139]
v_mfma_f32_16x16x32_bf16 v[140:143], a[76:79], a[116:119], v[140:143]
buffer_load_dwordx4 v7, s[8:11], s49 offen offset:3072 lds
s_add_u32 s49, s49, s50
v_mfma_f32_16x16x32_bf16 v[80:83], a[64:67], a[120:123], v[80:83]
v_mfma_f32_16x16x32_bf16 v[84:87], a[68:71], a[120:123], v[84:87]
v_mfma_f32_16x16x32_bf16 v[144:147], a[72:75], a[120:123], v[144:147]
v_mfma_f32_16x16x32_bf16 v[148:151], a[76:79], a[120:123], v[148:151]
v_mfma_f32_16x16x32_bf16 v[88:91], a[64:67], a[124:127], v[88:91]
v_mfma_f32_16x16x32_bf16 v[92:95], a[68:71], a[124:127], v[92:95]
v_mfma_f32_16x16x32_bf16 v[152:155], a[72:75], a[124:127], v[152:155]
v_mfma_f32_16x16x32_bf16 v[156:159], a[76:79], a[124:127], v[156:159]
s_sub_u32 s51, s51, 1
s_cmp_lg_u32 s51, 0
s_cbranch_scc1 L_gl_21330
L_gl_end_21329:
s_waitcnt lgkmcnt(0)
v_mfma_f32_16x16x32_bf16 v[32:35], a[0:3], a[32:35], v[32:35]
s_waitcnt vmcnt(12)
s_barrier
s_cmp_lg_u32 s91, 2
s_cbranch_scc1 L_nll_21331
s_cmp_lg_u32 s3, 0
s_cbranch_scc1 L_nll_21331
s_and_b32 s94, s73, 255
s_lshl_b32 s94, s94, 8
s_add_u32 s94, s94, 98566144
v_mov_b32 v29, 0
buffer_load_dword v31, v29, s[4:7], s94 offen sc1
L_nll_21331:
v_mfma_f32_16x16x32_bf16 v[36:39], a[4:7], a[32:35], v[36:39]
v_mfma_f32_16x16x32_bf16 v[96:99], a[8:11], a[32:35], v[96:99]
ds_read_b64_tr_b16 a[96:97], v10 offset:32768
v_mfma_f32_16x16x32_bf16 v[100:103], a[12:15], a[32:35], v[100:103]
ds_read_b64_tr_b16 a[98:99], v10 offset:34816
v_mfma_f32_16x16x32_bf16 v[40:43], a[0:3], a[36:39], v[40:43]
ds_read_b128 a[64:67], v26 offset:32768
v_mfma_f32_16x16x32_bf16 v[44:47], a[4:7], a[36:39], v[44:47]
ds_read_b128 a[68:71], v26 offset:33024
v_mfma_f32_16x16x32_bf16 v[104:107], a[8:11], a[36:39], v[104:107]
ds_read_b128 a[72:75], v26 offset:34816
v_mfma_f32_16x16x32_bf16 v[108:111], a[12:15], a[36:39], v[108:111]
ds_read_b128 a[76:79], v26 offset:35072
v_mfma_f32_16x16x32_bf16 v[48:51], a[0:3], a[40:43], v[48:51]
ds_read_b64_tr_b16 a[100:101], v12 offset:32768
v_mfma_f32_16x16x32_bf16 v[52:55], a[4:7], a[40:43], v[52:55]
ds_read_b64_tr_b16 a[102:103], v12 offset:34816
v_mfma_f32_16x16x32_bf16 v[112:115], a[8:11], a[40:43], v[112:115]
ds_read_b64_tr_b16 a[104:105], v14 offset:32768
v_mfma_f32_16x16x32_bf16 v[116:119], a[12:15], a[40:43], v[116:119]
ds_read_b64_tr_b16 a[106:107], v14 offset:34816
v_mfma_f32_16x16x32_bf16 v[56:59], a[0:3], a[44:47], v[56:59]
ds_read_b64_tr_b16 a[108:109], v16 offset:32768
v_mfma_f32_16x16x32_bf16 v[60:63], a[4:7], a[44:47], v[60:63]
ds_read_b64_tr_b16 a[110:111], v16 offset:34816
v_mfma_f32_16x16x32_bf16 v[120:123], a[8:11], a[44:47], v[120:123]
ds_read_b64_tr_b16 a[112:113], v10 offset:40960
v_mfma_f32_16x16x32_bf16 v[124:127], a[12:15], a[44:47], v[124:127]
ds_read_b64_tr_b16 a[114:115], v10 offset:43008
v_mfma_f32_16x16x32_bf16 v[64:67], a[0:3], a[48:51], v[64:67]
ds_read_b64_tr_b16 a[116:117], v12 offset:40960
s_cmp_lg_u32 s91, 1
s_cbranch_scc1 L_npf_21332
s_cmp_ge_u32 s90, 4
s_cbranch_scc1 L_pfh_21333
s_add_u32 m0, s87, 0
s_nop 0
buffer_load_dwordx4 v20, s[4:7], s84 offen sc1 lds
buffer_load_dwordx4 v20, s[4:7], s84 offen offset:1024 sc1 lds
buffer_load_dwordx4 v21, s[4:7], s84 offen offset:2048 sc1 lds
buffer_load_dwordx4 v21, s[4:7], s84 offen offset:3072 sc1 lds
s_add_u32 s84, s84, 2048
s_add_u32 m0, s54, 16384
s_nop 0
buffer_load_dwordx4 v22, s[80:83], s85 offen lds
buffer_load_dwordx4 v23, s[80:83], s85 offen offset:1024 lds
buffer_load_dwordx4 v24, s[80:83], s85 offen offset:2048 lds
buffer_load_dwordx4 v25, s[80:83], s85 offen offset:3072 lds
s_add_u32 s85, s85, s86
s_branch L_npf_21332
L_pfh_21333:
s_add_u32 m0, s87, 0
s_nop 0
buffer_load_dwordx4 v20, s[4:7], s84 offen sc1 lds
buffer_load_dwordx4 v20, s[4:7], s84 offen offset:1024 sc1 lds
s_add_u32 s84, s84, 2048
s_add_u32 m0, s54, 16384
s_nop 0
buffer_load_dwordx4 v22, s[80:83], s85 offen lds
buffer_load_dwordx4 v23, s[80:83], s85 offen offset:1024 lds
buffer_load_dwordx4 v24, s[80:83], s85 offen offset:2048 lds
buffer_load_dwordx4 v25, s[80:83], s85 offen offset:3072 lds
s_add_u32 s85, s85, s86
L_npf_21332:
v_mfma_f32_16x16x32_bf16 v[68:71], a[4:7], a[48:51], v[68:71]
ds_read_b64_tr_b16 a[118:119], v12 offset:43008
v_mfma_f32_16x16x32_bf16 v[128:131], a[8:11], a[48:51], v[128:131]
ds_read_b64_tr_b16 a[120:121], v14 offset:40960
v_mfma_f32_16x16x32_bf16 v[132:135], a[12:15], a[48:51], v[132:135]
ds_read_b64_tr_b16 a[122:123], v14 offset:43008
v_mfma_f32_16x16x32_bf16 v[72:75], a[0:3], a[52:55], v[72:75]
ds_read_b64_tr_b16 a[124:125], v16 offset:40960
v_mfma_f32_16x16x32_bf16 v[76:79], a[4:7], a[52:55], v[76:79]
ds_read_b64_tr_b16 a[126:127], v16 offset:43008
v_mfma_f32_16x16x32_bf16 v[136:139], a[8:11], a[52:55], v[136:139]
v_mfma_f32_16x16x32_bf16 v[140:143], a[12:15], a[52:55], v[140:143]
v_mfma_f32_16x16x32_bf16 v[80:83], a[0:3], a[56:59], v[80:83]
v_mfma_f32_16x16x32_bf16 v[84:87], a[4:7], a[56:59], v[84:87]
v_mfma_f32_16x16x32_bf16 v[144:147], a[8:11], a[56:59], v[144:147]
v_mfma_f32_16x16x32_bf16 v[148:151], a[12:15], a[56:59], v[148:151]
v_mfma_f32_16x16x32_bf16 v[88:91], a[0:3], a[60:63], v[88:91]
v_mfma_f32_16x16x32_bf16 v[92:95], a[4:7], a[60:63], v[92:95]
v_mfma_f32_16x16x32_bf16 v[152:155], a[8:11], a[60:63], v[152:155]
v_mfma_f32_16x16x32_bf16 v[156:159], a[12:15], a[60:63], v[156:159]
s_waitcnt lgkmcnt(0)
v_mfma_f32_16x16x32_bf16 v[32:35], a[64:67], a[96:99], v[32:35]
s_cmp_lg_u32 s91, 1
s_cbranch_scc1 L_tw_21334
s_waitcnt vmcnt(12)
s_branch L_tw_21335
L_tw_21334:
s_waitcnt vmcnt(6)
L_tw_21335:
s_barrier
v_mfma_f32_16x16x32_bf16 v[36:39], a[68:71], a[96:99], v[36:39]
v_mfma_f32_16x16x32_bf16 v[96:99], a[72:75], a[96:99], v[96:99]
ds_read_b64_tr_b16 a[32:33], v11 offset:0
v_mfma_f32_16x16x32_bf16 v[100:103], a[76:79], a[96:99], v[100:103]
ds_read_b64_tr_b16 a[34:35], v11 offset:2048
v_mfma_f32_16x16x32_bf16 v[40:43], a[64:67], a[100:103], v[40:43]
ds_read_b128 a[0:3], v27 offset:0
v_mfma_f32_16x16x32_bf16 v[44:47], a[68:71], a[100:103], v[44:47]
ds_read_b128 a[4:7], v27 offset:256
v_mfma_f32_16x16x32_bf16 v[104:107], a[72:75], a[100:103], v[104:107]
ds_read_b128 a[8:11], v27 offset:2048
v_mfma_f32_16x16x32_bf16 v[108:111], a[76:79], a[100:103], v[108:111]
ds_read_b128 a[12:15], v27 offset:2304
v_mfma_f32_16x16x32_bf16 v[48:51], a[64:67], a[104:107], v[48:51]
ds_read_b64_tr_b16 a[36:37], v13 offset:0
v_mfma_f32_16x16x32_bf16 v[52:55], a[68:71], a[104:107], v[52:55]
ds_read_b64_tr_b16 a[38:39], v13 offset:2048
v_mfma_f32_16x16x32_bf16 v[112:115], a[72:75], a[104:107], v[112:115]
ds_read_b64_tr_b16 a[40:41], v15 offset:0
v_mfma_f32_16x16x32_bf16 v[116:119], a[76:79], a[104:107], v[116:119]
ds_read_b64_tr_b16 a[42:43], v15 offset:2048
v_mfma_f32_16x16x32_bf16 v[56:59], a[64:67], a[108:111], v[56:59]
ds_read_b64_tr_b16 a[44:45], v17 offset:0
v_mfma_f32_16x16x32_bf16 v[60:63], a[68:71], a[108:111], v[60:63]
ds_read_b64_tr_b16 a[46:47], v17 offset:2048
v_mfma_f32_16x16x32_bf16 v[120:123], a[72:75], a[108:111], v[120:123]
ds_read_b64_tr_b16 a[48:49], v11 offset:8192
v_mfma_f32_16x16x32_bf16 v[124:127], a[76:79], a[108:111], v[124:127]
ds_read_b64_tr_b16 a[50:51], v11 offset:10240
v_mfma_f32_16x16x32_bf16 v[64:67], a[64:67], a[112:115], v[64:67]
ds_read_b64_tr_b16 a[52:53], v13 offset:8192
s_cmp_lg_u32 s91, 1
s_cbranch_scc1 L_npf_22336
s_cmp_ge_u32 s90, 4
s_cbranch_scc1 L_pfh_22337
s_add_u32 m0, s87, 32768
s_nop 0
buffer_load_dwordx4 v20, s[4:7], s84 offen sc1 lds
buffer_load_dwordx4 v20, s[4:7], s84 offen offset:1024 sc1 lds
buffer_load_dwordx4 v21, s[4:7], s84 offen offset:2048 sc1 lds
buffer_load_dwordx4 v21, s[4:7], s84 offen offset:3072 sc1 lds
s_add_u32 s84, s84, 2048
s_add_u32 m0, s54, 49152
s_nop 0
buffer_load_dwordx4 v22, s[80:83], s85 offen lds
buffer_load_dwordx4 v23, s[80:83], s85 offen offset:1024 lds
buffer_load_dwordx4 v24, s[80:83], s85 offen offset:2048 lds
buffer_load_dwordx4 v25, s[80:83], s85 offen offset:3072 lds
s_add_u32 s85, s85, s86
s_branch L_npf_22336
L_pfh_22337:
s_add_u32 m0, s87, 32768
s_nop 0
buffer_load_dwordx4 v20, s[4:7], s84 offen sc1 lds
buffer_load_dwordx4 v20, s[4:7], s84 offen offset:1024 sc1 lds
s_add_u32 s84, s84, 2048
s_add_u32 m0, s54, 49152
s_nop 0
buffer_load_dwordx4 v22, s[80:83], s85 offen lds
buffer_load_dwordx4 v23, s[80:83], s85 offen offset:1024 lds
buffer_load_dwordx4 v24, s[80:83], s85 offen offset:2048 lds
buffer_load_dwordx4 v25, s[80:83], s85 offen offset:3072 lds
s_add_u32 s85, s85, s86
L_npf_22336:
v_mfma_f32_16x16x32_bf16 v[68:71], a[68:71], a[112:115], v[68:71]
ds_read_b64_tr_b16 a[54:55], v13 offset:10240
v_mfma_f32_16x16x32_bf16 v[128:131], a[72:75], a[112:115], v[128:131]
ds_read_b64_tr_b16 a[56:57], v15 offset:8192
v_mfma_f32_16x16x32_bf16 v[132:135], a[76:79], a[112:115], v[132:135]
ds_read_b64_tr_b16 a[58:59], v15 offset:10240
v_mfma_f32_16x16x32_bf16 v[72:75], a[64:67], a[116:119], v[72:75]
ds_read_b64_tr_b16 a[60:61], v17 offset:8192
v_mfma_f32_16x16x32_bf16 v[76:79], a[68:71], a[116:119], v[76:79]
ds_read_b64_tr_b16 a[62:63], v17 offset:10240
v_mfma_f32_16x16x32_bf16 v[136:139], a[72:75], a[116:119], v[136:139]
v_mfma_f32_16x16x32_bf16 v[140:143], a[76:79], a[116:119], v[140:143]
v_mfma_f32_16x16x32_bf16 v[80:83], a[64:67], a[120:123], v[80:83]
v_mfma_f32_16x16x32_bf16 v[84:87], a[68:71], a[120:123], v[84:87]
v_mfma_f32_16x16x32_bf16 v[144:147], a[72:75], a[120:123], v[144:147]
v_mfma_f32_16x16x32_bf16 v[148:151], a[76:79], a[120:123], v[148:151]
v_mfma_f32_16x16x32_bf16 v[88:91], a[64:67], a[124:127], v[88:91]
v_mfma_f32_16x16x32_bf16 v[92:95], a[68:71], a[124:127], v[92:95]
v_mfma_f32_16x16x32_bf16 v[152:155], a[72:75], a[124:127], v[152:155]
v_mfma_f32_16x16x32_bf16 v[156:159], a[76:79], a[124:127], v[156:159]
s_waitcnt lgkmcnt(0)
v_mfma_f32_16x16x32_bf16 v[32:35], a[0:3], a[32:35], v[32:35]
s_cmp_lg_u32 s91, 1
s_cbranch_scc1 L_tw_22338
s_waitcnt vmcnt(12)
s_branch L_tw_22339
L_tw_22338:
s_waitcnt vmcnt(0)
L_tw_22339:
s_barrier
s_cmp_lg_u32 s91, 2
s_cbranch_scc1 L_nld_24340
s_cmp_lg_u32 s3, 0
s_cbranch_scc1 L_nld_24340
s_bfe_u32 s94, s73, 0x80008
v_cmp_le_u32 vcc, s94, v31
v_mov_b32 v29, 131072
s_nop 0
v_cndmask_b32 v30, 0, 3, vcc
ds_write_b32 v29, v30
L_nld_24340:
v_mfma_f32_16x16x32_bf16 v[36:39], a[4:7], a[32:35], v[36:39]
v_mfma_f32_16x16x32_bf16 v[96:99], a[8:11], a[32:35], v[96:99]
ds_read_b64_tr_b16 a[96:97], v11 offset:32768
v_mfma_f32_16x16x32_bf16 v[100:103], a[12:15], a[32:35], v[100:103]
ds_read_b64_tr_b16 a[98:99], v11 offset:34816
v_mfma_f32_16x16x32_bf16 v[40:43], a[0:3], a[36:39], v[40:43]
ds_read_b128 a[64:67], v27 offset:32768
v_mfma_f32_16x16x32_bf16 v[44:47], a[4:7], a[36:39], v[44:47]
ds_read_b128 a[68:71], v27 offset:33024
v_mfma_f32_16x16x32_bf16 v[104:107], a[8:11], a[36:39], v[104:107]
ds_read_b128 a[72:75], v27 offset:34816
v_mfma_f32_16x16x32_bf16 v[108:111], a[12:15], a[36:39], v[108:111]
ds_read_b128 a[76:79], v27 offset:35072
v_mfma_f32_16x16x32_bf16 v[48:51], a[0:3], a[40:43], v[48:51]
ds_read_b64_tr_b16 a[100:101], v13 offset:32768
v_mfma_f32_16x16x32_bf16 v[52:55], a[4:7], a[40:43], v[52:55]
ds_read_b64_tr_b16 a[102:103], v13 offset:34816
v_mfma_f32_16x16x32_bf16 v[112:115], a[8:11], a[40:43], v[112:115]
ds_read_b64_tr_b16 a[104:105], v15 offset:32768
v_mfma_f32_16x16x32_bf16 v[116:119], a[12:15], a[40:43], v[116:119]
ds_read_b64_tr_b16 a[106:107], v15 offset:34816
v_mfma_f32_16x16x32_bf16 v[56:59], a[0:3], a[44:47], v[56:59]
ds_read_b64_tr_b16 a[108:109], v17 offset:32768
v_mfma_f32_16x16x32_bf16 v[60:63], a[4:7], a[44:47], v[60:63]
ds_read_b64_tr_b16 a[110:111], v17 offset:34816
v_mfma_f32_16x16x32_bf16 v[120:123], a[8:11], a[44:47], v[120:123]
ds_read_b64_tr_b16 a[112:113], v11 offset:40960
v_mfma_f32_16x16x32_bf16 v[124:127], a[12:15], a[44:47], v[124:127]
ds_read_b64_tr_b16 a[114:115], v11 offset:43008
v_mfma_f32_16x16x32_bf16 v[64:67], a[0:3], a[48:51], v[64:67]
ds_read_b64_tr_b16 a[116:117], v13 offset:40960
s_cmp_lg_u32 s91, 1
s_cbranch_scc1 L_npf_24341
s_cmp_ge_u32 s90, 4
s_cbranch_scc1 L_pfh_24342
s_add_u32 m0, s87, 65536
s_nop 0
buffer_load_dwordx4 v20, s[4:7], s84 offen sc1 lds
buffer_load_dwordx4 v20, s[4:7], s84 offen offset:1024 sc1 lds
buffer_load_dwordx4 v21, s[4:7], s84 offen offset:2048 sc1 lds
buffer_load_dwordx4 v21, s[4:7], s84 offen offset:3072 sc1 lds
s_add_u32 s84, s84, 2048
s_add_u32 m0, s54, 81920
s_nop 0
buffer_load_dwordx4 v22, s[80:83], s85 offen lds
buffer_load_dwordx4 v23, s[80:83], s85 offen offset:1024 lds
buffer_load_dwordx4 v24, s[80:83], s85 offen offset:2048 lds
buffer_load_dwordx4 v25, s[80:83], s85 offen offset:3072 lds
s_add_u32 s85, s85, s86
s_branch L_npf_24341
L_pfh_24342:
s_add_u32 m0, s87, 65536
s_nop 0
buffer_load_dwordx4 v20, s[4:7], s84 offen sc1 lds
buffer_load_dwordx4 v20, s[4:7], s84 offen offset:1024 sc1 lds
s_add_u32 s84, s84, 2048
s_add_u32 m0, s54, 81920
s_nop 0
buffer_load_dwordx4 v22, s[80:83], s85 offen lds
buffer_load_dwordx4 v23, s[80:83], s85 offen offset:1024 lds
buffer_load_dwordx4 v24, s[80:83], s85 offen offset:2048 lds
buffer_load_dwordx4 v25, s[80:83], s85 offen offset:3072 lds
s_add_u32 s85, s85, s86
L_npf_24341:
v_mfma_f32_16x16x32_bf16 v[68:71], a[4:7], a[48:51], v[68:71]
ds_read_b64_tr_b16 a[118:119], v13 offset:43008
v_mfma_f32_16x16x32_bf16 v[128:131], a[8:11], a[48:51], v[128:131]
ds_read_b64_tr_b16 a[120:121], v15 offset:40960
v_mfma_f32_16x16x32_bf16 v[132:135], a[12:15], a[48:51], v[132:135]
ds_read_b64_tr_b16 a[122:123], v15 offset:43008
v_mfma_f32_16x16x32_bf16 v[72:75], a[0:3], a[52:55], v[72:75]
ds_read_b64_tr_b16 a[124:125], v17 offset:40960
v_mfma_f32_16x16x32_bf16 v[76:79], a[4:7], a[52:55], v[76:79]
ds_read_b64_tr_b16 a[126:127], v17 offset:43008
v_mfma_f32_16x16x32_bf16 v[136:139], a[8:11], a[52:55], v[136:139]
v_mfma_f32_16x16x32_bf16 v[140:143], a[12:15], a[52:55], v[140:143]
v_mfma_f32_16x16x32_bf16 v[80:83], a[0:3], a[56:59], v[80:83]
v_mfma_f32_16x16x32_bf16 v[84:87], a[4:7], a[56:59], v[84:87]
v_mfma_f32_16x16x32_bf16 v[144:147], a[8:11], a[56:59], v[144:147]
v_mfma_f32_16x16x32_bf16 v[148:151], a[12:15], a[56:59], v[148:151]
v_mfma_f32_16x16x32_bf16 v[88:91], a[0:3], a[60:63], v[88:91]
v_mfma_f32_16x16x32_bf16 v[92:95], a[4:7], a[60:63], v[92:95]
v_mfma_f32_16x16x32_bf16 v[152:155], a[8:11], a[60:63], v[152:155]
v_mfma_f32_16x16x32_bf16 v[156:159], a[12:15], a[60:63], v[156:159]
s_waitcnt lgkmcnt(0)
v_mfma_f32_16x16x32_bf16 v[32:35], a[64:67], a[96:99], v[32:35]
s_barrier
s_cmp_lg_u32 s91, 2
s_cbranch_scc1 L_nlp_24343
v_mov_b32 v29, 131072
ds_read_b32 v30, v29
s_waitcnt lgkmcnt(0)
v_readfirstlane_b32 s91, v30
s_cmp_eq_u32 s91, 0
s_cbranch_scc1 L_nlp_24343
s_cmp_ge_u32 s90, 4
s_cbranch_scc1 L_lph_24344
s_add_u32 m0, s87, 0
s_nop 0
buffer_load_dwordx4 v20, s[4:7], s84 offen sc1 lds
buffer_load_dwordx4 v20, s[4:7], s84 offen offset:1024 sc1 lds
buffer_load_dwordx4 v21, s[4:7], s84 offen offset:2048 sc1 lds
buffer_load_dwordx4 v21, s[4:7], s84 offen offset:3072 sc1 lds
s_add_u32 s84, s84, 2048
s_add_u32 m0, s54, 16384
s_nop 0
buffer_load_dwordx4 v22, s[80:83], s85 offen lds
buffer_load_dwordx4 v23, s[80:83], s85 offen offset:1024 lds
buffer_load_dwordx4 v24, s[80:83], s85 offen offset:2048 lds
buffer_load_dwordx4 v25, s[80:83], s85 offen offset:3072 lds
s_add_u32 s85, s85, s86
s_add_u32 m0, s87, 32768
s_nop 0
buffer_load_dwordx4 v20, s[4:7], s84 offen sc1 lds
buffer_load_dwordx4 v20, s[4:7], s84 offen offset:1024 sc1 lds
buffer_load_dwordx4 v21, s[4:7], s84 offen offset:2048 sc1 lds
buffer_load_dwordx4 v21, s[4:7], s84 offen offset:3072 sc1 lds
s_add_u32 s84, s84, 2048
s_add_u32 m0, s54, 49152
s_nop 0
buffer_load_dwordx4 v22, s[80:83], s85 offen lds
buffer_load_dwordx4 v23, s[80:83], s85 offen offset:1024 lds
buffer_load_dwordx4 v24, s[80:83], s85 offen offset:2048 lds
buffer_load_dwordx4 v25, s[80:83], s85 offen offset:3072 lds
s_add_u32 s85, s85, s86
s_add_u32 m0, s87, 65536
s_nop 0
buffer_load_dwordx4 v20, s[4:7], s84 offen sc1 lds
buffer_load_dwordx4 v20, s[4:7], s84 offen offset:1024 sc1 lds
buffer_load_dwordx4 v21, s[4:7], s84 offen offset:2048 sc1 lds
buffer_load_dwordx4 v21, s[4:7], s84 offen offset:3072 sc1 lds
s_add_u32 s84, s84, 2048
s_add_u32 m0, s54, 81920
s_nop 0
buffer_load_dwordx4 v22, s[80:83], s85 offen lds
buffer_load_dwordx4 v23, s[80:83], s85 offen offset:1024 lds
buffer_load_dwordx4 v24, s[80:83], s85 offen offset:2048 lds
buffer_load_dwordx4 v25, s[80:83], s85 offen offset:3072 lds
s_add_u32 s85, s85, s86
s_add_u32 m0, s87, 98304
s_nop 0
buffer_load_dwordx4 v20, s[4:7], s84 offen sc1 lds
buffer_load_dwordx4 v20, s[4:7], s84 offen offset:1024 sc1 lds
buffer_load_dwordx4 v21, s[4:7], s84 offen offset:2048 sc1 lds
buffer_load_dwordx4 v21, s[4:7], s84 offen offset:3072 sc1 lds
s_add_u32 s84, s84, 2048
s_add_u32 m0, s54, 114688
s_nop 0
buffer_load_dwordx4 v22, s[80:83], s85 offen lds
buffer_load_dwordx4 v23, s[80:83], s85 offen offset:1024 lds
buffer_load_dwordx4 v24, s[80:83], s85 offen offset:2048 lds
buffer_load_dwordx4 v25, s[80:83], s85 offen offset:3072 lds
s_add_u32 s85, s85, s86
s_branch L_nlp_24343
L_lph_24344:
s_add_u32 m0, s87, 0
s_nop 0
buffer_load_dwordx4 v20, s[4:7], s84 offen sc1 lds
buffer_load_dwordx4 v20, s[4:7], s84 offen offset:1024 sc1 lds
s_add_u32 s84, s84, 2048
s_add_u32 m0, s54, 16384
s_nop 0
buffer_load_dwordx4 v22, s[80:83], s85 offen lds
buffer_load_dwordx4 v23, s[80:83], s85 offen offset:1024 lds
buffer_load_dwordx4 v24, s[80:83], s85 offen offset:2048 lds
buffer_load_dwordx4 v25, s[80:83], s85 offen offset:3072 lds
s_add_u32 s85, s85, s86
s_add_u32 m0, s87, 32768
s_nop 0
buffer_load_dwordx4 v20, s[4:7], s84 offen sc1 lds
buffer_load_dwordx4 v20, s[4:7], s84 offen offset:1024 sc1 lds
s_add_u32 s84, s84, 2048
s_add_u32 m0, s54, 49152
s_nop 0
buffer_load_dwordx4 v22, s[80:83], s85 offen lds
buffer_load_dwordx4 v23, s[80:83], s85 offen offset:1024 lds
buffer_load_dwordx4 v24, s[80:83], s85 offen offset:2048 lds
buffer_load_dwordx4 v25, s[80:83], s85 offen offset:3072 lds
s_add_u32 s85, s85, s86
s_add_u32 m0, s87, 65536
s_nop 0
buffer_load_dwordx4 v20, s[4:7], s84 offen sc1 lds
buffer_load_dwordx4 v20, s[4:7], s84 offen offset:1024 sc1 lds
s_add_u32 s84, s84, 2048
s_add_u32 m0, s54, 81920
s_nop 0
buffer_load_dwordx4 v22, s[80:83], s85 offen lds
buffer_load_dwordx4 v23, s[80:83], s85 offen offset:1024 lds
buffer_load_dwordx4 v24, s[80:83], s85 offen offset:2048 lds
buffer_load_dwordx4 v25, s[80:83], s85 offen offset:3072 lds
s_add_u32 s85, s85, s86
s_add_u32 m0, s87, 98304
s_nop 0
buffer_load_dwordx4 v20, s[4:7], s84 offen sc1 lds
buffer_load_dwordx4 v20, s[4:7], s84 offen offset:1024 sc1 lds
s_add_u32 s84, s84, 2048
s_add_u32 m0, s54, 114688
s_nop 0
buffer_load_dwordx4 v22, s[80:83], s85 offen lds
buffer_load_dwordx4 v23, s[80:83], s85 offen offset:1024 lds
buffer_load_dwordx4 v24, s[80:83], s85 offen offset:2048 lds
buffer_load_dwordx4 v25, s[80:83], s85 offen offset:3072 lds
s_add_u32 s85, s85, s86
L_nlp_24343:
v_mfma_f32_16x16x32_bf16 v[36:39], a[68:71], a[96:99], v[36:39]
v_mfma_f32_16x16x32_bf16 v[96:99], a[72:75], a[96:99], v[96:99]
v_mfma_f32_16x16x32_bf16 v[100:103], a[76:79], a[96:99], v[100:103]
v_mfma_f32_16x16x32_bf16 v[40:43], a[64:67], a[100:103], v[40:43]
v_mfma_f32_16x16x32_bf16 v[44:47], a[68:71], a[100:103], v[44:47]
v_mfma_f32_16x16x32_bf16 v[104:107], a[72:75], a[100:103], v[104:107]
v_mfma_f32_16x16x32_bf16 v[108:111], a[76:79], a[100:103], v[108:111]
v_mfma_f32_16x16x32_bf16 v[48:51], a[64:67], a[104:107], v[48:51]
v_mfma_f32_16x16x32_bf16 v[52:55], a[68:71], a[104:107], v[52:55]
v_mfma_f32_16x16x32_bf16 v[112:115], a[72:75], a[104:107], v[112:115]
v_mfma_f32_16x16x32_bf16 v[116:119], a[76:79], a[104:107], v[116:119]
v_mfma_f32_16x16x32_bf16 v[56:59], a[64:67], a[108:111], v[56:59]
v_mfma_f32_16x16x32_bf16 v[60:63], a[68:71], a[108:111], v[60:63]
v_mfma_f32_16x16x32_bf16 v[120:123], a[72:75], a[108:111], v[120:123]
v_mfma_f32_16x16x32_bf16 v[124:127], a[76:79], a[108:111], v[124:127]
v_mfma_f32_16x16x32_bf16 v[64:67], a[64:67], a[112:115], v[64:67]
s_cmp_lg_u32 s91, 1
s_cbranch_scc1 L_npf_24345
s_cmp_ge_u32 s90, 4
s_cbranch_scc1 L_pfh_24346
s_add_u32 m0, s87, 98304
s_nop 0
buffer_load_dwordx4 v20, s[4:7], s84 offen sc1 lds
buffer_load_dwordx4 v20, s[4:7], s84 offen offset:1024 sc1 lds
buffer_load_dwordx4 v21, s[4:7], s84 offen offset:2048 sc1 lds
buffer_load_dwordx4 v21, s[4:7], s84 offen offset:3072 sc1 lds
s_add_u32 s84, s84, 2048
s_add_u32 m0, s54, 114688
s_nop 0
buffer_load_dwordx4 v22, s[80:83], s85 offen lds
buffer_load_dwordx4 v23, s[80:83], s85 offen offset:1024 lds
buffer_load_dwordx4 v24, s[80:83], s85 offen offset:2048 lds
buffer_load_dwordx4 v25, s[80:83], s85 offen offset:3072 lds
s_add_u32 s85, s85, s86
s_branch L_npf_24345
L_pfh_24346:
s_add_u32 m0, s87, 98304
s_nop 0
buffer_load_dwordx4 v20, s[4:7], s84 offen sc1 lds
buffer_load_dwordx4 v20, s[4:7], s84 offen offset:1024 sc1 lds
s_add_u32 s84, s84, 2048
s_add_u32 m0, s54, 114688
s_nop 0
buffer_load_dwordx4 v22, s[80:83], s85 offen lds
buffer_load_dwordx4 v23, s[80:83], s85 offen offset:1024 lds
buffer_load_dwordx4 v24, s[80:83], s85 offen offset:2048 lds
buffer_load_dwordx4 v25, s[80:83], s85 offen offset:3072 lds
s_add_u32 s85, s85, s86
L_npf_24345:
v_mfma_f32_16x16x32_bf16 v[68:71], a[68:71], a[112:115], v[68:71]
v_mfma_f32_16x16x32_bf16 v[128:131], a[72:75], a[112:115], v[128:131]
v_mfma_f32_16x16x32_bf16 v[132:135], a[76:79], a[112:115], v[132:135]
v_mfma_f32_16x16x32_bf16 v[72:75], a[64:67], a[116:119], v[72:75]
v_mfma_f32_16x16x32_bf16 v[76:79], a[68:71], a[116:119], v[76:79]
v_mfma_f32_16x16x32_bf16 v[136:139], a[72:75], a[116:119], v[136:139]
v_mfma_f32_16x16x32_bf16 v[140:143], a[76:79], a[116:119], v[140:143]
v_mfma_f32_16x16x32_bf16 v[80:83], a[64:67], a[120:123], v[80:83]
v_mfma_f32_16x16x32_bf16 v[84:87], a[68:71], a[120:123], v[84:87]
v_mfma_f32_16x16x32_bf16 v[144:147], a[72:75], a[120:123], v[144:147]
v_mfma_f32_16x16x32_bf16 v[148:151], a[76:79], a[120:123], v[148:151]
v_mfma_f32_16x16x32_bf16 v[88:91], a[64:67], a[124:127], v[88:91]
v_mfma_f32_16x16x32_bf16 v[92:95], a[68:71], a[124:127], v[92:95]
v_mfma_f32_16x16x32_bf16 v[152:155], a[72:75], a[124:127], v[152:155]
v_mfma_f32_16x16x32_bf16 v[156:159], a[76:79], a[124:127], v[156:159]
s_nop 7
s_lshr_b32 s56, s3, 1
s_lshl_b32 s56, s56, 1
s_mul_i32 s56, s56, s53
s_add_u32 s52, s52, s56
s_and_b32 s56, s3, 1
s_lshl_b32 s56, s56, 12
s_add_u32 s52, s52, s56
s_add_u32 s57, s52, 0
v_cvt_pk_bf16_f32 v32, v32, v33
v_cvt_pk_bf16_f32 v33, v34, v35
v_cvt_pk_bf16_f32 v34, v36, v37
v_cvt_pk_bf16_f32 v35, v38, v39
v_cvt_pk_bf16_f32 v40, v40, v41
v_cvt_pk_bf16_f32 v41, v42, v43
v_cvt_pk_bf16_f32 v42, v44, v45
v_cvt_pk_bf16_f32 v43, v46, v47
s_nop 0
v_permlane32_swap_b32 v32, v34
v_permlane32_swap_b32 v33, v35
v_permlane32_swap_b32 v40, v42
v_permlane32_swap_b32 v41, v43
buffer_store_dwordx4 v[32:35], v19, s[4:7], s57 offen offset:0 sc1
buffer_store_dwordx4 v[40:43], v19, s[4:7], s57 offen offset:128 sc1
v_cvt_pk_bf16_f32 v48, v48, v49
v_cvt_pk_bf16_f32 v49, v50, v51
v_cvt_pk_bf16_f32 v50, v52, v53
v_cvt_pk_bf16_f32 v51, v54, v55
v_cvt_pk_bf16_f32 v56, v56, v57
v_cvt_pk_bf16_f32 v57, v58, v59
v_cvt_pk_bf16_f32 v58, v60, v61
v_cvt_pk_bf16_f32 v59, v62, v63
s_nop 0
v_permlane32_swap_b32 v48, v50
v_permlane32_swap_b32 v49, v51
v_permlane32_swap_b32 v56, v58
v_permlane32_swap_b32 v57, v59
buffer_store_dwordx4 v[48:51], v19, s[4:7], s57 offen offset:2048 sc1
buffer_store_dwordx4 v[56:59], v19, s[4:7], s57 offen offset:2176 sc1
s_add_u32 s57, s52, 8192
v_cvt_pk_bf16_f32 v64, v64, v65
v_cvt_pk_bf16_f32 v65, v66, v67
v_cvt_pk_bf16_f32 v66, v68, v69
v_cvt_pk_bf16_f32 v67, v70, v71
v_cvt_pk_bf16_f32 v72, v72, v73
v_cvt_pk_bf16_f32 v73, v74, v75
v_cvt_pk_bf16_f32 v74, v76, v77
v_cvt_pk_bf16_f32 v75, v78, v79
s_nop 0
v_permlane32_swap_b32 v64, v66
v_permlane32_swap_b32 v65, v67
v_permlane32_swap_b32 v72, v74
v_permlane32_swap_b32 v73, v75
buffer_store_dwordx4 v[64:67], v19, s[4:7], s57 offen offset:0 sc1
buffer_store_dwordx4 v[72:75], v19, s[4:7], s57 offen offset:128 sc1
v_cvt_pk_bf16_f32 v80, v80, v81
v_cvt_pk_bf16_f32 v81, v82, v83
v_cvt_pk_bf16_f32 v82, v84, v85
v_cvt_pk_bf16_f32 v83, v86, v87
v_cvt_pk_bf16_f32 v88, v88, v89
v_cvt_pk_bf16_f32 v89, v90, v91
v_cvt_pk_bf16_f32 v90, v92, v93
v_cvt_pk_bf16_f32 v91, v94, v95
s_nop 0
v_permlane32_swap_b32 v80, v82
v_permlane32_swap_b32 v81, v83
v_permlane32_swap_b32 v88, v90
v_permlane32_swap_b32 v89, v91
buffer_store_dwordx4 v[80:83], v19, s[4:7], s57 offen offset:2048 sc1
buffer_store_dwordx4 v[88:91], v19, s[4:7], s57 offen offset:2176 sc1
s_add_u32 s52, s52, s53
s_add_u32 s57, s52, 0
v_cvt_pk_bf16_f32 v96, v96, v97
v_cvt_pk_bf16_f32 v97, v98, v99
v_cvt_pk_bf16_f32 v98, v100, v101
v_cvt_pk_bf16_f32 v99, v102, v103
v_cvt_pk_bf16_f32 v104, v104, v105
v_cvt_pk_bf16_f32 v105, v106, v107
v_cvt_pk_bf16_f32 v106, v108, v109
v_cvt_pk_bf16_f32 v107, v110, v111
s_nop 0
v_permlane32_swap_b32 v96, v98
v_permlane32_swap_b32 v97, v99
v_permlane32_swap_b32 v104, v106
v_permlane32_swap_b32 v105, v107
buffer_store_dwordx4 v[96:99], v19, s[4:7], s57 offen offset:0 sc1
buffer_store_dwordx4 v[104:107], v19, s[4:7], s57 offen offset:128 sc1
v_cvt_pk_bf16_f32 v112, v112, v113
v_cvt_pk_bf16_f32 v113, v114, v115
v_cvt_pk_bf16_f32 v114, v116, v117
v_cvt_pk_bf16_f32 v115, v118, v119
v_cvt_pk_bf16_f32 v120, v120, v121
v_cvt_pk_bf16_f32 v121, v122, v123
v_cvt_pk_bf16_f32 v122, v124, v125
v_cvt_pk_bf16_f32 v123, v126, v127
s_nop 0
v_permlane32_swap_b32 v112, v114
v_permlane32_swap_b32 v113, v115
v_permlane32_swap_b32 v120, v122
v_permlane32_swap_b32 v121, v123
buffer_store_dwordx4 v[112:115], v19, s[4:7], s57 offen offset:2048 sc1
buffer_store_dwordx4 v[120:123], v19, s[4:7], s57 offen offset:2176 sc1
s_add_u32 s57, s52, 8192
v_cvt_pk_bf16_f32 v128, v128, v129
v_cvt_pk_bf16_f32 v129, v130, v131
v_cvt_pk_bf16_f32 v130, v132, v133
v_cvt_pk_bf16_f32 v131, v134, v135
v_cvt_pk_bf16_f32 v136, v136, v137
v_cvt_pk_bf16_f32 v137, v138, v139
v_cvt_pk_bf16_f32 v138, v140, v141
v_cvt_pk_bf16_f32 v139, v142, v143
s_nop 0
v_permlane32_swap_b32 v128, v130
v_permlane32_swap_b32 v129, v131
v_permlane32_swap_b32 v136, v138
v_permlane32_swap_b32 v137, v139
buffer_store_dwordx4 v[128:131], v19, s[4:7], s57 offen offset:0 sc1
buffer_store_dwordx4 v[136:139], v19, s[4:7], s57 offen offset:128 sc1
v_cvt_pk_bf16_f32 v144, v144, v145
v_cvt_pk_bf16_f32 v145, v146, v147
v_cvt_pk_bf16_f32 v146, v148, v149
v_cvt_pk_bf16_f32 v147, v150, v151
v_cvt_pk_bf16_f32 v152, v152, v153
v_cvt_pk_bf16_f32 v153, v154, v155
v_cvt_pk_bf16_f32 v154, v156, v157
v_cvt_pk_bf16_f32 v155, v158, v159
s_nop 0
v_permlane32_swap_b32 v144, v146
v_permlane32_swap_b32 v145, v147
v_permlane32_swap_b32 v152, v154
v_permlane32_swap_b32 v153, v155
buffer_store_dwordx4 v[144:147], v19, s[4:7], s57 offen offset:2048 sc1
buffer_store_dwordx4 v[152:155], v19, s[4:7], s57 offen offset:2176 sc1
s_add_u32 s52, s52, s53
s_branch L_gdone
L_gdone:
s_mov_b32 s92, 255
s_bfe_u32 s96, s71, 0x20002
s_and_b32 s48, s71, 2
s_cmp_eq_u32 s91, 0
s_cbranch_scc1 L_sig
s_cmp_lg_u32 s48, 0
s_cbranch_scc1 L_sig
s_mov_b32 s92, s70
s_branch L_next
L_at:
s_lshl_b32 s48, s61, 2
s_add_u32 s48, s48, s3
s_lshl_b32 s49, s60, 18
s_lshl_b32 s50, s48, 13
s_add_u32 s49, s49, s50
s_mov_b32 s55, s49
s_lshl_b32 s50, s60, 16
s_lshl_b32 s51, s48, 11
s_add_u32 s50, s50, s51
v_bfe_u32 v3, v0, 5, 1
v_and_b32 v4, 7, v0
v_lshlrev_b32 v4, 4, v4
v_lshl_add_u32 v4, v3, 7, v4
v_lshrrev_b32 v5, 1, v1
v_mov_b32 v34, 0
v_mov_b32 v35, 0
v_mov_b32 v38, 0
v_mov_b32 v39, 0
v_mov_b32 v42, 0
v_mov_b32 v43, 0
v_mov_b32 v46, 0
v_mov_b32 v47, 0
v_mov_b32 v50, 0
v_mov_b32 v51, 0
v_mov_b32 v54, 0
v_mov_b32 v55, 0
v_mov_b32 v58, 0
v_mov_b32 v59, 0
v_mov_b32 v62, 0
v_mov_b32 v63, 0
v_and_b32 v6, 31, v0
v_lshlrev_b32 v7, 2, v3
v_sub_u32 v6, v6, v7
v_mov_b32 v7, 0xf149f2ca
v_cmp_gt_i32 vcc, 0, v6
s_nop 1
v_cndmask_b32 v96, 0, v7, vcc
v_cmp_gt_i32 vcc, 1, v6
s_nop 1
v_cndmask_b32 v97, 0, v7, vcc
v_cmp_gt_i32 vcc, 2, v6
s_nop 1
v_cndmask_b32 v98, 0, v7, vcc
v_cmp_gt_i32 vcc, 3, v6
s_nop 1
v_cndmask_b32 v99, 0, v7, vcc
v_cmp_gt_i32 vcc, 8, v6
s_nop 1
v_cndmask_b32 v100, 0, v7, vcc
v_cmp_gt_i32 vcc, 9, v6
s_nop 1
v_cndmask_b32 v101, 0, v7, vcc
v_cmp_gt_i32 vcc, 10, v6
s_nop 1
v_cndmask_b32 v102, 0, v7, vcc
v_cmp_gt_i32 vcc, 11, v6
s_nop 1
v_cndmask_b32 v103, 0, v7, vcc
v_cmp_gt_i32 vcc, 16, v6
s_nop 1
v_cndmask_b32 v104, 0, v7, vcc
v_cmp_gt_i32 vcc, 17, v6
s_nop 1
v_cndmask_b32 v105, 0, v7, vcc
v_cmp_gt_i32 vcc, 18, v6
s_nop 1
v_cndmask_b32 v106, 0, v7, vcc
v_cmp_gt_i32 vcc, 19, v6
s_nop 1
v_cndmask_b32 v107, 0, v7, vcc
v_cmp_gt_i32 vcc, 24, v6
s_nop 1
v_cndmask_b32 v108, 0, v7, vcc
v_cmp_gt_i32 vcc, 25, v6
s_nop 1
v_cndmask_b32 v109, 0, v7, vcc
v_cmp_gt_i32 vcc, 26, v6
s_nop 1
v_cndmask_b32 v110, 0, v7, vcc
v_cmp_gt_i32 vcc, 27, v6
s_nop 1
v_cndmask_b32 v111, 0, v7, vcc
v_mov_b32 v122, 0
v_mov_b32 v123, 0
s_mov_b32 s56, 0x3e0293ee
s_mov_b32 s57, s56
s_add_u32 s52, s49, 20971520
s_add_u32 s53, s49, 20975616
buffer_load_dwordx4 a[32:35], v1, s[4:7], s52 offen offset:0 sc1
buffer_load_dwordx4 a[36:39], v1, s[4:7], s52 offen offset:1024 sc1
buffer_load_dwordx4 a[40:43], v1, s[4:7], s52 offen offset:2048 sc1
buffer_load_dwordx4 a[44:47], v1, s[4:7], s52 offen offset:3072 sc1
buffer_load_dwordx4 a[48:51], v1, s[4:7], s53 offen offset:0 sc1
buffer_load_dwordx4 a[52:55], v1, s[4:7], s53 offen offset:1024 sc1
buffer_load_dwordx4 a[56:59], v1, s[4:7], s53 offen offset:2048 sc1
buffer_load_dwordx4 a[60:63], v1, s[4:7], s53 offen offset:3072 sc1
s_add_u32 s52, s49, 4194304
s_add_u32 s53, s49, 4198400
buffer_load_dwordx4 a[0:3], v1, s[4:7], s52 offen offset:0 sc1
buffer_load_dwordx4 a[4:7], v1, s[4:7], s52 offen offset:1024 sc1
buffer_load_dwordx4 a[8:11], v1, s[4:7], s52 offen offset:2048 sc1
buffer_load_dwordx4 a[12:15], v1, s[4:7], s52 offen offset:3072 sc1
buffer_load_dwordx4 a[16:19], v1, s[4:7], s53 offen offset:0 sc1
buffer_load_dwordx4 a[20:23], v1, s[4:7], s53 offen offset:1024 sc1
buffer_load_dwordx4 a[24:27], v1, s[4:7], s53 offen offset:2048 sc1
buffer_load_dwordx4 a[28:31], v1, s[4:7], s53 offen offset:3072 sc1
s_add_u32 s52, s49, 37748736
s_add_u32 s53, s49, 37752832
buffer_load_dwordx4 a[64:67], v1, s[4:7], s52 offen offset:0 sc1
buffer_load_dwordx4 a[68:71], v1, s[4:7], s52 offen offset:1024 sc1
buffer_load_dwordx4 a[72:75], v1, s[4:7], s52 offen offset:2048 sc1
buffer_load_dwordx4 a[76:79], v1, s[4:7], s52 offen offset:3072 sc1
buffer_load_dwordx4 a[80:83], v1, s[4:7], s53 offen offset:0 sc1
buffer_load_dwordx4 a[84:87], v1, s[4:7], s53 offen offset:1024 sc1
buffer_load_dwordx4 a[88:91], v1, s[4:7], s53 offen offset:2048 sc1
buffer_load_dwordx4 a[92:95], v1, s[4:7], s53 offen offset:3072 sc1
s_and_b32 s95, s71, 128
s_cbranch_scc0 L_nl_24347
s_bfe_u32 s97, s69, 0x80010
s_lshr_b32 s98, s69, 24
s_lshl_b32 s94, s97, 8
s_add_u32 s94, s94, 98566144
v_mov_b32 v250, 0
L_pc_24348:
buffer_load_dword v251, v250, s[4:7], s94 offen sc1
s_waitcnt vmcnt(0)
v_readfirstlane_b32 s95, v251
s_cmp_ge_u32 s95, s98
s_cbranch_scc1 L_pcok_24349
s_sleep 1
s_sub_u32 s78, s78, 1
s_cmp_lg_u32 s78, 0
s_cbranch_scc1 L_pc_24348
s_branch L_fail
L_pcok_24349:
L_nl_24347:
s_add_u32 s52, s50, 85983232
s_mov_b32 exec_lo, 0xff
s_mov_b32 exec_hi, 0xff
buffer_load_dwordx4 a[96:99], v4, s[4:7], s52 offen offset:0 sc1
buffer_load_dwordx4 a[100:103], v4, s[4:7], s52 offen offset:256 sc1
buffer_load_dwordx4 a[104:107], v4, s[4:7], s52 offen offset:512 sc1
buffer_load_dwordx4 a[108:111], v4, s[4:7], s52 offen offset:768 sc1
buffer_load_dwordx4 a[112:115], v4, s[4:7], s52 offen offset:1024 sc1
buffer_load_dwordx4 a[116:119], v4, s[4:7], s52 offen offset:1280 sc1
buffer_load_dwordx4 a[120:123], v4, s[4:7], s52 offen offset:1536 sc1
buffer_load_dwordx4 a[124:127], v4, s[4:7], s52 offen offset:1792 sc1
s_mov_b64 exec, -1
s_add_u32 s52, s50, 90177536
buffer_load_dwordx2 v[32:33], v5, s[4:7], s52 offen offset:0 sc1
buffer_load_dwordx2 v[36:37], v5, s[4:7], s52 offen offset:512 sc1
buffer_load_dwordx2 v[40:41], v5, s[4:7], s52 offen offset:1024 sc1
buffer_load_dwordx2 v[44:45], v5, s[4:7], s52 offen offset:1536 sc1
s_add_u32 s49, s49, 262144
s_add_u32 s50, s50, 65536
L_al_24350:
s_sub_u32 s62, s62, 1
s_cmp_eq_u32 s62, 0
s_cbranch_scc1 L_an_24352
s_add_u32 s52, s49, 20971520
s_add_u32 s53, s49, 20975616
buffer_load_dwordx4 a[160:163], v1, s[4:7], s52 offen offset:0 sc1
buffer_load_dwordx4 a[164:167], v1, s[4:7], s52 offen offset:1024 sc1
buffer_load_dwordx4 a[168:171], v1, s[4:7], s52 offen offset:2048 sc1
buffer_load_dwordx4 a[172:175], v1, s[4:7], s52 offen offset:3072 sc1
buffer_load_dwordx4 a[176:179], v1, s[4:7], s53 offen offset:0 sc1
buffer_load_dwordx4 a[180:183], v1, s[4:7], s53 offen offset:1024 sc1
buffer_load_dwordx4 a[184:187], v1, s[4:7], s53 offen offset:2048 sc1
buffer_load_dwordx4 a[188:191], v1, s[4:7], s53 offen offset:3072 sc1
s_add_u32 s52, s49, 4194304
s_add_u32 s53, s49, 4198400
buffer_load_dwordx4 a[128:131], v1, s[4:7], s52 offen offset:0 sc1
buffer_load_dwordx4 a[132:135], v1, s[4:7], s52 offen offset:1024 sc1
buffer_load_dwordx4 a[136:139], v1, s[4:7], s52 offen offset:2048 sc1
buffer_load_dwordx4 a[140:143], v1, s[4:7], s52 offen offset:3072 sc1
buffer_load_dwordx4 a[144:147], v1, s[4:7], s53 offen offset:0 sc1
buffer_load_dwordx4 a[148:151], v1, s[4:7], s53 offen offset:1024 sc1
buffer_load_dwordx4 a[152:155], v1, s[4:7], s53 offen offset:2048 sc1
buffer_load_dwordx4 a[156:159], v1, s[4:7], s53 offen offset:3072 sc1
s_add_u32 s52, s49, 37748736
s_add_u32 s53, s49, 37752832
buffer_load_dwordx4 a[192:195], v1, s[4:7], s52 offen offset:0 sc1
buffer_load_dwordx4 a[196:199], v1, s[4:7], s52 offen offset:1024 sc1
buffer_load_dwordx4 a[200:203], v1, s[4:7], s52 offen offset:2048 sc1
buffer_load_dwordx4 a[204:207], v1, s[4:7], s52 offen offset:3072 sc1
buffer_load_dwordx4 a[208:211], v1, s[4:7], s53 offen offset:0 sc1
buffer_load_dwordx4 a[212:215], v1, s[4:7], s53 offen offset:1024 sc1
buffer_load_dwordx4 a[216:219], v1, s[4:7], s53 offen offset:2048 sc1
buffer_load_dwordx4 a[220:223], v1, s[4:7], s53 offen offset:3072 sc1
s_add_u32 s52, s50, 85983232
s_mov_b32 exec_lo, 0xff
s_mov_b32 exec_hi, 0xff
buffer_load_dwordx4 a[224:227], v4, s[4:7], s52 offen offset:0 sc1
buffer_load_dwordx4 a[228:231], v4, s[4:7], s52 offen offset:256 sc1
buffer_load_dwordx4 a[232:235], v4, s[4:7], s52 offen offset:512 sc1
buffer_load_dwordx4 a[236:239], v4, s[4:7], s52 offen offset:768 sc1
buffer_load_dwordx4 a[240:243], v4, s[4:7], s52 offen offset:1024 sc1
buffer_load_dwordx4 a[244:247], v4, s[4:7], s52 offen offset:1280 sc1
buffer_load_dwordx4 a[248:251], v4, s[4:7], s52 offen offset:1536 sc1
buffer_load_dwordx4 a[252:255], v4, s[4:7], s52 offen offset:1792 sc1
s_mov_b64 exec, -1
s_add_u32 s52, s50, 90177536
buffer_load_dwordx2 v[48:49], v5, s[4:7], s52 offen offset:0 sc1
buffer_load_dwordx2 v[52:53], v5, s[4:7], s52 offen offset:512 sc1
buffer_load_dwordx2 v[56:57], v5, s[4:7], s52 offen offset:1024 sc1
buffer_load_dwordx2 v[60:61], v5, s[4:7], s52 offen offset:1536 sc1
s_add_u32 s49, s49, 262144
s_add_u32 s50, s50, 65536
s_waitcnt vmcnt(36)
s_branch L_ac_24353
L_an_24352:
s_waitcnt vmcnt(0)
L_ac_24353:
v_mfma_f32_32x32x16_bf16 v[64:79], a[32:35], a[0:3], v[96:111]
v_mfma_f32_32x32x16_bf16 v[64:79], a[36:39], a[4:7], v[64:79]
v_mfma_f32_32x32x16_bf16 v[64:79], a[40:43], a[8:11], v[64:79]
v_mfma_f32_32x32x16_bf16 v[64:79], a[44:47], a[12:15], v[64:79]
v_mfma_f32_32x32x16_bf16 v[64:79], a[48:51], a[16:19], v[64:79]
v_mfma_f32_32x32x16_bf16 v[64:79], a[52:55], a[20:23], v[64:79]
v_mfma_f32_32x32x16_bf16 v[64:79], a[56:59], a[24:27], v[64:79]
v_mfma_f32_32x32x16_bf16 v[64:79], a[60:63], a[28:31], v[64:79]
v_mfma_f32_32x32x16_bf16 v[80:95], a[96:99], a[0:3], 0
v_mfma_f32_32x32x16_bf16 v[80:95], a[100:103], a[4:7], v[80:95]
v_mfma_f32_32x32x16_bf16 v[80:95], a[104:107], a[8:11], v[80:95]
v_mfma_f32_32x32x16_bf16 v[80:95], a[108:111], a[12:15], v[80:95]
v_mfma_f32_32x32x16_bf16 v[80:95], a[112:115], a[16:19], v[80:95]
v_mfma_f32_32x32x16_bf16 v[80:95], a[116:119], a[20:23], v[80:95]
v_mfma_f32_32x32x16_bf16 v[80:95], a[120:123], a[24:27], v[80:95]
v_mfma_f32_32x32x16_bf16 v[80:95], a[124:127], a[28:31], v[80:95]
s_nop 3
v_max3_f32 v8, v64, v65, v66
v_max3_f32 v8, v8, v67, v68
v_max3_f32 v8, v8, v69, v70
v_max3_f32 v8, v8, v71, v72
v_max3_f32 v8, v8, v73, v74
v_max3_f32 v8, v8, v75, v76
v_max3_f32 v8, v8, v77, v78
v_max_f32 v8, v8, v79
v_max3_f32 v8, v8, v80, v81
v_max3_f32 v8, v8, v82, v83
v_mov_b32 v9, v8
s_nop 1
v_permlane32_swap_b32 v8, v9
v_max_f32 v8, v8, v9
v_mul_f32 v8, s56, v8
v_pk_fma_f32 v[64:65], v[64:65], s[56:57], v[8:9] op_sel_hi:[1,1,0] neg_lo:[0,0,1] neg_hi:[0,0,1]
v_pk_fma_f32 v[66:67], v[66:67], s[56:57], v[8:9] op_sel_hi:[1,1,0] neg_lo:[0,0,1] neg_hi:[0,0,1]
v_pk_fma_f32 v[68:69], v[68:69], s[56:57], v[8:9] op_sel_hi:[1,1,0] neg_lo:[0,0,1] neg_hi:[0,0,1]
v_pk_fma_f32 v[70:71], v[70:71], s[56:57], v[8:9] op_sel_hi:[1,1,0] neg_lo:[0,0,1] neg_hi:[0,0,1]
v_pk_fma_f32 v[72:73], v[72:73], s[56:57], v[8:9] op_sel_hi:[1,1,0] neg_lo:[0,0,1] neg_hi:[0,0,1]
v_pk_fma_f32 v[74:75], v[74:75], s[56:57], v[8:9] op_sel_hi:[1,1,0] neg_lo:[0,0,1] neg_hi:[0,0,1]
v_pk_fma_f32 v[76:77], v[76:77], s[56:57], v[8:9] op_sel_hi:[1,1,0] neg_lo:[0,0,1] neg_hi:[0,0,1]
v_pk_fma_f32 v[78:79], v[78:79], s[56:57], v[8:9] op_sel_hi:[1,1,0] neg_lo:[0,0,1] neg_hi:[0,0,1]
v_pk_fma_f32 v[80:81], v[80:81], s[56:57], v[8:9] op_sel_hi:[1,1,0] neg_lo:[0,0,1] neg_hi:[0,0,1]
v_pk_fma_f32 v[82:83], v[82:83], s[56:57], v[8:9] op_sel_hi:[1,1,0] neg_lo:[0,0,1] neg_hi:[0,0,1]
v_exp_f32 v64, v64
v_exp_f32 v65, v65
v_exp_f32 v66, v66
v_exp_f32 v67, v67
v_exp_f32 v68, v68
v_exp_f32 v69, v69
v_exp_f32 v70, v70
v_exp_f32 v71, v71
v_exp_f32 v72, v72
v_exp_f32 v73, v73
v_exp_f32 v74, v74
v_exp_f32 v75, v75
v_exp_f32 v76, v76
v_exp_f32 v77, v77
v_exp_f32 v78, v78
v_exp_f32 v79, v79
v_exp_f32 v80, v80
v_exp_f32 v81, v81
v_exp_f32 v82, v82
v_exp_f32 v83, v83
s_nop 0
v_cvt_pk_bf16_f32 v112, v64, v65
v_cvt_pk_bf16_f32 v113, v66, v67
v_cvt_pk_bf16_f32 v114, v68, v69
v_cvt_pk_bf16_f32 v115, v70, v71
v_cvt_pk_bf16_f32 v116, v72, v73
v_cvt_pk_bf16_f32 v117, v74, v75
v_cvt_pk_bf16_f32 v118, v76, v77
v_cvt_pk_bf16_f32 v119, v78, v79
v_cvt_pk_bf16_f32 v120, v80, v81
v_cvt_pk_bf16_f32 v121, v82, v83
s_nop 0
v_mfma_f32_32x32x16_bf16 v[128:143], a[64:67], v[112:115], 0
v_pk_add_f32 v[8:9], v[64:65], v[66:67]
v_mfma_f32_32x32x16_bf16 v[144:159], a[72:75], v[112:115], 0
v_pk_add_f32 v[8:9], v[8:9], v[68:69]
v_mfma_f32_32x32x16_bf16 v[160:175], a[80:83], v[112:115], 0
v_pk_add_f32 v[8:9], v[8:9], v[70:71]
v_mfma_f32_32x32x16_bf16 v[176:191], a[88:91], v[112:115], 0
v_pk_add_f32 v[8:9], v[8:9], v[72:73]
v_mfma_f32_32x32x16_bf16 v[128:143], a[68:71], v[116:119], v[128:143]
v_pk_add_f32 v[8:9], v[8:9], v[74:75]
v_mfma_f32_32x32x16_bf16 v[144:159], a[76:79], v[116:119], v[144:159]
v_pk_add_f32 v[8:9], v[8:9], v[76:77]
v_mfma_f32_32x32x16_bf16 v[160:175], a[84:87], v[116:119], v[160:175]
v_pk_add_f32 v[8:9], v[8:9], v[78:79]
v_mfma_f32_32x32x16_bf16 v[176:191], a[92:95], v[116:119], v[176:191]
v_pk_add_f32 v[8:9], v[8:9], v[80:81]
v_mfma_f32_32x32x16_bf16 v[128:143], v[32:35], v[120:123], v[128:143]
v_pk_add_f32 v[8:9], v[8:9], v[82:83]
v_mfma_f32_32x32x16_bf16 v[144:159], v[36:39], v[120:123], v[144:159]
v_add_f32 v8, v8, v9
v_mfma_f32_32x32x16_bf16 v[160:175], v[40:43], v[120:123], v[160:175]
v_mov_b32 v9, v8
s_nop 1
v_permlane32_swap_b32 v8, v9
v_add_f32 v8, v8, v9
v_rcp_f32 v8, v8
v_mfma_f32_32x32x16_bf16 v[176:191], v[44:47], v[120:123], v[176:191]
s_add_u32 s52, s55, 69206016
s_add_u32 s53, s55, 69210112
s_add_u32 s55, s55, 262144
s_nop 4
v_pk_mul_f32 v[128:129], v[128:129], v[8:9] op_sel_hi:[1,0]
v_pk_mul_f32 v[130:131], v[130:131], v[8:9] op_sel_hi:[1,0]
v_pk_mul_f32 v[132:133], v[132:133], v[8:9] op_sel_hi:[1,0]
v_pk_mul_f32 v[134:135], v[134:135], v[8:9] op_sel_hi:[1,0]
v_pk_mul_f32 v[136:137], v[136:137], v[8:9] op_sel_hi:[1,0]
v_pk_mul_f32 v[138:139], v[138:139], v[8:9] op_sel_hi:[1,0]
v_pk_mul_f32 v[140:141], v[140:141], v[8:9] op_sel_hi:[1,0]
v_pk_mul_f32 v[142:143], v[142:143], v[8:9] op_sel_hi:[1,0]
v_cvt_pk_bf16_f32 v192, v128, v129
v_cvt_pk_bf16_f32 v193, v130, v131
v_cvt_pk_bf16_f32 v194, v132, v133
v_cvt_pk_bf16_f32 v195, v134, v135
v_cvt_pk_bf16_f32 v196, v136, v137
v_cvt_pk_bf16_f32 v197, v138, v139
v_cvt_pk_bf16_f32 v198, v140, v141
v_cvt_pk_bf16_f32 v199, v142, v143
buffer_store_dwordx4 v[192:195], v1, s[4:7], s52 offen offset:0 sc1
buffer_store_dwordx4 v[196:199], v1, s[4:7], s52 offen offset:1024 sc1
v_pk_mul_f32 v[144:145], v[144:145], v[8:9] op_sel_hi:[1,0]
v_pk_mul_f32 v[146:147], v[146:147], v[8:9] op_sel_hi:[1,0]
v_pk_mul_f32 v[148:149], v[148:149], v[8:9] op_sel_hi:[1,0]
v_pk_mul_f32 v[150:151], v[150:151], v[8:9] op_sel_hi:[1,0]
v_pk_mul_f32 v[152:153], v[152:153], v[8:9] op_sel_hi:[1,0]
v_pk_mul_f32 v[154:155], v[154:155], v[8:9] op_sel_hi:[1,0]
v_pk_mul_f32 v[156:157], v[156:157], v[8:9] op_sel_hi:[1,0]
v_pk_mul_f32 v[158:159], v[158:159], v[8:9] op_sel_hi:[1,0]
v_cvt_pk_bf16_f32 v200, v144, v145
v_cvt_pk_bf16_f32 v201, v146, v147
v_cvt_pk_bf16_f32 v202, v148, v149
v_cvt_pk_bf16_f32 v203, v150, v151
v_cvt_pk_bf16_f32 v204, v152, v153
v_cvt_pk_bf16_f32 v205, v154, v155
v_cvt_pk_bf16_f32 v206, v156, v157
v_cvt_pk_bf16_f32 v207, v158, v159
buffer_store_dwordx4 v[200:203], v1, s[4:7], s52 offen offset:2048 sc1
buffer_store_dwordx4 v[204:207], v1, s[4:7], s52 offen offset:3072 sc1
v_pk_mul_f32 v[160:161], v[160:161], v[8:9] op_sel_hi:[1,0]
v_pk_mul_f32 v[162:163], v[162:163], v[8:9] op_sel_hi:[1,0]
v_pk_mul_f32 v[164:165], v[164:165], v[8:9] op_sel_hi:[1,0]
v_pk_mul_f32 v[166:167], v[166:167], v[8:9] op_sel_hi:[1,0]
v_pk_mul_f32 v[168:169], v[168:169], v[8:9] op_sel_hi:[1,0]
v_pk_mul_f32 v[170:171], v[170:171], v[8:9] op_sel_hi:[1,0]
v_pk_mul_f32 v[172:173], v[172:173], v[8:9] op_sel_hi:[1,0]
v_pk_mul_f32 v[174:175], v[174:175], v[8:9] op_sel_hi:[1,0]
v_cvt_pk_bf16_f32 v208, v160, v161
v_cvt_pk_bf16_f32 v209, v162, v163
v_cvt_pk_bf16_f32 v210, v164, v165
v_cvt_pk_bf16_f32 v211, v166, v167
v_cvt_pk_bf16_f32 v212, v168, v169
v_cvt_pk_bf16_f32 v213, v170, v171
v_cvt_pk_bf16_f32 v214, v172, v173
v_cvt_pk_bf16_f32 v215, v174, v175
buffer_store_dwordx4 v[208:211], v1, s[4:7], s53 offen offset:0 sc1
buffer_store_dwordx4 v[212:215], v1, s[4:7], s53 offen offset:1024 sc1
s_nop 3
v_pk_mul_f32 v[176:177], v[176:177], v[8:9] op_sel_hi:[1,0]
v_pk_mul_f32 v[178:179], v[178:179], v[8:9] op_sel_hi:[1,0]
v_pk_mul_f32 v[180:181], v[180:181], v[8:9] op_sel_hi:[1,0]
v_pk_mul_f32 v[182:183], v[182:183], v[8:9] op_sel_hi:[1,0]
v_pk_mul_f32 v[184:185], v[184:185], v[8:9] op_sel_hi:[1,0]
v_pk_mul_f32 v[186:187], v[186:187], v[8:9] op_sel_hi:[1,0]
v_pk_mul_f32 v[188:189], v[188:189], v[8:9] op_sel_hi:[1,0]
v_pk_mul_f32 v[190:191], v[190:191], v[8:9] op_sel_hi:[1,0]
v_cvt_pk_bf16_f32 v216, v176, v177
v_cvt_pk_bf16_f32 v217, v178, v179
v_cvt_pk_bf16_f32 v218, v180, v181
v_cvt_pk_bf16_f32 v219, v182, v183
v_cvt_pk_bf16_f32 v220, v184, v185
v_cvt_pk_bf16_f32 v221, v186, v187
v_cvt_pk_bf16_f32 v222, v188, v189
v_cvt_pk_bf16_f32 v223, v190, v191
buffer_store_dwordx4 v[216:219], v1, s[4:7], s53 offen offset:2048 sc1
buffer_store_dwordx4 v[220:223], v1, s[4:7], s53 offen offset:3072 sc1
s_cmp_eq_u32 s62, 0
s_cbranch_scc1 L_ad_24351
s_sub_u32 s62, s62, 1
s_cmp_eq_u32 s62, 0
s_cbranch_scc1 L_an_24354
s_add_u32 s52, s49, 20971520
s_add_u32 s53, s49, 20975616
buffer_load_dwordx4 a[32:35], v1, s[4:7], s52 offen offset:0 sc1
buffer_load_dwordx4 a[36:39], v1, s[4:7], s52 offen offset:1024 sc1
buffer_load_dwordx4 a[40:43], v1, s[4:7], s52 offen offset:2048 sc1
buffer_load_dwordx4 a[44:47], v1, s[4:7], s52 offen offset:3072 sc1
buffer_load_dwordx4 a[48:51], v1, s[4:7], s53 offen offset:0 sc1
buffer_load_dwordx4 a[52:55], v1, s[4:7], s53 offen offset:1024 sc1
buffer_load_dwordx4 a[56:59], v1, s[4:7], s53 offen offset:2048 sc1
buffer_load_dwordx4 a[60:63], v1, s[4:7], s53 offen offset:3072 sc1
s_add_u32 s52, s49, 4194304
s_add_u32 s53, s49, 4198400
buffer_load_dwordx4 a[0:3], v1, s[4:7], s52 offen offset:0 sc1
buffer_load_dwordx4 a[4:7], v1, s[4:7], s52 offen offset:1024 sc1
buffer_load_dwordx4 a[8:11], v1, s[4:7], s52 offen offset:2048 sc1
buffer_load_dwordx4 a[12:15], v1, s[4:7], s52 offen offset:3072 sc1
buffer_load_dwordx4 a[16:19], v1, s[4:7], s53 offen offset:0 sc1
buffer_load_dwordx4 a[20:23], v1, s[4:7], s53 offen offset:1024 sc1
buffer_load_dwordx4 a[24:27], v1, s[4:7], s53 offen offset:2048 sc1
buffer_load_dwordx4 a[28:31], v1, s[4:7], s53 offen offset:3072 sc1
s_add_u32 s52, s49, 37748736
s_add_u32 s53, s49, 37752832
buffer_load_dwordx4 a[64:67], v1, s[4:7], s52 offen offset:0 sc1
buffer_load_dwordx4 a[68:71], v1, s[4:7], s52 offen offset:1024 sc1
buffer_load_dwordx4 a[72:75], v1, s[4:7], s52 offen offset:2048 sc1
buffer_load_dwordx4 a[76:79], v1, s[4:7], s52 offen offset:3072 sc1
buffer_load_dwordx4 a[80:83], v1, s[4:7], s53 offen offset:0 sc1
buffer_load_dwordx4 a[84:87], v1, s[4:7], s53 offen offset:1024 sc1
buffer_load_dwordx4 a[88:91], v1, s[4:7], s53 offen offset:2048 sc1
buffer_load_dwordx4 a[92:95], v1, s[4:7], s53 offen offset:3072 sc1
s_add_u32 s52, s50, 85983232
s_mov_b32 exec_lo, 0xff
s_mov_b32 exec_hi, 0xff
buffer_load_dwordx4 a[96:99], v4, s[4:7], s52 offen offset:0 sc1
buffer_load_dwordx4 a[100:103], v4, s[4:7], s52 offen offset:256 sc1
buffer_load_dwordx4 a[104:107], v4, s[4:7], s52 offen offset:512 sc1
buffer_load_dwordx4 a[108:111], v4, s[4:7], s52 offen offset:768 sc1
buffer_load_dwordx4 a[112:115], v4, s[4:7], s52 offen offset:1024 sc1
buffer_load_dwordx4 a[116:119], v4, s[4:7], s52 offen offset:1280 sc1
buffer_load_dwordx4 a[120:123], v4, s[4:7], s52 offen offset:1536 sc1
buffer_load_dwordx4 a[124:127], v4, s[4:7], s52 offen offset:1792 sc1
s_mov_b64 exec, -1
s_add_u32 s52, s50, 90177536
buffer_load_dwordx2 v[32:33], v5, s[4:7], s52 offen offset:0 sc1
buffer_load_dwordx2 v[36:37], v5, s[4:7], s52 offen offset:512 sc1
buffer_load_dwordx2 v[40:41], v5, s[4:7], s52 offen offset:1024 sc1
buffer_load_dwordx2 v[44:45], v5, s[4:7], s52 offen offset:1536 sc1
s_add_u32 s49, s49, 262144
s_add_u32 s50, s50, 65536
s_waitcnt vmcnt(36)
s_branch L_ac_24355
L_an_24354:
s_waitcnt vmcnt(0)
L_ac_24355:
v_mfma_f32_32x32x16_bf16 v[64:79], a[160:163], a[128:131], v[96:111]
v_mfma_f32_32x32x16_bf16 v[64:79], a[164:167], a[132:135], v[64:79]
v_mfma_f32_32x32x16_bf16 v[64:79], a[168:171], a[136:139], v[64:79]
v_mfma_f32_32x32x16_bf16 v[64:79], a[172:175], a[140:143], v[64:79]
v_mfma_f32_32x32x16_bf16 v[64:79], a[176:179], a[144:147], v[64:79]
v_mfma_f32_32x32x16_bf16 v[64:79], a[180:183], a[148:151], v[64:79]
v_mfma_f32_32x32x16_bf16 v[64:79], a[184:187], a[152:155], v[64:79]
v_mfma_f32_32x32x16_bf16 v[64:79], a[188:191], a[156:159], v[64:79]
v_mfma_f32_32x32x16_bf16 v[80:95], a[224:227], a[128:131], 0
v_mfma_f32_32x32x16_bf16 v[80:95], a[228:231], a[132:135], v[80:95]
v_mfma_f32_32x32x16_bf16 v[80:95], a[232:235], a[136:139], v[80:95]
v_mfma_f32_32x32x16_bf16 v[80:95], a[236:239], a[140:143], v[80:95]
v_mfma_f32_32x32x16_bf16 v[80:95], a[240:243], a[144:147], v[80:95]
v_mfma_f32_32x32x16_bf16 v[80:95], a[244:247], a[148:151], v[80:95]
v_mfma_f32_32x32x16_bf16 v[80:95], a[248:251], a[152:155], v[80:95]
v_mfma_f32_32x32x16_bf16 v[80:95], a[252:255], a[156:159], v[80:95]
s_nop 3
v_max3_f32 v8, v64, v65, v66
v_max3_f32 v8, v8, v67, v68
v_max3_f32 v8, v8, v69, v70
v_max3_f32 v8, v8, v71, v72
v_max3_f32 v8, v8, v73, v74
v_max3_f32 v8, v8, v75, v76
v_max3_f32 v8, v8, v77, v78
v_max_f32 v8, v8, v79
v_max3_f32 v8, v8, v80, v81
v_max3_f32 v8, v8, v82, v83
v_mov_b32 v9, v8
s_nop 1
v_permlane32_swap_b32 v8, v9
v_max_f32 v8, v8, v9
v_mul_f32 v8, s56, v8
v_pk_fma_f32 v[64:65], v[64:65], s[56:57], v[8:9] op_sel_hi:[1,1,0] neg_lo:[0,0,1] neg_hi:[0,0,1]
v_pk_fma_f32 v[66:67], v[66:67], s[56:57], v[8:9] op_sel_hi:[1,1,0] neg_lo:[0,0,1] neg_hi:[0,0,1]
v_pk_fma_f32 v[68:69], v[68:69], s[56:57], v[8:9] op_sel_hi:[1,1,0] neg_lo:[0,0,1] neg_hi:[0,0,1]
v_pk_fma_f32 v[70:71], v[70:71], s[56:57], v[8:9] op_sel_hi:[1,1,0] neg_lo:[0,0,1] neg_hi:[0,0,1]
v_pk_fma_f32 v[72:73], v[72:73], s[56:57], v[8:9] op_sel_hi:[1,1,0] neg_lo:[0,0,1] neg_hi:[0,0,1]
v_pk_fma_f32 v[74:75], v[74:75], s[56:57], v[8:9] op_sel_hi:[1,1,0] neg_lo:[0,0,1] neg_hi:[0,0,1]
v_pk_fma_f32 v[76:77], v[76:77], s[56:57], v[8:9] op_sel_hi:[1,1,0] neg_lo:[0,0,1] neg_hi:[0,0,1]
v_pk_fma_f32 v[78:79], v[78:79], s[56:57], v[8:9] op_sel_hi:[1,1,0] neg_lo:[0,0,1] neg_hi:[0,0,1]
v_pk_fma_f32 v[80:81], v[80:81], s[56:57], v[8:9] op_sel_hi:[1,1,0] neg_lo:[0,0,1] neg_hi:[0,0,1]
v_pk_fma_f32 v[82:83], v[82:83], s[56:57], v[8:9] op_sel_hi:[1,1,0] neg_lo:[0,0,1] neg_hi:[0,0,1]
v_exp_f32 v64, v64
v_exp_f32 v65, v65
v_exp_f32 v66, v66
v_exp_f32 v67, v67
v_exp_f32 v68, v68
v_exp_f32 v69, v69
v_exp_f32 v70, v70
v_exp_f32 v71, v71
v_exp_f32 v72, v72
v_exp_f32 v73, v73
v_exp_f32 v74, v74
v_exp_f32 v75, v75
v_exp_f32 v76, v76
v_exp_f32 v77, v77
v_exp_f32 v78, v78
v_exp_f32 v79, v79
v_exp_f32 v80, v80
v_exp_f32 v81, v81
v_exp_f32 v82, v82
v_exp_f32 v83, v83
s_nop 0
v_cvt_pk_bf16_f32 v112, v64, v65
v_cvt_pk_bf16_f32 v113, v66, v67
v_cvt_pk_bf16_f32 v114, v68, v69
v_cvt_pk_bf16_f32 v115, v70, v71
v_cvt_pk_bf16_f32 v116, v72, v73
v_cvt_pk_bf16_f32 v117, v74, v75
v_cvt_pk_bf16_f32 v118, v76, v77
v_cvt_pk_bf16_f32 v119, v78, v79
v_cvt_pk_bf16_f32 v120, v80, v81
v_cvt_pk_bf16_f32 v121, v82, v83
s_nop 0
v_mfma_f32_32x32x16_bf16 v[128:143], a[192:195], v[112:115], 0
v_pk_add_f32 v[8:9], v[64:65], v[66:67]
v_mfma_f32_32x32x16_bf16 v[144:159], a[200:203], v[112:115], 0
v_pk_add_f32 v[8:9], v[8:9], v[68:69]
v_mfma_f32_32x32x16_bf16 v[160:175], a[208:211], v[112:115], 0
v_pk_add_f32 v[8:9], v[8:9], v[70:71]
v_mfma_f32_32x32x16_bf16 v[176:191], a[216:219], v[112:115], 0
v_pk_add_f32 v[8:9], v[8:9], v[72:73]
v_mfma_f32_32x32x16_bf16 v[128:143], a[196:199], v[116:119], v[128:143]
v_pk_add_f32 v[8:9], v[8:9], v[74:75]
v_mfma_f32_32x32x16_bf16 v[144:159], a[204:207], v[116:119], v[144:159]
v_pk_add_f32 v[8:9], v[8:9], v[76:77]
v_mfma_f32_32x32x16_bf16 v[160:175], a[212:215], v[116:119], v[160:175]
v_pk_add_f32 v[8:9], v[8:9], v[78:79]
v_mfma_f32_32x32x16_bf16 v[176:191], a[220:223], v[116:119], v[176:191]
v_pk_add_f32 v[8:9], v[8:9], v[80:81]
v_mfma_f32_32x32x16_bf16 v[128:143], v[48:51], v[120:123], v[128:143]
v_pk_add_f32 v[8:9], v[8:9], v[82:83]
v_mfma_f32_32x32x16_bf16 v[144:159], v[52:55], v[120:123], v[144:159]
v_add_f32 v8, v8, v9
v_mfma_f32_32x32x16_bf16 v[160:175], v[56:59], v[120:123], v[160:175]
v_mov_b32 v9, v8
s_nop 1
v_permlane32_swap_b32 v8, v9
v_add_f32 v8, v8, v9
v_rcp_f32 v8, v8
v_mfma_f32_32x32x16_bf16 v[176:191], v[60:63], v[120:123], v[176:191]
s_add_u32 s52, s55, 69206016
s_add_u32 s53, s55, 69210112
s_add_u32 s55, s55, 262144
s_nop 4
v_pk_mul_f32 v[128:129], v[128:129], v[8:9] op_sel_hi:[1,0]
v_pk_mul_f32 v[130:131], v[130:131], v[8:9] op_sel_hi:[1,0]
v_pk_mul_f32 v[132:133], v[132:133], v[8:9] op_sel_hi:[1,0]
v_pk_mul_f32 v[134:135], v[134:135], v[8:9] op_sel_hi:[1,0]
v_pk_mul_f32 v[136:137], v[136:137], v[8:9] op_sel_hi:[1,0]
v_pk_mul_f32 v[138:139], v[138:139], v[8:9] op_sel_hi:[1,0]
v_pk_mul_f32 v[140:141], v[140:141], v[8:9] op_sel_hi:[1,0]
v_pk_mul_f32 v[142:143], v[142:143], v[8:9] op_sel_hi:[1,0]
v_cvt_pk_bf16_f32 v192, v128, v129
v_cvt_pk_bf16_f32 v193, v130, v131
v_cvt_pk_bf16_f32 v194, v132, v133
v_cvt_pk_bf16_f32 v195, v134, v135
v_cvt_pk_bf16_f32 v196, v136, v137
v_cvt_pk_bf16_f32 v197, v138, v139
v_cvt_pk_bf16_f32 v198, v140, v141
v_cvt_pk_bf16_f32 v199, v142, v143
buffer_store_dwordx4 v[192:195], v1, s[4:7], s52 offen offset:0 sc1
buffer_store_dwordx4 v[196:199], v1, s[4:7], s52 offen offset:1024 sc1
v_pk_mul_f32 v[144:145], v[144:145], v[8:9] op_sel_hi:[1,0]
v_pk_mul_f32 v[146:147], v[146:147], v[8:9] op_sel_hi:[1,0]
v_pk_mul_f32 v[148:149], v[148:149], v[8:9] op_sel_hi:[1,0]
v_pk_mul_f32 v[150:151], v[150:151], v[8:9] op_sel_hi:[1,0]
v_pk_mul_f32 v[152:153], v[152:153], v[8:9] op_sel_hi:[1,0]
v_pk_mul_f32 v[154:155], v[154:155], v[8:9] op_sel_hi:[1,0]
v_pk_mul_f32 v[156:157], v[156:157], v[8:9] op_sel_hi:[1,0]
v_pk_mul_f32 v[158:159], v[158:159], v[8:9] op_sel_hi:[1,0]
v_cvt_pk_bf16_f32 v200, v144, v145
v_cvt_pk_bf16_f32 v201, v146, v147
v_cvt_pk_bf16_f32 v202, v148, v149
v_cvt_pk_bf16_f32 v203, v150, v151
v_cvt_pk_bf16_f32 v204, v152, v153
v_cvt_pk_bf16_f32 v205, v154, v155
v_cvt_pk_bf16_f32 v206, v156, v157
v_cvt_pk_bf16_f32 v207, v158, v159
buffer_store_dwordx4 v[200:203], v1, s[4:7], s52 offen offset:2048 sc1
buffer_store_dwordx4 v[204:207], v1, s[4:7], s52 offen offset:3072 sc1
v_pk_mul_f32 v[160:161], v[160:161], v[8:9] op_sel_hi:[1,0]
v_pk_mul_f32 v[162:163], v[162:163], v[8:9] op_sel_hi:[1,0]
v_pk_mul_f32 v[164:165], v[164:165], v[8:9] op_sel_hi:[1,0]
v_pk_mul_f32 v[166:167], v[166:167], v[8:9] op_sel_hi:[1,0]
v_pk_mul_f32 v[168:169], v[168:169], v[8:9] op_sel_hi:[1,0]
v_pk_mul_f32 v[170:171], v[170:171], v[8:9] op_sel_hi:[1,0]
v_pk_mul_f32 v[172:173], v[172:173], v[8:9] op_sel_hi:[1,0]
v_pk_mul_f32 v[174:175], v[174:175], v[8:9] op_sel_hi:[1,0]
v_cvt_pk_bf16_f32 v208, v160, v161
v_cvt_pk_bf16_f32 v209, v162, v163
v_cvt_pk_bf16_f32 v210, v164, v165
v_cvt_pk_bf16_f32 v211, v166, v167
v_cvt_pk_bf16_f32 v212, v168, v169
v_cvt_pk_bf16_f32 v213, v170, v171
v_cvt_pk_bf16_f32 v214, v172, v173
v_cvt_pk_bf16_f32 v215, v174, v175
buffer_store_dwordx4 v[208:211], v1, s[4:7], s53 offen offset:0 sc1
buffer_store_dwordx4 v[212:215], v1, s[4:7], s53 offen offset:1024 sc1
s_nop 3
v_pk_mul_f32 v[176:177], v[176:177], v[8:9] op_sel_hi:[1,0]
v_pk_mul_f32 v[178:179], v[178:179], v[8:9] op_sel_hi:[1,0]
v_pk_mul_f32 v[180:181], v[180:181], v[8:9] op_sel_hi:[1,0]
v_pk_mul_f32 v[182:183], v[182:183], v[8:9] op_sel_hi:[1,0]
v_pk_mul_f32 v[184:185], v[184:185], v[8:9] op_sel_hi:[1,0]
v_pk_mul_f32 v[186:187], v[186:187], v[8:9] op_sel_hi:[1,0]
v_pk_mul_f32 v[188:189], v[188:189], v[8:9] op_sel_hi:[1,0]
v_pk_mul_f32 v[190:191], v[190:191], v[8:9] op_sel_hi:[1,0]
v_cvt_pk_bf16_f32 v216, v176, v177
v_cvt_pk_bf16_f32 v217, v178, v179
v_cvt_pk_bf16_f32 v218, v180, v181
v_cvt_pk_bf16_f32 v219, v182, v183
v_cvt_pk_bf16_f32 v220, v184, v185
v_cvt_pk_bf16_f32 v221, v186, v187
v_cvt_pk_bf16_f32 v222, v188, v189
v_cvt_pk_bf16_f32 v223, v190, v191
buffer_store_dwordx4 v[216:219], v1, s[4:7], s53 offen offset:2048 sc1
buffer_store_dwordx4 v[220:223], v1, s[4:7], s53 offen offset:3072 sc1
s_cmp_eq_u32 s62, 0
s_cbranch_scc1 L_ad_24351
s_branch L_al_24350
L_ad_24351:
s_branch L_sig
L_fin:
s_cmp_eq_u32 s63, 1
s_cbranch_scc1 L_finf
s_cmp_eq_u32 s63, 3
s_cbranch_scc1 L_finb
s_lshl_b32 s48, s61, 2
s_add_u32 s48, s48, s3
s_mul_i32 s48, s48, 4
s_lshl_b32 s49, s60, 16
s_lshl_b32 s50, s48, 10
s_add_u32 s49, s49, s50
s_add_u32 s49, s49, 100663296
v_and_b32 v32, 31, v0
v_bfe_u32 v33, v0, 5, 1
v_lshlrev_b32 v32, 11, v32
v_lshl_add_u32 v32, v33, 3, v32
s_lshl_b32 s50, s60, 16
s_lshl_b32 s51, s48, 5
s_add_u32 s50, s50, s51
buffer_load_dwordx2 v[36:37], v32, s[12:15], s50 offen offset:0
buffer_load_dwordx2 v[38:39], v32, s[12:15], s50 offen offset:16
buffer_load_dwordx2 v[40:41], v32, s[12:15], s50 offen offset:32
buffer_load_dwordx2 v[42:43], v32, s[12:15], s50 offen offset:48
buffer_load_dwordx2 v[44:45], v32, s[12:15], s50 offen offset:64
buffer_load_dwordx2 v[46:47], v32, s[12:15], s50 offen offset:80
buffer_load_dwordx2 v[48:49], v32, s[12:15], s50 offen offset:96
buffer_load_dwordx2 v[50:51], v32, s[12:15], s50 offen offset:112
buffer_load_dwordx4 v[84:87], v1, s[4:7], s49 offen offset:0 sc1
buffer_load_dwordx4 v[88:91], v1, s[4:7], s49 offen offset:1024 sc1
buffer_load_dwordx4 v[92:95], v1, s[4:7], s49 offen offset:2048 sc1
buffer_load_dwordx4 v[96:99], v1, s[4:7], s49 offen offset:3072 sc1
s_add_u32 s49, s49, 4194304
buffer_load_dwordx4 v[100:103], v1, s[4:7], s49 offen offset:0 sc1
buffer_load_dwordx4 v[104:107], v1, s[4:7], s49 offen offset:1024 sc1
buffer_load_dwordx4 v[108:111], v1, s[4:7], s49 offen offset:2048 sc1
buffer_load_dwordx4 v[112:115], v1, s[4:7], s49 offen offset:3072 sc1
s_add_u32 s49, s49, 4194304
buffer_load_dwordx4 v[116:119], v1, s[4:7], s49 offen offset:0 sc1
buffer_load_dwordx4 v[120:123], v1, s[4:7], s49 offen offset:1024 sc1
buffer_load_dwordx4 v[124:127], v1, s[4:7], s49 offen offset:2048 sc1
buffer_load_dwordx4 v[128:131], v1, s[4:7], s49 offen offset:3072 sc1
s_add_u32 s49, s49, 4194304
buffer_load_dwordx4 v[132:135], v1, s[4:7], s49 offen offset:0 sc1
buffer_load_dwordx4 v[136:139], v1, s[4:7], s49 offen offset:1024 sc1
buffer_load_dwordx4 v[140:143], v1, s[4:7], s49 offen offset:2048 sc1
buffer_load_dwordx4 v[144:147], v1, s[4:7], s49 offen offset:3072 sc1
s_add_u32 s49, s49, 4194304
buffer_load_dwordx4 v[148:151], v1, s[4:7], s49 offen offset:0 sc1
buffer_load_dwordx4 v[152:155], v1, s[4:7], s49 offen offset:1024 sc1
buffer_load_dwordx4 v[156:159], v1, s[4:7], s49 offen offset:2048 sc1
buffer_load_dwordx4 v[160:163], v1, s[4:7], s49 offen offset:3072 sc1
s_add_u32 s49, s49, 4194304
buffer_load_dwordx4 v[164:167], v1, s[4:7], s49 offen offset:0 sc1
buffer_load_dwordx4 v[168:171], v1, s[4:7], s49 offen offset:1024 sc1
buffer_load_dwordx4 v[172:175], v1, s[4:7], s49 offen offset:2048 sc1
buffer_load_dwordx4 v[176:179], v1, s[4:7], s49 offen offset:3072 sc1
s_add_u32 s49, s49, 4194304
s_mov_b32 s51, 0x3f800000
s_mov_b32 s52, 0x00003f80
s_waitcnt vmcnt(24)
v_lshlrev_b32 v52, 16, v36
v_and_b32 v53, 0xffff0000, v36
v_lshlrev_b32 v54, 16, v37
v_and_b32 v55, 0xffff0000, v37
v_lshlrev_b32 v56, 16, v38
v_and_b32 v57, 0xffff0000, v38
v_lshlrev_b32 v58, 16, v39
v_and_b32 v59, 0xffff0000, v39
v_lshlrev_b32 v60, 16, v40
v_and_b32 v61, 0xffff0000, v40
v_lshlrev_b32 v62, 16, v41
v_and_b32 v63, 0xffff0000, v41
v_lshlrev_b32 v64, 16, v42
v_and_b32 v65, 0xffff0000, v42
v_lshlrev_b32 v66, 16, v43
v_and_b32 v67, 0xffff0000, v43
v_lshlrev_b32 v68, 16, v44
v_and_b32 v69, 0xffff0000, v44
v_lshlrev_b32 v70, 16, v45
v_and_b32 v71, 0xffff0000, v45
v_lshlrev_b32 v72, 16, v46
v_and_b32 v73, 0xffff0000, v46
v_lshlrev_b32 v74, 16, v47
v_and_b32 v75, 0xffff0000, v47
v_lshlrev_b32 v76, 16, v48
v_and_b32 v77, 0xffff0000, v48
v_lshlrev_b32 v78, 16, v49
v_and_b32 v79, 0xffff0000, v49
v_lshlrev_b32 v80, 16, v50
v_and_b32 v81, 0xffff0000, v50
v_lshlrev_b32 v82, 16, v51
v_and_b32 v83, 0xffff0000, v51
s_waitcnt vmcnt(20)
v_lshlrev_b32 v34, 16, v84
v_and_b32 v35, 0xffff0000, v84
v_pk_add_f32 v[52:53], v[52:53], v[34:35]
v_lshlrev_b32 v34, 16, v85
v_and_b32 v35, 0xffff0000, v85
v_pk_add_f32 v[54:55], v[54:55], v[34:35]
v_lshlrev_b32 v34, 16, v86
v_and_b32 v35, 0xffff0000, v86
v_pk_add_f32 v[56:57], v[56:57], v[34:35]
v_lshlrev_b32 v34, 16, v87
v_and_b32 v35, 0xffff0000, v87
v_pk_add_f32 v[58:59], v[58:59], v[34:35]
v_lshlrev_b32 v34, 16, v88
v_and_b32 v35, 0xffff0000, v88
v_pk_add_f32 v[60:61], v[60:61], v[34:35]
v_lshlrev_b32 v34, 16, v89
v_and_b32 v35, 0xffff0000, v89
v_pk_add_f32 v[62:63], v[62:63], v[34:35]
v_lshlrev_b32 v34, 16, v90
v_and_b32 v35, 0xffff0000, v90
v_pk_add_f32 v[64:65], v[64:65], v[34:35]
v_lshlrev_b32 v34, 16, v91
v_and_b32 v35, 0xffff0000, v91
v_pk_add_f32 v[66:67], v[66:67], v[34:35]
v_lshlrev_b32 v34, 16, v92
v_and_b32 v35, 0xffff0000, v92
v_pk_add_f32 v[68:69], v[68:69], v[34:35]
v_lshlrev_b32 v34, 16, v93
v_and_b32 v35, 0xffff0000, v93
v_pk_add_f32 v[70:71], v[70:71], v[34:35]
v_lshlrev_b32 v34, 16, v94
v_and_b32 v35, 0xffff0000, v94
v_pk_add_f32 v[72:73], v[72:73], v[34:35]
v_lshlrev_b32 v34, 16, v95
v_and_b32 v35, 0xffff0000, v95
v_pk_add_f32 v[74:75], v[74:75], v[34:35]
v_lshlrev_b32 v34, 16, v96
v_and_b32 v35, 0xffff0000, v96
v_pk_add_f32 v[76:77], v[76:77], v[34:35]
v_lshlrev_b32 v34, 16, v97
v_and_b32 v35, 0xffff0000, v97
v_pk_add_f32 v[78:79], v[78:79], v[34:35]
v_lshlrev_b32 v34, 16, v98
v_and_b32 v35, 0xffff0000, v98
v_pk_add_f32 v[80:81], v[80:81], v[34:35]
v_lshlrev_b32 v34, 16, v99
v_and_b32 v35, 0xffff0000, v99
v_pk_add_f32 v[82:83], v[82:83], v[34:35]
s_waitcnt vmcnt(16)
v_lshlrev_b32 v34, 16, v100
v_and_b32 v35, 0xffff0000, v100
v_pk_add_f32 v[52:53], v[52:53], v[34:35]
v_lshlrev_b32 v34, 16, v101
v_and_b32 v35, 0xffff0000, v101
v_pk_add_f32 v[54:55], v[54:55], v[34:35]
v_lshlrev_b32 v34, 16, v102
v_and_b32 v35, 0xffff0000, v102
v_pk_add_f32 v[56:57], v[56:57], v[34:35]
v_lshlrev_b32 v34, 16, v103
v_and_b32 v35, 0xffff0000, v103
v_pk_add_f32 v[58:59], v[58:59], v[34:35]
v_lshlrev_b32 v34, 16, v104
v_and_b32 v35, 0xffff0000, v104
v_pk_add_f32 v[60:61], v[60:61], v[34:35]
v_lshlrev_b32 v34, 16, v105
v_and_b32 v35, 0xffff0000, v105
v_pk_add_f32 v[62:63], v[62:63], v[34:35]
v_lshlrev_b32 v34, 16, v106
v_and_b32 v35, 0xffff0000, v106
v_pk_add_f32 v[64:65], v[64:65], v[34:35]
v_lshlrev_b32 v34, 16, v107
v_and_b32 v35, 0xffff0000, v107
v_pk_add_f32 v[66:67], v[66:67], v[34:35]
v_lshlrev_b32 v34, 16, v108
v_and_b32 v35, 0xffff0000, v108
v_pk_add_f32 v[68:69], v[68:69], v[34:35]
v_lshlrev_b32 v34, 16, v109
v_and_b32 v35, 0xffff0000, v109
v_pk_add_f32 v[70:71], v[70:71], v[34:35]
v_lshlrev_b32 v34, 16, v110
v_and_b32 v35, 0xffff0000, v110
v_pk_add_f32 v[72:73], v[72:73], v[34:35]
v_lshlrev_b32 v34, 16, v111
v_and_b32 v35, 0xffff0000, v111
v_pk_add_f32 v[74:75], v[74:75], v[34:35]
v_lshlrev_b32 v34, 16, v112
v_and_b32 v35, 0xffff0000, v112
v_pk_add_f32 v[76:77], v[76:77], v[34:35]
v_lshlrev_b32 v34, 16, v113
v_and_b32 v35, 0xffff0000, v113
v_pk_add_f32 v[78:79], v[78:79], v[34:35]
v_lshlrev_b32 v34, 16, v114
v_and_b32 v35, 0xffff0000, v114
v_pk_add_f32 v[80:81], v[80:81], v[34:35]
v_lshlrev_b32 v34, 16, v115
v_and_b32 v35, 0xffff0000, v115
v_pk_add_f32 v[82:83], v[82:83], v[34:35]
s_waitcnt vmcnt(12)
v_lshlrev_b32 v34, 16, v116
v_and_b32 v35, 0xffff0000, v116
v_pk_add_f32 v[52:53], v[52:53], v[34:35]
v_lshlrev_b32 v34, 16, v117
v_and_b32 v35, 0xffff0000, v117
v_pk_add_f32 v[54:55], v[54:55], v[34:35]
v_lshlrev_b32 v34, 16, v118
v_and_b32 v35, 0xffff0000, v118
v_pk_add_f32 v[56:57], v[56:57], v[34:35]
v_lshlrev_b32 v34, 16, v119
v_and_b32 v35, 0xffff0000, v119
v_pk_add_f32 v[58:59], v[58:59], v[34:35]
v_lshlrev_b32 v34, 16, v120
v_and_b32 v35, 0xffff0000, v120
v_pk_add_f32 v[60:61], v[60:61], v[34:35]
v_lshlrev_b32 v34, 16, v121
v_and_b32 v35, 0xffff0000, v121
v_pk_add_f32 v[62:63], v[62:63], v[34:35]
v_lshlrev_b32 v34, 16, v122
v_and_b32 v35, 0xffff0000, v122
v_pk_add_f32 v[64:65], v[64:65], v[34:35]
v_lshlrev_b32 v34, 16, v123
v_and_b32 v35, 0xffff0000, v123
v_pk_add_f32 v[66:67], v[66:67], v[34:35]
v_lshlrev_b32 v34, 16, v124
v_and_b32 v35, 0xffff0000, v124
v_pk_add_f32 v[68:69], v[68:69], v[34:35]
v_lshlrev_b32 v34, 16, v125
v_and_b32 v35, 0xffff0000, v125
v_pk_add_f32 v[70:71], v[70:71], v[34:35]
v_lshlrev_b32 v34, 16, v126
v_and_b32 v35, 0xffff0000, v126
v_pk_add_f32 v[72:73], v[72:73], v[34:35]
v_lshlrev_b32 v34, 16, v127
v_and_b32 v35, 0xffff0000, v127
v_pk_add_f32 v[74:75], v[74:75], v[34:35]
v_lshlrev_b32 v34, 16, v128
v_and_b32 v35, 0xffff0000, v128
v_pk_add_f32 v[76:77], v[76:77], v[34:35]
v_lshlrev_b32 v34, 16, v129
v_and_b32 v35, 0xffff0000, v129
v_pk_add_f32 v[78:79], v[78:79], v[34:35]
v_lshlrev_b32 v34, 16, v130
v_and_b32 v35, 0xffff0000, v130
v_pk_add_f32 v[80:81], v[80:81], v[34:35]
v_lshlrev_b32 v34, 16, v131
v_and_b32 v35, 0xffff0000, v131
v_pk_add_f32 v[82:83], v[82:83], v[34:35]
s_waitcnt vmcnt(8)
v_lshlrev_b32 v34, 16, v132
v_and_b32 v35, 0xffff0000, v132
v_pk_add_f32 v[52:53], v[52:53], v[34:35]
v_lshlrev_b32 v34, 16, v133
v_and_b32 v35, 0xffff0000, v133
v_pk_add_f32 v[54:55], v[54:55], v[34:35]
v_lshlrev_b32 v34, 16, v134
v_and_b32 v35, 0xffff0000, v134
v_pk_add_f32 v[56:57], v[56:57], v[34:35]
v_lshlrev_b32 v34, 16, v135
v_and_b32 v35, 0xffff0000, v135
v_pk_add_f32 v[58:59], v[58:59], v[34:35]
v_lshlrev_b32 v34, 16, v136
v_and_b32 v35, 0xffff0000, v136
v_pk_add_f32 v[60:61], v[60:61], v[34:35]
v_lshlrev_b32 v34, 16, v137
v_and_b32 v35, 0xffff0000, v137
v_pk_add_f32 v[62:63], v[62:63], v[34:35]
v_lshlrev_b32 v34, 16, v138
v_and_b32 v35, 0xffff0000, v138
v_pk_add_f32 v[64:65], v[64:65], v[34:35]
v_lshlrev_b32 v34, 16, v139
v_and_b32 v35, 0xffff0000, v139
v_pk_add_f32 v[66:67], v[66:67], v[34:35]
v_lshlrev_b32 v34, 16, v140
v_and_b32 v35, 0xffff0000, v140
v_pk_add_f32 v[68:69], v[68:69], v[34:35]
v_lshlrev_b32 v34, 16, v141
v_and_b32 v35, 0xffff0000, v141
v_pk_add_f32 v[70:71], v[70:71], v[34:35]
v_lshlrev_b32 v34, 16, v142
v_and_b32 v35, 0xffff0000, v142
v_pk_add_f32 v[72:73], v[72:73], v[34:35]
v_lshlrev_b32 v34, 16, v143
v_and_b32 v35, 0xffff0000, v143
v_pk_add_f32 v[74:75], v[74:75], v[34:35]
v_lshlrev_b32 v34, 16, v144
v_and_b32 v35, 0xffff0000, v144
v_pk_add_f32 v[76:77], v[76:77], v[34:35]
v_lshlrev_b32 v34, 16, v145
v_and_b32 v35, 0xffff0000, v145
v_pk_add_f32 v[78:79], v[78:79], v[34:35]
v_lshlrev_b32 v34, 16, v146
v_and_b32 v35, 0xffff0000, v146
v_pk_add_f32 v[80:81], v[80:81], v[34:35]
v_lshlrev_b32 v34, 16, v147
v_and_b32 v35, 0xffff0000, v147
v_pk_add_f32 v[82:83], v[82:83], v[34:35]
s_waitcnt vmcnt(4)
v_lshlrev_b32 v34, 16, v148
v_and_b32 v35, 0xffff0000, v148
v_pk_add_f32 v[52:53], v[52:53], v[34:35]
v_lshlrev_b32 v34, 16, v149
v_and_b32 v35, 0xffff0000, v149
v_pk_add_f32 v[54:55], v[54:55], v[34:35]
v_lshlrev_b32 v34, 16, v150
v_and_b32 v35, 0xffff0000, v150
v_pk_add_f32 v[56:57], v[56:57], v[34:35]
v_lshlrev_b32 v34, 16, v151
v_and_b32 v35, 0xffff0000, v151
v_pk_add_f32 v[58:59], v[58:59], v[34:35]
v_lshlrev_b32 v34, 16, v152
v_and_b32 v35, 0xffff0000, v152
v_pk_add_f32 v[60:61], v[60:61], v[34:35]
v_lshlrev_b32 v34, 16, v153
v_and_b32 v35, 0xffff0000, v153
v_pk_add_f32 v[62:63], v[62:63], v[34:35]
v_lshlrev_b32 v34, 16, v154
v_and_b32 v35, 0xffff0000, v154
v_pk_add_f32 v[64:65], v[64:65], v[34:35]
v_lshlrev_b32 v34, 16, v155
v_and_b32 v35, 0xffff0000, v155
v_pk_add_f32 v[66:67], v[66:67], v[34:35]
v_lshlrev_b32 v34, 16, v156
v_and_b32 v35, 0xffff0000, v156
v_pk_add_f32 v[68:69], v[68:69], v[34:35]
v_lshlrev_b32 v34, 16, v157
v_and_b32 v35, 0xffff0000, v157
v_pk_add_f32 v[70:71], v[70:71], v[34:35]
v_lshlrev_b32 v34, 16, v158
v_and_b32 v35, 0xffff0000, v158
v_pk_add_f32 v[72:73], v[72:73], v[34:35]
v_lshlrev_b32 v34, 16, v159
v_and_b32 v35, 0xffff0000, v159
v_pk_add_f32 v[74:75], v[74:75], v[34:35]
v_lshlrev_b32 v34, 16, v160
v_and_b32 v35, 0xffff0000, v160
v_pk_add_f32 v[76:77], v[76:77], v[34:35]
v_lshlrev_b32 v34, 16, v161
v_and_b32 v35, 0xffff0000, v161
v_pk_add_f32 v[78:79], v[78:79], v[34:35]
v_lshlrev_b32 v34, 16, v162
v_and_b32 v35, 0xffff0000, v162
v_pk_add_f32 v[80:81], v[80:81], v[34:35]
v_lshlrev_b32 v34, 16, v163
v_and_b32 v35, 0xffff0000, v163
v_pk_add_f32 v[82:83], v[82:83], v[34:35]
s_waitcnt vmcnt(0)
v_lshlrev_b32 v34, 16, v164
v_and_b32 v35, 0xffff0000, v164
v_pk_add_f32 v[52:53], v[52:53], v[34:35]
v_lshlrev_b32 v34, 16, v165
v_and_b32 v35, 0xffff0000, v165
v_pk_add_f32 v[54:55], v[54:55], v[34:35]
v_lshlrev_b32 v34, 16, v166
v_and_b32 v35, 0xffff0000, v166
v_pk_add_f32 v[56:57], v[56:57], v[34:35]
v_lshlrev_b32 v34, 16, v167
v_and_b32 v35, 0xffff0000, v167
v_pk_add_f32 v[58:59], v[58:59], v[34:35]
v_lshlrev_b32 v34, 16, v168
v_and_b32 v35, 0xffff0000, v168
v_pk_add_f32 v[60:61], v[60:61], v[34:35]
v_lshlrev_b32 v34, 16, v169
v_and_b32 v35, 0xffff0000, v169
v_pk_add_f32 v[62:63], v[62:63], v[34:35]
v_lshlrev_b32 v34, 16, v170
v_and_b32 v35, 0xffff0000, v170
v_pk_add_f32 v[64:65], v[64:65], v[34:35]
v_lshlrev_b32 v34, 16, v171
v_and_b32 v35, 0xffff0000, v171
v_pk_add_f32 v[66:67], v[66:67], v[34:35]
v_lshlrev_b32 v34, 16, v172
v_and_b32 v35, 0xffff0000, v172
v_pk_add_f32 v[68:69], v[68:69], v[34:35]
v_lshlrev_b32 v34, 16, v173
v_and_b32 v35, 0xffff0000, v173
v_pk_add_f32 v[70:71], v[70:71], v[34:35]
v_lshlrev_b32 v34, 16, v174
v_and_b32 v35, 0xffff0000, v174
v_pk_add_f32 v[72:73], v[72:73], v[34:35]
v_lshlrev_b32 v34, 16, v175
v_and_b32 v35, 0xffff0000, v175
v_pk_add_f32 v[74:75], v[74:75], v[34:35]
v_lshlrev_b32 v34, 16, v176
v_and_b32 v35, 0xffff0000, v176
v_pk_add_f32 v[76:77], v[76:77], v[34:35]
v_lshlrev_b32 v34, 16, v177
v_and_b32 v35, 0xffff0000, v177
v_pk_add_f32 v[78:79], v[78:79], v[34:35]
v_lshlrev_b32 v34, 16, v178
v_and_b32 v35, 0xffff0000, v178
v_pk_add_f32 v[80:81], v[80:81], v[34:35]
v_lshlrev_b32 v34, 16, v179
v_and_b32 v35, 0xffff0000, v179
v_pk_add_f32 v[82:83], v[82:83], v[34:35]
v_cvt_pk_bf16_f32 v36, v52, v53
v_cvt_pk_bf16_f32 v37, v54, v55
v_cvt_pk_bf16_f32 v38, v56, v57
v_cvt_pk_bf16_f32 v39, v58, v59
v_cvt_pk_bf16_f32 v40, v60, v61
v_cvt_pk_bf16_f32 v41, v62, v63
v_cvt_pk_bf16_f32 v42, v64, v65
v_cvt_pk_bf16_f32 v43, v66, v67
v_cvt_pk_bf16_f32 v44, v68, v69
v_cvt_pk_bf16_f32 v45, v70, v71
v_cvt_pk_bf16_f32 v46, v72, v73
v_cvt_pk_bf16_f32 v47, v74, v75
v_cvt_pk_bf16_f32 v48, v76, v77
v_cvt_pk_bf16_f32 v49, v78, v79
v_cvt_pk_bf16_f32 v50, v80, v81
v_cvt_pk_bf16_f32 v51, v82, v83
buffer_store_dwordx2 v[36:37], v32, s[16:19], s50 offen offset:0
buffer_store_dwordx2 v[38:39], v32, s[16:19], s50 offen offset:16
buffer_store_dwordx2 v[40:41], v32, s[16:19], s50 offen offset:32
buffer_store_dwordx2 v[42:43], v32, s[16:19], s50 offen offset:48
buffer_store_dwordx2 v[44:45], v32, s[16:19], s50 offen offset:64
buffer_store_dwordx2 v[46:47], v32, s[16:19], s50 offen offset:80
buffer_store_dwordx2 v[48:49], v32, s[16:19], s50 offen offset:96
buffer_store_dwordx2 v[50:51], v32, s[16:19], s50 offen offset:112
s_branch L_next
L_finb:
s_lshl_b32 s48, s61, 2
s_add_u32 s48, s48, s3
s_mul_i32 s48, s48, 1
s_lshl_b32 s49, s60, 16
s_lshl_b32 s50, s48, 10
s_add_u32 s49, s49, s50
s_add_u32 s49, s49, 100663296
v_and_b32 v32, 31, v0
v_bfe_u32 v33, v0, 5, 1
v_lshlrev_b32 v32, 11, v32
v_lshl_add_u32 v32, v33, 3, v32
s_lshl_b32 s50, s60, 16
s_lshl_b32 s51, s48, 5
s_add_u32 s50, s50, s51
buffer_load_dwordx2 v[36:37], v32, s[12:15], s50 offen offset:0
buffer_load_dwordx2 v[38:39], v32, s[12:15], s50 offen offset:16
buffer_load_dwordx4 v[48:51], v1, s[4:7], s49 offen offset:0 sc1
s_add_u32 s49, s49, 4194304
buffer_load_dwordx4 v[52:55], v1, s[4:7], s49 offen offset:0 sc1
s_add_u32 s49, s49, 4194304
buffer_load_dwordx4 v[56:59], v1, s[4:7], s49 offen offset:0 sc1
s_add_u32 s49, s49, 4194304
buffer_load_dwordx4 v[60:63], v1, s[4:7], s49 offen offset:0 sc1
s_add_u32 s49, s49, 4194304
buffer_load_dwordx4 v[64:67], v1, s[4:7], s49 offen offset:0 sc1
s_add_u32 s49, s49, 4194304
buffer_load_dwordx4 v[68:71], v1, s[4:7], s49 offen offset:0 sc1
s_add_u32 s49, s49, 4194304
buffer_load_dwordx4 v[72:75], v1, s[4:7], s49 offen offset:0 sc1
s_add_u32 s49, s49, 4194304
buffer_load_dwordx4 v[76:79], v1, s[4:7], s49 offen offset:0 sc1
s_add_u32 s49, s49, 4194304
buffer_load_dwordx4 v[80:83], v1, s[4:7], s49 offen offset:0 sc1
s_add_u32 s49, s49, 4194304
buffer_load_dwordx4 v[84:87], v1, s[4:7], s49 offen offset:0 sc1
s_add_u32 s49, s49, 4194304
s_mov_b32 s51, 0x3f800000
s_mov_b32 s52, 0x00003f80
s_waitcnt vmcnt(10)
v_lshlrev_b32 v40, 16, v36
v_and_b32 v41, 0xffff0000, v36
v_lshlrev_b32 v42, 16, v37
v_and_b32 v43, 0xffff0000, v37
v_lshlrev_b32 v44, 16, v38
v_and_b32 v45, 0xffff0000, v38
v_lshlrev_b32 v46, 16, v39
v_and_b32 v47, 0xffff0000, v39
s_waitcnt vmcnt(9)
v_lshlrev_b32 v34, 16, v48
v_and_b32 v35, 0xffff0000, v48
v_pk_add_f32 v[40:41], v[40:41], v[34:35]
v_lshlrev_b32 v34, 16, v49
v_and_b32 v35, 0xffff0000, v49
v_pk_add_f32 v[42:43], v[42:43], v[34:35]
v_lshlrev_b32 v34, 16, v50
v_and_b32 v35, 0xffff0000, v50
v_pk_add_f32 v[44:45], v[44:45], v[34:35]
v_lshlrev_b32 v34, 16, v51
v_and_b32 v35, 0xffff0000, v51
v_pk_add_f32 v[46:47], v[46:47], v[34:35]
s_waitcnt vmcnt(8)
v_lshlrev_b32 v34, 16, v52
v_and_b32 v35, 0xffff0000, v52
v_pk_add_f32 v[40:41], v[40:41], v[34:35]
v_lshlrev_b32 v34, 16, v53
v_and_b32 v35, 0xffff0000, v53
v_pk_add_f32 v[42:43], v[42:43], v[34:35]
v_lshlrev_b32 v34, 16, v54
v_and_b32 v35, 0xffff0000, v54
v_pk_add_f32 v[44:45], v[44:45], v[34:35]
v_lshlrev_b32 v34, 16, v55
v_and_b32 v35, 0xffff0000, v55
v_pk_add_f32 v[46:47], v[46:47], v[34:35]
s_waitcnt vmcnt(7)
v_lshlrev_b32 v34, 16, v56
v_and_b32 v35, 0xffff0000, v56
v_pk_add_f32 v[40:41], v[40:41], v[34:35]
v_lshlrev_b32 v34, 16, v57
v_and_b32 v35, 0xffff0000, v57
v_pk_add_f32 v[42:43], v[42:43], v[34:35]
v_lshlrev_b32 v34, 16, v58
v_and_b32 v35, 0xffff0000, v58
v_pk_add_f32 v[44:45], v[44:45], v[34:35]
v_lshlrev_b32 v34, 16, v59
v_and_b32 v35, 0xffff0000, v59
v_pk_add_f32 v[46:47], v[46:47], v[34:35]
s_waitcnt vmcnt(6)
v_lshlrev_b32 v34, 16, v60
v_and_b32 v35, 0xffff0000, v60
v_pk_add_f32 v[40:41], v[40:41], v[34:35]
v_lshlrev_b32 v34, 16, v61
v_and_b32 v35, 0xffff0000, v61
v_pk_add_f32 v[42:43], v[42:43], v[34:35]
v_lshlrev_b32 v34, 16, v62
v_and_b32 v35, 0xffff0000, v62
v_pk_add_f32 v[44:45], v[44:45], v[34:35]
v_lshlrev_b32 v34, 16, v63
v_and_b32 v35, 0xffff0000, v63
v_pk_add_f32 v[46:47], v[46:47], v[34:35]
s_waitcnt vmcnt(5)
v_lshlrev_b32 v34, 16, v64
v_and_b32 v35, 0xffff0000, v64
v_pk_add_f32 v[40:41], v[40:41], v[34:35]
v_lshlrev_b32 v34, 16, v65
v_and_b32 v35, 0xffff0000, v65
v_pk_add_f32 v[42:43], v[42:43], v[34:35]
v_lshlrev_b32 v34, 16, v66
v_and_b32 v35, 0xffff0000, v66
v_pk_add_f32 v[44:45], v[44:45], v[34:35]
v_lshlrev_b32 v34, 16, v67
v_and_b32 v35, 0xffff0000, v67
v_pk_add_f32 v[46:47], v[46:47], v[34:35]
s_waitcnt vmcnt(4)
v_lshlrev_b32 v34, 16, v68
v_and_b32 v35, 0xffff0000, v68
v_pk_add_f32 v[40:41], v[40:41], v[34:35]
v_lshlrev_b32 v34, 16, v69
v_and_b32 v35, 0xffff0000, v69
v_pk_add_f32 v[42:43], v[42:43], v[34:35]
v_lshlrev_b32 v34, 16, v70
v_and_b32 v35, 0xffff0000, v70
v_pk_add_f32 v[44:45], v[44:45], v[34:35]
v_lshlrev_b32 v34, 16, v71
v_and_b32 v35, 0xffff0000, v71
v_pk_add_f32 v[46:47], v[46:47], v[34:35]
s_waitcnt vmcnt(3)
v_lshlrev_b32 v34, 16, v72
v_and_b32 v35, 0xffff0000, v72
v_pk_add_f32 v[40:41], v[40:41], v[34:35]
v_lshlrev_b32 v34, 16, v73
v_and_b32 v35, 0xffff0000, v73
v_pk_add_f32 v[42:43], v[42:43], v[34:35]
v_lshlrev_b32 v34, 16, v74
v_and_b32 v35, 0xffff0000, v74
v_pk_add_f32 v[44:45], v[44:45], v[34:35]
v_lshlrev_b32 v34, 16, v75
v_and_b32 v35, 0xffff0000, v75
v_pk_add_f32 v[46:47], v[46:47], v[34:35]
s_waitcnt vmcnt(2)
v_lshlrev_b32 v34, 16, v76
v_and_b32 v35, 0xffff0000, v76
v_pk_add_f32 v[40:41], v[40:41], v[34:35]
v_lshlrev_b32 v34, 16, v77
v_and_b32 v35, 0xffff0000, v77
v_pk_add_f32 v[42:43], v[42:43], v[34:35]
v_lshlrev_b32 v34, 16, v78
v_and_b32 v35, 0xffff0000, v78
v_pk_add_f32 v[44:45], v[44:45], v[34:35]
v_lshlrev_b32 v34, 16, v79
v_and_b32 v35, 0xffff0000, v79
v_pk_add_f32 v[46:47], v[46:47], v[34:35]
s_waitcnt vmcnt(1)
v_lshlrev_b32 v34, 16, v80
v_and_b32 v35, 0xffff0000, v80
v_pk_add_f32 v[40:41], v[40:41], v[34:35]
v_lshlrev_b32 v34, 16, v81
v_and_b32 v35, 0xffff0000, v81
v_pk_add_f32 v[42:43], v[42:43], v[34:35]
v_lshlrev_b32 v34, 16, v82
v_and_b32 v35, 0xffff0000, v82
v_pk_add_f32 v[44:45], v[44:45], v[34:35]
v_lshlrev_b32 v34, 16, v83
v_and_b32 v35, 0xffff0000, v83
v_pk_add_f32 v[46:47], v[46:47], v[34:35]
s_waitcnt vmcnt(0)
v_lshlrev_b32 v34, 16, v84
v_and_b32 v35, 0xffff0000, v84
v_pk_add_f32 v[40:41], v[40:41], v[34:35]
v_lshlrev_b32 v34, 16, v85
v_and_b32 v35, 0xffff0000, v85
v_pk_add_f32 v[42:43], v[42:43], v[34:35]
v_lshlrev_b32 v34, 16, v86
v_and_b32 v35, 0xffff0000, v86
v_pk_add_f32 v[44:45], v[44:45], v[34:35]
v_lshlrev_b32 v34, 16, v87
v_and_b32 v35, 0xffff0000, v87
v_pk_add_f32 v[46:47], v[46:47], v[34:35]
v_cvt_pk_bf16_f32 v36, v40, v41
v_cvt_pk_bf16_f32 v37, v42, v43
v_cvt_pk_bf16_f32 v38, v44, v45
v_cvt_pk_bf16_f32 v39, v46, v47
buffer_store_dwordx2 v[36:37], v32, s[16:19], s50 offen offset:0
buffer_store_dwordx2 v[38:39], v32, s[16:19], s50 offen offset:16
s_branch L_next
L_finf:
s_lshl_b32 s48, s61, 2
s_add_u32 s48, s48, s3
s_mul_i32 s48, s48, 1
s_lshl_b32 s49, s60, 16
s_lshl_b32 s50, s48, 10
s_add_u32 s49, s49, s50
s_add_u32 s49, s49, 100663296
v_and_b32 v32, 31, v0
v_bfe_u32 v33, v0, 5, 1
v_lshlrev_b32 v32, 11, v32
v_lshl_add_u32 v32, v33, 3, v32
s_lshl_b32 s50, s60, 16
s_lshl_b32 s51, s48, 5
s_add_u32 s50, s50, s51
buffer_load_dwordx2 v[36:37], v32, s[12:15], s50 offen offset:0
buffer_load_dwordx2 v[38:39], v32, s[12:15], s50 offen offset:16
buffer_load_dwordx4 v[48:51], v1, s[4:7], s49 offen offset:0 sc1
s_add_u32 s49, s49, 4194304
buffer_load_dwordx4 v[52:55], v1, s[4:7], s49 offen offset:0 sc1
s_add_u32 s49, s49, 4194304
buffer_load_dwordx4 v[56:59], v1, s[4:7], s49 offen offset:0 sc1
s_add_u32 s49, s49, 4194304
buffer_load_dwordx4 v[60:63], v1, s[4:7], s49 offen offset:0 sc1
s_add_u32 s49, s49, 4194304
buffer_load_dwordx4 v[64:67], v1, s[4:7], s49 offen offset:0 sc1
s_add_u32 s49, s49, 4194304
buffer_load_dwordx4 v[68:71], v1, s[4:7], s49 offen offset:0 sc1
s_add_u32 s49, s49, 4194304
s_mov_b32 s51, 0x3f800000
s_mov_b32 s52, 0x00003f80
s_waitcnt vmcnt(6)
v_lshlrev_b32 v40, 16, v36
v_and_b32 v41, 0xffff0000, v36
v_lshlrev_b32 v42, 16, v37
v_and_b32 v43, 0xffff0000, v37
v_lshlrev_b32 v44, 16, v38
v_and_b32 v45, 0xffff0000, v38
v_lshlrev_b32 v46, 16, v39
v_and_b32 v47, 0xffff0000, v39
s_waitcnt vmcnt(5)
v_lshlrev_b32 v34, 16, v48
v_and_b32 v35, 0xffff0000, v48
v_pk_add_f32 v[40:41], v[40:41], v[34:35]
v_lshlrev_b32 v34, 16, v49
v_and_b32 v35, 0xffff0000, v49
v_pk_add_f32 v[42:43], v[42:43], v[34:35]
v_lshlrev_b32 v34, 16, v50
v_and_b32 v35, 0xffff0000, v50
v_pk_add_f32 v[44:45], v[44:45], v[34:35]
v_lshlrev_b32 v34, 16, v51
v_and_b32 v35, 0xffff0000, v51
v_pk_add_f32 v[46:47], v[46:47], v[34:35]
s_waitcnt vmcnt(4)
v_lshlrev_b32 v34, 16, v52
v_and_b32 v35, 0xffff0000, v52
v_pk_add_f32 v[40:41], v[40:41], v[34:35]
v_lshlrev_b32 v34, 16, v53
v_and_b32 v35, 0xffff0000, v53
v_pk_add_f32 v[42:43], v[42:43], v[34:35]
v_lshlrev_b32 v34, 16, v54
v_and_b32 v35, 0xffff0000, v54
v_pk_add_f32 v[44:45], v[44:45], v[34:35]
v_lshlrev_b32 v34, 16, v55
v_and_b32 v35, 0xffff0000, v55
v_pk_add_f32 v[46:47], v[46:47], v[34:35]
s_waitcnt vmcnt(3)
v_lshlrev_b32 v34, 16, v56
v_and_b32 v35, 0xffff0000, v56
v_pk_add_f32 v[40:41], v[40:41], v[34:35]
v_lshlrev_b32 v34, 16, v57
v_and_b32 v35, 0xffff0000, v57
v_pk_add_f32 v[42:43], v[42:43], v[34:35]
v_lshlrev_b32 v34, 16, v58
v_and_b32 v35, 0xffff0000, v58
v_pk_add_f32 v[44:45], v[44:45], v[34:35]
v_lshlrev_b32 v34, 16, v59
v_and_b32 v35, 0xffff0000, v59
v_pk_add_f32 v[46:47], v[46:47], v[34:35]
s_waitcnt vmcnt(2)
v_lshlrev_b32 v34, 16, v60
v_and_b32 v35, 0xffff0000, v60
v_pk_add_f32 v[40:41], v[40:41], v[34:35]
v_lshlrev_b32 v34, 16, v61
v_and_b32 v35, 0xffff0000, v61
v_pk_add_f32 v[42:43], v[42:43], v[34:35]
v_lshlrev_b32 v34, 16, v62
v_and_b32 v35, 0xffff0000, v62
v_pk_add_f32 v[44:45], v[44:45], v[34:35]
v_lshlrev_b32 v34, 16, v63
v_and_b32 v35, 0xffff0000, v63
v_pk_add_f32 v[46:47], v[46:47], v[34:35]
s_waitcnt vmcnt(1)
v_lshlrev_b32 v34, 16, v64
v_and_b32 v35, 0xffff0000, v64
v_pk_add_f32 v[40:41], v[40:41], v[34:35]
v_lshlrev_b32 v34, 16, v65
v_and_b32 v35, 0xffff0000, v65
v_pk_add_f32 v[42:43], v[42:43], v[34:35]
v_lshlrev_b32 v34, 16, v66
v_and_b32 v35, 0xffff0000, v66
v_pk_add_f32 v[44:45], v[44:45], v[34:35]
v_lshlrev_b32 v34, 16, v67
v_and_b32 v35, 0xffff0000, v67
v_pk_add_f32 v[46:47], v[46:47], v[34:35]
s_waitcnt vmcnt(0)
v_lshlrev_b32 v34, 16, v68
v_and_b32 v35, 0xffff0000, v68
v_pk_add_f32 v[40:41], v[40:41], v[34:35]
v_lshlrev_b32 v34, 16, v69
v_and_b32 v35, 0xffff0000, v69
v_pk_add_f32 v[42:43], v[42:43], v[34:35]
v_lshlrev_b32 v34, 16, v70
v_and_b32 v35, 0xffff0000, v70
v_pk_add_f32 v[44:45], v[44:45], v[34:35]
v_lshlrev_b32 v34, 16, v71
v_and_b32 v35, 0xffff0000, v71
v_pk_add_f32 v[46:47], v[46:47], v[34:35]
v_cvt_pk_bf16_f32 v36, v40, v41
v_cvt_pk_bf16_f32 v37, v42, v43
v_cvt_pk_bf16_f32 v38, v44, v45
v_cvt_pk_bf16_f32 v39, v46, v47
buffer_store_dwordx2 v[36:37], v32, s[16:19], s50 offen offset:0
buffer_store_dwordx2 v[38:39], v32, s[16:19], s50 offen offset:16
s_branch L_next
L_sig:
s_waitcnt vmcnt(0)
s_barrier
s_cmp_lg_u32 s3, 0
s_cbranch_scc1 L_next
s_lshl_b32 s94, s70, 8
s_add_u32 s94, s94, 98566144
v_mov_b32 v29, 0
v_mov_b32 v30, 1
s_mov_b64 exec, 1
buffer_atomic_add v30, v29, s[4:7], s94 offen sc1
s_mov_b64 exec, -1
s_branch L_next
L_fail:
v_mov_b32 v16, 0
v_mov_b32 v17, s2
v_add_u32 v17, 0x1000, v17
global_store_dword v16, v17, s[44:45] offset:44
L_done:
L_end:
s_endpgm
.p2align 6
.type L_table,@object
L_table:
.long 0x600364, 0x282e, 0xff, 0x8, 0x0, 0x0, 0x0, 0x0, 0x0, 0x0, 0x0, 0x0, 0x0, 0x0, 0x0, 0x0
.long 0x0, 0x0, 0x0, 0x0, 0x0, 0x0, 0x0, 0x0, 0x0, 0x0, 0x0, 0x0, 0x0, 0x0, 0x0, 0x0
.long 0x0, 0x0, 0x0, 0x0, 0x0, 0x0, 0x0, 0x0, 0x0, 0x0, 0x0, 0x0, 0x0, 0x0, 0x0, 0x0
.long 0x0, 0x0, 0x0, 0x0, 0x0, 0x0, 0x0, 0x0
.long 0x601364, 0x282e, 0xff, 0x8, 0x0, 0x0, 0x0, 0x0, 0x0, 0x0, 0x0, 0x0, 0x0, 0x0, 0x0, 0x0
.long 0x0, 0x0, 0x0, 0x0, 0x0, 0x0, 0x0, 0x0, 0x0, 0x0, 0x0, 0x0, 0x0, 0x0, 0x0, 0x0
.long 0x0, 0x0, 0x0, 0x0, 0x0, 0x0, 0x0, 0x0, 0x0, 0x0, 0x0, 0x0, 0x0, 0x0, 0x0, 0x0
.long 0x0, 0x0, 0x0, 0x0, 0x0, 0x0, 0x0, 0x0
.long 0x602364, 0x282e, 0xff, 0x8, 0x0, 0x0, 0x0, 0x0, 0x0, 0x0, 0x0, 0x0, 0x0, 0x0, 0x0, 0x0
.long 0x0, 0x0, 0x0, 0x0, 0x0, 0x0, 0x0, 0x0, 0x0, 0x0, 0x0, 0x0, 0x0, 0x0, 0x0, 0x0
.long 0x0, 0x0, 0x0, 0x0, 0x0, 0x0, 0x0, 0x0, 0x0, 0x0, 0x0, 0x0, 0x0, 0x0, 0x0, 0x0
.long 0x0, 0x0, 0x0, 0x0, 0x0, 0x0, 0x0, 0x0
.long 0x603364, 0x282e, 0xff, 0x8, 0x0, 0x0, 0x0, 0x0, 0x0, 0x0, 0x0, 0x0, 0x0, 0x0, 0x0, 0x0
.long 0x0, 0x0, 0x0, 0x0, 0x0, 0x0, 0x0, 0x0, 0x0, 0x0, 0x0, 0x0, 0x0, 0x0, 0x0, 0x0
.long 0x0, 0x0, 0x0, 0x0, 0x0, 0x0, 0x0, 0x0, 0x0, 0x0, 0x0, 0x0, 0x0, 0x0, 0x0, 0x0
.long 0x0, 0x0, 0x0, 0x0, 0x0, 0x0, 0x0, 0x0
.long 0x200001, 0x1000, 0x8, 0x6, 0x31, 0x1003, 0xb, 0x39, 0x48021, 0x1002, 0x1a, 0x5, 0x3c071, 0x1007, 0x1f, 0x5
.long 0x20061, 0x1006, 0x16, 0x9, 0x400283, 0x2c301015, 0x25, 0x8, 0x8202012, 0x821, 0x29, 0x8, 0x1003c3, 0x10a01017, 0x6c, 0x88
.long 0xc204072, 0x2027, 0x3c, 0x4, 0x6001c4, 0x182b, 0xff, 0x8, 0x0, 0x0, 0x0, 0x0, 0x0, 0x0, 0x0, 0x0
.long 0x0, 0x0, 0x0, 0x0, 0x0, 0x0, 0x0, 0x0
.long 0x201001, 0x1000, 0x8, 0x6, 0x1031, 0x1003, 0xb, 0x39, 0x49021, 0x1002, 0x1a, 0x5, 0x3d071, 0x1007, 0x1f, 0x5
.long 0x21061, 0x1006, 0x16, 0x9, 0x401283, 0x2c301015, 0x25, 0x8, 0x8302012, 0x821, 0x29, 0x8, 0x1013c3, 0x10a11017, 0x6c, 0x88
.long 0xc304072, 0x2027, 0x3c, 0x4, 0x6011c4, 0x182b, 0xff, 0x8, 0x0, 0x0, 0x0, 0x0, 0x0, 0x0, 0x0, 0x0
.long 0x0, 0x0, 0x0, 0x0, 0x0, 0x0, 0x0, 0x0
.long 0x202001, 0x1000, 0x8, 0x6, 0x2031, 0x1003, 0xb, 0x39, 0x4a021, 0x1002, 0x1a, 0x5, 0x3e071, 0x1007, 0x1f, 0x5
.long 0x22061, 0x1006, 0x16, 0x9, 0x402283, 0x2c301015, 0x25, 0x8, 0x8402012, 0x821, 0x29, 0x8, 0x1023c3, 0x10a21017, 0x6c, 0x88
.long 0xc404072, 0x2027, 0x3c, 0x4, 0x6021c4, 0x182b, 0xff, 0x8, 0x0, 0x0, 0x0, 0x0, 0x0, 0x0, 0x0, 0x0
.long 0x0, 0x0, 0x0, 0x0, 0x0, 0x0, 0x0, 0x0
.long 0x203001, 0x1000, 0x8, 0x6, 0x3031, 0x1003, 0xb, 0x39, 0x4b021, 0x1002, 0x1a, 0x5, 0x3f071, 0x1007, 0x1f, 0x5
.long 0x23061, 0x1006, 0x16, 0x9, 0x403283, 0x2c301015, 0x25, 0x8, 0x8502012, 0x821, 0x29, 0x8, 0x1033c3, 0x10a31017, 0x6c, 0x88
.long 0xc504072, 0x2027, 0x3c, 0x4, 0x6031c4, 0x182b, 0xff, 0x8, 0x0, 0x0, 0x0, 0x0, 0x0, 0x0, 0x0, 0x0
.long 0x0, 0x0, 0x0, 0x0, 0x0, 0x0, 0x0, 0x0
.long 0x600374, 0x282e, 0xff, 0x8, 0x0, 0x0, 0x0, 0x0, 0x0, 0x0, 0x0, 0x0, 0x0, 0x0, 0x0, 0x0
.long 0x0, 0x0, 0x0, 0x0, 0x0, 0x0, 0x0, 0x0, 0x0, 0x0, 0x0, 0x0, 0x0, 0x0, 0x0, 0x0
.long 0x0, 0x0, 0x0, 0x0, 0x0, 0x0, 0x0, 0x0, 0x0, 0x0, 0x0, 0x0, 0x0, 0x0, 0x0, 0x0
.long 0x0, 0x0, 0x0, 0x0, 0x0, 0x0, 0x0, 0x0
.long 0x601374, 0x282e, 0xff, 0x8, 0x0, 0x0, 0x0, 0x0, 0x0, 0x0, 0x0, 0x0, 0x0, 0x0, 0x0, 0x0
.long 0x0, 0x0, 0x0, 0x0, 0x0, 0x0, 0x0, 0x0, 0x0, 0x0, 0x0, 0x0, 0x0, 0x0, 0x0, 0x0
.long 0x0, 0x0, 0x0, 0x0, 0x0, 0x0, 0x0, 0x0, 0x0, 0x0, 0x0, 0x0, 0x0, 0x0, 0x0, 0x0
.long 0x0, 0x0, 0x0, 0x0, 0x0, 0x0, 0x0, 0x0
.long 0x602374, 0x282e, 0xff, 0x8, 0x0, 0x0, 0x0, 0x0, 0x0, 0x0, 0x0, 0x0, 0x0, 0x0, 0x0, 0x0
.long 0x0, 0x0, 0x0, 0x0, 0x0, 0x0, 0x0, 0x0, 0x0, 0x0, 0x0, 0x0, 0x0, 0x0, 0x0, 0x0
.long 0x0, 0x0, 0x0, 0x0, 0x0, 0x0, 0x0, 0x0, 0x0, 0x0, 0x0, 0x0, 0x0, 0x0, 0x0, 0x0
.long 0x0, 0x0, 0x0, 0x0, 0x0, 0x0, 0x0, 0x0
.long 0x603374, 0x282e, 0xff, 0x8, 0x0, 0x0, 0x0, 0x0, 0x0, 0x0, 0x0, 0x0, 0x0, 0x0, 0x0, 0x0
.long 0x0, 0x0, 0x0, 0x0, 0x0, 0x0, 0x0, 0x0, 0x0, 0x0, 0x0, 0x0, 0x0, 0x0, 0x0, 0x0
.long 0x0, 0x0, 0x0, 0x0, 0x0, 0x0, 0x0, 0x0, 0x0, 0x0, 0x0, 0x0, 0x0, 0x0, 0x0, 0x0
.long 0x0, 0x0, 0x0, 0x0, 0x0, 0x0, 0x0, 0x0
.long 0x204001, 0x1000, 0x8, 0x6, 0x4031, 0x1003, 0xb, 0x39, 0x30031, 0x1003, 0x1b, 0x5, 0x40071, 0x1007, 0x1f, 0x5
.long 0x24061, 0x1006, 0x16, 0x9, 0x404283, 0x2c301015, 0x25, 0x8, 0x8203012, 0x821, 0x29, 0x8, 0x1043c3, 0x10a41017, 0x6c, 0x88
.long 0xc205072, 0x2027, 0x3c, 0x4, 0x6001d4, 0x182b, 0xff, 0x8, 0x0, 0x0, 0x0, 0x0, 0x0, 0x0, 0x0, 0x0
.long 0x0, 0x0, 0x0, 0x0, 0x0, 0x0, 0x0, 0x0
.long 0x205001, 0x1000, 0x8, 0x6, 0x5031, 0x1003, 0xb, 0x39, 0x31031, 0x1003, 0x1b, 0x5, 0x41071, 0x1007, 0x1f, 0x5
.long 0x25061, 0x1006, 0x16, 0x9, 0x405283, 0x2c301015, 0x25, 0x8, 0x8303012, 0x821, 0x29, 0x8, 0x1053c3, 0x10a51017, 0x6c, 0x88
.long 0xc305072, 0x2027, 0x3c, 0x4, 0x6011d4, 0x182b, 0xff, 0x8, 0x0, 0x0, 0x0, 0x0, 0x0, 0x0, 0x0, 0x0
.long 0x0, 0x0, 0x0, 0x0, 0x0, 0x0, 0x0, 0x0
.long 0x206001, 0x1000, 0x8, 0x6, 0x6031, 0x1003, 0xb, 0x39, 0x32031, 0x1003, 0x1b, 0x5, 0x42071, 0x1007, 0x1f, 0x5
.long 0x26061, 0x1006, 0x16, 0x9, 0x406283, 0x2c301015, 0x25, 0x8, 0x8403012, 0x821, 0x29, 0x8, 0x1063c3, 0x10a61017, 0x6c, 0x88
.long 0xc405072, 0x2027, 0x3c, 0x4, 0x6021d4, 0x182b, 0xff, 0x8, 0x0, 0x0, 0x0, 0x0, 0x0, 0x0, 0x0, 0x0
.long 0x0, 0x0, 0x0, 0x0, 0x0, 0x0, 0x0, 0x0
.long 0x207001, 0x1000, 0x8, 0x6, 0x7031, 0x1003, 0xb, 0x39, 0x33031, 0x1003, 0x1b, 0x5, 0x43071, 0x1007, 0x1f, 0x5
.long 0x27061, 0x1006, 0x16, 0x9, 0x407283, 0x2c301015, 0x25, 0x8, 0x8503012, 0x821, 0x29, 0x8, 0x1073c3, 0x10a71017, 0x6c, 0x88
.long 0xc505072, 0x2027, 0x3c, 0x4, 0x6031d4, 0x182b, 0xff, 0x8, 0x0, 0x0, 0x0, 0x0, 0x0, 0x0, 0x0, 0x0
.long 0x0, 0x0, 0x0, 0x0, 0x0, 0x0, 0x0, 0x0
.long 0x40003c4, 0x82f0870, 0xff, 0x8, 0x0, 0x0, 0x0, 0x0, 0x0, 0x0, 0x0, 0x0, 0x0, 0x0, 0x0, 0x0
.long 0x0, 0x0, 0x0, 0x0, 0x0, 0x0, 0x0, 0x0, 0x0, 0x0, 0x0, 0x0, 0x0, 0x0, 0x0, 0x0
.long 0x0, 0x0, 0x0, 0x0, 0x0, 0x0, 0x0, 0x0, 0x0, 0x0, 0x0, 0x0, 0x0, 0x0, 0x0, 0x0
.long 0x0, 0x0, 0x0, 0x0, 0x0, 0x0, 0x0, 0x0
.long 0x40013c4, 0x82f0871, 0xff, 0x8, 0x0, 0x0, 0x0, 0x0, 0x0, 0x0, 0x0, 0x0, 0x0, 0x0, 0x0, 0x0
.long 0x0, 0x0, 0x0, 0x0, 0x0, 0x0, 0x0, 0x0, 0x0, 0x0, 0x0, 0x0, 0x0, 0x0, 0x0, 0x0
.long 0x0, 0x0, 0x0, 0x0, 0x0, 0x0, 0x0, 0x0, 0x0, 0x0, 0x0, 0x0, 0x0, 0x0, 0x0, 0x0
.long 0x0, 0x0, 0x0, 0x0, 0x0, 0x0, 0x0, 0x0
.long 0x40023c4, 0x82f0872, 0xff, 0x8, 0x0, 0x0, 0x0, 0x0, 0x0, 0x0, 0x0, 0x0, 0x0, 0x0, 0x0, 0x0
.long 0x0, 0x0, 0x0, 0x0, 0x0, 0x0, 0x0, 0x0, 0x0, 0x0, 0x0, 0x0, 0x0, 0x0, 0x0, 0x0
.long 0x0, 0x0, 0x0, 0x0, 0x0, 0x0, 0x0, 0x0, 0x0, 0x0, 0x0, 0x0, 0x0, 0x0, 0x0, 0x0
.long 0x0, 0x0, 0x0, 0x0, 0x0, 0x0, 0x0, 0x0
.long 0x40033c4, 0x82f0873, 0xff, 0x8, 0x0, 0x0, 0x0, 0x0, 0x0, 0x0, 0x0, 0x0, 0x0, 0x0, 0x0, 0x0
.long 0x0, 0x0, 0x0, 0x0, 0x0, 0x0, 0x0, 0x0, 0x0, 0x0, 0x0, 0x0, 0x0, 0x0, 0x0, 0x0
.long 0x0, 0x0, 0x0, 0x0, 0x0, 0x0, 0x0, 0x0, 0x0, 0x0, 0x0, 0x0, 0x0, 0x0, 0x0, 0x0
.long 0x0, 0x0, 0x0, 0x0, 0x0, 0x0, 0x0, 0x0
.long 0x208001, 0x1000, 0x8, 0x6, 0x8031, 0x1003, 0xb, 0x39, 0x34031, 0x1003, 0x1b, 0x5, 0x44071, 0x1007, 0x1f, 0x5
.long 0x28061, 0x1006, 0x16, 0x9, 0x8202002, 0x820, 0x28, 0x9, 0x100363, 0x37301016, 0x26, 0x88, 0x100393, 0x10881017, 0x27, 0x88
.long 0x820a062, 0x2826, 0x2e, 0x4, 0x6001a4, 0x182b, 0xff, 0x8, 0x0, 0x0, 0x0, 0x0, 0x0, 0x0, 0x0, 0x0
.long 0x0, 0x0, 0x0, 0x0, 0x0, 0x0, 0x0, 0x0
.long 0x209001, 0x1000, 0x8, 0x6, 0x9031, 0x1003, 0xb, 0x39, 0x35031, 0x1003, 0x1b, 0x5, 0x45071, 0x1007, 0x1f, 0x5
.long 0x29061, 0x1006, 0x16, 0x9, 0x8302002, 0x820, 0x28, 0x9, 0x101363, 0x37301016, 0x26, 0x88, 0x101393, 0x10891017, 0x27, 0x88
.long 0x830a062, 0x2826, 0x2e, 0x4, 0x6011a4, 0x182b, 0xff, 0x8, 0x0, 0x0, 0x0, 0x0, 0x0, 0x0, 0x0, 0x0
.long 0x0, 0x0, 0x0, 0x0, 0x0, 0x0, 0x0, 0x0
.long 0x20a001, 0x1000, 0x8, 0x6, 0xa031, 0x1003, 0xb, 0x39, 0x36031, 0x1003, 0x1b, 0x5, 0x46071, 0x1007, 0x1f, 0x5
.long 0x2a061, 0x1006, 0x16, 0x9, 0x8402002, 0x820, 0x28, 0x9, 0x102363, 0x37301016, 0x26, 0x88, 0x102393, 0x108a1017, 0x27, 0x88
.long 0x840a062, 0x2826, 0x2e, 0x4, 0x6021a4, 0x182b, 0xff, 0x8, 0x0, 0x0, 0x0, 0x0, 0x0, 0x0, 0x0, 0x0
.long 0x0, 0x0, 0x0, 0x0, 0x0, 0x0, 0x0, 0x0
.long 0x20b001, 0x1000, 0x8, 0x6, 0xb031, 0x1003, 0xb, 0x39, 0x37031, 0x1003, 0x1b, 0x5, 0x47071, 0x1007, 0x1f, 0x5
.long 0x2b061, 0x1006, 0x16, 0x9, 0x8502002, 0x820, 0x28, 0x9, 0x103363, 0x37301016, 0x26, 0x88, 0x103393, 0x108b1017, 0x27, 0x88
.long 0x850a062, 0x2826, 0x2e, 0x4, 0x6031a4, 0x182b, 0xff, 0x8, 0x0, 0x0, 0x0, 0x0, 0x0, 0x0, 0x0, 0x0
.long 0x0, 0x0, 0x0, 0x0, 0x0, 0x0, 0x0, 0x0
.long 0x40043c4, 0x82f0874, 0xff, 0x8, 0x0, 0x0, 0x0, 0x0, 0x0, 0x0, 0x0, 0x0, 0x0, 0x0, 0x0, 0x0
.long 0x0, 0x0, 0x0, 0x0, 0x0, 0x0, 0x0, 0x0, 0x0, 0x0, 0x0, 0x0, 0x0, 0x0, 0x0, 0x0
.long 0x0, 0x0, 0x0, 0x0, 0x0, 0x0, 0x0, 0x0, 0x0, 0x0, 0x0, 0x0, 0x0, 0x0, 0x0, 0x0
.long 0x0, 0x0, 0x0, 0x0, 0x0, 0x0, 0x0, 0x0
.long 0x40053c4, 0x82f0875, 0xff, 0x8, 0x0, 0x0, 0x0, 0x0, 0x0, 0x0, 0x0, 0x0, 0x0, 0x0, 0x0, 0x0
.long 0x0, 0x0, 0x0, 0x0, 0x0, 0x0, 0x0, 0x0, 0x0, 0x0, 0x0, 0x0, 0x0, 0x0, 0x0, 0x0
.long 0x0, 0x0, 0x0, 0x0, 0x0, 0x0, 0x0, 0x0, 0x0, 0x0, 0x0, 0x0, 0x0, 0x0, 0x0, 0x0
.long 0x0, 0x0, 0x0, 0x0, 0x0, 0x0, 0x0, 0x0
.long 0x40063c4, 0x82f0876, 0xff, 0x8, 0x0, 0x0, 0x0, 0x0, 0x0, 0x0, 0x0, 0x0, 0x0, 0x0, 0x0, 0x0
.long 0x0, 0x0, 0x0, 0x0, 0x0, 0x0, 0x0, 0x0, 0x0, 0x0, 0x0, 0x0, 0x0, 0x0, 0x0, 0x0
.long 0x0, 0x0, 0x0, 0x0, 0x0, 0x0, 0x0, 0x0, 0x0, 0x0, 0x0, 0x0, 0x0, 0x0, 0x0, 0x0
.long 0x0, 0x0, 0x0, 0x0, 0x0, 0x0, 0x0, 0x0
.long 0x40073c4, 0x82f0877, 0xff, 0x8, 0x0, 0x0, 0x0, 0x0, 0x0, 0x0, 0x0, 0x0, 0x0, 0x0, 0x0, 0x0
.long 0x0, 0x0, 0x0, 0x0, 0x0, 0x0, 0x0, 0x0, 0x0, 0x0, 0x0, 0x0, 0x0, 0x0, 0x0, 0x0
.long 0x0, 0x0, 0x0, 0x0, 0x0, 0x0, 0x0, 0x0, 0x0, 0x0, 0x0, 0x0, 0x0, 0x0, 0x0, 0x0
.long 0x0, 0x0, 0x0, 0x0, 0x0, 0x0, 0x0, 0x0
.long 0x20c001, 0x1000, 0x8, 0x6, 0xc031, 0x1003, 0xb, 0x39, 0x38031, 0x1003, 0x1b, 0x5, 0x48071, 0x1007, 0x1f, 0x5
.long 0x2c061, 0x1006, 0x16, 0x9, 0x8203002, 0x820, 0x28, 0x9, 0x104363, 0x37301016, 0x26, 0x88, 0x104393, 0x108c1017, 0x27, 0x88
.long 0x820b062, 0x2826, 0x2e, 0x4, 0x6001b4, 0x182b, 0xff, 0x8, 0x0, 0x0, 0x0, 0x0, 0x0, 0x0, 0x0, 0x0
.long 0x0, 0x0, 0x0, 0x0, 0x0, 0x0, 0x0, 0x0
.long 0x20d001, 0x1000, 0x8, 0x6, 0xd031, 0x1003, 0xb, 0x39, 0x39031, 0x1003, 0x1b, 0x5, 0x49071, 0x1007, 0x1f, 0x5
.long 0x2d061, 0x1006, 0x16, 0x9, 0x8303002, 0x820, 0x28, 0x9, 0x105363, 0x37301016, 0x26, 0x88, 0x105393, 0x108d1017, 0x27, 0x88
.long 0x830b062, 0x2826, 0x2e, 0x4, 0x6011b4, 0x182b, 0xff, 0x8, 0x0, 0x0, 0x0, 0x0, 0x0, 0x0, 0x0, 0x0
.long 0x0, 0x0, 0x0, 0x0, 0x0, 0x0, 0x0, 0x0
.long 0x20e001, 0x1000, 0x8, 0x6, 0xe031, 0x1003, 0xb, 0x39, 0x3a031, 0x1003, 0x1b, 0x5, 0x4a071, 0x1007, 0x1f, 0x5
.long 0x2e061, 0x1006, 0x16, 0x9, 0x8403002, 0x820, 0x28, 0x9, 0x106363, 0x37301016, 0x26, 0x88, 0x106393, 0x108e1017, 0x27, 0x88
.long 0x840b062, 0x2826, 0x2e, 0x4, 0x6021b4, 0x182b, 0xff, 0x8, 0x0, 0x0, 0x0, 0x0, 0x0, 0x0, 0x0, 0x0
.long 0x0, 0x0, 0x0, 0x0, 0x0, 0x0, 0x0, 0x0
.long 0x20f001, 0x1000, 0x8, 0x6, 0xf031, 0x1003, 0xb, 0x39, 0x3b031, 0x1003, 0x1b, 0x5, 0x4b071, 0x1007, 0x1f, 0x5
.long 0x2f061, 0x1006, 0x16, 0x9, 0x8503002, 0x820, 0x28, 0x9, 0x107363, 0x37301016, 0x26, 0x88, 0x107393, 0x108f1017, 0x27, 0x88
.long 0x850b062, 0x2826, 0x2e, 0x4, 0x6031b4, 0x182b, 0xff, 0x8, 0x0, 0x0, 0x0, 0x0, 0x0, 0x0, 0x0, 0x0
.long 0x0, 0x0, 0x0, 0x0, 0x0, 0x0, 0x0, 0x0
.long 0x40083c4, 0x82f0878, 0xff, 0x8, 0x0, 0x0, 0x0, 0x0, 0x0, 0x0, 0x0, 0x0, 0x0, 0x0, 0x0, 0x0
.long 0x0, 0x0, 0x0, 0x0, 0x0, 0x0, 0x0, 0x0, 0x0, 0x0, 0x0, 0x0, 0x0, 0x0, 0x0, 0x0
.long 0x0, 0x0, 0x0, 0x0, 0x0, 0x0, 0x0, 0x0, 0x0, 0x0, 0x0, 0x0, 0x0, 0x0, 0x0, 0x0
.long 0x0, 0x0, 0x0, 0x0, 0x0, 0x0, 0x0, 0x0
.long 0x40093c4, 0x82f0879, 0xff, 0x8, 0x0, 0x0, 0x0, 0x0, 0x0, 0x0, 0x0, 0x0, 0x0, 0x0, 0x0, 0x0
.long 0x0, 0x0, 0x0, 0x0, 0x0, 0x0, 0x0, 0x0, 0x0, 0x0, 0x0, 0x0, 0x0, 0x0, 0x0, 0x0
.long 0x0, 0x0, 0x0, 0x0, 0x0, 0x0, 0x0, 0x0, 0x0, 0x0, 0x0, 0x0, 0x0, 0x0, 0x0, 0x0
.long 0x0, 0x0, 0x0, 0x0, 0x0, 0x0, 0x0, 0x0
.long 0x400a3c4, 0x82f087a, 0xff, 0x8, 0x0, 0x0, 0x0, 0x0, 0x0, 0x0, 0x0, 0x0, 0x0, 0x0, 0x0, 0x0
.long 0x0, 0x0, 0x0, 0x0, 0x0, 0x0, 0x0, 0x0, 0x0, 0x0, 0x0, 0x0, 0x0, 0x0, 0x0, 0x0
.long 0x0, 0x0, 0x0, 0x0, 0x0, 0x0, 0x0, 0x0, 0x0, 0x0, 0x0, 0x0, 0x0, 0x0, 0x0, 0x0
.long 0x0, 0x0, 0x0, 0x0, 0x0, 0x0, 0x0, 0x0
.long 0x400b3c4, 0x82f087b, 0xff, 0x8, 0x0, 0x0, 0x0, 0x0, 0x0, 0x0, 0x0, 0x0, 0x0, 0x0, 0x0, 0x0
.long 0x0, 0x0, 0x0, 0x0, 0x0, 0x0, 0x0, 0x0, 0x0, 0x0, 0x0, 0x0, 0x0, 0x0, 0x0, 0x0
.long 0x0, 0x0, 0x0, 0x0, 0x0, 0x0, 0x0, 0x0, 0x0, 0x0, 0x0, 0x0, 0x0, 0x0, 0x0, 0x0
.long 0x0, 0x0, 0x0, 0x0, 0x0, 0x0, 0x0, 0x0
.long 0x210001, 0x1000, 0x8, 0x6, 0x10031, 0x1003, 0xb, 0x9, 0x10061, 0x1006, 0xe, 0x9, 0x30041, 0x1004, 0x1c, 0x5
.long 0x10071, 0x1007, 0xf, 0x9, 0x62, 0x1c1e, 0x2e, 0x9, 0x600024, 0x1828, 0xff, 0x8, 0x600064, 0x1828, 0xff, 0x8
.long 0x600084, 0x1829, 0xff, 0x8, 0x1003e3, 0x10b01017, 0x6e, 0x88, 0x6000c4, 0x1829, 0xff, 0x8, 0x6001e4, 0x182b, 0xff, 0x8
.long 0x0, 0x0, 0x0, 0x0, 0x0, 0x0, 0x0, 0x0
.long 0x211001, 0x1000, 0x8, 0x6, 0x11031, 0x1003, 0xb, 0x9, 0x11061, 0x1006, 0xe, 0x9, 0x31041, 0x1004, 0x1c, 0x5
.long 0x11071, 0x1007, 0xf, 0x9, 0x100062, 0x1c1e, 0x2e, 0x9, 0x601024, 0x1828, 0xff, 0x8, 0x601064, 0x1828, 0xff, 0x8
.long 0x601084, 0x1829, 0xff, 0x8, 0x1013e3, 0x10b11017, 0x6e, 0x88, 0x6010c4, 0x1829, 0xff, 0x8, 0x6011e4, 0x182b, 0xff, 0x8
.long 0x0, 0x0, 0x0, 0x0, 0x0, 0x0, 0x0, 0x0
.long 0x212001, 0x1000, 0x8, 0x6, 0x12031, 0x1003, 0xb, 0x9, 0x12061, 0x1006, 0xe, 0x9, 0x32041, 0x1004, 0x1c, 0x5
.long 0x12071, 0x1007, 0xf, 0x9, 0x72, 0x1c1f, 0x2f, 0x9, 0x602024, 0x1828, 0xff, 0x8, 0x602064, 0x1828, 0xff, 0x8
.long 0x602084, 0x1829, 0xff, 0x8, 0x1023e3, 0x10b21017, 0x6e, 0x88, 0x6020c4, 0x1829, 0xff, 0x8, 0x6021e4, 0x182b, 0xff, 0x8
.long 0x0, 0x0, 0x0, 0x0, 0x0, 0x0, 0x0, 0x0
.long 0x213001, 0x1000, 0x8, 0x6, 0x13031, 0x1003, 0xb, 0x9, 0x13061, 0x1006, 0xe, 0x9, 0x33041, 0x1004, 0x1c, 0x5
.long 0x13071, 0x1007, 0xf, 0x9, 0x100072, 0x1c1f, 0x2f, 0x9, 0x603024, 0x1828, 0xff, 0x8, 0x603064, 0x1828, 0xff, 0x8
.long 0x603084, 0x1829, 0xff, 0x8, 0x1033e3, 0x10b31017, 0x6e, 0x88, 0x6030c4, 0x1829, 0xff, 0x8, 0x6031e4, 0x182b, 0xff, 0x8
.long 0x0, 0x0, 0x0, 0x0, 0x0, 0x0, 0x0, 0x0
.long 0x400c3c4, 0x82f087c, 0xff, 0x8, 0x0, 0x0, 0x0, 0x0, 0x0, 0x0, 0x0, 0x0, 0x0, 0x0, 0x0, 0x0
.long 0x0, 0x0, 0x0, 0x0, 0x0, 0x0, 0x0, 0x0, 0x0, 0x0, 0x0, 0x0, 0x0, 0x0, 0x0, 0x0
.long 0x0, 0x0, 0x0, 0x0, 0x0, 0x0, 0x0, 0x0, 0x0, 0x0, 0x0, 0x0, 0x0, 0x0, 0x0, 0x0
.long 0x0, 0x0, 0x0, 0x0, 0x0, 0x0, 0x0, 0x0
.long 0x400d3c4, 0x82f087d, 0xff, 0x8, 0x0, 0x0, 0x0, 0x0, 0x0, 0x0, 0x0, 0x0, 0x0, 0x0, 0x0, 0x0
.long 0x0, 0x0, 0x0, 0x0, 0x0, 0x0, 0x0, 0x0, 0x0, 0x0, 0x0, 0x0, 0x0, 0x0, 0x0, 0x0
.long 0x0, 0x0, 0x0, 0x0, 0x0, 0x0, 0x0, 0x0, 0x0, 0x0, 0x0, 0x0, 0x0, 0x0, 0x0, 0x0
.long 0x0, 0x0, 0x0, 0x0, 0x0, 0x0, 0x0, 0x0
.long 0x400e3c4, 0x82f087e, 0xff, 0x8, 0x0, 0x0, 0x0, 0x0, 0x0, 0x0, 0x0, 0x0, 0x0, 0x0, 0x0, 0x0
.long 0x0, 0x0, 0x0, 0x0, 0x0, 0x0, 0x0, 0x0, 0x0, 0x0, 0x0, 0x0, 0x0, 0x0, 0x0, 0x0
.long 0x0, 0x0, 0x0, 0x0, 0x0, 0x0, 0x0, 0x0, 0x0, 0x0, 0x0, 0x0, 0x0, 0x0, 0x0, 0x0
.long 0x0, 0x0, 0x0, 0x0, 0x0, 0x0, 0x0, 0x0
.long 0x400f3c4, 0x82f087f, 0xff, 0x8, 0x0, 0x0, 0x0, 0x0, 0x0, 0x0, 0x0, 0x0, 0x0, 0x0, 0x0, 0x0
.long 0x0, 0x0, 0x0, 0x0, 0x0, 0x0, 0x0, 0x0, 0x0, 0x0, 0x0, 0x0, 0x0, 0x0, 0x0, 0x0
.long 0x0, 0x0, 0x0, 0x0, 0x0, 0x0, 0x0, 0x0, 0x0, 0x0, 0x0, 0x0, 0x0, 0x0, 0x0, 0x0
.long 0x0, 0x0, 0x0, 0x0, 0x0, 0x0, 0x0, 0x0
.long 0x214001, 0x1000, 0x8, 0x6, 0x14031, 0x1003, 0xb, 0x9, 0x14061, 0x1006, 0xe, 0x9, 0x34041, 0x1004, 0x1c, 0x5
.long 0x14071, 0x1007, 0xf, 0x9, 0x1062, 0x1c1e, 0x2e, 0x9, 0x600034, 0x1828, 0xff, 0x8, 0x600074, 0x1828, 0xff, 0x8
.long 0x600094, 0x1829, 0xff, 0x8, 0x1043e3, 0x10b41017, 0x6e, 0x88, 0x6000d4, 0x1829, 0xff, 0x8, 0x6001f4, 0x182b, 0xff, 0x8
.long 0x0, 0x0, 0x0, 0x0, 0x0, 0x0, 0x0, 0x0
.long 0x215001, 0x1000, 0x8, 0x6, 0x15031, 0x1003, 0xb, 0x9, 0x15061, 0x1006, 0xe, 0x9, 0x35041, 0x1004, 0x1c, 0x5
.long 0x15071, 0x1007, 0xf, 0x9, 0x101062, 0x1c1e, 0x2e, 0x9, 0x601034, 0x1828, 0xff, 0x8, 0x601074, 0x1828, 0xff, 0x8
.long 0x601094, 0x1829, 0xff, 0x8, 0x1053e3, 0x10b51017, 0x6e, 0x88, 0x6010d4, 0x1829, 0xff, 0x8, 0x6011f4, 0x182b, 0xff, 0x8
.long 0x0, 0x0, 0x0, 0x0, 0x0, 0x0, 0x0, 0x0
.long 0x216001, 0x1000, 0x8, 0x6, 0x16031, 0x1003, 0xb, 0x9, 0x16061, 0x1006, 0xe, 0x9, 0x36041, 0x1004, 0x1c, 0x5
.long 0x16071, 0x1007, 0xf, 0x9, 0x1072, 0x1c1f, 0x2f, 0x9, 0x602034, 0x1828, 0xff, 0x8, 0x602074, 0x1828, 0xff, 0x8
.long 0x602094, 0x1829, 0xff, 0x8, 0x1063e3, 0x10b61017, 0x6e, 0x88, 0x6020d4, 0x1829, 0xff, 0x8, 0x6021f4, 0x182b, 0xff, 0x8
.long 0x0, 0x0, 0x0, 0x0, 0x0, 0x0, 0x0, 0x0
.long 0x217001, 0x1000, 0x8, 0x6, 0x17031, 0x1003, 0xb, 0x9, 0x17061, 0x1006, 0xe, 0x9, 0x37041, 0x1004, 0x1c, 0x5
.long 0x17071, 0x1007, 0xf, 0x9, 0x101072, 0x1c1f, 0x2f, 0x9, 0x603034, 0x1828, 0xff, 0x8, 0x603074, 0x1828, 0xff, 0x8
.long 0x603094, 0x1829, 0xff, 0x8, 0x1073e3, 0x10b71017, 0x6e, 0x88, 0x6030d4, 0x1829, 0xff, 0x8, 0x6031f4, 0x182b, 0xff, 0x8
.long 0x0, 0x0, 0x0, 0x0, 0x0, 0x0, 0x0, 0x0
.long 0x40003d4, 0x82f0870, 0xff, 0x8, 0x0, 0x0, 0x0, 0x0, 0x0, 0x0, 0x0, 0x0, 0x0, 0x0, 0x0, 0x0
.long 0x0, 0x0, 0x0, 0x0, 0x0, 0x0, 0x0, 0x0, 0x0, 0x0, 0x0, 0x0, 0x0, 0x0, 0x0, 0x0
.long 0x0, 0x0, 0x0, 0x0, 0x0, 0x0, 0x0, 0x0, 0x0, 0x0, 0x0, 0x0, 0x0, 0x0, 0x0, 0x0
.long 0x0, 0x0, 0x0, 0x0, 0x0, 0x0, 0x0, 0x0
.long 0x40013d4, 0x82f0871, 0xff, 0x8, 0x0, 0x0, 0x0, 0x0, 0x0, 0x0, 0x0, 0x0, 0x0, 0x0, 0x0, 0x0
.long 0x0, 0x0, 0x0, 0x0, 0x0, 0x0, 0x0, 0x0, 0x0, 0x0, 0x0, 0x0, 0x0, 0x0, 0x0, 0x0
.long 0x0, 0x0, 0x0, 0x0, 0x0, 0x0, 0x0, 0x0, 0x0, 0x0, 0x0, 0x0, 0x0, 0x0, 0x0, 0x0
.long 0x0, 0x0, 0x0, 0x0, 0x0, 0x0, 0x0, 0x0
.long 0x40023d4, 0x82f0872, 0xff, 0x8, 0x0, 0x0, 0x0, 0x0, 0x0, 0x0, 0x0, 0x0, 0x0, 0x0, 0x0, 0x0
.long 0x0, 0x0, 0x0, 0x0, 0x0, 0x0, 0x0, 0x0, 0x0, 0x0, 0x0, 0x0, 0x0, 0x0, 0x0, 0x0
.long 0x0, 0x0, 0x0, 0x0, 0x0, 0x0, 0x0, 0x0, 0x0, 0x0, 0x0, 0x0, 0x0, 0x0, 0x0, 0x0
.long 0x0, 0x0, 0x0, 0x0, 0x0, 0x0, 0x0, 0x0
.long 0x40033d4, 0x82f0873, 0xff, 0x8, 0x0, 0x0, 0x0, 0x0, 0x0, 0x0, 0x0, 0x0, 0x0, 0x0, 0x0, 0x0
.long 0x0, 0x0, 0x0, 0x0, 0x0, 0x0, 0x0, 0x0, 0x0, 0x0, 0x0, 0x0, 0x0, 0x0, 0x0, 0x0
.long 0x0, 0x0, 0x0, 0x0, 0x0, 0x0, 0x0, 0x0, 0x0, 0x0, 0x0, 0x0, 0x0, 0x0, 0x0, 0x0
.long 0x0, 0x0, 0x0, 0x0, 0x0, 0x0, 0x0, 0x0
.long 0x218001, 0x1000, 0x8, 0x6, 0x18031, 0x1003, 0xb, 0x9, 0x18061, 0x1006, 0xe, 0x9, 0x38041, 0x1004, 0x1c, 0x5
.long 0x18071, 0x1007, 0xf, 0x9, 0x2062, 0x1c1e, 0x2e, 0x9, 0x600044, 0x1828, 0xff, 0x8, 0x1003b3, 0x10981017, 0x27, 0x88
.long 0x1003d3, 0x10a81017, 0x6d, 0x88, 0xc604072, 0x2027, 0x3c, 0x4, 0xc000394, 0x82f203c, 0xff, 0x8, 0x0, 0x0, 0x0, 0x0
.long 0x0, 0x0, 0x0, 0x0, 0x0, 0x0, 0x0, 0x0
.long 0x219001, 0x1000, 0x8, 0x6, 0x19031, 0x1003, 0xb, 0x9, 0x19061, 0x1006, 0xe, 0x9, 0x39041, 0x1004, 0x1c, 0x5
.long 0x19071, 0x1007, 0xf, 0x9, 0x102062, 0x1c1e, 0x2e, 0x9, 0x601044, 0x1828, 0xff, 0x8, 0x1013b3, 0x10991017, 0x27, 0x88
.long 0x1013d3, 0x10a91017, 0x6d, 0x88, 0xc704072, 0x2027, 0x3c, 0x4, 0xc001394, 0x82f203c, 0xff, 0x8, 0x0, 0x0, 0x0, 0x0
.long 0x0, 0x0, 0x0, 0x0, 0x0, 0x0, 0x0, 0x0
.long 0x21a001, 0x1000, 0x8, 0x6, 0x1a031, 0x1003, 0xb, 0x9, 0x1a061, 0x1006, 0xe, 0x9, 0x3a041, 0x1004, 0x1c, 0x5
.long 0x1a071, 0x1007, 0xf, 0x9, 0x2072, 0x1c1f, 0x2f, 0x9, 0x602044, 0x1828, 0xff, 0x8, 0x1023b3, 0x109a1017, 0x27, 0x88
.long 0x1023d3, 0x10aa1017, 0x6d, 0x88, 0xc804072, 0x2027, 0x3c, 0x4, 0xc002394, 0x82f203c, 0xff, 0x8, 0x0, 0x0, 0x0, 0x0
.long 0x0, 0x0, 0x0, 0x0, 0x0, 0x0, 0x0, 0x0
.long 0x21b001, 0x1000, 0x8, 0x6, 0x1b031, 0x1003, 0xb, 0x9, 0x1b061, 0x1006, 0xe, 0x9, 0x3b041, 0x1004, 0x1c, 0x5
.long 0x1b071, 0x1007, 0xf, 0x9, 0x102072, 0x1c1f, 0x2f, 0x9, 0x603044, 0x1828, 0xff, 0x8, 0x1033b3, 0x109b1017, 0x27, 0x88
.long 0x1033d3, 0x10ab1017, 0x6d, 0x88, 0xc904072, 0x2027, 0x3c, 0x4, 0xc003394, 0x82f203c, 0xff, 0x8, 0x0, 0x0, 0x0, 0x0
.long 0x0, 0x0, 0x0, 0x0, 0x0, 0x0, 0x0, 0x0
.long 0x40043d4, 0x82f0874, 0xff, 0x8, 0x0, 0x0, 0x0, 0x0, 0x0, 0x0, 0x0, 0x0, 0x0, 0x0, 0x0, 0x0
.long 0x0, 0x0, 0x0, 0x0, 0x0, 0x0, 0x0, 0x0, 0x0, 0x0, 0x0, 0x0, 0x0, 0x0, 0x0, 0x0
.long 0x0, 0x0, 0x0, 0x0, 0x0, 0x0, 0x0, 0x0, 0x0, 0x0, 0x0, 0x0, 0x0, 0x0, 0x0, 0x0
.long 0x0, 0x0, 0x0, 0x0, 0x0, 0x0, 0x0, 0x0
.long 0x40053d4, 0x82f0875, 0xff, 0x8, 0x0, 0x0, 0x0, 0x0, 0x0, 0x0, 0x0, 0x0, 0x0, 0x0, 0x0, 0x0
.long 0x0, 0x0, 0x0, 0x0, 0x0, 0x0, 0x0, 0x0, 0x0, 0x0, 0x0, 0x0, 0x0, 0x0, 0x0, 0x0
.long 0x0, 0x0, 0x0, 0x0, 0x0, 0x0, 0x0, 0x0, 0x0, 0x0, 0x0, 0x0, 0x0, 0x0, 0x0, 0x0
.long 0x0, 0x0, 0x0, 0x0, 0x0, 0x0, 0x0, 0x0
.long 0x40063d4, 0x82f0876, 0xff, 0x8, 0x0, 0x0, 0x0, 0x0, 0x0, 0x0, 0x0, 0x0, 0x0, 0x0, 0x0, 0x0
.long 0x0, 0x0, 0x0, 0x0, 0x0, 0x0, 0x0, 0x0, 0x0, 0x0, 0x0, 0x0, 0x0, 0x0, 0x0, 0x0
.long 0x0, 0x0, 0x0, 0x0, 0x0, 0x0, 0x0, 0x0, 0x0, 0x0, 0x0, 0x0, 0x0, 0x0, 0x0, 0x0
.long 0x0, 0x0, 0x0, 0x0, 0x0, 0x0, 0x0, 0x0
.long 0x40073d4, 0x82f0877, 0xff, 0x8, 0x0, 0x0, 0x0, 0x0, 0x0, 0x0, 0x0, 0x0, 0x0, 0x0, 0x0, 0x0
.long 0x0, 0x0, 0x0, 0x0, 0x0, 0x0, 0x0, 0x0, 0x0, 0x0, 0x0, 0x0, 0x0, 0x0, 0x0, 0x0
.long 0x0, 0x0, 0x0, 0x0, 0x0, 0x0, 0x0, 0x0, 0x0, 0x0, 0x0, 0x0, 0x0, 0x0, 0x0, 0x0
.long 0x0, 0x0, 0x0, 0x0, 0x0, 0x0, 0x0, 0x0
.long 0x21c001, 0x1000, 0x8, 0x6, 0x1c031, 0x1003, 0xb, 0x9, 0x1c061, 0x1006, 0xe, 0x9, 0x3c041, 0x1004, 0x1c, 0x5
.long 0x1c071, 0x1007, 0xf, 0x9, 0x3062, 0x1c1e, 0x2e, 0x9, 0x600054, 0x1828, 0xff, 0x8, 0x1043b3, 0x109c1017, 0x27, 0x88
.long 0x1043d3, 0x10ac1017, 0x6d, 0x88, 0xc605072, 0x2027, 0x3c, 0x4, 0xc004394, 0x82f203c, 0xff, 0x8, 0x0, 0x0, 0x0, 0x0
.long 0x0, 0x0, 0x0, 0x0, 0x0, 0x0, 0x0, 0x0
.long 0x21d001, 0x1000, 0x8, 0x6, 0x1d031, 0x1003, 0xb, 0x9, 0x1d061, 0x1006, 0xe, 0x9, 0x3d041, 0x1004, 0x1c, 0x5
.long 0x1d071, 0x1007, 0xf, 0x9, 0x103062, 0x1c1e, 0x2e, 0x9, 0x601054, 0x1828, 0xff, 0x8, 0x1053b3, 0x109d1017, 0x27, 0x88
.long 0x1053d3, 0x10ad1017, 0x6d, 0x88, 0xc705072, 0x2027, 0x3c, 0x4, 0xc005394, 0x82f203c, 0xff, 0x8, 0x0, 0x0, 0x0, 0x0
.long 0x0, 0x0, 0x0, 0x0, 0x0, 0x0, 0x0, 0x0
.long 0x21e001, 0x1000, 0x8, 0x6, 0x1e031, 0x1003, 0xb, 0x9, 0x1e061, 0x1006, 0xe, 0x9, 0x3e041, 0x1004, 0x1c, 0x5
.long 0x1e071, 0x1007, 0xf, 0x9, 0x3072, 0x1c1f, 0x2f, 0x9, 0x602054, 0x1828, 0xff, 0x8, 0x1063b3, 0x109e1017, 0x27, 0x88
.long 0x1063d3, 0x10ae1017, 0x6d, 0x88, 0xc805072, 0x2027, 0x3c, 0x4, 0xc006394, 0x82f203c, 0xff, 0x8, 0x0, 0x0, 0x0, 0x0
.long 0x0, 0x0, 0x0, 0x0, 0x0, 0x0, 0x0, 0x0
.long 0x21f001, 0x1000, 0x8, 0x6, 0x1f031, 0x1003, 0xb, 0x9, 0x1f061, 0x1006, 0xe, 0x9, 0x3f041, 0x1004, 0x1c, 0x5
.long 0x1f071, 0x1007, 0xf, 0x9, 0x103072, 0x1c1f, 0x2f, 0x9, 0x603054, 0x1828, 0xff, 0x8, 0x1073b3, 0x109f1017, 0x27, 0x88
.long 0x1073d3, 0x10af1017, 0x6d, 0x88, 0xc905072, 0x2027, 0x3c, 0x4, 0xc007394, 0x82f203c, 0xff, 0x8, 0x0, 0x0, 0x0, 0x0
.long 0x0, 0x0, 0x0, 0x0, 0x0, 0x0, 0x0, 0x0
.long 0x40083d4, 0x82f0878, 0xff, 0x8, 0x0, 0x0, 0x0, 0x0, 0x0, 0x0, 0x0, 0x0, 0x0, 0x0, 0x0, 0x0
.long 0x0, 0x0, 0x0, 0x0, 0x0, 0x0, 0x0, 0x0, 0x0, 0x0, 0x0, 0x0, 0x0, 0x0, 0x0, 0x0
.long 0x0, 0x0, 0x0, 0x0, 0x0, 0x0, 0x0, 0x0, 0x0, 0x0, 0x0, 0x0, 0x0, 0x0, 0x0, 0x0
.long 0x0, 0x0, 0x0, 0x0, 0x0, 0x0, 0x0, 0x0
.long 0x40093d4, 0x82f0879, 0xff, 0x8, 0x0, 0x0, 0x0, 0x0, 0x0, 0x0, 0x0, 0x0, 0x0, 0x0, 0x0, 0x0
.long 0x0, 0x0, 0x0, 0x0, 0x0, 0x0, 0x0, 0x0, 0x0, 0x0, 0x0, 0x0, 0x0, 0x0, 0x0, 0x0
.long 0x0, 0x0, 0x0, 0x0, 0x0, 0x0, 0x0, 0x0, 0x0, 0x0, 0x0, 0x0, 0x0, 0x0, 0x0, 0x0
.long 0x0, 0x0, 0x0, 0x0, 0x0, 0x0, 0x0, 0x0
.long 0x400a3d4, 0x82f087a, 0xff, 0x8, 0x0, 0x0, 0x0, 0x0, 0x0, 0x0, 0x0, 0x0, 0x0, 0x0, 0x0, 0x0
.long 0x0, 0x0, 0x0, 0x0, 0x0, 0x0, 0x0, 0x0, 0x0, 0x0, 0x0, 0x0, 0x0, 0x0, 0x0, 0x0
.long 0x0, 0x0, 0x0, 0x0, 0x0, 0x0, 0x0, 0x0, 0x0, 0x0, 0x0, 0x0, 0x0, 0x0, 0x0, 0x0
.long 0x0, 0x0, 0x0, 0x0, 0x0, 0x0, 0x0, 0x0
.long 0x400b3d4, 0x82f087b, 0xff, 0x8, 0x0, 0x0, 0x0, 0x0, 0x0, 0x0, 0x0, 0x0, 0x0, 0x0, 0x0, 0x0
.long 0x0, 0x0, 0x0, 0x0, 0x0, 0x0, 0x0, 0x0, 0x0, 0x0, 0x0, 0x0, 0x0, 0x0, 0x0, 0x0
.long 0x0, 0x0, 0x0, 0x0, 0x0, 0x0, 0x0, 0x0, 0x0, 0x0, 0x0, 0x0, 0x0, 0x0, 0x0, 0x0
.long 0x0, 0x0, 0x0, 0x0, 0x0, 0x0, 0x0, 0x0
.long 0x100011, 0x1001, 0x9, 0x6, 0x41, 0x1004, 0xc, 0x9, 0x20011, 0x1001, 0x11, 0x9, 0x3c031, 0x1003, 0x1b, 0x5
.long 0x71, 0x1007, 0xf, 0x9, 0x2, 0x1c18, 0x28, 0x9, 0x100383, 0x10801017, 0x27, 0x88, 0x8204062, 0x2826, 0x2e, 0x4
.long 0x600104, 0x182a, 0xff, 0x8, 0xc0003a4, 0x82f203c, 0xff, 0x8, 0x0, 0x0, 0x0, 0x0, 0x0, 0x0, 0x0, 0x0
.long 0x0, 0x0, 0x0, 0x0, 0x0, 0x0, 0x0, 0x0
.long 0x101011, 0x1001, 0x9, 0x6, 0x1041, 0x1004, 0xc, 0x9, 0x21011, 0x1001, 0x11, 0x9, 0x3d031, 0x1003, 0x1b, 0x5
.long 0x1071, 0x1007, 0xf, 0x9, 0x100002, 0x1c18, 0x28, 0x9, 0x101383, 0x10811017, 0x27, 0x88, 0x8304062, 0x2826, 0x2e, 0x4
.long 0x601104, 0x182a, 0xff, 0x8, 0xc0013a4, 0x82f203c, 0xff, 0x8, 0x0, 0x0, 0x0, 0x0, 0x0, 0x0, 0x0, 0x0
.long 0x0, 0x0, 0x0, 0x0, 0x0, 0x0, 0x0, 0x0
.long 0x102011, 0x1001, 0x9, 0x6, 0x2041, 0x1004, 0xc, 0x9, 0x22011, 0x1001, 0x11, 0x9, 0x3e031, 0x1003, 0x1b, 0x5
.long 0x2071, 0x1007, 0xf, 0x9, 0x12, 0x1c19, 0x29, 0x9, 0x102383, 0x10821017, 0x27, 0x88, 0x8404062, 0x2826, 0x2e, 0x4
.long 0x602104, 0x182a, 0xff, 0x8, 0xc0023a4, 0x82f203c, 0xff, 0x8, 0x0, 0x0, 0x0, 0x0, 0x0, 0x0, 0x0, 0x0
.long 0x0, 0x0, 0x0, 0x0, 0x0, 0x0, 0x0, 0x0
.long 0x103011, 0x1001, 0x9, 0x6, 0x3041, 0x1004, 0xc, 0x9, 0x23011, 0x1001, 0x11, 0x9, 0x3f031, 0x1003, 0x1b, 0x5
.long 0x3071, 0x1007, 0xf, 0x9, 0x100012, 0x1c19, 0x29, 0x9, 0x103383, 0x10831017, 0x27, 0x88, 0x8504062, 0x2826, 0x2e, 0x4
.long 0x603104, 0x182a, 0xff, 0x8, 0xc0033a4, 0x82f203c, 0xff, 0x8, 0x0, 0x0, 0x0, 0x0, 0x0, 0x0, 0x0, 0x0
.long 0x0, 0x0, 0x0, 0x0, 0x0, 0x0, 0x0, 0x0
.long 0x400c3d4, 0x82f087c, 0xff, 0x8, 0x0, 0x0, 0x0, 0x0, 0x0, 0x0, 0x0, 0x0, 0x0, 0x0, 0x0, 0x0
.long 0x0, 0x0, 0x0, 0x0, 0x0, 0x0, 0x0, 0x0, 0x0, 0x0, 0x0, 0x0, 0x0, 0x0, 0x0, 0x0
.long 0x0, 0x0, 0x0, 0x0, 0x0, 0x0, 0x0, 0x0, 0x0, 0x0, 0x0, 0x0, 0x0, 0x0, 0x0, 0x0
.long 0x0, 0x0, 0x0, 0x0, 0x0, 0x0, 0x0, 0x0
.long 0x400d3d4, 0x82f087d, 0xff, 0x8, 0x0, 0x0, 0x0, 0x0, 0x0, 0x0, 0x0, 0x0, 0x0, 0x0, 0x0, 0x0
.long 0x0, 0x0, 0x0, 0x0, 0x0, 0x0, 0x0, 0x0, 0x0, 0x0, 0x0, 0x0, 0x0, 0x0, 0x0, 0x0
.long 0x0, 0x0, 0x0, 0x0, 0x0, 0x0, 0x0, 0x0, 0x0, 0x0, 0x0, 0x0, 0x0, 0x0, 0x0, 0x0
.long 0x0, 0x0, 0x0, 0x0, 0x0, 0x0, 0x0, 0x0
.long 0x400e3d4, 0x82f087e, 0xff, 0x8, 0x0, 0x0, 0x0, 0x0, 0x0, 0x0, 0x0, 0x0, 0x0, 0x0, 0x0, 0x0
.long 0x0, 0x0, 0x0, 0x0, 0x0, 0x0, 0x0, 0x0, 0x0, 0x0, 0x0, 0x0, 0x0, 0x0, 0x0, 0x0
.long 0x0, 0x0, 0x0, 0x0, 0x0, 0x0, 0x0, 0x0, 0x0, 0x0, 0x0, 0x0, 0x0, 0x0, 0x0, 0x0
.long 0x0, 0x0, 0x0, 0x0, 0x0, 0x0, 0x0, 0x0
.long 0x400f3d4, 0x82f087f, 0xff, 0x8, 0x0, 0x0, 0x0, 0x0, 0x0, 0x0, 0x0, 0x0, 0x0, 0x0, 0x0, 0x0
.long 0x0, 0x0, 0x0, 0x0, 0x0, 0x0, 0x0, 0x0, 0x0, 0x0, 0x0, 0x0, 0x0, 0x0, 0x0, 0x0
.long 0x0, 0x0, 0x0, 0x0, 0x0, 0x0, 0x0, 0x0, 0x0, 0x0, 0x0, 0x0, 0x0, 0x0, 0x0, 0x0
.long 0x0, 0x0, 0x0, 0x0, 0x0, 0x0, 0x0, 0x0
.long 0x104011, 0x1001, 0x9, 0x6, 0x4041, 0x1004, 0xc, 0x9, 0x24011, 0x1001, 0x11, 0x9, 0x40031, 0x1003, 0x1b, 0x5
.long 0x4071, 0x1007, 0xf, 0x9, 0x1002, 0x1c18, 0x28, 0x9, 0x104383, 0x10841017, 0x27, 0x88, 0x8205062, 0x2826, 0x2e, 0x4
.long 0x600114, 0x182a, 0xff, 0x8, 0xc0043a4, 0x82f203c, 0xff, 0x8, 0x0, 0x0, 0x0, 0x0, 0x0, 0x0, 0x0, 0x0
.long 0x0, 0x0, 0x0, 0x0, 0x0, 0x0, 0x0, 0x0
.long 0x105011, 0x1001, 0x9, 0x6, 0x5041, 0x1004, 0xc, 0x9, 0x25011, 0x1001, 0x11, 0x9, 0x41031, 0x1003, 0x1b, 0x5
.long 0x5071, 0x1007, 0xf, 0x9, 0x101002, 0x1c18, 0x28, 0x9, 0x105383, 0x10851017, 0x27, 0x88, 0x8305062, 0x2826, 0x2e, 0x4
.long 0x601114, 0x182a, 0xff, 0x8, 0xc0053a4, 0x82f203c, 0xff, 0x8, 0x0, 0x0, 0x0, 0x0, 0x0, 0x0, 0x0, 0x0
.long 0x0, 0x0, 0x0, 0x0, 0x0, 0x0, 0x0, 0x0
.long 0x106011, 0x1001, 0x9, 0x6, 0x6041, 0x1004, 0xc, 0x9, 0x26011, 0x1001, 0x11, 0x9, 0x42031, 0x1003, 0x1b, 0x5
.long 0x6071, 0x1007, 0xf, 0x9, 0x1012, 0x1c19, 0x29, 0x9, 0x106383, 0x10861017, 0x27, 0x88, 0x8405062, 0x2826, 0x2e, 0x4
.long 0x602114, 0x182a, 0xff, 0x8, 0xc0063a4, 0x82f203c, 0xff, 0x8, 0x0, 0x0, 0x0, 0x0, 0x0, 0x0, 0x0, 0x0
.long 0x0, 0x0, 0x0, 0x0, 0x0, 0x0, 0x0, 0x0
.long 0x107011, 0x1001, 0x9, 0x6, 0x7041, 0x1004, 0xc, 0x9, 0x27011, 0x1001, 0x11, 0x9, 0x43031, 0x1003, 0x1b, 0x5
.long 0x7071, 0x1007, 0xf, 0x9, 0x101012, 0x1c19, 0x29, 0x9, 0x107383, 0x10871017, 0x27, 0x88, 0x8505062, 0x2826, 0x2e, 0x4
.long 0x603114, 0x182a, 0xff, 0x8, 0xc0073a4, 0x82f203c, 0xff, 0x8, 0x0, 0x0, 0x0, 0x0, 0x0, 0x0, 0x0, 0x0
.long 0x0, 0x0, 0x0, 0x0, 0x0, 0x0, 0x0, 0x0
.long 0x40003e4, 0x82f0870, 0xff, 0x8, 0x0, 0x0, 0x0, 0x0, 0x0, 0x0, 0x0, 0x0, 0x0, 0x0, 0x0, 0x0
.long 0x0, 0x0, 0x0, 0x0, 0x0, 0x0, 0x0, 0x0, 0x0, 0x0, 0x0, 0x0, 0x0, 0x0, 0x0, 0x0
.long 0x0, 0x0, 0x0, 0x0, 0x0, 0x0, 0x0, 0x0, 0x0, 0x0, 0x0, 0x0, 0x0, 0x0, 0x0, 0x0
.long 0x0, 0x0, 0x0, 0x0, 0x0, 0x0, 0x0, 0x0
.long 0x40013e4, 0x82f0871, 0xff, 0x8, 0x0, 0x0, 0x0, 0x0, 0x0, 0x0, 0x0, 0x0, 0x0, 0x0, 0x0, 0x0
.long 0x0, 0x0, 0x0, 0x0, 0x0, 0x0, 0x0, 0x0, 0x0, 0x0, 0x0, 0x0, 0x0, 0x0, 0x0, 0x0
.long 0x0, 0x0, 0x0, 0x0, 0x0, 0x0, 0x0, 0x0, 0x0, 0x0, 0x0, 0x0, 0x0, 0x0, 0x0, 0x0
.long 0x0, 0x0, 0x0, 0x0, 0x0, 0x0, 0x0, 0x0
.long 0x40023e4, 0x82f0872, 0xff, 0x8, 0x0, 0x0, 0x0, 0x0, 0x0, 0x0, 0x0, 0x0, 0x0, 0x0, 0x0, 0x0
.long 0x0, 0x0, 0x0, 0x0, 0x0, 0x0, 0x0, 0x0, 0x0, 0x0, 0x0, 0x0, 0x0, 0x0, 0x0, 0x0
.long 0x0, 0x0, 0x0, 0x0, 0x0, 0x0, 0x0, 0x0, 0x0, 0x0, 0x0, 0x0, 0x0, 0x0, 0x0, 0x0
.long 0x0, 0x0, 0x0, 0x0, 0x0, 0x0, 0x0, 0x0
.long 0x40033e4, 0x82f0873, 0xff, 0x8, 0x0, 0x0, 0x0, 0x0, 0x0, 0x0, 0x0, 0x0, 0x0, 0x0, 0x0, 0x0
.long 0x0, 0x0, 0x0, 0x0, 0x0, 0x0, 0x0, 0x0, 0x0, 0x0, 0x0, 0x0, 0x0, 0x0, 0x0, 0x0
.long 0x0, 0x0, 0x0, 0x0, 0x0, 0x0, 0x0, 0x0, 0x0, 0x0, 0x0, 0x0, 0x0, 0x0, 0x0, 0x0
.long 0x0, 0x0, 0x0, 0x0, 0x0, 0x0, 0x0, 0x0
.long 0x108011, 0x1001, 0x9, 0x6, 0x8041, 0x1004, 0xc, 0x9, 0x28011, 0x1001, 0x11, 0x9, 0x44031, 0x1003, 0x1b, 0x5
.long 0x8071, 0x1007, 0xf, 0x9, 0x2002, 0x1c18, 0x28, 0x9, 0x8200042, 0x824, 0x2c, 0x9, 0x600324, 0x282e, 0xff, 0x8
.long 0x0, 0x0, 0x0, 0x0, 0x0, 0x0, 0x0, 0x0, 0x0, 0x0, 0x0, 0x0, 0x0, 0x0, 0x0, 0x0
.long 0x0, 0x0, 0x0, 0x0, 0x0, 0x0, 0x0, 0x0
.long 0x109011, 0x1001, 0x9, 0x6, 0x9041, 0x1004, 0xc, 0x9, 0x29011, 0x1001, 0x11, 0x9, 0x45031, 0x1003, 0x1b, 0x5
.long 0x9071, 0x1007, 0xf, 0x9, 0x102002, 0x1c18, 0x28, 0x9, 0x8300042, 0x824, 0x2c, 0x9, 0x601324, 0x282e, 0xff, 0x8
.long 0x0, 0x0, 0x0, 0x0, 0x0, 0x0, 0x0, 0x0, 0x0, 0x0, 0x0, 0x0, 0x0, 0x0, 0x0, 0x0
.long 0x0, 0x0, 0x0, 0x0, 0x0, 0x0, 0x0, 0x0
.long 0x10a011, 0x1001, 0x9, 0x6, 0xa041, 0x1004, 0xc, 0x9, 0x2a011, 0x1001, 0x11, 0x9, 0x46031, 0x1003, 0x1b, 0x5
.long 0xa071, 0x1007, 0xf, 0x9, 0x2012, 0x1c19, 0x29, 0x9, 0x8400042, 0x824, 0x2c, 0x9, 0x602324, 0x282e, 0xff, 0x8
.long 0x0, 0x0, 0x0, 0x0, 0x0, 0x0, 0x0, 0x0, 0x0, 0x0, 0x0, 0x0, 0x0, 0x0, 0x0, 0x0
.long 0x0, 0x0, 0x0, 0x0, 0x0, 0x0, 0x0, 0x0
.long 0x10b011, 0x1001, 0x9, 0x6, 0xb041, 0x1004, 0xc, 0x9, 0x2b011, 0x1001, 0x11, 0x9, 0x47031, 0x1003, 0x1b, 0x5
.long 0xb071, 0x1007, 0xf, 0x9, 0x102012, 0x1c19, 0x29, 0x9, 0x8500042, 0x824, 0x2c, 0x9, 0x603324, 0x282e, 0xff, 0x8
.long 0x0, 0x0, 0x0, 0x0, 0x0, 0x0, 0x0, 0x0, 0x0, 0x0, 0x0, 0x0, 0x0, 0x0, 0x0, 0x0
.long 0x0, 0x0, 0x0, 0x0, 0x0, 0x0, 0x0, 0x0
.long 0x40043e4, 0x82f0874, 0xff, 0x8, 0x0, 0x0, 0x0, 0x0, 0x0, 0x0, 0x0, 0x0, 0x0, 0x0, 0x0, 0x0
.long 0x0, 0x0, 0x0, 0x0, 0x0, 0x0, 0x0, 0x0, 0x0, 0x0, 0x0, 0x0, 0x0, 0x0, 0x0, 0x0
.long 0x0, 0x0, 0x0, 0x0, 0x0, 0x0, 0x0, 0x0, 0x0, 0x0, 0x0, 0x0, 0x0, 0x0, 0x0, 0x0
.long 0x0, 0x0, 0x0, 0x0, 0x0, 0x0, 0x0, 0x0
.long 0x40053e4, 0x82f0875, 0xff, 0x8, 0x0, 0x0, 0x0, 0x0, 0x0, 0x0, 0x0, 0x0, 0x0, 0x0, 0x0, 0x0
.long 0x0, 0x0, 0x0, 0x0, 0x0, 0x0, 0x0, 0x0, 0x0, 0x0, 0x0, 0x0, 0x0, 0x0, 0x0, 0x0
.long 0x0, 0x0, 0x0, 0x0, 0x0, 0x0, 0x0, 0x0, 0x0, 0x0, 0x0, 0x0, 0x0, 0x0, 0x0, 0x0
.long 0x0, 0x0, 0x0, 0x0, 0x0, 0x0, 0x0, 0x0
.long 0x40063e4, 0x82f0876, 0xff, 0x8, 0x0, 0x0, 0x0, 0x0, 0x0, 0x0, 0x0, 0x0, 0x0, 0x0, 0x0, 0x0
.long 0x0, 0x0, 0x0, 0x0, 0x0, 0x0, 0x0, 0x0, 0x0, 0x0, 0x0, 0x0, 0x0, 0x0, 0x0, 0x0
.long 0x0, 0x0, 0x0, 0x0, 0x0, 0x0, 0x0, 0x0, 0x0, 0x0, 0x0, 0x0, 0x0, 0x0, 0x0, 0x0
.long 0x0, 0x0, 0x0, 0x0, 0x0, 0x0, 0x0, 0x0
.long 0x40073e4, 0x82f0877, 0xff, 0x8, 0x0, 0x0, 0x0, 0x0, 0x0, 0x0, 0x0, 0x0, 0x0, 0x0, 0x0, 0x0
.long 0x0, 0x0, 0x0, 0x0, 0x0, 0x0, 0x0, 0x0, 0x0, 0x0, 0x0, 0x0, 0x0, 0x0, 0x0, 0x0
.long 0x0, 0x0, 0x0, 0x0, 0x0, 0x0, 0x0, 0x0, 0x0, 0x0, 0x0, 0x0, 0x0, 0x0, 0x0, 0x0
.long 0x0, 0x0, 0x0, 0x0, 0x0, 0x0, 0x0, 0x0
.long 0x10c011, 0x1001, 0x9, 0x6, 0xc041, 0x1004, 0xc, 0x9, 0x2c011, 0x1001, 0x11, 0x9, 0x48031, 0x1003, 0x1b, 0x5
.long 0xc071, 0x1007, 0xf, 0x9, 0x3002, 0x1c18, 0x28, 0x9, 0x8201042, 0x824, 0x2c, 0x9, 0x600334, 0x282e, 0xff, 0x8
.long 0x0, 0x0, 0x0, 0x0, 0x0, 0x0, 0x0, 0x0, 0x0, 0x0, 0x0, 0x0, 0x0, 0x0, 0x0, 0x0
.long 0x0, 0x0, 0x0, 0x0, 0x0, 0x0, 0x0, 0x0
.long 0x10d011, 0x1001, 0x9, 0x6, 0xd041, 0x1004, 0xc, 0x9, 0x2d011, 0x1001, 0x11, 0x9, 0x49031, 0x1003, 0x1b, 0x5
.long 0xd071, 0x1007, 0xf, 0x9, 0x103002, 0x1c18, 0x28, 0x9, 0x8301042, 0x824, 0x2c, 0x9, 0x601334, 0x282e, 0xff, 0x8
.long 0x0, 0x0, 0x0, 0x0, 0x0, 0x0, 0x0, 0x0, 0x0, 0x0, 0x0, 0x0, 0x0, 0x0, 0x0, 0x0
.long 0x0, 0x0, 0x0, 0x0, 0x0, 0x0, 0x0, 0x0
.long 0x10e011, 0x1001, 0x9, 0x6, 0xe041, 0x1004, 0xc, 0x9, 0x2e011, 0x1001, 0x11, 0x9, 0x4a031, 0x1003, 0x1b, 0x5
.long 0xe071, 0x1007, 0xf, 0x9, 0x3012, 0x1c19, 0x29, 0x9, 0x8401042, 0x824, 0x2c, 0x9, 0x602334, 0x282e, 0xff, 0x8
.long 0x0, 0x0, 0x0, 0x0, 0x0, 0x0, 0x0, 0x0, 0x0, 0x0, 0x0, 0x0, 0x0, 0x0, 0x0, 0x0
.long 0x0, 0x0, 0x0, 0x0, 0x0, 0x0, 0x0, 0x0
.long 0x10f011, 0x1001, 0x9, 0x6, 0xf041, 0x1004, 0xc, 0x9, 0x2f011, 0x1001, 0x11, 0x9, 0x4b031, 0x1003, 0x1b, 0x5
.long 0xf071, 0x1007, 0xf, 0x9, 0x103012, 0x1c19, 0x29, 0x9, 0x8501042, 0x824, 0x2c, 0x9, 0x603334, 0x282e, 0xff, 0x8
.long 0x0, 0x0, 0x0, 0x0, 0x0, 0x0, 0x0, 0x0, 0x0, 0x0, 0x0, 0x0, 0x0, 0x0, 0x0, 0x0
.long 0x0, 0x0, 0x0, 0x0, 0x0, 0x0, 0x0, 0x0
.long 0x40083e4, 0x82f0878, 0xff, 0x8, 0x0, 0x0, 0x0, 0x0, 0x0, 0x0, 0x0, 0x0, 0x0, 0x0, 0x0, 0x0
.long 0x0, 0x0, 0x0, 0x0, 0x0, 0x0, 0x0, 0x0, 0x0, 0x0, 0x0, 0x0, 0x0, 0x0, 0x0, 0x0
.long 0x0, 0x0, 0x0, 0x0, 0x0, 0x0, 0x0, 0x0, 0x0, 0x0, 0x0, 0x0, 0x0, 0x0, 0x0, 0x0
.long 0x0, 0x0, 0x0, 0x0, 0x0, 0x0, 0x0, 0x0
.long 0x40093e4, 0x82f0879, 0xff, 0x8, 0x0, 0x0, 0x0, 0x0, 0x0, 0x0, 0x0, 0x0, 0x0, 0x0, 0x0, 0x0
.long 0x0, 0x0, 0x0, 0x0, 0x0, 0x0, 0x0, 0x0, 0x0, 0x0, 0x0, 0x0, 0x0, 0x0, 0x0, 0x0
.long 0x0, 0x0, 0x0, 0x0, 0x0, 0x0, 0x0, 0x0, 0x0, 0x0, 0x0, 0x0, 0x0, 0x0, 0x0, 0x0
.long 0x0, 0x0, 0x0, 0x0, 0x0, 0x0, 0x0, 0x0
.long 0x400a3e4, 0x82f087a, 0xff, 0x8, 0x0, 0x0, 0x0, 0x0, 0x0, 0x0, 0x0, 0x0, 0x0, 0x0, 0x0, 0x0
.long 0x0, 0x0, 0x0, 0x0, 0x0, 0x0, 0x0, 0x0, 0x0, 0x0, 0x0, 0x0, 0x0, 0x0, 0x0, 0x0
.long 0x0, 0x0, 0x0, 0x0, 0x0, 0x0, 0x0, 0x0, 0x0, 0x0, 0x0, 0x0, 0x0, 0x0, 0x0, 0x0
.long 0x0, 0x0, 0x0, 0x0, 0x0, 0x0, 0x0, 0x0
.long 0x400b3e4, 0x82f087b, 0xff, 0x8, 0x0, 0x0, 0x0, 0x0, 0x0, 0x0, 0x0, 0x0, 0x0, 0x0, 0x0, 0x0
.long 0x0, 0x0, 0x0, 0x0, 0x0, 0x0, 0x0, 0x0, 0x0, 0x0, 0x0, 0x0, 0x0, 0x0, 0x0, 0x0
.long 0x0, 0x0, 0x0, 0x0, 0x0, 0x0, 0x0, 0x0, 0x0, 0x0, 0x0, 0x0, 0x0, 0x0, 0x0, 0x0
.long 0x0, 0x0, 0x0, 0x0, 0x0, 0x0, 0x0, 0x0
.long 0x110011, 0x1001, 0x9, 0x6, 0x10041, 0x1004, 0xc, 0x9, 0x30001, 0x1000, 0x18, 0x5, 0x40041, 0x1004, 0x1c, 0x5
.long 0x20021, 0x1002, 0x12, 0x9, 0x22, 0x1c1a, 0x2a, 0x9, 0x8202042, 0x824, 0x2c, 0x9, 0x6002e4, 0x182d, 0xff, 0x8
.long 0x0, 0x0, 0x0, 0x0, 0x0, 0x0, 0x0, 0x0, 0x0, 0x0, 0x0, 0x0, 0x0, 0x0, 0x0, 0x0
.long 0x0, 0x0, 0x0, 0x0, 0x0, 0x0, 0x0, 0x0
.long 0x111011, 0x1001, 0x9, 0x6, 0x11041, 0x1004, 0xc, 0x9, 0x31001, 0x1000, 0x18, 0x5, 0x41041, 0x1004, 0x1c, 0x5
.long 0x21021, 0x1002, 0x12, 0x9, 0x100022, 0x1c1a, 0x2a, 0x9, 0x8302042, 0x824, 0x2c, 0x9, 0x6012e4, 0x182d, 0xff, 0x8
.long 0x0, 0x0, 0x0, 0x0, 0x0, 0x0, 0x0, 0x0, 0x0, 0x0, 0x0, 0x0, 0x0, 0x0, 0x0, 0x0
.long 0x0, 0x0, 0x0, 0x0, 0x0, 0x0, 0x0, 0x0
.long 0x112011, 0x1001, 0x9, 0x6, 0x12041, 0x1004, 0xc, 0x9, 0x32001, 0x1000, 0x18, 0x5, 0x42041, 0x1004, 0x1c, 0x5
.long 0x22021, 0x1002, 0x12, 0x9, 0x32, 0x1c1b, 0x2b, 0x9, 0x8402042, 0x824, 0x2c, 0x9, 0x6022e4, 0x182d, 0xff, 0x8
.long 0x0, 0x0, 0x0, 0x0, 0x0, 0x0, 0x0, 0x0, 0x0, 0x0, 0x0, 0x0, 0x0, 0x0, 0x0, 0x0
.long 0x0, 0x0, 0x0, 0x0, 0x0, 0x0, 0x0, 0x0
.long 0x113011, 0x1001, 0x9, 0x6, 0x13041, 0x1004, 0xc, 0x9, 0x33001, 0x1000, 0x18, 0x5, 0x43041, 0x1004, 0x1c, 0x5
.long 0x23021, 0x1002, 0x12, 0x9, 0x100032, 0x1c1b, 0x2b, 0x9, 0x8502042, 0x824, 0x2c, 0x9, 0x6032e4, 0x182d, 0xff, 0x8
.long 0x0, 0x0, 0x0, 0x0, 0x0, 0x0, 0x0, 0x0, 0x0, 0x0, 0x0, 0x0, 0x0, 0x0, 0x0, 0x0
.long 0x0, 0x0, 0x0, 0x0, 0x0, 0x0, 0x0, 0x0
.long 0x400c3e4, 0x82f087c, 0xff, 0x8, 0x0, 0x0, 0x0, 0x0, 0x0, 0x0, 0x0, 0x0, 0x0, 0x0, 0x0, 0x0
.long 0x0, 0x0, 0x0, 0x0, 0x0, 0x0, 0x0, 0x0, 0x0, 0x0, 0x0, 0x0, 0x0, 0x0, 0x0, 0x0
.long 0x0, 0x0, 0x0, 0x0, 0x0, 0x0, 0x0, 0x0, 0x0, 0x0, 0x0, 0x0, 0x0, 0x0, 0x0, 0x0
.long 0x0, 0x0, 0x0, 0x0, 0x0, 0x0, 0x0, 0x0
.long 0x400d3e4, 0x82f087d, 0xff, 0x8, 0x0, 0x0, 0x0, 0x0, 0x0, 0x0, 0x0, 0x0, 0x0, 0x0, 0x0, 0x0
.long 0x0, 0x0, 0x0, 0x0, 0x0, 0x0, 0x0, 0x0, 0x0, 0x0, 0x0, 0x0, 0x0, 0x0, 0x0, 0x0
.long 0x0, 0x0, 0x0, 0x0, 0x0, 0x0, 0x0, 0x0, 0x0, 0x0, 0x0, 0x0, 0x0, 0x0, 0x0, 0x0
.long 0x0, 0x0, 0x0, 0x0, 0x0, 0x0, 0x0, 0x0
.long 0x400e3e4, 0x82f087e, 0xff, 0x8, 0x0, 0x0, 0x0, 0x0, 0x0, 0x0, 0x0, 0x0, 0x0, 0x0, 0x0, 0x0
.long 0x0, 0x0, 0x0, 0x0, 0x0, 0x0, 0x0, 0x0, 0x0, 0x0, 0x0, 0x0, 0x0, 0x0, 0x0, 0x0
.long 0x0, 0x0, 0x0, 0x0, 0x0, 0x0, 0x0, 0x0, 0x0, 0x0, 0x0, 0x0, 0x0, 0x0, 0x0, 0x0
.long 0x0, 0x0, 0x0, 0x0, 0x0, 0x0, 0x0, 0x0
.long 0x400f3e4, 0x82f087f, 0xff, 0x8, 0x0, 0x0, 0x0, 0x0, 0x0, 0x0, 0x0, 0x0, 0x0, 0x0, 0x0, 0x0
.long 0x0, 0x0, 0x0, 0x0, 0x0, 0x0, 0x0, 0x0, 0x0, 0x0, 0x0, 0x0, 0x0, 0x0, 0x0, 0x0
.long 0x0, 0x0, 0x0, 0x0, 0x0, 0x0, 0x0, 0x0, 0x0, 0x0, 0x0, 0x0, 0x0, 0x0, 0x0, 0x0
.long 0x0, 0x0, 0x0, 0x0, 0x0, 0x0, 0x0, 0x0
.long 0x114011, 0x1001, 0x9, 0x6, 0x14041, 0x1004, 0xc, 0x9, 0x34001, 0x1000, 0x18, 0x5, 0x44041, 0x1004, 0x1c, 0x5
.long 0x24021, 0x1002, 0x12, 0x9, 0x1022, 0x1c1a, 0x2a, 0x9, 0x8203042, 0x824, 0x2c, 0x9, 0x6002f4, 0x182d, 0xff, 0x8
.long 0x0, 0x0, 0x0, 0x0, 0x0, 0x0, 0x0, 0x0, 0x0, 0x0, 0x0, 0x0, 0x0, 0x0, 0x0, 0x0
.long 0x0, 0x0, 0x0, 0x0, 0x0, 0x0, 0x0, 0x0
.long 0x115011, 0x1001, 0x9, 0x6, 0x15041, 0x1004, 0xc, 0x9, 0x35001, 0x1000, 0x18, 0x5, 0x45041, 0x1004, 0x1c, 0x5
.long 0x25021, 0x1002, 0x12, 0x9, 0x101022, 0x1c1a, 0x2a, 0x9, 0x8303042, 0x824, 0x2c, 0x9, 0x6012f4, 0x182d, 0xff, 0x8
.long 0x0, 0x0, 0x0, 0x0, 0x0, 0x0, 0x0, 0x0, 0x0, 0x0, 0x0, 0x0, 0x0, 0x0, 0x0, 0x0
.long 0x0, 0x0, 0x0, 0x0, 0x0, 0x0, 0x0, 0x0
.long 0x116011, 0x1001, 0x9, 0x6, 0x16041, 0x1004, 0xc, 0x9, 0x36001, 0x1000, 0x18, 0x5, 0x46041, 0x1004, 0x1c, 0x5
.long 0x26021, 0x1002, 0x12, 0x9, 0x1032, 0x1c1b, 0x2b, 0x9, 0x8403042, 0x824, 0x2c, 0x9, 0x6022f4, 0x182d, 0xff, 0x8
.long 0x0, 0x0, 0x0, 0x0, 0x0, 0x0, 0x0, 0x0, 0x0, 0x0, 0x0, 0x0, 0x0, 0x0, 0x0, 0x0
.long 0x0, 0x0, 0x0, 0x0, 0x0, 0x0, 0x0, 0x0
.long 0x117011, 0x1001, 0x9, 0x6, 0x17041, 0x1004, 0xc, 0x9, 0x37001, 0x1000, 0x18, 0x5, 0x47041, 0x1004, 0x1c, 0x5
.long 0x27021, 0x1002, 0x12, 0x9, 0x101032, 0x1c1b, 0x2b, 0x9, 0x8503042, 0x824, 0x2c, 0x9, 0x6032f4, 0x182d, 0xff, 0x8
.long 0x0, 0x0, 0x0, 0x0, 0x0, 0x0, 0x0, 0x0, 0x0, 0x0, 0x0, 0x0, 0x0, 0x0, 0x0, 0x0
.long 0x0, 0x0, 0x0, 0x0, 0x0, 0x0, 0x0, 0x0
.long 0x40003f4, 0x82f0870, 0xff, 0x8, 0x0, 0x0, 0x0, 0x0, 0x0, 0x0, 0x0, 0x0, 0x0, 0x0, 0x0, 0x0
.long 0x0, 0x0, 0x0, 0x0, 0x0, 0x0, 0x0, 0x0, 0x0, 0x0, 0x0, 0x0, 0x0, 0x0, 0x0, 0x0
.long 0x0, 0x0, 0x0, 0x0, 0x0, 0x0, 0x0, 0x0, 0x0, 0x0, 0x0, 0x0, 0x0, 0x0, 0x0, 0x0
.long 0x0, 0x0, 0x0, 0x0, 0x0, 0x0, 0x0, 0x0
.long 0x40013f4, 0x82f0871, 0xff, 0x8, 0x0, 0x0, 0x0, 0x0, 0x0, 0x0, 0x0, 0x0, 0x0, 0x0, 0x0, 0x0
.long 0x0, 0x0, 0x0, 0x0, 0x0, 0x0, 0x0, 0x0, 0x0, 0x0, 0x0, 0x0, 0x0, 0x0, 0x0, 0x0
.long 0x0, 0x0, 0x0, 0x0, 0x0, 0x0, 0x0, 0x0, 0x0, 0x0, 0x0, 0x0, 0x0, 0x0, 0x0, 0x0
.long 0x0, 0x0, 0x0, 0x0, 0x0, 0x0, 0x0, 0x0
.long 0x40023f4, 0x82f0872, 0xff, 0x8, 0x0, 0x0, 0x0, 0x0, 0x0, 0x0, 0x0, 0x0, 0x0, 0x0, 0x0, 0x0
.long 0x0, 0x0, 0x0, 0x0, 0x0, 0x0, 0x0, 0x0, 0x0, 0x0, 0x0, 0x0, 0x0, 0x0, 0x0, 0x0
.long 0x0, 0x0, 0x0, 0x0, 0x0, 0x0, 0x0, 0x0, 0x0, 0x0, 0x0, 0x0, 0x0, 0x0, 0x0, 0x0
.long 0x0, 0x0, 0x0, 0x0, 0x0, 0x0, 0x0, 0x0
.long 0x40033f4, 0x82f0873, 0xff, 0x8, 0x0, 0x0, 0x0, 0x0, 0x0, 0x0, 0x0, 0x0, 0x0, 0x0, 0x0, 0x0
.long 0x0, 0x0, 0x0, 0x0, 0x0, 0x0, 0x0, 0x0, 0x0, 0x0, 0x0, 0x0, 0x0, 0x0, 0x0, 0x0
.long 0x0, 0x0, 0x0, 0x0, 0x0, 0x0, 0x0, 0x0, 0x0, 0x0, 0x0, 0x0, 0x0, 0x0, 0x0, 0x0
.long 0x0, 0x0, 0x0, 0x0, 0x0, 0x0, 0x0, 0x0
.long 0x118011, 0x1001, 0x9, 0x6, 0x18041, 0x1004, 0xc, 0x9, 0x38001, 0x1000, 0x18, 0x5, 0x48041, 0x1004, 0x1c, 0x5
.long 0x28021, 0x1002, 0x12, 0x9, 0x2022, 0x1c1a, 0x2a, 0x9, 0x8200052, 0x1025, 0x2d, 0x9, 0xc000384, 0x82f203c, 0xff, 0x8
.long 0x0, 0x0, 0x0, 0x0, 0x0, 0x0, 0x0, 0x0, 0x0, 0x0, 0x0, 0x0, 0x0, 0x0, 0x0, 0x0
.long 0x0, 0x0, 0x0, 0x0, 0x0, 0x0, 0x0, 0x0
.long 0x119011, 0x1001, 0x9, 0x6, 0x19041, 0x1004, 0xc, 0x9, 0x39001, 0x1000, 0x18, 0x5, 0x49041, 0x1004, 0x1c, 0x5
.long 0x29021, 0x1002, 0x12, 0x9, 0x102022, 0x1c1a, 0x2a, 0x9, 0x8300052, 0x1025, 0x2d, 0x9, 0xc001384, 0x82f203c, 0xff, 0x8
.long 0x0, 0x0, 0x0, 0x0, 0x0, 0x0, 0x0, 0x0, 0x0, 0x0, 0x0, 0x0, 0x0, 0x0, 0x0, 0x0
.long 0x0, 0x0, 0x0, 0x0, 0x0, 0x0, 0x0, 0x0
.long 0x11a011, 0x1001, 0x9, 0x6, 0x1a041, 0x1004, 0xc, 0x9, 0x3a001, 0x1000, 0x18, 0x5, 0x4a041, 0x1004, 0x1c, 0x5
.long 0x2a021, 0x1002, 0x12, 0x9, 0x2032, 0x1c1b, 0x2b, 0x9, 0x8400052, 0x1025, 0x2d, 0x9, 0xc002384, 0x82f203c, 0xff, 0x8
.long 0x0, 0x0, 0x0, 0x0, 0x0, 0x0, 0x0, 0x0, 0x0, 0x0, 0x0, 0x0, 0x0, 0x0, 0x0, 0x0
.long 0x0, 0x0, 0x0, 0x0, 0x0, 0x0, 0x0, 0x0
.long 0x11b011, 0x1001, 0x9, 0x6, 0x1b041, 0x1004, 0xc, 0x9, 0x3b001, 0x1000, 0x18, 0x5, 0x4b041, 0x1004, 0x1c, 0x5
.long 0x2b021, 0x1002, 0x12, 0x9, 0x102032, 0x1c1b, 0x2b, 0x9, 0x8500052, 0x1025, 0x2d, 0x9, 0xc003384, 0x82f203c, 0xff, 0x8
.long 0x0, 0x0, 0x0, 0x0, 0x0, 0x0, 0x0, 0x0, 0x0, 0x0, 0x0, 0x0, 0x0, 0x0, 0x0, 0x0
.long 0x0, 0x0, 0x0, 0x0, 0x0, 0x0, 0x0, 0x0
.long 0x40043f4, 0x82f0874, 0xff, 0x8, 0x0, 0x0, 0x0, 0x0, 0x0, 0x0, 0x0, 0x0, 0x0, 0x0, 0x0, 0x0
.long 0x0, 0x0, 0x0, 0x0, 0x0, 0x0, 0x0, 0x0, 0x0, 0x0, 0x0, 0x0, 0x0, 0x0, 0x0, 0x0
.long 0x0, 0x0, 0x0, 0x0, 0x0, 0x0, 0x0, 0x0, 0x0, 0x0, 0x0, 0x0, 0x0, 0x0, 0x0, 0x0
.long 0x0, 0x0, 0x0, 0x0, 0x0, 0x0, 0x0, 0x0
.long 0x40053f4, 0x82f0875, 0xff, 0x8, 0x0, 0x0, 0x0, 0x0, 0x0, 0x0, 0x0, 0x0, 0x0, 0x0, 0x0, 0x0
.long 0x0, 0x0, 0x0, 0x0, 0x0, 0x0, 0x0, 0x0, 0x0, 0x0, 0x0, 0x0, 0x0, 0x0, 0x0, 0x0
.long 0x0, 0x0, 0x0, 0x0, 0x0, 0x0, 0x0, 0x0, 0x0, 0x0, 0x0, 0x0, 0x0, 0x0, 0x0, 0x0
.long 0x0, 0x0, 0x0, 0x0, 0x0, 0x0, 0x0, 0x0
.long 0x40063f4, 0x82f0876, 0xff, 0x8, 0x0, 0x0, 0x0, 0x0, 0x0, 0x0, 0x0, 0x0, 0x0, 0x0, 0x0, 0x0
.long 0x0, 0x0, 0x0, 0x0, 0x0, 0x0, 0x0, 0x0, 0x0, 0x0, 0x0, 0x0, 0x0, 0x0, 0x0, 0x0
.long 0x0, 0x0, 0x0, 0x0, 0x0, 0x0, 0x0, 0x0, 0x0, 0x0, 0x0, 0x0, 0x0, 0x0, 0x0, 0x0
.long 0x0, 0x0, 0x0, 0x0, 0x0, 0x0, 0x0, 0x0
.long 0x40073f4, 0x82f0877, 0xff, 0x8, 0x0, 0x0, 0x0, 0x0, 0x0, 0x0, 0x0, 0x0, 0x0, 0x0, 0x0, 0x0
.long 0x0, 0x0, 0x0, 0x0, 0x0, 0x0, 0x0, 0x0, 0x0, 0x0, 0x0, 0x0, 0x0, 0x0, 0x0, 0x0
.long 0x0, 0x0, 0x0, 0x0, 0x0, 0x0, 0x0, 0x0, 0x0, 0x0, 0x0, 0x0, 0x0, 0x0, 0x0, 0x0
.long 0x0, 0x0, 0x0, 0x0, 0x0, 0x0, 0x0, 0x0
.long 0x11c011, 0x1001, 0x9, 0x6, 0x1c041, 0x1004, 0xc, 0x9, 0x3c001, 0x1000, 0x18, 0x5, 0x30051, 0x1005, 0x1d, 0x5
.long 0x2c021, 0x1002, 0x12, 0x9, 0x3022, 0x1c1a, 0x2a, 0x9, 0x8201052, 0x1025, 0x2d, 0x9, 0xc004384, 0x82f203c, 0xff, 0x8
.long 0x0, 0x0, 0x0, 0x0, 0x0, 0x0, 0x0, 0x0, 0x0, 0x0, 0x0, 0x0, 0x0, 0x0, 0x0, 0x0
.long 0x0, 0x0, 0x0, 0x0, 0x0, 0x0, 0x0, 0x0
.long 0x11d011, 0x1001, 0x9, 0x6, 0x1d041, 0x1004, 0xc, 0x9, 0x3d001, 0x1000, 0x18, 0x5, 0x31051, 0x1005, 0x1d, 0x5
.long 0x2d021, 0x1002, 0x12, 0x9, 0x103022, 0x1c1a, 0x2a, 0x9, 0x8301052, 0x1025, 0x2d, 0x9, 0xc005384, 0x82f203c, 0xff, 0x8
.long 0x0, 0x0, 0x0, 0x0, 0x0, 0x0, 0x0, 0x0, 0x0, 0x0, 0x0, 0x0, 0x0, 0x0, 0x0, 0x0
.long 0x0, 0x0, 0x0, 0x0, 0x0, 0x0, 0x0, 0x0
.long 0x11e011, 0x1001, 0x9, 0x6, 0x1e041, 0x1004, 0xc, 0x9, 0x3e001, 0x1000, 0x18, 0x5, 0x32051, 0x1005, 0x1d, 0x5
.long 0x2e021, 0x1002, 0x12, 0x9, 0x3032, 0x1c1b, 0x2b, 0x9, 0x8401052, 0x1025, 0x2d, 0x9, 0xc006384, 0x82f203c, 0xff, 0x8
.long 0x0, 0x0, 0x0, 0x0, 0x0, 0x0, 0x0, 0x0, 0x0, 0x0, 0x0, 0x0, 0x0, 0x0, 0x0, 0x0
.long 0x0, 0x0, 0x0, 0x0, 0x0, 0x0, 0x0, 0x0
.long 0x11f011, 0x1001, 0x9, 0x6, 0x1f041, 0x1004, 0xc, 0x9, 0x3f001, 0x1000, 0x18, 0x5, 0x33051, 0x1005, 0x1d, 0x5
.long 0x2f021, 0x1002, 0x12, 0x9, 0x103032, 0x1c1b, 0x2b, 0x9, 0x8501052, 0x1025, 0x2d, 0x9, 0xc007384, 0x82f203c, 0xff, 0x8
.long 0x0, 0x0, 0x0, 0x0, 0x0, 0x0, 0x0, 0x0, 0x0, 0x0, 0x0, 0x0, 0x0, 0x0, 0x0, 0x0
.long 0x0, 0x0, 0x0, 0x0, 0x0, 0x0, 0x0, 0x0
.long 0x40083f4, 0x82f0878, 0xff, 0x8, 0x0, 0x0, 0x0, 0x0, 0x0, 0x0, 0x0, 0x0, 0x0, 0x0, 0x0, 0x0
.long 0x0, 0x0, 0x0, 0x0, 0x0, 0x0, 0x0, 0x0, 0x0, 0x0, 0x0, 0x0, 0x0, 0x0, 0x0, 0x0
.long 0x0, 0x0, 0x0, 0x0, 0x0, 0x0, 0x0, 0x0, 0x0, 0x0, 0x0, 0x0, 0x0, 0x0, 0x0, 0x0
.long 0x0, 0x0, 0x0, 0x0, 0x0, 0x0, 0x0, 0x0
.long 0x40093f4, 0x82f0879, 0xff, 0x8, 0x0, 0x0, 0x0, 0x0, 0x0, 0x0, 0x0, 0x0, 0x0, 0x0, 0x0, 0x0
.long 0x0, 0x0, 0x0, 0x0, 0x0, 0x0, 0x0, 0x0, 0x0, 0x0, 0x0, 0x0, 0x0, 0x0, 0x0, 0x0
.long 0x0, 0x0, 0x0, 0x0, 0x0, 0x0, 0x0, 0x0, 0x0, 0x0, 0x0, 0x0, 0x0, 0x0, 0x0, 0x0
.long 0x0, 0x0, 0x0, 0x0, 0x0, 0x0, 0x0, 0x0
.long 0x400a3f4, 0x82f087a, 0xff, 0x8, 0x0, 0x0, 0x0, 0x0, 0x0, 0x0, 0x0, 0x0, 0x0, 0x0, 0x0, 0x0
.long 0x0, 0x0, 0x0, 0x0, 0x0, 0x0, 0x0, 0x0, 0x0, 0x0, 0x0, 0x0, 0x0, 0x0, 0x0, 0x0
.long 0x0, 0x0, 0x0, 0x0, 0x0, 0x0, 0x0, 0x0, 0x0, 0x0, 0x0, 0x0, 0x0, 0x0, 0x0, 0x0
.long 0x0, 0x0, 0x0, 0x0, 0x0, 0x0, 0x0, 0x0
.long 0x400b3f4, 0x82f087b, 0xff, 0x8, 0x0, 0x0, 0x0, 0x0, 0x0, 0x0, 0x0, 0x0, 0x0, 0x0, 0x0, 0x0
.long 0x0, 0x0, 0x0, 0x0, 0x0, 0x0, 0x0, 0x0, 0x0, 0x0, 0x0, 0x0, 0x0, 0x0, 0x0, 0x0
.long 0x0, 0x0, 0x0, 0x0, 0x0, 0x0, 0x0, 0x0, 0x0, 0x0, 0x0, 0x0, 0x0, 0x0, 0x0, 0x0
.long 0x0, 0x0, 0x0, 0x0, 0x0, 0x0, 0x0, 0x0
.long 0x200011, 0x1001, 0x9, 0x6, 0x51, 0x1005, 0xd, 0x9, 0x40001, 0x1000, 0x18, 0x5, 0x34051, 0x1005, 0x1d, 0x5
.long 0x800003, 0x8301010, 0x20, 0x8, 0x20071, 0x1007, 0x17, 0x8, 0x4002c3, 0x30301015, 0x25, 0x8, 0x8202022, 0x822, 0x2a, 0x8
.long 0xc606072, 0x2027, 0x3c, 0x5, 0xc008394, 0x82f203c, 0xff, 0x8, 0x0, 0x0, 0x0, 0x0, 0x0, 0x0, 0x0, 0x0
.long 0x0, 0x0, 0x0, 0x0, 0x0, 0x0, 0x0, 0x0
.long 0x201011, 0x1001, 0x9, 0x6, 0x1051, 0x1005, 0xd, 0x9, 0x41001, 0x1000, 0x18, 0x5, 0x35051, 0x1005, 0x1d, 0x5
.long 0x801003, 0x8301010, 0x20, 0x8, 0x21071, 0x1007, 0x17, 0x8, 0x4012c3, 0x30301015, 0x25, 0x8, 0x8302022, 0x822, 0x2a, 0x8
.long 0xc706072, 0x2027, 0x3c, 0x5, 0xc009394, 0x82f203c, 0xff, 0x8, 0x0, 0x0, 0x0, 0x0, 0x0, 0x0, 0x0, 0x0
.long 0x0, 0x0, 0x0, 0x0, 0x0, 0x0, 0x0, 0x0
.long 0x202011, 0x1001, 0x9, 0x6, 0x2051, 0x1005, 0xd, 0x9, 0x42001, 0x1000, 0x18, 0x5, 0x36051, 0x1005, 0x1d, 0x5
.long 0x802003, 0x8301010, 0x20, 0x8, 0x22071, 0x1007, 0x17, 0x8, 0x4022c3, 0x30301015, 0x25, 0x8, 0x8402022, 0x822, 0x2a, 0x8
.long 0xc806072, 0x2027, 0x3c, 0x5, 0xc00a394, 0x82f203c, 0xff, 0x8, 0x0, 0x0, 0x0, 0x0, 0x0, 0x0, 0x0, 0x0
.long 0x0, 0x0, 0x0, 0x0, 0x0, 0x0, 0x0, 0x0
.long 0x203011, 0x1001, 0x9, 0x6, 0x3051, 0x1005, 0xd, 0x9, 0x43001, 0x1000, 0x18, 0x5, 0x37051, 0x1005, 0x1d, 0x5
.long 0x803003, 0x8301010, 0x20, 0x8, 0x23071, 0x1007, 0x17, 0x8, 0x4032c3, 0x30301015, 0x25, 0x8, 0x8502022, 0x822, 0x2a, 0x8
.long 0xc906072, 0x2027, 0x3c, 0x5, 0xc00b394, 0x82f203c, 0xff, 0x8, 0x0, 0x0, 0x0, 0x0, 0x0, 0x0, 0x0, 0x0
.long 0x0, 0x0, 0x0, 0x0, 0x0, 0x0, 0x0, 0x0
.long 0x400c3f4, 0x82f087c, 0xff, 0x8, 0x0, 0x0, 0x0, 0x0, 0x0, 0x0, 0x0, 0x0, 0x0, 0x0, 0x0, 0x0
.long 0x0, 0x0, 0x0, 0x0, 0x0, 0x0, 0x0, 0x0, 0x0, 0x0, 0x0, 0x0, 0x0, 0x0, 0x0, 0x0
.long 0x0, 0x0, 0x0, 0x0, 0x0, 0x0, 0x0, 0x0, 0x0, 0x0, 0x0, 0x0, 0x0, 0x0, 0x0, 0x0
.long 0x0, 0x0, 0x0, 0x0, 0x0, 0x0, 0x0, 0x0
.long 0x400d3f4, 0x82f087d, 0xff, 0x8, 0x0, 0x0, 0x0, 0x0, 0x0, 0x0, 0x0, 0x0, 0x0, 0x0, 0x0, 0x0
.long 0x0, 0x0, 0x0, 0x0, 0x0, 0x0, 0x0, 0x0, 0x0, 0x0, 0x0, 0x0, 0x0, 0x0, 0x0, 0x0
.long 0x0, 0x0, 0x0, 0x0, 0x0, 0x0, 0x0, 0x0, 0x0, 0x0, 0x0, 0x0, 0x0, 0x0, 0x0, 0x0
.long 0x0, 0x0, 0x0, 0x0, 0x0, 0x0, 0x0, 0x0
.long 0x400e3f4, 0x82f087e, 0xff, 0x8, 0x0, 0x0, 0x0, 0x0, 0x0, 0x0, 0x0, 0x0, 0x0, 0x0, 0x0, 0x0
.long 0x0, 0x0, 0x0, 0x0, 0x0, 0x0, 0x0, 0x0, 0x0, 0x0, 0x0, 0x0, 0x0, 0x0, 0x0, 0x0
.long 0x0, 0x0, 0x0, 0x0, 0x0, 0x0, 0x0, 0x0, 0x0, 0x0, 0x0, 0x0, 0x0, 0x0, 0x0, 0x0
.long 0x0, 0x0, 0x0, 0x0, 0x0, 0x0, 0x0, 0x0
.long 0x400f3f4, 0x82f087f, 0xff, 0x8, 0x0, 0x0, 0x0, 0x0, 0x0, 0x0, 0x0, 0x0, 0x0, 0x0, 0x0, 0x0
.long 0x0, 0x0, 0x0, 0x0, 0x0, 0x0, 0x0, 0x0, 0x0, 0x0, 0x0, 0x0, 0x0, 0x0, 0x0, 0x0
.long 0x0, 0x0, 0x0, 0x0, 0x0, 0x0, 0x0, 0x0, 0x0, 0x0, 0x0, 0x0, 0x0, 0x0, 0x0, 0x0
.long 0x0, 0x0, 0x0, 0x0, 0x0, 0x0, 0x0, 0x0
.long 0x204011, 0x1001, 0x9, 0x6, 0x4051, 0x1005, 0xd, 0x9, 0x44001, 0x1000, 0x18, 0x5, 0x38051, 0x1005, 0x1d, 0x5
.long 0x804003, 0x8301010, 0x20, 0x8, 0x24071, 0x1007, 0x17, 0x8, 0x4042c3, 0x30301015, 0x25, 0x8, 0x8203022, 0x822, 0x2a, 0x8
.long 0xc607072, 0x2027, 0x3c, 0x5, 0xc00c394, 0x82f203c, 0xff, 0x8, 0x0, 0x0, 0x0, 0x0, 0x0, 0x0, 0x0, 0x0
.long 0x0, 0x0, 0x0, 0x0, 0x0, 0x0, 0x0, 0x0
.long 0x205011, 0x1001, 0x9, 0x6, 0x5051, 0x1005, 0xd, 0x9, 0x45001, 0x1000, 0x18, 0x5, 0x39051, 0x1005, 0x1d, 0x5
.long 0x805003, 0x8301010, 0x20, 0x8, 0x25071, 0x1007, 0x17, 0x8, 0x4052c3, 0x30301015, 0x25, 0x8, 0x8303022, 0x822, 0x2a, 0x8
.long 0xc707072, 0x2027, 0x3c, 0x5, 0xc00d394, 0x82f203c, 0xff, 0x8, 0x0, 0x0, 0x0, 0x0, 0x0, 0x0, 0x0, 0x0
.long 0x0, 0x0, 0x0, 0x0, 0x0, 0x0, 0x0, 0x0
.long 0x206011, 0x1001, 0x9, 0x6, 0x6051, 0x1005, 0xd, 0x9, 0x46001, 0x1000, 0x18, 0x5, 0x3a051, 0x1005, 0x1d, 0x5
.long 0x806003, 0x8301010, 0x20, 0x8, 0x26071, 0x1007, 0x17, 0x8, 0x4062c3, 0x30301015, 0x25, 0x8, 0x8403022, 0x822, 0x2a, 0x8
.long 0xc807072, 0x2027, 0x3c, 0x5, 0xc00e394, 0x82f203c, 0xff, 0x8, 0x0, 0x0, 0x0, 0x0, 0x0, 0x0, 0x0, 0x0
.long 0x0, 0x0, 0x0, 0x0, 0x0, 0x0, 0x0, 0x0
.long 0x207011, 0x1001, 0x9, 0x6, 0x7051, 0x1005, 0xd, 0x9, 0x47001, 0x1000, 0x18, 0x5, 0x3b051, 0x1005, 0x1d, 0x5
.long 0x807003, 0x8301010, 0x20, 0x8, 0x27071, 0x1007, 0x17, 0x8, 0x4072c3, 0x30301015, 0x25, 0x8, 0x8503022, 0x822, 0x2a, 0x8
.long 0xc907072, 0x2027, 0x3c, 0x5, 0xc00f394, 0x82f203c, 0xff, 0x8, 0x0, 0x0, 0x0, 0x0, 0x0, 0x0, 0x0, 0x0
.long 0x0, 0x0, 0x0, 0x0, 0x0, 0x0, 0x0, 0x0
.long 0x600204, 0x182c, 0xff, 0x8, 0x0, 0x0, 0x0, 0x0, 0x0, 0x0, 0x0, 0x0, 0x0, 0x0, 0x0, 0x0
.long 0x0, 0x0, 0x0, 0x0, 0x0, 0x0, 0x0, 0x0, 0x0, 0x0, 0x0, 0x0, 0x0, 0x0, 0x0, 0x0
.long 0x0, 0x0, 0x0, 0x0, 0x0, 0x0, 0x0, 0x0, 0x0, 0x0, 0x0, 0x0, 0x0, 0x0, 0x0, 0x0
.long 0x0, 0x0, 0x0, 0x0, 0x0, 0x0, 0x0, 0x0
.long 0x601204, 0x182c, 0xff, 0x8, 0x0, 0x0, 0x0, 0x0, 0x0, 0x0, 0x0, 0x0, 0x0, 0x0, 0x0, 0x0
.long 0x0, 0x0, 0x0, 0x0, 0x0, 0x0, 0x0, 0x0, 0x0, 0x0, 0x0, 0x0, 0x0, 0x0, 0x0, 0x0
.long 0x0, 0x0, 0x0, 0x0, 0x0, 0x0, 0x0, 0x0, 0x0, 0x0, 0x0, 0x0, 0x0, 0x0, 0x0, 0x0
.long 0x0, 0x0, 0x0, 0x0, 0x0, 0x0, 0x0, 0x0
.long 0x602204, 0x182c, 0xff, 0x8, 0x0, 0x0, 0x0, 0x0, 0x0, 0x0, 0x0, 0x0, 0x0, 0x0, 0x0, 0x0
.long 0x0, 0x0, 0x0, 0x0, 0x0, 0x0, 0x0, 0x0, 0x0, 0x0, 0x0, 0x0, 0x0, 0x0, 0x0, 0x0
.long 0x0, 0x0, 0x0, 0x0, 0x0, 0x0, 0x0, 0x0, 0x0, 0x0, 0x0, 0x0, 0x0, 0x0, 0x0, 0x0
.long 0x0, 0x0, 0x0, 0x0, 0x0, 0x0, 0x0, 0x0
.long 0x603204, 0x182c, 0xff, 0x8, 0x0, 0x0, 0x0, 0x0, 0x0, 0x0, 0x0, 0x0, 0x0, 0x0, 0x0, 0x0
.long 0x0, 0x0, 0x0, 0x0, 0x0, 0x0, 0x0, 0x0, 0x0, 0x0, 0x0, 0x0, 0x0, 0x0, 0x0, 0x0
.long 0x0, 0x0, 0x0, 0x0, 0x0, 0x0, 0x0, 0x0, 0x0, 0x0, 0x0, 0x0, 0x0, 0x0, 0x0, 0x0
.long 0x0, 0x0, 0x0, 0x0, 0x0, 0x0, 0x0, 0x0
.long 0x208011, 0x1001, 0x9, 0x6, 0x8051, 0x1005, 0xd, 0x9, 0x48001, 0x1000, 0x18, 0x5, 0x3c051, 0x1005, 0x1d, 0x5
.long 0x800083, 0x10301011, 0x21, 0x8, 0x28071, 0x1007, 0x17, 0x8, 0x8200012, 0x821, 0x29, 0x9, 0x8206062, 0x2826, 0x2e, 0x5
.long 0x600124, 0x182a, 0xff, 0x8, 0xc0083a4, 0x82f203c, 0xff, 0x8, 0x0, 0x0, 0x0, 0x0, 0x0, 0x0, 0x0, 0x0
.long 0x0, 0x0, 0x0, 0x0, 0x0, 0x0, 0x0, 0x0
.long 0x209011, 0x1001, 0x9, 0x6, 0x9051, 0x1005, 0xd, 0x9, 0x49001, 0x1000, 0x18, 0x5, 0x3d051, 0x1005, 0x1d, 0x5
.long 0x801083, 0x10301011, 0x21, 0x8, 0x29071, 0x1007, 0x17, 0x8, 0x8300012, 0x821, 0x29, 0x9, 0x8306062, 0x2826, 0x2e, 0x5
.long 0x601124, 0x182a, 0xff, 0x8, 0xc0093a4, 0x82f203c, 0xff, 0x8, 0x0, 0x0, 0x0, 0x0, 0x0, 0x0, 0x0, 0x0
.long 0x0, 0x0, 0x0, 0x0, 0x0, 0x0, 0x0, 0x0
.long 0x20a011, 0x1001, 0x9, 0x6, 0xa051, 0x1005, 0xd, 0x9, 0x4a001, 0x1000, 0x18, 0x5, 0x3e051, 0x1005, 0x1d, 0x5
.long 0x802083, 0x10301011, 0x21, 0x8, 0x2a071, 0x1007, 0x17, 0x8, 0x8400012, 0x821, 0x29, 0x9, 0x8406062, 0x2826, 0x2e, 0x5
.long 0x602124, 0x182a, 0xff, 0x8, 0xc00a3a4, 0x82f203c, 0xff, 0x8, 0x0, 0x0, 0x0, 0x0, 0x0, 0x0, 0x0, 0x0
.long 0x0, 0x0, 0x0, 0x0, 0x0, 0x0, 0x0, 0x0
.long 0x20b011, 0x1001, 0x9, 0x6, 0xb051, 0x1005, 0xd, 0x9, 0x4b001, 0x1000, 0x18, 0x5, 0x3f051, 0x1005, 0x1d, 0x5
.long 0x803083, 0x10301011, 0x21, 0x8, 0x2b071, 0x1007, 0x17, 0x8, 0x8500012, 0x821, 0x29, 0x9, 0x8506062, 0x2826, 0x2e, 0x5
.long 0x603124, 0x182a, 0xff, 0x8, 0xc00b3a4, 0x82f203c, 0xff, 0x8, 0x0, 0x0, 0x0, 0x0, 0x0, 0x0, 0x0, 0x0
.long 0x0, 0x0, 0x0, 0x0, 0x0, 0x0, 0x0, 0x0
.long 0x600214, 0x182c, 0xff, 0x8, 0x0, 0x0, 0x0, 0x0, 0x0, 0x0, 0x0, 0x0, 0x0, 0x0, 0x0, 0x0
.long 0x0, 0x0, 0x0, 0x0, 0x0, 0x0, 0x0, 0x0, 0x0, 0x0, 0x0, 0x0, 0x0, 0x0, 0x0, 0x0
.long 0x0, 0x0, 0x0, 0x0, 0x0, 0x0, 0x0, 0x0, 0x0, 0x0, 0x0, 0x0, 0x0, 0x0, 0x0, 0x0
.long 0x0, 0x0, 0x0, 0x0, 0x0, 0x0, 0x0, 0x0
.long 0x601214, 0x182c, 0xff, 0x8, 0x0, 0x0, 0x0, 0x0, 0x0, 0x0, 0x0, 0x0, 0x0, 0x0, 0x0, 0x0
.long 0x0, 0x0, 0x0, 0x0, 0x0, 0x0, 0x0, 0x0, 0x0, 0x0, 0x0, 0x0, 0x0, 0x0, 0x0, 0x0
.long 0x0, 0x0, 0x0, 0x0, 0x0, 0x0, 0x0, 0x0, 0x0, 0x0, 0x0, 0x0, 0x0, 0x0, 0x0, 0x0
.long 0x0, 0x0, 0x0, 0x0, 0x0, 0x0, 0x0, 0x0
.long 0x602214, 0x182c, 0xff, 0x8, 0x0, 0x0, 0x0, 0x0, 0x0, 0x0, 0x0, 0x0, 0x0, 0x0, 0x0, 0x0
.long 0x0, 0x0, 0x0, 0x0, 0x0, 0x0, 0x0, 0x0, 0x0, 0x0, 0x0, 0x0, 0x0, 0x0, 0x0, 0x0
.long 0x0, 0x0, 0x0, 0x0, 0x0, 0x0, 0x0, 0x0, 0x0, 0x0, 0x0, 0x0, 0x0, 0x0, 0x0, 0x0
.long 0x0, 0x0, 0x0, 0x0, 0x0, 0x0, 0x0, 0x0
.long 0x603214, 0x182c, 0xff, 0x8, 0x0, 0x0, 0x0, 0x0, 0x0, 0x0, 0x0, 0x0, 0x0, 0x0, 0x0, 0x0
.long 0x0, 0x0, 0x0, 0x0, 0x0, 0x0, 0x0, 0x0, 0x0, 0x0, 0x0, 0x0, 0x0, 0x0, 0x0, 0x0
.long 0x0, 0x0, 0x0, 0x0, 0x0, 0x0, 0x0, 0x0, 0x0, 0x0, 0x0, 0x0, 0x0, 0x0, 0x0, 0x0
.long 0x0, 0x0, 0x0, 0x0, 0x0, 0x0, 0x0, 0x0
.long 0x20c011, 0x1001, 0x9, 0x6, 0xc051, 0x1005, 0xd, 0x9, 0x30011, 0x1001, 0x19, 0x5, 0x40051, 0x1005, 0x1d, 0x5
.long 0x804083, 0x10301011, 0x21, 0x8, 0x2c071, 0x1007, 0x17, 0x8, 0x8201012, 0x821, 0x29, 0x9, 0x8207062, 0x2826, 0x2e, 0x5
.long 0x600134, 0x182a, 0xff, 0x8, 0xc00c3a4, 0x82f203c, 0xff, 0x8, 0x0, 0x0, 0x0, 0x0, 0x0, 0x0, 0x0, 0x0
.long 0x0, 0x0, 0x0, 0x0, 0x0, 0x0, 0x0, 0x0
.long 0x20d011, 0x1001, 0x9, 0x6, 0xd051, 0x1005, 0xd, 0x9, 0x31011, 0x1001, 0x19, 0x5, 0x41051, 0x1005, 0x1d, 0x5
.long 0x805083, 0x10301011, 0x21, 0x8, 0x2d071, 0x1007, 0x17, 0x8, 0x8301012, 0x821, 0x29, 0x9, 0x8307062, 0x2826, 0x2e, 0x5
.long 0x601134, 0x182a, 0xff, 0x8, 0xc00d3a4, 0x82f203c, 0xff, 0x8, 0x0, 0x0, 0x0, 0x0, 0x0, 0x0, 0x0, 0x0
.long 0x0, 0x0, 0x0, 0x0, 0x0, 0x0, 0x0, 0x0
.long 0x20e011, 0x1001, 0x9, 0x6, 0xe051, 0x1005, 0xd, 0x9, 0x32011, 0x1001, 0x19, 0x5, 0x42051, 0x1005, 0x1d, 0x5
.long 0x806083, 0x10301011, 0x21, 0x8, 0x2e071, 0x1007, 0x17, 0x8, 0x8401012, 0x821, 0x29, 0x9, 0x8407062, 0x2826, 0x2e, 0x5
.long 0x602134, 0x182a, 0xff, 0x8, 0xc00e3a4, 0x82f203c, 0xff, 0x8, 0x0, 0x0, 0x0, 0x0, 0x0, 0x0, 0x0, 0x0
.long 0x0, 0x0, 0x0, 0x0, 0x0, 0x0, 0x0, 0x0
.long 0x20f011, 0x1001, 0x9, 0x6, 0xf051, 0x1005, 0xd, 0x9, 0x33011, 0x1001, 0x19, 0x5, 0x43051, 0x1005, 0x1d, 0x5
.long 0x807083, 0x10301011, 0x21, 0x8, 0x2f071, 0x1007, 0x17, 0x8, 0x8501012, 0x821, 0x29, 0x9, 0x8507062, 0x2826, 0x2e, 0x5
.long 0x603134, 0x182a, 0xff, 0x8, 0xc00f3a4, 0x82f203c, 0xff, 0x8, 0x0, 0x0, 0x0, 0x0, 0x0, 0x0, 0x0, 0x0
.long 0x0, 0x0, 0x0, 0x0, 0x0, 0x0, 0x0, 0x0
.long 0x600224, 0x182c, 0xff, 0x8, 0x0, 0x0, 0x0, 0x0, 0x0, 0x0, 0x0, 0x0, 0x0, 0x0, 0x0, 0x0
.long 0x0, 0x0, 0x0, 0x0, 0x0, 0x0, 0x0, 0x0, 0x0, 0x0, 0x0, 0x0, 0x0, 0x0, 0x0, 0x0
.long 0x0, 0x0, 0x0, 0x0, 0x0, 0x0, 0x0, 0x0, 0x0, 0x0, 0x0, 0x0, 0x0, 0x0, 0x0, 0x0
.long 0x0, 0x0, 0x0, 0x0, 0x0, 0x0, 0x0, 0x0
.long 0x601224, 0x182c, 0xff, 0x8, 0x0, 0x0, 0x0, 0x0, 0x0, 0x0, 0x0, 0x0, 0x0, 0x0, 0x0, 0x0
.long 0x0, 0x0, 0x0, 0x0, 0x0, 0x0, 0x0, 0x0, 0x0, 0x0, 0x0, 0x0, 0x0, 0x0, 0x0, 0x0
.long 0x0, 0x0, 0x0, 0x0, 0x0, 0x0, 0x0, 0x0, 0x0, 0x0, 0x0, 0x0, 0x0, 0x0, 0x0, 0x0
.long 0x0, 0x0, 0x0, 0x0, 0x0, 0x0, 0x0, 0x0
.long 0x602224, 0x182c, 0xff, 0x8, 0x0, 0x0, 0x0, 0x0, 0x0, 0x0, 0x0, 0x0, 0x0, 0x0, 0x0, 0x0
.long 0x0, 0x0, 0x0, 0x0, 0x0, 0x0, 0x0, 0x0, 0x0, 0x0, 0x0, 0x0, 0x0, 0x0, 0x0, 0x0
.long 0x0, 0x0, 0x0, 0x0, 0x0, 0x0, 0x0, 0x0, 0x0, 0x0, 0x0, 0x0, 0x0, 0x0, 0x0, 0x0
.long 0x0, 0x0, 0x0, 0x0, 0x0, 0x0, 0x0, 0x0
.long 0x603224, 0x182c, 0xff, 0x8, 0x0, 0x0, 0x0, 0x0, 0x0, 0x0, 0x0, 0x0, 0x0, 0x0, 0x0, 0x0
.long 0x0, 0x0, 0x0, 0x0, 0x0, 0x0, 0x0, 0x0, 0x0, 0x0, 0x0, 0x0, 0x0, 0x0, 0x0, 0x0
.long 0x0, 0x0, 0x0, 0x0, 0x0, 0x0, 0x0, 0x0, 0x0, 0x0, 0x0, 0x0, 0x0, 0x0, 0x0, 0x0
.long 0x0, 0x0, 0x0, 0x0, 0x0, 0x0, 0x0, 0x0
.long 0x210011, 0x1001, 0x9, 0x6, 0x10051, 0x1005, 0xd, 0x9, 0x34011, 0x1001, 0x19, 0x5, 0x44051, 0x1005, 0x1d, 0x5
.long 0x20031, 0x1003, 0x13, 0x9, 0x42, 0x1c1c, 0x2c, 0x9, 0x8202052, 0x1025, 0x2d, 0x9, 0xc008384, 0x82f203c, 0xff, 0x8
.long 0x0, 0x0, 0x0, 0x0, 0x0, 0x0, 0x0, 0x0, 0x0, 0x0, 0x0, 0x0, 0x0, 0x0, 0x0, 0x0
.long 0x0, 0x0, 0x0, 0x0, 0x0, 0x0, 0x0, 0x0
.long 0x211011, 0x1001, 0x9, 0x6, 0x11051, 0x1005, 0xd, 0x9, 0x35011, 0x1001, 0x19, 0x5, 0x45051, 0x1005, 0x1d, 0x5
.long 0x21031, 0x1003, 0x13, 0x9, 0x100042, 0x1c1c, 0x2c, 0x9, 0x8302052, 0x1025, 0x2d, 0x9, 0xc009384, 0x82f203c, 0xff, 0x8
.long 0x0, 0x0, 0x0, 0x0, 0x0, 0x0, 0x0, 0x0, 0x0, 0x0, 0x0, 0x0, 0x0, 0x0, 0x0, 0x0
.long 0x0, 0x0, 0x0, 0x0, 0x0, 0x0, 0x0, 0x0
.long 0x212011, 0x1001, 0x9, 0x6, 0x12051, 0x1005, 0xd, 0x9, 0x36011, 0x1001, 0x19, 0x5, 0x46051, 0x1005, 0x1d, 0x5
.long 0x22031, 0x1003, 0x13, 0x9, 0x52, 0x1c1d, 0x2d, 0x9, 0x8402052, 0x1025, 0x2d, 0x9, 0xc00a384, 0x82f203c, 0xff, 0x8
.long 0x0, 0x0, 0x0, 0x0, 0x0, 0x0, 0x0, 0x0, 0x0, 0x0, 0x0, 0x0, 0x0, 0x0, 0x0, 0x0
.long 0x0, 0x0, 0x0, 0x0, 0x0, 0x0, 0x0, 0x0
.long 0x213011, 0x1001, 0x9, 0x6, 0x13051, 0x1005, 0xd, 0x9, 0x37011, 0x1001, 0x19, 0x5, 0x47051, 0x1005, 0x1d, 0x5
.long 0x23031, 0x1003, 0x13, 0x9, 0x100052, 0x1c1d, 0x2d, 0x9, 0x8502052, 0x1025, 0x2d, 0x9, 0xc00b384, 0x82f203c, 0xff, 0x8
.long 0x0, 0x0, 0x0, 0x0, 0x0, 0x0, 0x0, 0x0, 0x0, 0x0, 0x0, 0x0, 0x0, 0x0, 0x0, 0x0
.long 0x0, 0x0, 0x0, 0x0, 0x0, 0x0, 0x0, 0x0
.long 0x600234, 0x182c, 0xff, 0x8, 0x0, 0x0, 0x0, 0x0, 0x0, 0x0, 0x0, 0x0, 0x0, 0x0, 0x0, 0x0
.long 0x0, 0x0, 0x0, 0x0, 0x0, 0x0, 0x0, 0x0, 0x0, 0x0, 0x0, 0x0, 0x0, 0x0, 0x0, 0x0
.long 0x0, 0x0, 0x0, 0x0, 0x0, 0x0, 0x0, 0x0, 0x0, 0x0, 0x0, 0x0, 0x0, 0x0, 0x0, 0x0
.long 0x0, 0x0, 0x0, 0x0, 0x0, 0x0, 0x0, 0x0
.long 0x601234, 0x182c, 0xff, 0x8, 0x0, 0x0, 0x0, 0x0, 0x0, 0x0, 0x0, 0x0, 0x0, 0x0, 0x0, 0x0
.long 0x0, 0x0, 0x0, 0x0, 0x0, 0x0, 0x0, 0x0, 0x0, 0x0, 0x0, 0x0, 0x0, 0x0, 0x0, 0x0
.long 0x0, 0x0, 0x0, 0x0, 0x0, 0x0, 0x0, 0x0, 0x0, 0x0, 0x0, 0x0, 0x0, 0x0, 0x0, 0x0
.long 0x0, 0x0, 0x0, 0x0, 0x0, 0x0, 0x0, 0x0
.long 0x602234, 0x182c, 0xff, 0x8, 0x0, 0x0, 0x0, 0x0, 0x0, 0x0, 0x0, 0x0, 0x0, 0x0, 0x0, 0x0
.long 0x0, 0x0, 0x0, 0x0, 0x0, 0x0, 0x0, 0x0, 0x0, 0x0, 0x0, 0x0, 0x0, 0x0, 0x0, 0x0
.long 0x0, 0x0, 0x0, 0x0, 0x0, 0x0, 0x0, 0x0, 0x0, 0x0, 0x0, 0x0, 0x0, 0x0, 0x0, 0x0
.long 0x0, 0x0, 0x0, 0x0, 0x0, 0x0, 0x0, 0x0
.long 0x603234, 0x182c, 0xff, 0x8, 0x0, 0x0, 0x0, 0x0, 0x0, 0x0, 0x0, 0x0, 0x0, 0x0, 0x0, 0x0
.long 0x0, 0x0, 0x0, 0x0, 0x0, 0x0, 0x0, 0x0, 0x0, 0x0, 0x0, 0x0, 0x0, 0x0, 0x0, 0x0
.long 0x0, 0x0, 0x0, 0x0, 0x0, 0x0, 0x0, 0x0, 0x0, 0x0, 0x0, 0x0, 0x0, 0x0, 0x0, 0x0
.long 0x0, 0x0, 0x0, 0x0, 0x0, 0x0, 0x0, 0x0
.long 0x214011, 0x1001, 0x9, 0x6, 0x14051, 0x1005, 0xd, 0x9, 0x38011, 0x1001, 0x19, 0x5, 0x48051, 0x1005, 0x1d, 0x5
.long 0x24031, 0x1003, 0x13, 0x9, 0x1042, 0x1c1c, 0x2c, 0x9, 0x8203052, 0x1025, 0x2d, 0x9, 0xc00c384, 0x82f203c, 0xff, 0x8
.long 0x0, 0x0, 0x0, 0x0, 0x0, 0x0, 0x0, 0x0, 0x0, 0x0, 0x0, 0x0, 0x0, 0x0, 0x0, 0x0
.long 0x0, 0x0, 0x0, 0x0, 0x0, 0x0, 0x0, 0x0
.long 0x215011, 0x1001, 0x9, 0x6, 0x15051, 0x1005, 0xd, 0x9, 0x39011, 0x1001, 0x19, 0x5, 0x49051, 0x1005, 0x1d, 0x5
.long 0x25031, 0x1003, 0x13, 0x9, 0x101042, 0x1c1c, 0x2c, 0x9, 0x8303052, 0x1025, 0x2d, 0x9, 0xc00d384, 0x82f203c, 0xff, 0x8
.long 0x0, 0x0, 0x0, 0x0, 0x0, 0x0, 0x0, 0x0, 0x0, 0x0, 0x0, 0x0, 0x0, 0x0, 0x0, 0x0
.long 0x0, 0x0, 0x0, 0x0, 0x0, 0x0, 0x0, 0x0
.long 0x216011, 0x1001, 0x9, 0x6, 0x16051, 0x1005, 0xd, 0x9, 0x3a011, 0x1001, 0x19, 0x5, 0x4a051, 0x1005, 0x1d, 0x5
.long 0x26031, 0x1003, 0x13, 0x9, 0x1052, 0x1c1d, 0x2d, 0x9, 0x8403052, 0x1025, 0x2d, 0x9, 0xc00e384, 0x82f203c, 0xff, 0x8
.long 0x0, 0x0, 0x0, 0x0, 0x0, 0x0, 0x0, 0x0, 0x0, 0x0, 0x0, 0x0, 0x0, 0x0, 0x0, 0x0
.long 0x0, 0x0, 0x0, 0x0, 0x0, 0x0, 0x0, 0x0
.long 0x217011, 0x1001, 0x9, 0x6, 0x17051, 0x1005, 0xd, 0x9, 0x3b011, 0x1001, 0x19, 0x5, 0x4b051, 0x1005, 0x1d, 0x5
.long 0x27031, 0x1003, 0x13, 0x9, 0x101052, 0x1c1d, 0x2d, 0x9, 0x8503052, 0x1025, 0x2d, 0x9, 0xc00f384, 0x82f203c, 0xff, 0x8
.long 0x0, 0x0, 0x0, 0x0, 0x0, 0x0, 0x0, 0x0, 0x0, 0x0, 0x0, 0x0, 0x0, 0x0, 0x0, 0x0
.long 0x0, 0x0, 0x0, 0x0, 0x0, 0x0, 0x0, 0x0
.long 0x600244, 0x182c, 0xff, 0x8, 0x0, 0x0, 0x0, 0x0, 0x0, 0x0, 0x0, 0x0, 0x0, 0x0, 0x0, 0x0
.long 0x0, 0x0, 0x0, 0x0, 0x0, 0x0, 0x0, 0x0, 0x0, 0x0, 0x0, 0x0, 0x0, 0x0, 0x0, 0x0
.long 0x0, 0x0, 0x0, 0x0, 0x0, 0x0, 0x0, 0x0, 0x0, 0x0, 0x0, 0x0, 0x0, 0x0, 0x0, 0x0
.long 0x0, 0x0, 0x0, 0x0, 0x0, 0x0, 0x0, 0x0
.long 0x601244, 0x182c, 0xff, 0x8, 0x0, 0x0, 0x0, 0x0, 0x0, 0x0, 0x0, 0x0, 0x0, 0x0, 0x0, 0x0
.long 0x0, 0x0, 0x0, 0x0, 0x0, 0x0, 0x0, 0x0, 0x0, 0x0, 0x0, 0x0, 0x0, 0x0, 0x0, 0x0
.long 0x0, 0x0, 0x0, 0x0, 0x0, 0x0, 0x0, 0x0, 0x0, 0x0, 0x0, 0x0, 0x0, 0x0, 0x0, 0x0
.long 0x0, 0x0, 0x0, 0x0, 0x0, 0x0, 0x0, 0x0
.long 0x602244, 0x182c, 0xff, 0x8, 0x0, 0x0, 0x0, 0x0, 0x0, 0x0, 0x0, 0x0, 0x0, 0x0, 0x0, 0x0
.long 0x0, 0x0, 0x0, 0x0, 0x0, 0x0, 0x0, 0x0, 0x0, 0x0, 0x0, 0x0, 0x0, 0x0, 0x0, 0x0
.long 0x0, 0x0, 0x0, 0x0, 0x0, 0x0, 0x0, 0x0, 0x0, 0x0, 0x0, 0x0, 0x0, 0x0, 0x0, 0x0
.long 0x0, 0x0, 0x0, 0x0, 0x0, 0x0, 0x0, 0x0
.long 0x603244, 0x182c, 0xff, 0x8, 0x0, 0x0, 0x0, 0x0, 0x0, 0x0, 0x0, 0x0, 0x0, 0x0, 0x0, 0x0
.long 0x0, 0x0, 0x0, 0x0, 0x0, 0x0, 0x0, 0x0, 0x0, 0x0, 0x0, 0x0, 0x0, 0x0, 0x0, 0x0
.long 0x0, 0x0, 0x0, 0x0, 0x0, 0x0, 0x0, 0x0, 0x0, 0x0, 0x0, 0x0, 0x0, 0x0, 0x0, 0x0
.long 0x0, 0x0, 0x0, 0x0, 0x0, 0x0, 0x0, 0x0
.long 0x218011, 0x1001, 0x9, 0x6, 0x18051, 0x1005, 0xd, 0x9, 0x3c011, 0x1001, 0x19, 0x5, 0x30061, 0x1006, 0x1e, 0x5
.long 0x28031, 0x1003, 0x13, 0x9, 0x2042, 0x1c1c, 0x2c, 0x9, 0x600004, 0x1828, 0xff, 0x8, 0x1003a3, 0x10901017, 0x27, 0x88
.long 0x6000a4, 0x1829, 0xff, 0x8, 0x1003f3, 0x10b81017, 0x6f, 0x88, 0x6000e4, 0x1829, 0xff, 0x8, 0x600344, 0x282e, 0xff, 0x8
.long 0x0, 0x0, 0x0, 0x0, 0x0, 0x0, 0x0, 0x0
.long 0x219011, 0x1001, 0x9, 0x6, 0x19051, 0x1005, 0xd, 0x9, 0x3d011, 0x1001, 0x19, 0x5, 0x31061, 0x1006, 0x1e, 0x5
.long 0x29031, 0x1003, 0x13, 0x9, 0x102042, 0x1c1c, 0x2c, 0x9, 0x601004, 0x1828, 0xff, 0x8, 0x1013a3, 0x10911017, 0x27, 0x88
.long 0x6010a4, 0x1829, 0xff, 0x8, 0x1013f3, 0x10b91017, 0x6f, 0x88, 0x6010e4, 0x1829, 0xff, 0x8, 0x601344, 0x282e, 0xff, 0x8
.long 0x0, 0x0, 0x0, 0x0, 0x0, 0x0, 0x0, 0x0
.long 0x21a011, 0x1001, 0x9, 0x6, 0x1a051, 0x1005, 0xd, 0x9, 0x3e011, 0x1001, 0x19, 0x5, 0x32061, 0x1006, 0x1e, 0x5
.long 0x2a031, 0x1003, 0x13, 0x9, 0x2052, 0x1c1d, 0x2d, 0x9, 0x602004, 0x1828, 0xff, 0x8, 0x1023a3, 0x10921017, 0x27, 0x88
.long 0x6020a4, 0x1829, 0xff, 0x8, 0x1023f3, 0x10ba1017, 0x6f, 0x88, 0x6020e4, 0x1829, 0xff, 0x8, 0x602344, 0x282e, 0xff, 0x8
.long 0x0, 0x0, 0x0, 0x0, 0x0, 0x0, 0x0, 0x0
.long 0x21b011, 0x1001, 0x9, 0x6, 0x1b051, 0x1005, 0xd, 0x9, 0x3f011, 0x1001, 0x19, 0x5, 0x33061, 0x1006, 0x1e, 0x5
.long 0x2b031, 0x1003, 0x13, 0x9, 0x102052, 0x1c1d, 0x2d, 0x9, 0x603004, 0x1828, 0xff, 0x8, 0x1033a3, 0x10931017, 0x27, 0x88
.long 0x6030a4, 0x1829, 0xff, 0x8, 0x1033f3, 0x10bb1017, 0x6f, 0x88, 0x6030e4, 0x1829, 0xff, 0x8, 0x603344, 0x282e, 0xff, 0x8
.long 0x0, 0x0, 0x0, 0x0, 0x0, 0x0, 0x0, 0x0
.long 0x600254, 0x182c, 0xff, 0x8, 0x0, 0x0, 0x0, 0x0, 0x0, 0x0, 0x0, 0x0, 0x0, 0x0, 0x0, 0x0
.long 0x0, 0x0, 0x0, 0x0, 0x0, 0x0, 0x0, 0x0, 0x0, 0x0, 0x0, 0x0, 0x0, 0x0, 0x0, 0x0
.long 0x0, 0x0, 0x0, 0x0, 0x0, 0x0, 0x0, 0x0, 0x0, 0x0, 0x0, 0x0, 0x0, 0x0, 0x0, 0x0
.long 0x0, 0x0, 0x0, 0x0, 0x0, 0x0, 0x0, 0x0
.long 0x601254, 0x182c, 0xff, 0x8, 0x0, 0x0, 0x0, 0x0, 0x0, 0x0, 0x0, 0x0, 0x0, 0x0, 0x0, 0x0
.long 0x0, 0x0, 0x0, 0x0, 0x0, 0x0, 0x0, 0x0, 0x0, 0x0, 0x0, 0x0, 0x0, 0x0, 0x0, 0x0
.long 0x0, 0x0, 0x0, 0x0, 0x0, 0x0, 0x0, 0x0, 0x0, 0x0, 0x0, 0x0, 0x0, 0x0, 0x0, 0x0
.long 0x0, 0x0, 0x0, 0x0, 0x0, 0x0, 0x0, 0x0
.long 0x602254, 0x182c, 0xff, 0x8, 0x0, 0x0, 0x0, 0x0, 0x0, 0x0, 0x0, 0x0, 0x0, 0x0, 0x0, 0x0
.long 0x0, 0x0, 0x0, 0x0, 0x0, 0x0, 0x0, 0x0, 0x0, 0x0, 0x0, 0x0, 0x0, 0x0, 0x0, 0x0
.long 0x0, 0x0, 0x0, 0x0, 0x0, 0x0, 0x0, 0x0, 0x0, 0x0, 0x0, 0x0, 0x0, 0x0, 0x0, 0x0
.long 0x0, 0x0, 0x0, 0x0, 0x0, 0x0, 0x0, 0x0
.long 0x603254, 0x182c, 0xff, 0x8, 0x0, 0x0, 0x0, 0x0, 0x0, 0x0, 0x0, 0x0, 0x0, 0x0, 0x0, 0x0
.long 0x0, 0x0, 0x0, 0x0, 0x0, 0x0, 0x0, 0x0, 0x0, 0x0, 0x0, 0x0, 0x0, 0x0, 0x0, 0x0
.long 0x0, 0x0, 0x0, 0x0, 0x0, 0x0, 0x0, 0x0, 0x0, 0x0, 0x0, 0x0, 0x0, 0x0, 0x0, 0x0
.long 0x0, 0x0, 0x0, 0x0, 0x0, 0x0, 0x0, 0x0
.long 0x21c011, 0x1001, 0x9, 0x6, 0x1c051, 0x1005, 0xd, 0x9, 0x40011, 0x1001, 0x19, 0x5, 0x34061, 0x1006, 0x1e, 0x5
.long 0x2c031, 0x1003, 0x13, 0x9, 0x3042, 0x1c1c, 0x2c, 0x9, 0x600014, 0x1828, 0xff, 0x8, 0x1043a3, 0x10941017, 0x27, 0x88
.long 0x6000b4, 0x1829, 0xff, 0x8, 0x1043f3, 0x10bc1017, 0x6f, 0x88, 0x6000f4, 0x1829, 0xff, 0x8, 0x600354, 0x282e, 0xff, 0x8
.long 0x0, 0x0, 0x0, 0x0, 0x0, 0x0, 0x0, 0x0
.long 0x21d011, 0x1001, 0x9, 0x6, 0x1d051, 0x1005, 0xd, 0x9, 0x41011, 0x1001, 0x19, 0x5, 0x35061, 0x1006, 0x1e, 0x5
.long 0x2d031, 0x1003, 0x13, 0x9, 0x103042, 0x1c1c, 0x2c, 0x9, 0x601014, 0x1828, 0xff, 0x8, 0x1053a3, 0x10951017, 0x27, 0x88
.long 0x6010b4, 0x1829, 0xff, 0x8, 0x1053f3, 0x10bd1017, 0x6f, 0x88, 0x6010f4, 0x1829, 0xff, 0x8, 0x601354, 0x282e, 0xff, 0x8
.long 0x0, 0x0, 0x0, 0x0, 0x0, 0x0, 0x0, 0x0
.long 0x21e011, 0x1001, 0x9, 0x6, 0x1e051, 0x1005, 0xd, 0x9, 0x42011, 0x1001, 0x19, 0x5, 0x36061, 0x1006, 0x1e, 0x5
.long 0x2e031, 0x1003, 0x13, 0x9, 0x3052, 0x1c1d, 0x2d, 0x9, 0x602014, 0x1828, 0xff, 0x8, 0x1063a3, 0x10961017, 0x27, 0x88
.long 0x6020b4, 0x1829, 0xff, 0x8, 0x1063f3, 0x10be1017, 0x6f, 0x88, 0x6020f4, 0x1829, 0xff, 0x8, 0x602354, 0x282e, 0xff, 0x8
.long 0x0, 0x0, 0x0, 0x0, 0x0, 0x0, 0x0, 0x0
.long 0x21f011, 0x1001, 0x9, 0x6, 0x1f051, 0x1005, 0xd, 0x9, 0x43011, 0x1001, 0x19, 0x5, 0x37061, 0x1006, 0x1e, 0x5
.long 0x2f031, 0x1003, 0x13, 0x9, 0x103052, 0x1c1d, 0x2d, 0x9, 0x603014, 0x1828, 0xff, 0x8, 0x1073a3, 0x10971017, 0x27, 0x88
.long 0x6030b4, 0x1829, 0xff, 0x8, 0x1073f3, 0x10bf1017, 0x6f, 0x88, 0x6030f4, 0x1829, 0xff, 0x8, 0x603354, 0x282e, 0xff, 0x8
.long 0x0, 0x0, 0x0, 0x0, 0x0, 0x0, 0x0, 0x0
.long 0x600264, 0x182c, 0xff, 0x8, 0x0, 0x0, 0x0, 0x0, 0x0, 0x0, 0x0, 0x0, 0x0, 0x0, 0x0, 0x0
.long 0x0, 0x0, 0x0, 0x0, 0x0, 0x0, 0x0, 0x0, 0x0, 0x0, 0x0, 0x0, 0x0, 0x0, 0x0, 0x0
.long 0x0, 0x0, 0x0, 0x0, 0x0, 0x0, 0x0, 0x0, 0x0, 0x0, 0x0, 0x0, 0x0, 0x0, 0x0, 0x0
.long 0x0, 0x0, 0x0, 0x0, 0x0, 0x0, 0x0, 0x0
.long 0x601264, 0x182c, 0xff, 0x8, 0x0, 0x0, 0x0, 0x0, 0x0, 0x0, 0x0, 0x0, 0x0, 0x0, 0x0, 0x0
.long 0x0, 0x0, 0x0, 0x0, 0x0, 0x0, 0x0, 0x0, 0x0, 0x0, 0x0, 0x0, 0x0, 0x0, 0x0, 0x0
.long 0x0, 0x0, 0x0, 0x0, 0x0, 0x0, 0x0, 0x0, 0x0, 0x0, 0x0, 0x0, 0x0, 0x0, 0x0, 0x0
.long 0x0, 0x0, 0x0, 0x0, 0x0, 0x0, 0x0, 0x0
.long 0x602264, 0x182c, 0xff, 0x8, 0x0, 0x0, 0x0, 0x0, 0x0, 0x0, 0x0, 0x0, 0x0, 0x0, 0x0, 0x0
.long 0x0, 0x0, 0x0, 0x0, 0x0, 0x0, 0x0, 0x0, 0x0, 0x0, 0x0, 0x0, 0x0, 0x0, 0x0, 0x0
.long 0x0, 0x0, 0x0, 0x0, 0x0, 0x0, 0x0, 0x0, 0x0, 0x0, 0x0, 0x0, 0x0, 0x0, 0x0, 0x0
.long 0x0, 0x0, 0x0, 0x0, 0x0, 0x0, 0x0, 0x0
.long 0x603264, 0x182c, 0xff, 0x8, 0x0, 0x0, 0x0, 0x0, 0x0, 0x0, 0x0, 0x0, 0x0, 0x0, 0x0, 0x0
.long 0x0, 0x0, 0x0, 0x0, 0x0, 0x0, 0x0, 0x0, 0x0, 0x0, 0x0, 0x0, 0x0, 0x0, 0x0, 0x0
.long 0x0, 0x0, 0x0, 0x0, 0x0, 0x0, 0x0, 0x0, 0x0, 0x0, 0x0, 0x0, 0x0, 0x0, 0x0, 0x0
.long 0x0, 0x0, 0x0, 0x0, 0x0, 0x0, 0x0, 0x0
.long 0x21, 0x1002, 0xa, 0xa, 0x20001, 0x1000, 0x10, 0x9, 0x44011, 0x1001, 0x19, 0x5, 0x38061, 0x1006, 0x1e, 0x5
.long 0x20041, 0x1004, 0x14, 0x9, 0x800103, 0x18301012, 0x22, 0x8, 0x200303, 0x32301016, 0x26, 0x8, 0x8200032, 0x823, 0x2b, 0x8
.long 0x600164, 0x182a, 0xff, 0x8, 0xc0083b4, 0x82f203c, 0xff, 0x8, 0x0, 0x0, 0x0, 0x0, 0x0, 0x0, 0x0, 0x0
.long 0x0, 0x0, 0x0, 0x0, 0x0, 0x0, 0x0, 0x0
.long 0x1021, 0x1002, 0xa, 0xa, 0x21001, 0x1000, 0x10, 0x9, 0x45011, 0x1001, 0x19, 0x5, 0x39061, 0x1006, 0x1e, 0x5
.long 0x21041, 0x1004, 0x14, 0x9, 0x801103, 0x18301012, 0x22, 0x8, 0x201303, 0x32301016, 0x26, 0x8, 0x8300032, 0x823, 0x2b, 0x8
.long 0x601164, 0x182a, 0xff, 0x8, 0xc0093b4, 0x82f203c, 0xff, 0x8, 0x0, 0x0, 0x0, 0x0, 0x0, 0x0, 0x0, 0x0
.long 0x0, 0x0, 0x0, 0x0, 0x0, 0x0, 0x0, 0x0
.long 0x2021, 0x1002, 0xa, 0xa, 0x22001, 0x1000, 0x10, 0x9, 0x46011, 0x1001, 0x19, 0x5, 0x3a061, 0x1006, 0x1e, 0x5
.long 0x22041, 0x1004, 0x14, 0x9, 0x802103, 0x18301012, 0x22, 0x8, 0x202303, 0x32301016, 0x26, 0x8, 0x8400032, 0x823, 0x2b, 0x8
.long 0x602164, 0x182a, 0xff, 0x8, 0xc00a3b4, 0x82f203c, 0xff, 0x8, 0x0, 0x0, 0x0, 0x0, 0x0, 0x0, 0x0, 0x0
.long 0x0, 0x0, 0x0, 0x0, 0x0, 0x0, 0x0, 0x0
.long 0x3021, 0x1002, 0xa, 0xa, 0x23001, 0x1000, 0x10, 0x9, 0x47011, 0x1001, 0x19, 0x5, 0x3b061, 0x1006, 0x1e, 0x5
.long 0x23041, 0x1004, 0x14, 0x9, 0x803103, 0x18301012, 0x22, 0x8, 0x203303, 0x32301016, 0x26, 0x8, 0x8500032, 0x823, 0x2b, 0x8
.long 0x603164, 0x182a, 0xff, 0x8, 0xc00b3b4, 0x82f203c, 0xff, 0x8, 0x0, 0x0, 0x0, 0x0, 0x0, 0x0, 0x0, 0x0
.long 0x0, 0x0, 0x0, 0x0, 0x0, 0x0, 0x0, 0x0
.long 0x600274, 0x182c, 0xff, 0x8, 0x0, 0x0, 0x0, 0x0, 0x0, 0x0, 0x0, 0x0, 0x0, 0x0, 0x0, 0x0
.long 0x0, 0x0, 0x0, 0x0, 0x0, 0x0, 0x0, 0x0, 0x0, 0x0, 0x0, 0x0, 0x0, 0x0, 0x0, 0x0
.long 0x0, 0x0, 0x0, 0x0, 0x0, 0x0, 0x0, 0x0, 0x0, 0x0, 0x0, 0x0, 0x0, 0x0, 0x0, 0x0
.long 0x0, 0x0, 0x0, 0x0, 0x0, 0x0, 0x0, 0x0
.long 0x601274, 0x182c, 0xff, 0x8, 0x0, 0x0, 0x0, 0x0, 0x0, 0x0, 0x0, 0x0, 0x0, 0x0, 0x0, 0x0
.long 0x0, 0x0, 0x0, 0x0, 0x0, 0x0, 0x0, 0x0, 0x0, 0x0, 0x0, 0x0, 0x0, 0x0, 0x0, 0x0
.long 0x0, 0x0, 0x0, 0x0, 0x0, 0x0, 0x0, 0x0, 0x0, 0x0, 0x0, 0x0, 0x0, 0x0, 0x0, 0x0
.long 0x0, 0x0, 0x0, 0x0, 0x0, 0x0, 0x0, 0x0
.long 0x602274, 0x182c, 0xff, 0x8, 0x0, 0x0, 0x0, 0x0, 0x0, 0x0, 0x0, 0x0, 0x0, 0x0, 0x0, 0x0
.long 0x0, 0x0, 0x0, 0x0, 0x0, 0x0, 0x0, 0x0, 0x0, 0x0, 0x0, 0x0, 0x0, 0x0, 0x0, 0x0
.long 0x0, 0x0, 0x0, 0x0, 0x0, 0x0, 0x0, 0x0, 0x0, 0x0, 0x0, 0x0, 0x0, 0x0, 0x0, 0x0
.long 0x0, 0x0, 0x0, 0x0, 0x0, 0x0, 0x0, 0x0
.long 0x603274, 0x182c, 0xff, 0x8, 0x0, 0x0, 0x0, 0x0, 0x0, 0x0, 0x0, 0x0, 0x0, 0x0, 0x0, 0x0
.long 0x0, 0x0, 0x0, 0x0, 0x0, 0x0, 0x0, 0x0, 0x0, 0x0, 0x0, 0x0, 0x0, 0x0, 0x0, 0x0
.long 0x0, 0x0, 0x0, 0x0, 0x0, 0x0, 0x0, 0x0, 0x0, 0x0, 0x0, 0x0, 0x0, 0x0, 0x0, 0x0
.long 0x0, 0x0, 0x0, 0x0, 0x0, 0x0, 0x0, 0x0
.long 0x4021, 0x1002, 0xa, 0xa, 0x24001, 0x1000, 0x10, 0x9, 0x48011, 0x1001, 0x19, 0x5, 0x3c061, 0x1006, 0x1e, 0x5
.long 0x24041, 0x1004, 0x14, 0x9, 0x804103, 0x18301012, 0x22, 0x8, 0x204303, 0x32301016, 0x26, 0x8, 0x8201032, 0x823, 0x2b, 0x8
.long 0x600174, 0x182a, 0xff, 0x8, 0xc00c3b4, 0x82f203c, 0xff, 0x8, 0x0, 0x0, 0x0, 0x0, 0x0, 0x0, 0x0, 0x0
.long 0x0, 0x0, 0x0, 0x0, 0x0, 0x0, 0x0, 0x0
.long 0x5021, 0x1002, 0xa, 0xa, 0x25001, 0x1000, 0x10, 0x9, 0x49011, 0x1001, 0x19, 0x5, 0x3d061, 0x1006, 0x1e, 0x5
.long 0x25041, 0x1004, 0x14, 0x9, 0x805103, 0x18301012, 0x22, 0x8, 0x205303, 0x32301016, 0x26, 0x8, 0x8301032, 0x823, 0x2b, 0x8
.long 0x601174, 0x182a, 0xff, 0x8, 0xc00d3b4, 0x82f203c, 0xff, 0x8, 0x0, 0x0, 0x0, 0x0, 0x0, 0x0, 0x0, 0x0
.long 0x0, 0x0, 0x0, 0x0, 0x0, 0x0, 0x0, 0x0
.long 0x6021, 0x1002, 0xa, 0xa, 0x26001, 0x1000, 0x10, 0x9, 0x4a011, 0x1001, 0x19, 0x5, 0x3e061, 0x1006, 0x1e, 0x5
.long 0x26041, 0x1004, 0x14, 0x9, 0x806103, 0x18301012, 0x22, 0x8, 0x206303, 0x32301016, 0x26, 0x8, 0x8401032, 0x823, 0x2b, 0x8
.long 0x602174, 0x182a, 0xff, 0x8, 0xc00e3b4, 0x82f203c, 0xff, 0x8, 0x0, 0x0, 0x0, 0x0, 0x0, 0x0, 0x0, 0x0
.long 0x0, 0x0, 0x0, 0x0, 0x0, 0x0, 0x0, 0x0
.long 0x7021, 0x1002, 0xa, 0xa, 0x27001, 0x1000, 0x10, 0x9, 0x4b011, 0x1001, 0x19, 0x5, 0x3f061, 0x1006, 0x1e, 0x5
.long 0x27041, 0x1004, 0x14, 0x9, 0x807103, 0x18301012, 0x22, 0x8, 0x207303, 0x32301016, 0x26, 0x8, 0x8501032, 0x823, 0x2b, 0x8
.long 0x603174, 0x182a, 0xff, 0x8, 0xc00f3b4, 0x82f203c, 0xff, 0x8, 0x0, 0x0, 0x0, 0x0, 0x0, 0x0, 0x0, 0x0
.long 0x0, 0x0, 0x0, 0x0, 0x0, 0x0, 0x0, 0x0
.long 0x600284, 0x182d, 0xff, 0x8, 0x0, 0x0, 0x0, 0x0, 0x0, 0x0, 0x0, 0x0, 0x0, 0x0, 0x0, 0x0
.long 0x0, 0x0, 0x0, 0x0, 0x0, 0x0, 0x0, 0x0, 0x0, 0x0, 0x0, 0x0, 0x0, 0x0, 0x0, 0x0
.long 0x0, 0x0, 0x0, 0x0, 0x0, 0x0, 0x0, 0x0, 0x0, 0x0, 0x0, 0x0, 0x0, 0x0, 0x0, 0x0
.long 0x0, 0x0, 0x0, 0x0, 0x0, 0x0, 0x0, 0x0
.long 0x601284, 0x182d, 0xff, 0x8, 0x0, 0x0, 0x0, 0x0, 0x0, 0x0, 0x0, 0x0, 0x0, 0x0, 0x0, 0x0
.long 0x0, 0x0, 0x0, 0x0, 0x0, 0x0, 0x0, 0x0, 0x0, 0x0, 0x0, 0x0, 0x0, 0x0, 0x0, 0x0
.long 0x0, 0x0, 0x0, 0x0, 0x0, 0x0, 0x0, 0x0, 0x0, 0x0, 0x0, 0x0, 0x0, 0x0, 0x0, 0x0
.long 0x0, 0x0, 0x0, 0x0, 0x0, 0x0, 0x0, 0x0
.long 0x602284, 0x182d, 0xff, 0x8, 0x0, 0x0, 0x0, 0x0, 0x0, 0x0, 0x0, 0x0, 0x0, 0x0, 0x0, 0x0
.long 0x0, 0x0, 0x0, 0x0, 0x0, 0x0, 0x0, 0x0, 0x0, 0x0, 0x0, 0x0, 0x0, 0x0, 0x0, 0x0
.long 0x0, 0x0, 0x0, 0x0, 0x0, 0x0, 0x0, 0x0, 0x0, 0x0, 0x0, 0x0, 0x0, 0x0, 0x0, 0x0
.long 0x0, 0x0, 0x0, 0x0, 0x0, 0x0, 0x0, 0x0
.long 0x603284, 0x182d, 0xff, 0x8, 0x0, 0x0, 0x0, 0x0, 0x0, 0x0, 0x0, 0x0, 0x0, 0x0, 0x0, 0x0
.long 0x0, 0x0, 0x0, 0x0, 0x0, 0x0, 0x0, 0x0, 0x0, 0x0, 0x0, 0x0, 0x0, 0x0, 0x0, 0x0
.long 0x0, 0x0, 0x0, 0x0, 0x0, 0x0, 0x0, 0x0, 0x0, 0x0, 0x0, 0x0, 0x0, 0x0, 0x0, 0x0
.long 0x0, 0x0, 0x0, 0x0, 0x0, 0x0, 0x0, 0x0
.long 0x8021, 0x1002, 0xa, 0xa, 0x28001, 0x1000, 0x10, 0x9, 0x30021, 0x1002, 0x1a, 0x5, 0x40061, 0x1006, 0x1e, 0x5
.long 0x28041, 0x1004, 0x14, 0x9, 0x800183, 0x20301013, 0x23, 0x8, 0x200323, 0x34301016, 0x26, 0x8, 0x8202032, 0x823, 0x2b, 0x8
.long 0x600184, 0x182b, 0xff, 0x8, 0x0, 0x0, 0x0, 0x0, 0x0, 0x0, 0x0, 0x0, 0x0, 0x0, 0x0, 0x0
.long 0x0, 0x0, 0x0, 0x0, 0x0, 0x0, 0x0, 0x0
.long 0x9021, 0x1002, 0xa, 0xa, 0x29001, 0x1000, 0x10, 0x9, 0x31021, 0x1002, 0x1a, 0x5, 0x41061, 0x1006, 0x1e, 0x5
.long 0x29041, 0x1004, 0x14, 0x9, 0x801183, 0x20301013, 0x23, 0x8, 0x201323, 0x34301016, 0x26, 0x8, 0x8302032, 0x823, 0x2b, 0x8
.long 0x601184, 0x182b, 0xff, 0x8, 0x0, 0x0, 0x0, 0x0, 0x0, 0x0, 0x0, 0x0, 0x0, 0x0, 0x0, 0x0
.long 0x0, 0x0, 0x0, 0x0, 0x0, 0x0, 0x0, 0x0
.long 0xa021, 0x1002, 0xa, 0xa, 0x2a001, 0x1000, 0x10, 0x9, 0x32021, 0x1002, 0x1a, 0x5, 0x42061, 0x1006, 0x1e, 0x5
.long 0x2a041, 0x1004, 0x14, 0x9, 0x802183, 0x20301013, 0x23, 0x8, 0x202323, 0x34301016, 0x26, 0x8, 0x8402032, 0x823, 0x2b, 0x8
.long 0x602184, 0x182b, 0xff, 0x8, 0x0, 0x0, 0x0, 0x0, 0x0, 0x0, 0x0, 0x0, 0x0, 0x0, 0x0, 0x0
.long 0x0, 0x0, 0x0, 0x0, 0x0, 0x0, 0x0, 0x0
.long 0xb021, 0x1002, 0xa, 0xa, 0x2b001, 0x1000, 0x10, 0x9, 0x33021, 0x1002, 0x1a, 0x5, 0x43061, 0x1006, 0x1e, 0x5
.long 0x2b041, 0x1004, 0x14, 0x9, 0x803183, 0x20301013, 0x23, 0x8, 0x203323, 0x34301016, 0x26, 0x8, 0x8502032, 0x823, 0x2b, 0x8
.long 0x603184, 0x182b, 0xff, 0x8, 0x0, 0x0, 0x0, 0x0, 0x0, 0x0, 0x0, 0x0, 0x0, 0x0, 0x0, 0x0
.long 0x0, 0x0, 0x0, 0x0, 0x0, 0x0, 0x0, 0x0
.long 0x600294, 0x182d, 0xff, 0x8, 0x0, 0x0, 0x0, 0x0, 0x0, 0x0, 0x0, 0x0, 0x0, 0x0, 0x0, 0x0
.long 0x0, 0x0, 0x0, 0x0, 0x0, 0x0, 0x0, 0x0, 0x0, 0x0, 0x0, 0x0, 0x0, 0x0, 0x0, 0x0
.long 0x0, 0x0, 0x0, 0x0, 0x0, 0x0, 0x0, 0x0, 0x0, 0x0, 0x0, 0x0, 0x0, 0x0, 0x0, 0x0
.long 0x0, 0x0, 0x0, 0x0, 0x0, 0x0, 0x0, 0x0
.long 0x601294, 0x182d, 0xff, 0x8, 0x0, 0x0, 0x0, 0x0, 0x0, 0x0, 0x0, 0x0, 0x0, 0x0, 0x0, 0x0
.long 0x0, 0x0, 0x0, 0x0, 0x0, 0x0, 0x0, 0x0, 0x0, 0x0, 0x0, 0x0, 0x0, 0x0, 0x0, 0x0
.long 0x0, 0x0, 0x0, 0x0, 0x0, 0x0, 0x0, 0x0, 0x0, 0x0, 0x0, 0x0, 0x0, 0x0, 0x0, 0x0
.long 0x0, 0x0, 0x0, 0x0, 0x0, 0x0, 0x0, 0x0
.long 0x602294, 0x182d, 0xff, 0x8, 0x0, 0x0, 0x0, 0x0, 0x0, 0x0, 0x0, 0x0, 0x0, 0x0, 0x0, 0x0
.long 0x0, 0x0, 0x0, 0x0, 0x0, 0x0, 0x0, 0x0, 0x0, 0x0, 0x0, 0x0, 0x0, 0x0, 0x0, 0x0
.long 0x0, 0x0, 0x0, 0x0, 0x0, 0x0, 0x0, 0x0, 0x0, 0x0, 0x0, 0x0, 0x0, 0x0, 0x0, 0x0
.long 0x0, 0x0, 0x0, 0x0, 0x0, 0x0, 0x0, 0x0
.long 0x603294, 0x182d, 0xff, 0x8, 0x0, 0x0, 0x0, 0x0, 0x0, 0x0, 0x0, 0x0, 0x0, 0x0, 0x0, 0x0
.long 0x0, 0x0, 0x0, 0x0, 0x0, 0x0, 0x0, 0x0, 0x0, 0x0, 0x0, 0x0, 0x0, 0x0, 0x0, 0x0
.long 0x0, 0x0, 0x0, 0x0, 0x0, 0x0, 0x0, 0x0, 0x0, 0x0, 0x0, 0x0, 0x0, 0x0, 0x0, 0x0
.long 0x0, 0x0, 0x0, 0x0, 0x0, 0x0, 0x0, 0x0
.long 0xc021, 0x1002, 0xa, 0xa, 0x2c001, 0x1000, 0x10, 0x9, 0x34021, 0x1002, 0x1a, 0x5, 0x44061, 0x1006, 0x1e, 0x5
.long 0x2c041, 0x1004, 0x14, 0x9, 0x804183, 0x20301013, 0x23, 0x8, 0x204323, 0x34301016, 0x26, 0x8, 0x8203032, 0x823, 0x2b, 0x8
.long 0x600194, 0x182b, 0xff, 0x8, 0x0, 0x0, 0x0, 0x0, 0x0, 0x0, 0x0, 0x0, 0x0, 0x0, 0x0, 0x0
.long 0x0, 0x0, 0x0, 0x0, 0x0, 0x0, 0x0, 0x0
.long 0xd021, 0x1002, 0xa, 0xa, 0x2d001, 0x1000, 0x10, 0x9, 0x35021, 0x1002, 0x1a, 0x5, 0x45061, 0x1006, 0x1e, 0x5
.long 0x2d041, 0x1004, 0x14, 0x9, 0x805183, 0x20301013, 0x23, 0x8, 0x205323, 0x34301016, 0x26, 0x8, 0x8303032, 0x823, 0x2b, 0x8
.long 0x601194, 0x182b, 0xff, 0x8, 0x0, 0x0, 0x0, 0x0, 0x0, 0x0, 0x0, 0x0, 0x0, 0x0, 0x0, 0x0
.long 0x0, 0x0, 0x0, 0x0, 0x0, 0x0, 0x0, 0x0
.long 0xe021, 0x1002, 0xa, 0xa, 0x2e001, 0x1000, 0x10, 0x9, 0x36021, 0x1002, 0x1a, 0x5, 0x46061, 0x1006, 0x1e, 0x5
.long 0x2e041, 0x1004, 0x14, 0x9, 0x806183, 0x20301013, 0x23, 0x8, 0x206323, 0x34301016, 0x26, 0x8, 0x8403032, 0x823, 0x2b, 0x8
.long 0x602194, 0x182b, 0xff, 0x8, 0x0, 0x0, 0x0, 0x0, 0x0, 0x0, 0x0, 0x0, 0x0, 0x0, 0x0, 0x0
.long 0x0, 0x0, 0x0, 0x0, 0x0, 0x0, 0x0, 0x0
.long 0xf021, 0x1002, 0xa, 0xa, 0x2f001, 0x1000, 0x10, 0x9, 0x37021, 0x1002, 0x1a, 0x5, 0x47061, 0x1006, 0x1e, 0x5
.long 0x2f041, 0x1004, 0x14, 0x9, 0x807183, 0x20301013, 0x23, 0x8, 0x207323, 0x34301016, 0x26, 0x8, 0x8503032, 0x823, 0x2b, 0x8
.long 0x603194, 0x182b, 0xff, 0x8, 0x0, 0x0, 0x0, 0x0, 0x0, 0x0, 0x0, 0x0, 0x0, 0x0, 0x0, 0x0
.long 0x0, 0x0, 0x0, 0x0, 0x0, 0x0, 0x0, 0x0
.long 0x6002a4, 0x182d, 0xff, 0x8, 0x0, 0x0, 0x0, 0x0, 0x0, 0x0, 0x0, 0x0, 0x0, 0x0, 0x0, 0x0
.long 0x0, 0x0, 0x0, 0x0, 0x0, 0x0, 0x0, 0x0, 0x0, 0x0, 0x0, 0x0, 0x0, 0x0, 0x0, 0x0
.long 0x0, 0x0, 0x0, 0x0, 0x0, 0x0, 0x0, 0x0, 0x0, 0x0, 0x0, 0x0, 0x0, 0x0, 0x0, 0x0
.long 0x0, 0x0, 0x0, 0x0, 0x0, 0x0, 0x0, 0x0
.long 0x6012a4, 0x182d, 0xff, 0x8, 0x0, 0x0, 0x0, 0x0, 0x0, 0x0, 0x0, 0x0, 0x0, 0x0, 0x0, 0x0
.long 0x0, 0x0, 0x0, 0x0, 0x0, 0x0, 0x0, 0x0, 0x0, 0x0, 0x0, 0x0, 0x0, 0x0, 0x0, 0x0
.long 0x0, 0x0, 0x0, 0x0, 0x0, 0x0, 0x0, 0x0, 0x0, 0x0, 0x0, 0x0, 0x0, 0x0, 0x0, 0x0
.long 0x0, 0x0, 0x0, 0x0, 0x0, 0x0, 0x0, 0x0
.long 0x6022a4, 0x182d, 0xff, 0x8, 0x0, 0x0, 0x0, 0x0, 0x0, 0x0, 0x0, 0x0, 0x0, 0x0, 0x0, 0x0
.long 0x0, 0x0, 0x0, 0x0, 0x0, 0x0, 0x0, 0x0, 0x0, 0x0, 0x0, 0x0, 0x0, 0x0, 0x0, 0x0
.long 0x0, 0x0, 0x0, 0x0, 0x0, 0x0, 0x0, 0x0, 0x0, 0x0, 0x0, 0x0, 0x0, 0x0, 0x0, 0x0
.long 0x0, 0x0, 0x0, 0x0, 0x0, 0x0, 0x0, 0x0
.long 0x6032a4, 0x182d, 0xff, 0x8, 0x0, 0x0, 0x0, 0x0, 0x0, 0x0, 0x0, 0x0, 0x0, 0x0, 0x0, 0x0
.long 0x0, 0x0, 0x0, 0x0, 0x0, 0x0, 0x0, 0x0, 0x0, 0x0, 0x0, 0x0, 0x0, 0x0, 0x0, 0x0
.long 0x0, 0x0, 0x0, 0x0, 0x0, 0x0, 0x0, 0x0, 0x0, 0x0, 0x0, 0x0, 0x0, 0x0, 0x0, 0x0
.long 0x0, 0x0, 0x0, 0x0, 0x0, 0x0, 0x0, 0x0
.long 0x10021, 0x1002, 0xa, 0xa, 0x61, 0x1006, 0xe, 0x9, 0x38021, 0x1002, 0x1a, 0x5, 0x48061, 0x1006, 0x1e, 0x5
.long 0x20051, 0x1005, 0x15, 0x9, 0x800203, 0x28301014, 0x24, 0x8, 0x8200022, 0x822, 0x2a, 0x8, 0xc206072, 0x2027, 0x3c, 0x5
.long 0x600304, 0x282e, 0xff, 0x8, 0x0, 0x0, 0x0, 0x0, 0x0, 0x0, 0x0, 0x0, 0x0, 0x0, 0x0, 0x0
.long 0x0, 0x0, 0x0, 0x0, 0x0, 0x0, 0x0, 0x0
.long 0x11021, 0x1002, 0xa, 0xa, 0x1061, 0x1006, 0xe, 0x9, 0x39021, 0x1002, 0x1a, 0x5, 0x49061, 0x1006, 0x1e, 0x5
.long 0x21051, 0x1005, 0x15, 0x9, 0x801203, 0x28301014, 0x24, 0x8, 0x8300022, 0x822, 0x2a, 0x8, 0xc306072, 0x2027, 0x3c, 0x5
.long 0x601304, 0x282e, 0xff, 0x8, 0x0, 0x0, 0x0, 0x0, 0x0, 0x0, 0x0, 0x0, 0x0, 0x0, 0x0, 0x0
.long 0x0, 0x0, 0x0, 0x0, 0x0, 0x0, 0x0, 0x0
.long 0x12021, 0x1002, 0xa, 0xa, 0x2061, 0x1006, 0xe, 0x9, 0x3a021, 0x1002, 0x1a, 0x5, 0x4a061, 0x1006, 0x1e, 0x5
.long 0x22051, 0x1005, 0x15, 0x9, 0x802203, 0x28301014, 0x24, 0x8, 0x8400022, 0x822, 0x2a, 0x8, 0xc406072, 0x2027, 0x3c, 0x5
.long 0x602304, 0x282e, 0xff, 0x8, 0x0, 0x0, 0x0, 0x0, 0x0, 0x0, 0x0, 0x0, 0x0, 0x0, 0x0, 0x0
.long 0x0, 0x0, 0x0, 0x0, 0x0, 0x0, 0x0, 0x0
.long 0x13021, 0x1002, 0xa, 0xa, 0x3061, 0x1006, 0xe, 0x9, 0x3b021, 0x1002, 0x1a, 0x5, 0x4b061, 0x1006, 0x1e, 0x5
.long 0x23051, 0x1005, 0x15, 0x9, 0x803203, 0x28301014, 0x24, 0x8, 0x8500022, 0x822, 0x2a, 0x8, 0xc506072, 0x2027, 0x3c, 0x5
.long 0x603304, 0x282e, 0xff, 0x8, 0x0, 0x0, 0x0, 0x0, 0x0, 0x0, 0x0, 0x0, 0x0, 0x0, 0x0, 0x0
.long 0x0, 0x0, 0x0, 0x0, 0x0, 0x0, 0x0, 0x0
.long 0x6002b4, 0x182d, 0xff, 0x8, 0x0, 0x0, 0x0, 0x0, 0x0, 0x0, 0x0, 0x0, 0x0, 0x0, 0x0, 0x0
.long 0x0, 0x0, 0x0, 0x0, 0x0, 0x0, 0x0, 0x0, 0x0, 0x0, 0x0, 0x0, 0x0, 0x0, 0x0, 0x0
.long 0x0, 0x0, 0x0, 0x0, 0x0, 0x0, 0x0, 0x0, 0x0, 0x0, 0x0, 0x0, 0x0, 0x0, 0x0, 0x0
.long 0x0, 0x0, 0x0, 0x0, 0x0, 0x0, 0x0, 0x0
.long 0x6012b4, 0x182d, 0xff, 0x8, 0x0, 0x0, 0x0, 0x0, 0x0, 0x0, 0x0, 0x0, 0x0, 0x0, 0x0, 0x0
.long 0x0, 0x0, 0x0, 0x0, 0x0, 0x0, 0x0, 0x0, 0x0, 0x0, 0x0, 0x0, 0x0, 0x0, 0x0, 0x0
.long 0x0, 0x0, 0x0, 0x0, 0x0, 0x0, 0x0, 0x0, 0x0, 0x0, 0x0, 0x0, 0x0, 0x0, 0x0, 0x0
.long 0x0, 0x0, 0x0, 0x0, 0x0, 0x0, 0x0, 0x0
.long 0x6022b4, 0x182d, 0xff, 0x8, 0x0, 0x0, 0x0, 0x0, 0x0, 0x0, 0x0, 0x0, 0x0, 0x0, 0x0, 0x0
.long 0x0, 0x0, 0x0, 0x0, 0x0, 0x0, 0x0, 0x0, 0x0, 0x0, 0x0, 0x0, 0x0, 0x0, 0x0, 0x0
.long 0x0, 0x0, 0x0, 0x0, 0x0, 0x0, 0x0, 0x0, 0x0, 0x0, 0x0, 0x0, 0x0, 0x0, 0x0, 0x0
.long 0x0, 0x0, 0x0, 0x0, 0x0, 0x0, 0x0, 0x0
.long 0x6032b4, 0x182d, 0xff, 0x8, 0x0, 0x0, 0x0, 0x0, 0x0, 0x0, 0x0, 0x0, 0x0, 0x0, 0x0, 0x0
.long 0x0, 0x0, 0x0, 0x0, 0x0, 0x0, 0x0, 0x0, 0x0, 0x0, 0x0, 0x0, 0x0, 0x0, 0x0, 0x0
.long 0x0, 0x0, 0x0, 0x0, 0x0, 0x0, 0x0, 0x0, 0x0, 0x0, 0x0, 0x0, 0x0, 0x0, 0x0, 0x0
.long 0x0, 0x0, 0x0, 0x0, 0x0, 0x0, 0x0, 0x0
.long 0x14021, 0x1002, 0xa, 0xa, 0x4061, 0x1006, 0xe, 0x9, 0x3c021, 0x1002, 0x1a, 0x5, 0x30071, 0x1007, 0x1f, 0x5
.long 0x24051, 0x1005, 0x15, 0x9, 0x804203, 0x28301014, 0x24, 0x8, 0x8201022, 0x822, 0x2a, 0x8, 0xc207072, 0x2027, 0x3c, 0x5
.long 0x600314, 0x282e, 0xff, 0x8, 0x0, 0x0, 0x0, 0x0, 0x0, 0x0, 0x0, 0x0, 0x0, 0x0, 0x0, 0x0
.long 0x0, 0x0, 0x0, 0x0, 0x0, 0x0, 0x0, 0x0
.long 0x15021, 0x1002, 0xa, 0xa, 0x5061, 0x1006, 0xe, 0x9, 0x3d021, 0x1002, 0x1a, 0x5, 0x31071, 0x1007, 0x1f, 0x5
.long 0x25051, 0x1005, 0x15, 0x9, 0x805203, 0x28301014, 0x24, 0x8, 0x8301022, 0x822, 0x2a, 0x8, 0xc307072, 0x2027, 0x3c, 0x5
.long 0x601314, 0x282e, 0xff, 0x8, 0x0, 0x0, 0x0, 0x0, 0x0, 0x0, 0x0, 0x0, 0x0, 0x0, 0x0, 0x0
.long 0x0, 0x0, 0x0, 0x0, 0x0, 0x0, 0x0, 0x0
.long 0x16021, 0x1002, 0xa, 0xa, 0x6061, 0x1006, 0xe, 0x9, 0x3e021, 0x1002, 0x1a, 0x5, 0x32071, 0x1007, 0x1f, 0x5
.long 0x26051, 0x1005, 0x15, 0x9, 0x806203, 0x28301014, 0x24, 0x8, 0x8401022, 0x822, 0x2a, 0x8, 0xc407072, 0x2027, 0x3c, 0x5
.long 0x602314, 0x282e, 0xff, 0x8, 0x0, 0x0, 0x0, 0x0, 0x0, 0x0, 0x0, 0x0, 0x0, 0x0, 0x0, 0x0
.long 0x0, 0x0, 0x0, 0x0, 0x0, 0x0, 0x0, 0x0
.long 0x17021, 0x1002, 0xa, 0xa, 0x7061, 0x1006, 0xe, 0x9, 0x3f021, 0x1002, 0x1a, 0x5, 0x33071, 0x1007, 0x1f, 0x5
.long 0x27051, 0x1005, 0x15, 0x9, 0x807203, 0x28301014, 0x24, 0x8, 0x8501022, 0x822, 0x2a, 0x8, 0xc507072, 0x2027, 0x3c, 0x5
.long 0x603314, 0x282e, 0xff, 0x8, 0x0, 0x0, 0x0, 0x0, 0x0, 0x0, 0x0, 0x0, 0x0, 0x0, 0x0, 0x0
.long 0x0, 0x0, 0x0, 0x0, 0x0, 0x0, 0x0, 0x0
.long 0x6002c4, 0x182d, 0xff, 0x8, 0x0, 0x0, 0x0, 0x0, 0x0, 0x0, 0x0, 0x0, 0x0, 0x0, 0x0, 0x0
.long 0x0, 0x0, 0x0, 0x0, 0x0, 0x0, 0x0, 0x0, 0x0, 0x0, 0x0, 0x0, 0x0, 0x0, 0x0, 0x0
.long 0x0, 0x0, 0x0, 0x0, 0x0, 0x0, 0x0, 0x0, 0x0, 0x0, 0x0, 0x0, 0x0, 0x0, 0x0, 0x0
.long 0x0, 0x0, 0x0, 0x0, 0x0, 0x0, 0x0, 0x0
.long 0x6012c4, 0x182d, 0xff, 0x8, 0x0, 0x0, 0x0, 0x0, 0x0, 0x0, 0x0, 0x0, 0x0, 0x0, 0x0, 0x0
.long 0x0, 0x0, 0x0, 0x0, 0x0, 0x0, 0x0, 0x0, 0x0, 0x0, 0x0, 0x0, 0x0, 0x0, 0x0, 0x0
.long 0x0, 0x0, 0x0, 0x0, 0x0, 0x0, 0x0, 0x0, 0x0, 0x0, 0x0, 0x0, 0x0, 0x0, 0x0, 0x0
.long 0x0, 0x0, 0x0, 0x0, 0x0, 0x0, 0x0, 0x0
.long 0x6022c4, 0x182d, 0xff, 0x8, 0x0, 0x0, 0x0, 0x0, 0x0, 0x0, 0x0, 0x0, 0x0, 0x0, 0x0, 0x0
.long 0x0, 0x0, 0x0, 0x0, 0x0, 0x0, 0x0, 0x0, 0x0, 0x0, 0x0, 0x0, 0x0, 0x0, 0x0, 0x0
.long 0x0, 0x0, 0x0, 0x0, 0x0, 0x0, 0x0, 0x0, 0x0, 0x0, 0x0, 0x0, 0x0, 0x0, 0x0, 0x0
.long 0x0, 0x0, 0x0, 0x0, 0x0, 0x0, 0x0, 0x0
.long 0x6032c4, 0x182d, 0xff, 0x8, 0x0, 0x0, 0x0, 0x0, 0x0, 0x0, 0x0, 0x0, 0x0, 0x0, 0x0, 0x0
.long 0x0, 0x0, 0x0, 0x0, 0x0, 0x0, 0x0, 0x0, 0x0, 0x0, 0x0, 0x0, 0x0, 0x0, 0x0, 0x0
.long 0x0, 0x0, 0x0, 0x0, 0x0, 0x0, 0x0, 0x0, 0x0, 0x0, 0x0, 0x0, 0x0, 0x0, 0x0, 0x0
.long 0x0, 0x0, 0x0, 0x0, 0x0, 0x0, 0x0, 0x0
.long 0x18021, 0x1002, 0xa, 0xa, 0x8061, 0x1006, 0xe, 0x9, 0x40021, 0x1002, 0x1a, 0x5, 0x34071, 0x1007, 0x1f, 0x5
.long 0x28051, 0x1005, 0x15, 0x9, 0x8200002, 0x820, 0x28, 0x9, 0x200343, 0x36301016, 0x26, 0x8, 0x100373, 0x38301016, 0x26, 0x88
.long 0x8208062, 0x2826, 0x2e, 0x4, 0x600144, 0x182a, 0xff, 0x8, 0xc0003b4, 0x82f203c, 0xff, 0x8, 0x0, 0x0, 0x0, 0x0
.long 0x0, 0x0, 0x0, 0x0, 0x0, 0x0, 0x0, 0x0
.long 0x19021, 0x1002, 0xa, 0xa, 0x9061, 0x1006, 0xe, 0x9, 0x41021, 0x1002, 0x1a, 0x5, 0x35071, 0x1007, 0x1f, 0x5
.long 0x29051, 0x1005, 0x15, 0x9, 0x8300002, 0x820, 0x28, 0x9, 0x201343, 0x36301016, 0x26, 0x8, 0x101373, 0x38301016, 0x26, 0x88
.long 0x8308062, 0x2826, 0x2e, 0x4, 0x601144, 0x182a, 0xff, 0x8, 0xc0013b4, 0x82f203c, 0xff, 0x8, 0x0, 0x0, 0x0, 0x0
.long 0x0, 0x0, 0x0, 0x0, 0x0, 0x0, 0x0, 0x0
.long 0x1a021, 0x1002, 0xa, 0xa, 0xa061, 0x1006, 0xe, 0x9, 0x42021, 0x1002, 0x1a, 0x5, 0x36071, 0x1007, 0x1f, 0x5
.long 0x2a051, 0x1005, 0x15, 0x9, 0x8400002, 0x820, 0x28, 0x9, 0x202343, 0x36301016, 0x26, 0x8, 0x102373, 0x38301016, 0x26, 0x88
.long 0x8408062, 0x2826, 0x2e, 0x4, 0x602144, 0x182a, 0xff, 0x8, 0xc0023b4, 0x82f203c, 0xff, 0x8, 0x0, 0x0, 0x0, 0x0
.long 0x0, 0x0, 0x0, 0x0, 0x0, 0x0, 0x0, 0x0
.long 0x1b021, 0x1002, 0xa, 0xa, 0xb061, 0x1006, 0xe, 0x9, 0x43021, 0x1002, 0x1a, 0x5, 0x37071, 0x1007, 0x1f, 0x5
.long 0x2b051, 0x1005, 0x15, 0x9, 0x8500002, 0x820, 0x28, 0x9, 0x203343, 0x36301016, 0x26, 0x8, 0x103373, 0x38301016, 0x26, 0x88
.long 0x8508062, 0x2826, 0x2e, 0x4, 0x603144, 0x182a, 0xff, 0x8, 0xc0033b4, 0x82f203c, 0xff, 0x8, 0x0, 0x0, 0x0, 0x0
.long 0x0, 0x0, 0x0, 0x0, 0x0, 0x0, 0x0, 0x0
.long 0x6002d4, 0x182d, 0xff, 0x8, 0x0, 0x0, 0x0, 0x0, 0x0, 0x0, 0x0, 0x0, 0x0, 0x0, 0x0, 0x0
.long 0x0, 0x0, 0x0, 0x0, 0x0, 0x0, 0x0, 0x0, 0x0, 0x0, 0x0, 0x0, 0x0, 0x0, 0x0, 0x0
.long 0x0, 0x0, 0x0, 0x0, 0x0, 0x0, 0x0, 0x0, 0x0, 0x0, 0x0, 0x0, 0x0, 0x0, 0x0, 0x0
.long 0x0, 0x0, 0x0, 0x0, 0x0, 0x0, 0x0, 0x0
.long 0x6012d4, 0x182d, 0xff, 0x8, 0x0, 0x0, 0x0, 0x0, 0x0, 0x0, 0x0, 0x0, 0x0, 0x0, 0x0, 0x0
.long 0x0, 0x0, 0x0, 0x0, 0x0, 0x0, 0x0, 0x0, 0x0, 0x0, 0x0, 0x0, 0x0, 0x0, 0x0, 0x0
.long 0x0, 0x0, 0x0, 0x0, 0x0, 0x0, 0x0, 0x0, 0x0, 0x0, 0x0, 0x0, 0x0, 0x0, 0x0, 0x0
.long 0x0, 0x0, 0x0, 0x0, 0x0, 0x0, 0x0, 0x0
.long 0x6022d4, 0x182d, 0xff, 0x8, 0x0, 0x0, 0x0, 0x0, 0x0, 0x0, 0x0, 0x0, 0x0, 0x0, 0x0, 0x0
.long 0x0, 0x0, 0x0, 0x0, 0x0, 0x0, 0x0, 0x0, 0x0, 0x0, 0x0, 0x0, 0x0, 0x0, 0x0, 0x0
.long 0x0, 0x0, 0x0, 0x0, 0x0, 0x0, 0x0, 0x0, 0x0, 0x0, 0x0, 0x0, 0x0, 0x0, 0x0, 0x0
.long 0x0, 0x0, 0x0, 0x0, 0x0, 0x0, 0x0, 0x0
.long 0x6032d4, 0x182d, 0xff, 0x8, 0x0, 0x0, 0x0, 0x0, 0x0, 0x0, 0x0, 0x0, 0x0, 0x0, 0x0, 0x0
.long 0x0, 0x0, 0x0, 0x0, 0x0, 0x0, 0x0, 0x0, 0x0, 0x0, 0x0, 0x0, 0x0, 0x0, 0x0, 0x0
.long 0x0, 0x0, 0x0, 0x0, 0x0, 0x0, 0x0, 0x0, 0x0, 0x0, 0x0, 0x0, 0x0, 0x0, 0x0, 0x0
.long 0x0, 0x0, 0x0, 0x0, 0x0, 0x0, 0x0, 0x0
.long 0x1c021, 0x1002, 0xa, 0xa, 0xc061, 0x1006, 0xe, 0x9, 0x44021, 0x1002, 0x1a, 0x5, 0x38071, 0x1007, 0x1f, 0x5
.long 0x2c051, 0x1005, 0x15, 0x9, 0x8201002, 0x820, 0x28, 0x9, 0x204343, 0x36301016, 0x26, 0x8, 0x104373, 0x38301016, 0x26, 0x88
.long 0x8209062, 0x2826, 0x2e, 0x4, 0x600154, 0x182a, 0xff, 0x8, 0xc0043b4, 0x82f203c, 0xff, 0x8, 0x0, 0x0, 0x0, 0x0
.long 0x0, 0x0, 0x0, 0x0, 0x0, 0x0, 0x0, 0x0
.long 0x1d021, 0x1002, 0xa, 0xa, 0xd061, 0x1006, 0xe, 0x9, 0x45021, 0x1002, 0x1a, 0x5, 0x39071, 0x1007, 0x1f, 0x5
.long 0x2d051, 0x1005, 0x15, 0x9, 0x8301002, 0x820, 0x28, 0x9, 0x205343, 0x36301016, 0x26, 0x8, 0x105373, 0x38301016, 0x26, 0x88
.long 0x8309062, 0x2826, 0x2e, 0x4, 0x601154, 0x182a, 0xff, 0x8, 0xc0053b4, 0x82f203c, 0xff, 0x8, 0x0, 0x0, 0x0, 0x0
.long 0x0, 0x0, 0x0, 0x0, 0x0, 0x0, 0x0, 0x0
.long 0x1e021, 0x1002, 0xa, 0xa, 0xe061, 0x1006, 0xe, 0x9, 0x46021, 0x1002, 0x1a, 0x5, 0x3a071, 0x1007, 0x1f, 0x5
.long 0x2e051, 0x1005, 0x15, 0x9, 0x8401002, 0x820, 0x28, 0x9, 0x206343, 0x36301016, 0x26, 0x8, 0x106373, 0x38301016, 0x26, 0x88
.long 0x8409062, 0x2826, 0x2e, 0x4, 0x602154, 0x182a, 0xff, 0x8, 0xc0063b4, 0x82f203c, 0xff, 0x8, 0x0, 0x0, 0x0, 0x0
.long 0x0, 0x0, 0x0, 0x0, 0x0, 0x0, 0x0, 0x0
.long 0x1f021, 0x1002, 0xa, 0xa, 0xf061, 0x1006, 0xe, 0x9, 0x47021, 0x1002, 0x1a, 0x5, 0x3b071, 0x1007, 0x1f, 0x5
.long 0x2f051, 0x1005, 0x15, 0x9, 0x8501002, 0x820, 0x28, 0x9, 0x207343, 0x36301016, 0x26, 0x8, 0x107373, 0x38301016, 0x26, 0x88
.long 0x8509062, 0x2826, 0x2e, 0x4, 0x603154, 0x182a, 0xff, 0x8, 0xc0073b4, 0x82f203c, 0xff, 0x8, 0x0, 0x0, 0x0, 0x0
.long 0x0, 0x0, 0x0, 0x0, 0x0, 0x0, 0x0, 0x0
L_tend:
.section .rodata,"a"
.p2align 6
.amdhsa_kernel parallel_sum__memory_aug_recurrent_mem_tr__glu_gated_geglu__prompt_kernel
  .amdhsa_next_free_vgpr 512
  .amdhsa_next_free_sgpr 102
  .amdhsa_accum_offset 256
  .amdhsa_group_segment_fixed_size 0
  .amdhsa_kernarg_size 112
  .amdhsa_user_sgpr_count 2
  .amdhsa_user_sgpr_kernarg_segment_ptr 1
  .amdhsa_system_sgpr_workgroup_id_x 1
  .amdhsa_float_denorm_mode_32 3
  .amdhsa_float_denorm_mode_16_64 3
.end_amdhsa_kernel
```
